```python
import torch

def _softmax(x, axis=-1):
    return torch.softmax(x, dim=axis)
def _gelu(x):
    return torch.nn.functional.gelu(x, approximate="tanh")
def _silu(x):
    return torch.nn.functional.silu(x)
def _sigmoid(x):
    return torch.sigmoid(x)
def _layernorm(x, axis=-1, eps=1e-5):
    m = x.mean(dim=axis, keepdim=True)
    v = x.var(dim=axis, keepdim=True, unbiased=False)
    return (x - m) / torch.sqrt(v + eps)
def _scatter_add(tgt, idx, src, axis=0):
    return tgt.clone().index_add_(axis, idx, src)
def _segment_sum(src, seg, n):
    out = torch.zeros((n,) + src.shape[1:], dtype=src.dtype)
    return out.index_add_(0, seg, src)
def _pad(x, pw):
    flat = tuple(v for pair in reversed(pw) for v in pair)
    return torch.nn.functional.pad(x, flat)

kernel_name = 'concat_heads__grouped_kv_mqa__ssm_conv_s5__prompt'

def setup_inputs():

    _w = (lambda a: (lambda t: t.to(torch.bfloat16) if t.is_floating_point() else t)(torch.as_tensor(a)))
    def _A_setup():
        B, S, D, H = 1, 2048, 640, 32
        Dh = D // H
        return {
            "x": _w((lambda *s: torch.randn(*s, dtype=torch.bfloat16) * 0.05)(B, S, D)),
            "wq": _w((lambda *s: torch.randn(*s, dtype=torch.bfloat16) * 0.8)(D, H * Dh)),
            "wk": _w((lambda *s: torch.randn(*s, dtype=torch.bfloat16) * 0.8)(D, Dh)),
            "wv": _w((lambda *s: torch.randn(*s, dtype=torch.bfloat16) * 0.05)(D, Dh)),
            "wo": _w((lambda *s: torch.randn(*s, dtype=torch.bfloat16) * 0.05)(H * Dh, D)),
        }
    _A_in = _A_setup()

    def _B_setup():
        B, S, D = 1, 2048, 640
        P = D
        Lambda_re = -0.5 * (lambda _x: torch.exp(torch.as_tensor(_x)))((lambda *s: torch.randn(*s, dtype=torch.bfloat16) * 0.2)(P))
        Lambda_im = (lambda *s: torch.randn(*s, dtype=torch.bfloat16) * 0.4)(P) * 1.0
        B_re = (lambda *s: torch.randn(*s, dtype=torch.bfloat16) * 0.2)(P, D) * (D ** -0.5)
        B_im = (lambda *s: torch.randn(*s, dtype=torch.bfloat16) * 0.2)(P, D) * (D ** -0.5)
        C_re = (lambda *s: torch.randn(*s, dtype=torch.bfloat16) * 0.2)(D, P) * (P ** -0.5)
        C_im = (lambda *s: torch.randn(*s, dtype=torch.bfloat16) * 0.2)(D, P) * (P ** -0.5)
        log_dt = (lambda *s: torch.randn(*s, dtype=torch.bfloat16) * 0.2)(P) * 0.3 - 2.0
        Dskip = (lambda *s: torch.randn(*s, dtype=torch.bfloat16) * 0.05)(D)
        return {
            "x": _w((lambda *s: torch.randn(*s, dtype=torch.bfloat16) * 0.05)(B, S, D)),
            "Lambda_re": _w(Lambda_re),
            "Lambda_im": _w(Lambda_im),
            "B_re": _w(B_re),
            "B_im": _w(B_im),
            "C_re": _w(C_re),
            "C_im": _w(C_im),
            "log_dt": _w(log_dt),
            "Dskip": _w(Dskip),
        }
    _B_in = _B_setup()

    return {
        "A_x": _A_in["x"],
        "A_wq": _A_in["wq"],
        "A_wk": _A_in["wk"],
        "A_wv": _A_in["wv"],
        "A_wo": _A_in["wo"],
        "B_x": _B_in["x"],
        "B_Lambda_re": _B_in["Lambda_re"],
        "B_Lambda_im": _B_in["Lambda_im"],
        "B_B_re": _B_in["B_re"],
        "B_B_im": _B_in["B_im"],
        "B_C_re": _B_in["C_re"],
        "B_C_im": _B_in["C_im"],
        "B_log_dt": _B_in["log_dt"],
        "B_Dskip": _B_in["Dskip"],
    }

def reference(A_x, A_wq, A_wk, A_wv, A_wo, B_x, B_Lambda_re, B_Lambda_im, B_B_re, B_B_im, B_C_re, B_C_im, B_log_dt, B_Dskip):
    def _A_ref(x, wq, wk, wv, wo):
        B, S, D = x.shape
        H = 32
        Dh = D // H
        q = (lambda x, *d: x.permute(*d))((x @ wq).reshape(B, S, H, Dh), 0, 2, 1, 3)
        k = x @ wk
        v = x @ wv
        scores = torch.einsum("bhqd,bkd->bhqk", q, k) * (Dh ** -0.5)
        p = _softmax(scores, axis=-1)
        o = torch.einsum("bhqk,bkd->bhqd", p, v)
        return (lambda x, *d: x.permute(*d))(o, 0, 2, 1, 3).reshape(B, S, H * Dh) @ wo

    def _B_ref(x, Lambda_re, Lambda_im, B_re, B_im, C_re, C_im, log_dt, Dskip):
        Bsz, L, H = x.shape
        Lam = Lambda_re + 1j * Lambda_im
        Bmat = B_re + 1j * B_im
        Cmat = C_re + 1j * C_im
        dt = torch.exp(log_dt)
        Lam_bar = torch.exp(dt * Lam)
        B_bar = ((Lam_bar - 1.0) / Lam)[:, None] * Bmat
        Bu = torch.einsum("bld,pd->blp", x + 0j, B_bar)
        h = torch.zeros_like(Bu[:, 0, :])
        hs = []
        for t in range(L):
            h = Lam_bar[None, :] * h + Bu[:, t, :]
            hs.append(h)
        hseq = torch.stack(hs, 1)
        y = 2.0 * torch.einsum("blp,dp->bld", hseq, Cmat).real + x * Dskip[None, None, :]
        return y

    a = _A_ref(A_x, A_wq, A_wk, A_wv, A_wo)
    b = _B_ref(B_x, B_Lambda_re, B_Lambda_im, B_B_re, B_B_im, B_C_re, B_C_im, B_log_dt, B_Dskip)
    return torch.concatenate([a, b], axis=-1)
```

```asm
; @launch grid=(256,1,1) block=(256,1,1) lds=163840
.amdgcn_target "amdgcn-amd-amdhsa--gfx950"
.text
.globl concat_heads__grouped_kv_mqa__ssm_conv_s5__prompt_kernel
.p2align 8
.type concat_heads__grouped_kv_mqa__ssm_conv_s5__prompt_kernel,@function
concat_heads__grouped_kv_mqa__ssm_conv_s5__prompt_kernel:
L_start:
    s_load_dwordx8 s[4:11], s[0:1], 0
    s_cmp_ge_u32 s2, 256
    s_cbranch_scc1 L_end
    s_getpc_b64 s[12:13]
L_pc:
    s_lshr_b32 s100, s2, 3
    s_lshl_b32 s101, s100, 12
    v_lshl_add_u32 v3, v0, 4, s101
    v_min_u32 v3, L_tabend-L_pc-4, v3
    global_load_dword v116, v3, s[12:13]
    v_lshrrev_b32 v2, 6, v0
    v_and_b32 v1, 63, v0
    v_readfirstlane_b32 s84, v2
    s_and_b32 s99, s2, 7
    s_lshr_b32 s88, s100, 2
    s_and_b32 s101, s100, 3
    s_lshl_b32 s87, s99, 2
    s_add_u32 s87, s87, s101
    s_mul_i32 s91, s87, 81920
    v_lshlrev_b32 v110, 4, v1
    v_bfe_u32 v5, v0, 3, 3
    v_lshl_add_u32 v5, v2, 4, v5
    v_mul_u32_u24 v5, 1280, v5
    v_and_b32 v4, 7, v0
    s_and_b32 s85, s84, 1
    s_lshr_b32 s86, s84, 1
    s_mov_b32 s42, 2621440
    s_mov_b32 s43, 0x00020000
    s_cmp_ge_u32 s2, 32
    s_cbranch_scc1 L_normal
    v_bfe_u32 v3, v0, 4, 1
    v_xor_b32 v4, v4, v3
    v_lshl_add_u32 v112, v4, 4, v5
    v_add_u32 v113, 9184, v112
    s_mul_i32 s20, s84, 2112
    s_mov_b32 s50, 25600
    s_mov_b32 s51, 0x00020000
    s_lshl_b32 s97, s85, 10
    s_mul_i32 s98, s86, 26624
    s_add_u32 s98, s98, s97
    s_cmp_eq_u32 s86, 0
    s_waitcnt lgkmcnt(0)
    s_cselect_b64 s[48:49], s[8:9], s[10:11]
    s_mov_b64 s[40:41], s[4:5]
    s_mov_b64 s[44:45], s[6:7]
    s_add_u32 m0, s98, 104960
    s_add_u32 s96, s97, 0
    buffer_load_dwordx4 v110, s[48:51], s96 offen offset:0 sc0 lds
    s_add_u32 m0, s98, 104960
    s_nop 0
    buffer_load_dwordx4 v110, s[48:51], s96 offen offset:2048 sc0 lds
    s_add_u32 m0, s20, 0
    s_nop 0
    buffer_load_dwordx4 v112, s[40:43], s91 offen offset:0 sc0 lds
    buffer_load_dwordx4 v113, s[40:43], s91 offen offset:1056 sc0 lds
    s_add_u32 m0, s98, 109056
    s_add_u32 s96, s97, 4096
    buffer_load_dwordx4 v110, s[48:51], s96 offen offset:0 sc0 lds
    s_add_u32 m0, s20, 8320
    s_nop 0
    buffer_load_dwordx4 v112, s[40:43], s91 offen offset:128 sc0 lds
    buffer_load_dwordx4 v113, s[40:43], s91 offen offset:1184 sc0 lds
    s_load_dwordx2 s[64:65], s[0:1], 128
    s_load_dwordx2 s[68:69], s[0:1], 120
    s_load_dwordx2 s[76:77], s[0:1], 32
    s_load_dwordx2 s[14:15], s[0:1], 40
    s_load_dwordx4 s[16:19], s[0:1], 48
    s_load_dwordx2 s[56:57], s[0:1], 64
    s_load_dwordx2 s[60:61], s[0:1], 72
    s_load_dwordx8 s[24:31], s[0:1], 80
    s_load_dwordx2 s[80:81], s[0:1], 112
    s_branch L_producer
L_normal:
    v_bfe_u32 v3, v0, 4, 2
    v_xor_b32 v4, v4, v3
    v_lshl_add_u32 v112, v4, 4, v5
    v_add_u32 v113, 9152, v112
    s_mul_i32 s20, s84, 2176
    s_mul_i32 s92, s88, 160
    s_mul_i32 s93, s88, 1
    s_add_u32 s93, s93, s99
    s_add_u32 s93, s93, 2
    s_mul_i32 s94, s93, 205
    s_lshr_b32 s94, s94, 10
    s_mul_i32 s94, s94, 5
    s_sub_u32 s93, s93, s94
    s_sub_u32 s99, s100, 4
    s_lshl_b32 s99, s99, 1
    s_add_u32 s99, s99, s85
    s_lshl_b32 s99, s99, 9
    v_lshl_add_u32 v2, v1, 3, s99
    v_min_u32 v2, 25592, v2
    s_lshl_b32 s94, s93, 8
    s_add_u32 s94, s94, s91
    s_mul_i32 s95, s93, 163840
    s_add_u32 s95, s95, s92
    s_cmp_eq_u32 s86, 0
    s_waitcnt lgkmcnt(0)
    s_cselect_b64 s[48:49], s[8:9], s[10:11]
    s_mov_b64 s[40:41], s[4:5]
    s_mov_b64 s[44:45], s[6:7]
    global_load_dword v252, v2, s[48:49]
    s_add_u32 m0, s20, 154624
    s_nop 0
    buffer_load_dwordx4 v112, s[40:43], s94 offen sc0 lds
    buffer_load_dwordx4 v113, s[40:43], s94 offen offset:1088 sc0 lds
    s_load_dwordx2 s[64:65], s[0:1], 128
    s_load_dwordx2 s[68:69], s[0:1], 120
    s_load_dwordx2 s[76:77], s[0:1], 32
    s_load_dwordx2 s[14:15], s[0:1], 40
    s_load_dwordx4 s[16:19], s[0:1], 48
    s_load_dwordx2 s[56:57], s[0:1], 64
    s_load_dwordx2 s[60:61], s[0:1], 72
    s_load_dwordx8 s[24:31], s[0:1], 80
    s_load_dwordx2 s[80:81], s[0:1], 112
    s_mul_i32 s21, s84, 3072
    s_lshl_b32 s39, s84, 11
    s_mov_b32 s46, 819200
    s_mov_b32 s47, 0x00020000
    s_mov_b32 s66, 9469952
    s_mov_b32 s67, 0x00020000
    s_add_u32 m0, s21, 0
    s_mul_i32 s99, s84, 192
    s_add_u32 s99, s99, 0
    v_add_u32 v6, s99, v1
    v_mul_u32_u24 v7, 6554, v6
    v_lshrrev_b32 v7, 16, v7
    v_mul_u32_u24 v8, 10, v7
    v_sub_u32 v6, v6, v8
    v_lshrrev_b32 v8, 1, v7
    v_xor_b32 v8, v8, v7
    v_and_b32 v8, 4, v8
    v_mul_u32_u24 v8, 3, v8
    v_xor_b32 v7, v7, v8
    v_mul_u32_u24 v7, 1280, v7
    v_lshl_add_u32 v7, v6, 4, v7
    v_subrev_u32 v178, 0, v7
    buffer_load_dwordx4 v178, s[44:47], s95 offen offset:0 sc0 lds
    s_mul_i32 s99, s84, 192
    s_add_u32 s99, s99, 64
    v_add_u32 v6, s99, v1
    v_mul_u32_u24 v7, 6554, v6
    v_lshrrev_b32 v7, 16, v7
    v_mul_u32_u24 v8, 10, v7
    v_sub_u32 v6, v6, v8
    v_lshrrev_b32 v8, 1, v7
    v_xor_b32 v8, v8, v7
    v_and_b32 v8, 4, v8
    v_mul_u32_u24 v8, 3, v8
    v_xor_b32 v7, v7, v8
    v_mul_u32_u24 v7, 1280, v7
    v_lshl_add_u32 v7, v6, 4, v7
    v_subrev_u32 v179, 1024, v7
    buffer_load_dwordx4 v179, s[44:47], s95 offen offset:1024 sc0 lds
    s_mul_i32 s99, s84, 192
    s_add_u32 s99, s99, 128
    v_add_u32 v6, s99, v1
    v_mul_u32_u24 v7, 6554, v6
    v_lshrrev_b32 v7, 16, v7
    v_mul_u32_u24 v8, 10, v7
    v_sub_u32 v6, v6, v8
    v_lshrrev_b32 v8, 1, v7
    v_xor_b32 v8, v8, v7
    v_and_b32 v8, 4, v8
    v_mul_u32_u24 v8, 3, v8
    v_xor_b32 v7, v7, v8
    v_mul_u32_u24 v7, 1280, v7
    v_lshl_add_u32 v7, v6, 4, v7
    v_subrev_u32 v180, 2048, v7
    buffer_load_dwordx4 v180, s[44:47], s95 offen offset:2048 sc0 lds
    s_mul_i32 s99, s84, 128
    s_add_u32 s99, s99, 768
    v_add_u32 v6, s99, v1
    v_mul_u32_u24 v7, 6554, v6
    v_lshrrev_b32 v7, 16, v7
    v_mul_u32_u24 v8, 10, v7
    v_sub_u32 v6, v6, v8
    v_lshrrev_b32 v8, 1, v7
    v_xor_b32 v8, v8, v7
    v_and_b32 v8, 4, v8
    v_mul_u32_u24 v8, 3, v8
    v_xor_b32 v7, v7, v8
    v_mul_u32_u24 v7, 1280, v7
    v_lshl_add_u32 v7, v6, 4, v7
    v_subrev_u32 v181, 0, v7
    s_mul_i32 s99, s84, 128
    s_add_u32 s99, s99, 832
    v_add_u32 v6, s99, v1
    v_mul_u32_u24 v7, 6554, v6
    v_lshrrev_b32 v7, 16, v7
    v_mul_u32_u24 v8, 10, v7
    v_sub_u32 v6, v6, v8
    v_lshrrev_b32 v8, 1, v7
    v_xor_b32 v8, v8, v7
    v_and_b32 v8, 4, v8
    v_mul_u32_u24 v8, 3, v8
    v_xor_b32 v7, v7, v8
    v_mul_u32_u24 v7, 1280, v7
    v_lshl_add_u32 v7, v6, 4, v7
    v_subrev_u32 v182, 1024, v7
    v_mov_b64 v[66:67], 0
    v_mov_b64 v[68:69], 0
    v_mov_b32 v253, 0xdddddddd
    s_lshl_b32 s97, s84, 10
    s_add_u32 s97, s97, 458752
    s_lshl_b32 s98, s84, 2
    s_cmp_eq_u32 s2, 33
    s_cselect_b32 s97, s97, 2130706432
    s_cselect_b32 s98, s98, 2130706432
    s_waitcnt lgkmcnt(0)
    buffer_store_dwordx4 v[66:69], v110, s[64:67], s97 offen sc1
    s_add_u32 s94, s94, 128
    s_add_u32 m0, s20, 102400
    s_nop 0
    buffer_load_dwordx4 v112, s[40:43], s94 offen sc0 lds
    buffer_load_dwordx4 v113, s[40:43], s94 offen offset:1088 sc0 lds
    s_add_u32 m0, s39, 12288
    s_nop 0
    buffer_load_dwordx4 v181, s[44:47], s95 offen offset:0 sc0 lds
    buffer_load_dwordx4 v182, s[44:47], s95 offen offset:1024 sc0 lds
    s_cmp_eq_u32 s84, 3
    s_cbranch_scc1 L_page0
L_tp_n:
    v_bfe_u32 v2, v1, 3, 1
    v_mul_u32_u24 v2, 1088, v2
    v_and_b32 v3, 7, v1
    v_lshl_add_u32 v2, v3, 7, v2
    v_lshrrev_b32 v6, 4, v1
    v_bfe_u32 v7, v1, 1, 2
    v_xor_b32 v7, v7, v6
    v_lshl_add_u32 v111, v7, 4, v2
    s_mul_i32 s99, s85, 4352
    s_add_u32 s99, s99, 102400
    v_add_u32 v183, s99, v111
    v_lshrrev_b32 v3, 5, v1
    v_bfe_u32 v4, v1, 2, 3
    v_lshl_add_u32 v4, v3, 4, v4
    v_mul_u32_u24 v4, 160, v4
    v_and_b32 v5, 1, v1
    v_bfe_u32 v6, v1, 1, 1
    v_lshl_add_u32 v7, v5, 1, v6
    s_mul_i32 s99, s86, 80
    v_add_u32 v4, s99, v4
    v_lshl_add_u32 v185, v7, 3, v4
    v_add_u32 v184, 61440, v185
    v_mul_u32_u24 v5, 40, v5
    v_lshl_add_u32 v5, v6, 18, v5
    v_add3_u32 v186, v5, v4, 32
    v_add_u32 v190, 61440, v186
    s_mov_b32 s22, 0
    s_mov_b32 s23, -1
    s_mov_b32 s70, 256
    s_mov_b32 s71, 0x00020000
    v_and_b32 v192, 3, v1
    v_lshlrev_b32 v192, 2, v192
    v_lshlrev_b32 v117, 25, v1
    v_lshlrev_b32 v254, 30, v3
    v_lshl_add_u32 v254, v1, 2, v254
    s_and_b32 s99, s2, 7
    s_lshr_b32 s100, s2, 3
    s_lshr_b32 s101, s99, 1
    s_mul_i32 s101, s101, 28
    s_add_u32 s100, s100, s101
    s_sub_u32 s100, s100, 4
    s_mul_i32 s89, s100, 205
    s_lshr_b32 s89, s89, 10
    s_mul_i32 s90, s89, 5
    s_sub_u32 s90, s100, s90
    s_and_b32 s99, s99, 1
    s_mul_i32 s99, s99, 5
    s_add_u32 s90, s90, s99
    s_cmp_lt_u32 s100, 110
    s_cselect_b32 s38, 1, 0
    s_lshl_b32 s3, s90, 2
    s_add_u32 s3, s3, s84
    s_lshl_b32 s99, s3, 4
    v_and_b32 v6, 15, v1
    v_add_lshl_u32 v189, v6, s99, 1
    s_mul_i32 s7, s84, 3264
    s_mul_i32 s4, s84, 4352
    s_min_u32 s99, s89, 21
    s_mul_i32 s99, s99, 122880
    s_sub_u32 s54, 2620272, s99
    s_add_u32 s52, s14, s99
    s_addc_u32 s53, s15, 0
    s_mul_i32 s99, s90, 81920
    s_add_u32 s56, s56, s99
    s_addc_u32 s57, s57, 0
    s_add_u32 s60, s60, s99
    s_addc_u32 s61, s61, 0
    s_mul_i32 s99, s90, 2
    s_bfe_u32 s100, s2, 0x20001
    s_mul_i32 s100, s100, 2
    s_add_u32 s99, s99, s100
    s_mul_i32 s100, s89, 0
    s_add_u32 s99, s99, s100
    s_mul_i32 s100, s99, 205
    s_lshr_b32 s100, s100, 11
    s_mul_i32 s100, s100, 10
    s_sub_u32 s99, s99, s100
    s_lshl_b32 s36, s99, 7
    global_load_ushort v187, v189, s[16:17]
    global_load_ushort v188, v189, s[18:19]
    global_load_ushort v189, v189, s[28:29]
    s_add_u32 s93, s93, 1
    s_cmp_eq_u32 s93, 5
    s_cselect_b32 s93, 0, s93
    s_lshl_b32 s94, s93, 8
    s_add_u32 s94, s94, s91
    s_mul_i32 s95, s93, 163840
    s_add_u32 s95, s95, s92
    s_add_u32 m0, s20, 111104
    s_nop 0
    buffer_load_dwordx4 v112, s[40:43], s94 offen sc0 lds
    buffer_load_dwordx4 v113, s[40:43], s94 offen offset:1088 sc0 lds
    s_add_u32 m0, s21, 20480
    s_nop 0
    buffer_load_dwordx4 v178, s[44:47], s95 offen offset:0 sc0 lds
    buffer_load_dwordx4 v179, s[44:47], s95 offen offset:1024 sc0 lds
    buffer_load_dwordx4 v180, s[44:47], s95 offen offset:2048 sc0 lds
    v_mov_b64 v[70:71], 0
    v_mov_b64 v[72:73], 0
    v_mov_b64 v[74:75], 0
    v_mov_b64 v[76:77], 0
    v_mov_b64 v[78:79], 0
    v_mov_b64 v[80:81], 0
    v_mov_b64 v[82:83], 0
    v_mov_b64 v[84:85], 0
    v_mov_b64 v[86:87], 0
    v_mov_b64 v[88:89], 0
    v_mov_b64 v[90:91], 0
    v_mov_b64 v[92:93], 0
    v_mov_b64 v[94:95], 0
    v_mov_b64 v[96:97], 0
    v_add_u32 v118, 126976, v110
    v_add_u32 v119, s21, v110
    v_lshlrev_b32 v122, 3, v1
    v_add_u32 v121, 126976, v122
    v_lshrrev_b32 v3, 5, v1
    v_lshlrev_b32 v5, 7, v3
    v_sub_u32 v5, v118, v5
    v_add_u32 v5, 3072, v5
    v_and_b32 v2, 31, v1
    v_cmp_lt_u32 vcc, 20, v2
    v_mov_b32 v4, 0x40000
    v_min_u32 v129, 9, v1
    v_cndmask_b32 v120, v5, v4, vcc
    v_lshlrev_b32 v129, 7, v129
    v_and_b32 v2, 15, v1
    v_lshrrev_b32 v4, 4, v1
    v_lshlrev_b32 v4, 28, v4
    v_lshl_add_u32 v128, v2, 7, v4
    v_bfe_u32 v2, v1, 3, 1
    v_and_b32 v5, 7, v1
    v_lshrrev_b32 v6, 4, v1
    v_add_u32 v126, 60928, v111
    s_add_u32 s99, s4, 13056
    v_add_u32 v127, s99, v111
    v_xor_b32 v5, v5, v6
    v_lshlrev_b32 v5, 4, v5
    v_lshl_add_u32 v2, v3, 1, v2
    v_mul_u32_u24 v2, 12, v2
    v_and_b32 v6, 1, v6
    v_add_u32 v2, v2, v6
    v_mul_u32_u24 v2, 1280, v2
    s_mul_i32 s99, s84, 3840
    s_mul_i32 s100, s85, 60160
    s_add_u32 s101, s99, s100
    v_add3_u32 v123, v2, v5, s101
    v_add_u32 v125, 384, v123
    s_sub_u32 s101, s99, s100
    s_add_u32 s101, s101, 60352
    v_add3_u32 v124, v2, v5, s101
    v_min_u32 v123, s54, v123
    s_sub_u32 s99, s54, 1088
    v_min_u32 v124, s99, v124
    s_sub_u32 s99, s54, 2176
    v_min_u32 v125, s99, v125
    s_getpc_b64 s[48:49]
L_tab_1:
    s_mul_i32 s99, s84, 6144
    s_add_u32 s99, s99, L_tab-L_tab_1+4096
    s_add_u32 s48, s48, s99
    s_addc_u32 s49, s49, 0
    s_branch L_loop0
.p2align 12
L_page0:
    s_branch L_tp_n
L_loop0:
    s_waitcnt vmcnt(13)
    s_barrier
    ds_read_b128 a[0:3], v183 offset:52224
    ds_read_b64_tr_b16 a[8:9], v185 offset:0
    ds_read_b64_tr_b16 a[10:11], v185 offset:1280
    ds_read_b128 a[4:7], v183 offset:54400
    ds_read_b64_tr_b16 a[12:13], v185 offset:40
    ds_read_b64_tr_b16 a[14:15], v185 offset:1320
    ds_read_b64_tr_b16 a[16:17], v186 offset:0
    ds_read_b64_tr_b16 a[18:19], v186 offset:1280
    s_waitcnt lgkmcnt(5)
    v_mfma_f32_16x16x32_bf16 v[18:21], a[8:11], a[0:3], 0
    s_waitcnt vmcnt(12) lgkmcnt(4)
    ds_read_b128 a[20:23], v183 offset:52288
    ds_read_b64_tr_b16 a[28:29], v185 offset:5120
    buffer_store_dword v253, v117, s[68:71], s98 offen sc1
    s_add_u32 s94, s94, 128
    v_mfma_f32_16x16x32_bf16 v[22:25], a[8:11], a[4:7], 0
    s_waitcnt lgkmcnt(4)
    s_add_u32 m0, s20, 119808
    ds_read_b64_tr_b16 a[30:31], v185 offset:6400
    ds_read_b128 a[24:27], v183 offset:54464
    buffer_load_dwordx4 v112, s[40:43], s94 offen sc0 lds
    v_mfma_f32_16x16x32_bf16 v[30:33], a[12:15], a[4:7], 0
    ds_read_b64_tr_b16 a[32:33], v185 offset:5160
    ds_read_b64_tr_b16 a[34:35], v185 offset:6440
    buffer_load_dwordx4 v113, s[40:43], s94 offen offset:1088 sc0 lds
    v_mfma_f32_16x16x32_bf16 v[26:29], a[12:15], a[0:3], 0
    s_waitcnt lgkmcnt(6)
    s_add_u32 m0, s39, 32768
    ds_read_b64_tr_b16 a[36:37], v186 offset:5120
    ds_read_b64_tr_b16 a[38:39], v186 offset:6400
    v_mfma_f32_16x16x32_bf16 v[34:37], a[16:19], a[0:3], 0
    buffer_load_dwordx4 v181, s[44:47], s95 offen offset:0 sc0 lds
    v_mfma_f32_16x16x32_bf16 v[38:41], a[16:19], a[4:7], 0
    s_waitcnt lgkmcnt(5)
    buffer_load_dwordx4 v182, s[44:47], s95 offen offset:1024 sc0 lds
    v_mfma_f32_16x16x32_bf16 v[18:21], a[28:31], a[20:23], v[18:21]
    s_waitcnt vmcnt(13) lgkmcnt(4)
    s_barrier
    s_add_u32 s93, s93, 1
    ds_read_b128 a[0:3], v183 offset:0
    ds_read_b64_tr_b16 a[8:9], v185 offset:10240
    s_cmp_eq_u32 s93, 5
    v_mfma_f32_16x16x32_bf16 v[22:25], a[28:31], a[24:27], v[22:25]
    s_waitcnt lgkmcnt(4)
    s_cselect_b32 s93, 0, s93
    ds_read_b64_tr_b16 a[10:11], v185 offset:11520
    ds_read_b128 a[4:7], v183 offset:2176
    v_mfma_f32_16x16x32_bf16 v[30:33], a[32:35], a[24:27], v[30:33]
    s_lshl_b32 s94, s93, 8
    ds_read_b64_tr_b16 a[12:13], v185 offset:10280
    ds_read_b64_tr_b16 a[14:15], v185 offset:11560
    v_mfma_f32_16x16x32_bf16 v[26:29], a[32:35], a[20:23], v[26:29]
    s_waitcnt lgkmcnt(6)
    s_add_u32 s94, s94, s91
    ds_read_b64_tr_b16 a[16:17], v186 offset:10240
    ds_read_b64_tr_b16 a[18:19], v186 offset:11520
    v_mfma_f32_16x16x32_bf16 v[34:37], a[36:39], a[20:23], v[34:37]
    s_mul_i32 s95, s93, 163840
    v_mfma_f32_16x16x32_bf16 v[38:41], a[36:39], a[24:27], v[38:41]
    s_waitcnt lgkmcnt(5)
    s_add_u32 s95, s95, s92
    v_mfma_f32_16x16x32_bf16 v[18:21], a[8:11], a[0:3], v[18:21]
    s_waitcnt lgkmcnt(4)
    s_add_u32 m0, s20, 128512
    ds_read_b128 a[20:23], v183 offset:64
    ds_read_b64_tr_b16 a[28:29], v185 offset:15360
    buffer_load_dwordx4 v112, s[40:43], s94 offen sc0 lds
    v_mfma_f32_16x16x32_bf16 v[22:25], a[8:11], a[4:7], v[22:25]
    s_waitcnt lgkmcnt(4)
    ds_read_b64_tr_b16 a[30:31], v185 offset:16640
    ds_read_b128 a[24:27], v183 offset:2240
    buffer_load_dwordx4 v113, s[40:43], s94 offen offset:1088 sc0 lds
    v_mfma_f32_16x16x32_bf16 v[30:33], a[12:15], a[4:7], v[30:33]
    s_add_u32 m0, s21, 40960
    ds_read_b64_tr_b16 a[32:33], v185 offset:15400
    ds_read_b64_tr_b16 a[34:35], v185 offset:16680
    v_mfma_f32_16x16x32_bf16 v[26:29], a[12:15], a[0:3], v[26:29]
    s_waitcnt lgkmcnt(6)
    ds_read_b64_tr_b16 a[36:37], v186 offset:15360
    ds_read_b64_tr_b16 a[38:39], v186 offset:16640
    buffer_load_dwordx4 v178, s[44:47], s95 offen offset:0 sc0 lds
    v_mfma_f32_16x16x32_bf16 v[34:37], a[16:19], a[0:3], v[34:37]
    buffer_load_dwordx4 v179, s[44:47], s95 offen offset:1024 sc0 lds
    v_mfma_f32_16x16x32_bf16 v[38:41], a[16:19], a[4:7], v[38:41]
    s_waitcnt lgkmcnt(5)
    buffer_load_dwordx4 v180, s[44:47], s95 offen offset:2048 sc0 lds
    v_mfma_f32_16x16x32_bf16 v[18:21], a[28:31], a[20:23], v[18:21]
    s_waitcnt vmcnt(10) lgkmcnt(4)
    s_barrier
    s_add_u32 s94, s94, 128
    ds_read_b128 a[0:3], v183 offset:8704
    ds_read_b64_tr_b16 a[8:9], v185 offset:20480
    v_mfma_f32_16x16x32_bf16 v[22:25], a[28:31], a[24:27], v[22:25]
    s_waitcnt lgkmcnt(4)
    s_add_u32 m0, s20, 137216
    ds_read_b64_tr_b16 a[10:11], v185 offset:21760
    ds_read_b128 a[4:7], v183 offset:10880
    v_mfma_f32_16x16x32_bf16 v[30:33], a[32:35], a[24:27], v[30:33]
    ds_read_b64_tr_b16 a[12:13], v185 offset:20520
    ds_read_b64_tr_b16 a[14:15], v185 offset:21800
    buffer_load_dwordx4 v112, s[40:43], s94 offen sc0 lds
    v_mfma_f32_16x16x32_bf16 v[26:29], a[32:35], a[20:23], v[26:29]
    s_waitcnt lgkmcnt(6)
    ds_read_b64_tr_b16 a[16:17], v186 offset:20480
    ds_read_b64_tr_b16 a[18:19], v186 offset:21760
    buffer_load_dwordx4 v113, s[40:43], s94 offen offset:1088 sc0 lds
    v_mfma_f32_16x16x32_bf16 v[34:37], a[36:39], a[20:23], v[34:37]
    v_mfma_f32_16x16x32_bf16 v[38:41], a[36:39], a[24:27], v[38:41]
    s_waitcnt lgkmcnt(5)
    v_mfma_f32_16x16x32_bf16 v[18:21], a[8:11], a[0:3], v[18:21]
    s_waitcnt lgkmcnt(4)
    s_add_u32 m0, s39, 53248
    ds_read_b128 a[20:23], v183 offset:8768
    ds_read_b64_tr_b16 a[28:29], v185 offset:25600
    v_mfma_f32_16x16x32_bf16 v[22:25], a[8:11], a[4:7], v[22:25]
    s_waitcnt lgkmcnt(4)
    ds_read_b64_tr_b16 a[30:31], v185 offset:26880
    ds_read_b128 a[24:27], v183 offset:10944
    buffer_load_dwordx4 v181, s[44:47], s95 offen offset:0 sc0 lds
    v_mfma_f32_16x16x32_bf16 v[30:33], a[12:15], a[4:7], v[30:33]
    ds_read_b64_tr_b16 a[32:33], v185 offset:25640
    ds_read_b64_tr_b16 a[34:35], v185 offset:26920
    buffer_load_dwordx4 v182, s[44:47], s95 offen offset:1024 sc0 lds
    v_mfma_f32_16x16x32_bf16 v[26:29], a[12:15], a[0:3], v[26:29]
    s_waitcnt lgkmcnt(6)
    ds_read_b64_tr_b16 a[36:37], v186 offset:25600
    ds_read_b64_tr_b16 a[38:39], v186 offset:26880
    v_mfma_f32_16x16x32_bf16 v[34:37], a[16:19], a[0:3], v[34:37]
    v_mfma_f32_16x16x32_bf16 v[38:41], a[16:19], a[4:7], v[38:41]
    s_waitcnt lgkmcnt(5)
    v_mfma_f32_16x16x32_bf16 v[18:21], a[28:31], a[20:23], v[18:21]
    s_waitcnt vmcnt(9) lgkmcnt(4)
    s_barrier
    s_add_u32 s93, s93, 1
    ds_read_b128 a[0:3], v183 offset:17408
    ds_read_b64_tr_b16 a[8:9], v185 offset:30720
    s_cmp_eq_u32 s93, 5
    v_mfma_f32_16x16x32_bf16 v[22:25], a[28:31], a[24:27], v[22:25]
    s_waitcnt lgkmcnt(4)
    s_cselect_b32 s93, 0, s93
    ds_read_b64_tr_b16 a[10:11], v185 offset:32000
    ds_read_b128 a[4:7], v183 offset:19584
    v_mfma_f32_16x16x32_bf16 v[30:33], a[32:35], a[24:27], v[30:33]
    s_lshl_b32 s94, s93, 8
    ds_read_b64_tr_b16 a[12:13], v185 offset:30760
    ds_read_b64_tr_b16 a[14:15], v185 offset:32040
    v_mfma_f32_16x16x32_bf16 v[26:29], a[32:35], a[20:23], v[26:29]
    s_waitcnt lgkmcnt(6)
    s_add_u32 s94, s94, s91
    ds_read_b64_tr_b16 a[16:17], v186 offset:30720
    ds_read_b64_tr_b16 a[18:19], v186 offset:32000
    v_mfma_f32_16x16x32_bf16 v[34:37], a[36:39], a[20:23], v[34:37]
    s_mul_i32 s95, s93, 163840
    v_mfma_f32_16x16x32_bf16 v[38:41], a[36:39], a[24:27], v[38:41]
    s_waitcnt lgkmcnt(5)
    s_add_u32 s95, s95, s92
    v_mfma_f32_16x16x32_bf16 v[18:21], a[8:11], a[0:3], v[18:21]
    s_waitcnt lgkmcnt(4)
    s_add_u32 m0, s20, 145920
    ds_read_b128 a[20:23], v183 offset:17472
    ds_read_b64_tr_b16 a[28:29], v185 offset:35840
    buffer_load_dwordx4 v112, s[40:43], s94 offen sc0 lds
    v_mfma_f32_16x16x32_bf16 v[22:25], a[8:11], a[4:7], v[22:25]
    s_waitcnt lgkmcnt(4)
    ds_read_b64_tr_b16 a[30:31], v185 offset:37120
    ds_read_b128 a[24:27], v183 offset:19648
    buffer_load_dwordx4 v113, s[40:43], s94 offen offset:1088 sc0 lds
    v_mfma_f32_16x16x32_bf16 v[30:33], a[12:15], a[4:7], v[30:33]
    s_add_u32 m0, s21, 61440
    ds_read_b64_tr_b16 a[32:33], v185 offset:35880
    ds_read_b64_tr_b16 a[34:35], v185 offset:37160
    v_mfma_f32_16x16x32_bf16 v[26:29], a[12:15], a[0:3], v[26:29]
    s_waitcnt lgkmcnt(6)
    ds_read_b64_tr_b16 a[36:37], v186 offset:35840
    ds_read_b64_tr_b16 a[38:39], v186 offset:37120
    buffer_load_dwordx4 v178, s[44:47], s95 offen offset:0 sc0 lds
    v_mfma_f32_16x16x32_bf16 v[34:37], a[16:19], a[0:3], v[34:37]
    buffer_load_dwordx4 v179, s[44:47], s95 offen offset:1024 sc0 lds
    v_mfma_f32_16x16x32_bf16 v[38:41], a[16:19], a[4:7], v[38:41]
    s_waitcnt lgkmcnt(5)
    buffer_load_dwordx4 v180, s[44:47], s95 offen offset:2048 sc0 lds
    v_mfma_f32_16x16x32_bf16 v[18:21], a[28:31], a[20:23], v[18:21]
    s_waitcnt vmcnt(9) lgkmcnt(4)
    s_barrier
    s_add_u32 s94, s94, 128
    ds_read_b128 a[0:3], v183 offset:26112
    ds_read_b64_tr_b16 a[8:9], v185 offset:40960
    v_mfma_f32_16x16x32_bf16 v[22:25], a[28:31], a[24:27], v[22:25]
    s_waitcnt lgkmcnt(4)
    s_add_u32 m0, s20, 154624
    ds_read_b64_tr_b16 a[10:11], v185 offset:42240
    ds_read_b128 a[4:7], v183 offset:28288
    v_mfma_f32_16x16x32_bf16 v[30:33], a[32:35], a[24:27], v[30:33]
    ds_read_b64_tr_b16 a[12:13], v185 offset:41000
    ds_read_b64_tr_b16 a[14:15], v185 offset:42280
    buffer_load_dwordx4 v112, s[40:43], s94 offen sc0 lds
    v_mfma_f32_16x16x32_bf16 v[26:29], a[32:35], a[20:23], v[26:29]
    s_waitcnt lgkmcnt(6)
    ds_read_b64_tr_b16 a[16:17], v186 offset:40960
    ds_read_b64_tr_b16 a[18:19], v186 offset:42240
    buffer_load_dwordx4 v113, s[40:43], s94 offen offset:1088 sc0 lds
    v_mfma_f32_16x16x32_bf16 v[34:37], a[36:39], a[20:23], v[34:37]
    v_mfma_f32_16x16x32_bf16 v[38:41], a[36:39], a[24:27], v[38:41]
    s_waitcnt lgkmcnt(5)
    v_mfma_f32_16x16x32_bf16 v[18:21], a[8:11], a[0:3], v[18:21]
    s_waitcnt lgkmcnt(4)
    s_add_u32 m0, s39, 73728
    ds_read_b128 a[20:23], v183 offset:26176
    ds_read_b64_tr_b16 a[28:29], v185 offset:46080
    v_mfma_f32_16x16x32_bf16 v[22:25], a[8:11], a[4:7], v[22:25]
    s_waitcnt lgkmcnt(4)
    ds_read_b64_tr_b16 a[30:31], v185 offset:47360
    ds_read_b128 a[24:27], v183 offset:28352
    buffer_load_dwordx4 v181, s[44:47], s95 offen offset:0 sc0 lds
    v_mfma_f32_16x16x32_bf16 v[30:33], a[12:15], a[4:7], v[30:33]
    ds_read_b64_tr_b16 a[32:33], v185 offset:46120
    ds_read_b64_tr_b16 a[34:35], v185 offset:47400
    buffer_load_dwordx4 v182, s[44:47], s95 offen offset:1024 sc0 lds
    v_mfma_f32_16x16x32_bf16 v[26:29], a[12:15], a[0:3], v[26:29]
    s_waitcnt lgkmcnt(6)
    ds_read_b64_tr_b16 a[36:37], v186 offset:46080
    ds_read_b64_tr_b16 a[38:39], v186 offset:47360
    v_mfma_f32_16x16x32_bf16 v[34:37], a[16:19], a[0:3], v[34:37]
    v_mfma_f32_16x16x32_bf16 v[38:41], a[16:19], a[4:7], v[38:41]
    s_waitcnt lgkmcnt(5)
    v_mfma_f32_16x16x32_bf16 v[18:21], a[28:31], a[20:23], v[18:21]
    s_waitcnt vmcnt(9) lgkmcnt(4)
    s_barrier
    s_add_u32 s93, s93, 1
    ds_read_b128 a[0:3], v183 offset:34816
    ds_read_b64_tr_b16 a[8:9], v185 offset:51200
    s_cmp_eq_u32 s93, 5
    s_cselect_b32 s93, 0, s93
    s_lshl_b32 s94, s93, 8
    s_add_u32 s94, s94, s91
    s_mul_i32 s95, s93, 163840
    v_mfma_f32_16x16x32_bf16 v[22:25], a[28:31], a[24:27], v[22:25]
    s_waitcnt lgkmcnt(4)
    s_add_u32 s95, s95, s92
    ds_read_b64_tr_b16 a[10:11], v185 offset:52480
    ds_read_b128 a[4:7], v183 offset:36992
    s_add_u32 m0, s20, 102400
    s_nop 0
    buffer_load_dwordx4 v112, s[40:43], s94 offen sc0 lds
    buffer_load_dwordx4 v113, s[40:43], s94 offen offset:1088 sc0 lds
    s_add_u32 m0, s21, 81920
    s_nop 0
    buffer_load_dwordx4 v178, s[44:47], s95 offen offset:0 sc0 lds
    v_mfma_f32_16x16x32_bf16 v[30:33], a[32:35], a[24:27], v[30:33]
    ds_read_b64_tr_b16 a[12:13], v185 offset:51240
    ds_read_b64_tr_b16 a[14:15], v185 offset:52520
    buffer_load_dwordx4 v179, s[44:47], s95 offen offset:1024 sc0 lds
    buffer_load_dwordx4 v180, s[44:47], s95 offen offset:2048 sc0 lds
    buffer_load_dword v255, v192, s[68:71], s39 offen sc1
    v_lshlrev_b32 v2, 16, v187
    v_lshlrev_b32 v3, 16, v188
    v_lshlrev_b32 v4, 16, v189
    v_mfma_f32_16x16x32_bf16 v[26:29], a[32:35], a[20:23], v[26:29]
    s_waitcnt lgkmcnt(6)
    ds_read_b64_tr_b16 a[16:17], v186 offset:51200
    ds_read_b64_tr_b16 a[18:19], v186 offset:52480
    v_mul_f32 v4, 0x3fb8aa3b, v4
    v_exp_f32 v4, v4
    s_nop 0
    v_cvt_pk_bf16_f32 v4, v4, v4
    v_and_b32 v4, 0xffff0000, v4
    v_mul_f32 v5, v4, v2
    v_mul_f32 v6, v4, v3
    v_mfma_f32_16x16x32_bf16 v[34:37], a[36:39], a[20:23], v[34:37]
    v_mul_f32 v5, 0x3fb8aa3b, v5
    v_mul_f32 v6, 0.15915494, v6
    v_rndne_f32 v7, v6
    v_sub_f32 v6, v6, v7
    v_exp_f32 v5, v5
    v_cos_f32 v7, v6
    v_mfma_f32_16x16x32_bf16 v[38:41], a[36:39], a[24:27], v[38:41]
    s_waitcnt lgkmcnt(3)
    v_sin_f32 v6, v6
    v_mul_f32 v8, v2, v2
    v_fmac_f32 v8, v3, v3
    v_rcp_f32 v8, v8
    v_mul_f32 v202, v5, v7
    v_mul_f32 v203, v5, v6
    v_mfma_f32_16x16x32_bf16 v[18:21], a[8:11], a[0:3], v[18:21]
    ds_read_b128 a[20:23], v183 offset:34880
    ds_read_b64_tr_b16 a[28:29], v185 offset:56320
    v_add_f32 v8, v8, v8
    v_mul_f32 v2, v2, v8
    v_mul_f32 v3, -v3, v8
    v_add_f32 v4, -1.0, v202
    v_mov_b32 v5, v203
    v_pk_mul_f32 v[6:7], v[2:3], v[4:5] op_sel:[1,1] op_sel_hi:[1,0] neg_lo:[1,0]
    v_mfma_f32_16x16x32_bf16 v[22:25], a[8:11], a[4:7], v[22:25]
    s_waitcnt lgkmcnt(2)
    ds_read_b64_tr_b16 a[30:31], v185 offset:57600
    ds_read_b128 a[24:27], v183 offset:37056
    v_pk_fma_f32 v[204:205], v[2:3], v[4:5], v[6:7] op_sel:[0,0,0] op_sel_hi:[0,1,1]
    v_pk_mul_f32 v[6:7], v[202:203], v[202:203] op_sel:[1,1] op_sel_hi:[1,0] neg_lo:[1,0]
    v_pk_fma_f32 v[8:9], v[202:203], v[202:203], v[6:7] op_sel:[0,0,0] op_sel_hi:[0,1,1]
    v_pk_mul_f32 v[6:7], v[8:9], v[202:203] op_sel:[1,1] op_sel_hi:[1,0] neg_lo:[1,0]
    v_pk_fma_f32 v[10:11], v[8:9], v[202:203], v[6:7] op_sel:[0,0,0] op_sel_hi:[0,1,1]
    v_pk_mul_f32 v[6:7], v[10:11], v[10:11] op_sel:[1,1] op_sel_hi:[1,0] neg_lo:[1,0]
    v_mfma_f32_16x16x32_bf16 v[30:33], a[12:15], a[4:7], v[30:33]
    ds_read_b64_tr_b16 a[32:33], v185 offset:56360
    ds_read_b64_tr_b16 a[34:35], v185 offset:57640
    v_pk_fma_f32 v[8:9], v[10:11], v[10:11], v[6:7] op_sel:[0,0,0] op_sel_hi:[0,1,1]
    v_pk_mul_f32 v[6:7], v[8:9], v[8:9] op_sel:[1,1] op_sel_hi:[1,0] neg_lo:[1,0]
    v_pk_fma_f32 v[250:251], v[8:9], v[8:9], v[6:7] op_sel:[0,0,0] op_sel_hi:[0,1,1]
    v_pk_mul_f32 v[6:7], v[250:251], v[250:251] op_sel:[1,1] op_sel_hi:[1,0] neg_lo:[1,0]
    v_pk_fma_f32 v[206:207], v[250:251], v[250:251], v[6:7] op_sel:[0,0,0] op_sel_hi:[0,1,1]
    v_pk_mul_f32 v[6:7], v[206:207], v[206:207] op_sel:[1,1] op_sel_hi:[1,0] neg_lo:[1,0]
    v_mfma_f32_16x16x32_bf16 v[26:29], a[12:15], a[0:3], v[26:29]
    ds_read_b64_tr_b16 a[36:37], v186 offset:56320
    ds_read_b64_tr_b16 a[38:39], v186 offset:57600
    v_pk_fma_f32 v[208:209], v[206:207], v[206:207], v[6:7] op_sel:[0,0,0] op_sel_hi:[0,1,1]
    v_pk_mul_f32 v[6:7], v[208:209], v[208:209] op_sel:[1,1] op_sel_hi:[1,0] neg_lo:[1,0]
    v_pk_fma_f32 v[210:211], v[208:209], v[208:209], v[6:7] op_sel:[0,0,0] op_sel_hi:[0,1,1]
    v_pk_mul_f32 v[6:7], v[210:211], v[210:211] op_sel:[1,1] op_sel_hi:[1,0] neg_lo:[1,0]
    v_pk_fma_f32 v[8:9], v[210:211], v[210:211], v[6:7] op_sel:[0,0,0] op_sel_hi:[0,1,1]
    v_pk_mul_f32 v[6:7], v[8:9], v[210:211] op_sel:[1,1] op_sel_hi:[1,0] neg_lo:[1,0]
    v_mfma_f32_16x16x32_bf16 v[34:37], a[16:19], a[0:3], v[34:37]
    v_pk_fma_f32 v[10:11], v[8:9], v[210:211], v[6:7] op_sel:[0,0,0] op_sel_hi:[0,1,1]
    v_pk_mul_f32 v[6:7], v[10:11], v[10:11] op_sel:[1,1] op_sel_hi:[1,0] neg_lo:[1,0]
    v_pk_fma_f32 v[212:213], v[10:11], v[10:11], v[6:7] op_sel:[0,0,0] op_sel_hi:[0,1,1]
    v_pk_mul_f32 v[6:7], v[212:213], v[212:213] op_sel:[1,1] op_sel_hi:[1,0] neg_lo:[1,0]
    v_pk_fma_f32 v[214:215], v[212:213], v[212:213], v[6:7] op_sel:[0,0,0] op_sel_hi:[0,1,1]
    v_and_b32 v2, 16, v1
    v_mfma_f32_16x16x32_bf16 v[38:41], a[16:19], a[4:7], v[38:41]
    s_waitcnt lgkmcnt(4)
    v_cmp_ne_u32 vcc, 0, v2
    s_nop 1
    v_cndmask_b32 v216, 1.0, v206, vcc
    v_cndmask_b32 v217, 0, v207, vcc
    v_cndmask_b32 v218, 1.0, v208, s[22:23]
    v_cndmask_b32 v219, 0, v209, s[22:23]
    v_mfma_f32_16x16x32_bf16 v[18:21], a[28:31], a[20:23], v[18:21]
    s_waitcnt vmcnt(10) lgkmcnt(2)
    s_barrier
    s_add_u32 s94, s94, 128
    ds_read_b128 a[0:3], v183 offset:43520
    ds_read_b64_tr_b16 a[8:9], v184 offset:0
    v_mfma_f32_16x16x32_bf16 v[22:25], a[28:31], a[24:27], v[22:25]
    s_add_u32 m0, s20, 111104
    ds_read_b64_tr_b16 a[10:11], v184 offset:1280
    ds_read_b128 a[4:7], v183 offset:45696
    v_mfma_f32_16x16x32_bf16 v[30:33], a[32:35], a[24:27], v[30:33]
    ds_read_b64_tr_b16 a[12:13], v184 offset:40
    ds_read_b64_tr_b16 a[14:15], v184 offset:1320
    buffer_load_dwordx4 v112, s[40:43], s94 offen sc0 lds
    v_mfma_f32_16x16x32_bf16 v[26:29], a[32:35], a[20:23], v[26:29]
    s_waitcnt lgkmcnt(6)
    ds_read_b64_tr_b16 a[16:17], v190 offset:0
    ds_read_b64_tr_b16 a[18:19], v190 offset:1280
    buffer_load_dwordx4 v113, s[40:43], s94 offen offset:1088 sc0 lds
    v_mfma_f32_16x16x32_bf16 v[34:37], a[36:39], a[20:23], v[34:37]
    v_mfma_f32_16x16x32_bf16 v[38:41], a[36:39], a[24:27], v[38:41]
    s_waitcnt lgkmcnt(5)
    v_mfma_f32_16x16x32_bf16 v[18:21], a[8:11], a[0:3], v[18:21]
    s_waitcnt lgkmcnt(4)
    s_add_u32 m0, s39, 94208
    ds_read_b128 a[20:23], v183 offset:43584
    ds_read_b64_tr_b16 a[28:29], v184 offset:5120
    v_mfma_f32_16x16x32_bf16 v[22:25], a[8:11], a[4:7], v[22:25]
    s_waitcnt lgkmcnt(4)
    ds_read_b64_tr_b16 a[30:31], v184 offset:6400
    ds_read_b128 a[24:27], v183 offset:45760
    buffer_load_dwordx4 v181, s[44:47], s95 offen offset:0 sc0 lds
    v_mfma_f32_16x16x32_bf16 v[30:33], a[12:15], a[4:7], v[30:33]
    ds_read_b64_tr_b16 a[32:33], v184 offset:5160
    ds_read_b64_tr_b16 a[34:35], v184 offset:6440
    buffer_load_dwordx4 v182, s[44:47], s95 offen offset:1024 sc0 lds
    v_mfma_f32_16x16x32_bf16 v[26:29], a[12:15], a[0:3], v[26:29]
    s_waitcnt lgkmcnt(6)
    ds_read_b64_tr_b16 a[36:37], v190 offset:5120
    ds_read_b64_tr_b16 a[38:39], v190 offset:6400
    v_mfma_f32_16x16x32_bf16 v[34:37], a[16:19], a[0:3], v[34:37]
    v_mfma_f32_16x16x32_bf16 v[38:41], a[16:19], a[4:7], v[38:41]
    s_waitcnt lgkmcnt(5)
    v_mfma_f32_16x16x32_bf16 v[18:21], a[28:31], a[20:23], v[18:21]
    s_waitcnt vmcnt(10) lgkmcnt(4)
    s_barrier
    ds_read_b128 a[0:3], v183 offset:52224
    ds_read_b64_tr_b16 a[8:9], v184 offset:10240
    v_and_b32 v17, 31, v1
    v_mfma_f32_16x16x32_bf16 v[22:25], a[28:31], a[24:27], v[22:25]
    s_waitcnt lgkmcnt(4)
    ds_read_b64_tr_b16 a[10:11], v184 offset:11520
    ds_read_b128 a[4:7], v183 offset:54400
    v_lshlrev_b32 v16, 2, v17
    v_mfma_f32_16x16x32_bf16 v[30:33], a[32:35], a[24:27], v[30:33]
    ds_read_b64_tr_b16 a[12:13], v184 offset:10280
    ds_read_b64_tr_b16 a[14:15], v184 offset:11560
    v_add_u32 v16, 4096, v16
    v_mfma_f32_16x16x32_bf16 v[26:29], a[32:35], a[20:23], v[26:29]
    s_waitcnt lgkmcnt(6)
    ds_read_b64_tr_b16 a[16:17], v190 offset:10240
    ds_read_b64_tr_b16 a[18:19], v190 offset:11520
    v_lshlrev_b32 v17, 7, v17
    v_mfma_f32_16x16x32_bf16 v[34:37], a[36:39], a[20:23], v[34:37]
    v_mfma_f32_16x16x32_bf16 v[38:41], a[36:39], a[24:27], v[38:41]
    s_waitcnt lgkmcnt(5)
    v_mfma_f32_16x16x32_bf16 v[18:21], a[8:11], a[0:3], v[18:21]
    s_waitcnt lgkmcnt(4)
    s_cmp_eq_u32 s84, 0
    ds_read_b128 a[20:23], v183 offset:52288
    ds_read_b64_tr_b16 a[28:29], v184 offset:15360
    v_mfma_f32_16x16x32_bf16 v[22:25], a[8:11], a[4:7], v[22:25]
    s_waitcnt lgkmcnt(4)
    s_cselect_b32 s96, 0, 2130706432
    ds_read_b64_tr_b16 a[30:31], v184 offset:16640
    ds_read_b128 a[24:27], v183 offset:54464
    v_mfma_f32_16x16x32_bf16 v[30:33], a[12:15], a[4:7], v[30:33]
    s_add_u32 s96, s96, 458752
    ds_read_b64_tr_b16 a[32:33], v184 offset:15400
    ds_read_b64_tr_b16 a[34:35], v184 offset:16680
    v_mfma_f32_16x16x32_bf16 v[26:29], a[12:15], a[0:3], v[26:29]
    s_waitcnt lgkmcnt(6)
    ds_read_b64_tr_b16 a[36:37], v190 offset:15360
    ds_read_b64_tr_b16 a[38:39], v190 offset:16640
    v_mfma_f32_16x16x32_bf16 v[34:37], a[16:19], a[0:3], v[34:37]
    v_mfma_f32_16x16x32_bf16 v[38:41], a[16:19], a[4:7], v[38:41]
    s_waitcnt lgkmcnt(5)
    v_mfma_f32_16x16x32_bf16 v[18:21], a[28:31], a[20:23], v[18:21]
    s_waitcnt vmcnt(4) lgkmcnt(4)
    s_barrier
    ds_read_b128 a[0:3], v183 offset:0
    ds_read_b64_tr_b16 a[8:9], v184 offset:20480
    v_cmp_eq_u32 vcc, s84, v255
    v_mfma_f32_16x16x32_bf16 v[22:25], a[28:31], a[24:27], v[22:25]
    ds_read_b64_tr_b16 a[10:11], v184 offset:21760
    ds_read_b128 a[4:7], v183 offset:2176
    s_nop 0
    s_cbranch_vccnz L_retry_2
L_ok_3:
    s_waitcnt lgkmcnt(6)
    v_mfma_f32_16x16x32_bf16 v[30:33], a[32:35], a[24:27], v[30:33]
    ds_read_b64_tr_b16 a[12:13], v184 offset:20520
    ds_read_b64_tr_b16 a[14:15], v184 offset:21800
    v_mfma_f32_16x16x32_bf16 v[26:29], a[32:35], a[20:23], v[26:29]
    s_waitcnt lgkmcnt(6)
    ds_read_b64_tr_b16 a[16:17], v190 offset:20480
    ds_read_b64_tr_b16 a[18:19], v190 offset:21760
    v_mfma_f32_16x16x32_bf16 v[34:37], a[36:39], a[20:23], v[34:37]
    v_mfma_f32_16x16x32_bf16 v[38:41], a[36:39], a[24:27], v[38:41]
    s_waitcnt lgkmcnt(5)
    v_mfma_f32_16x16x32_bf16 v[18:21], a[8:11], a[0:3], v[18:21]
    s_waitcnt lgkmcnt(4)
    ds_read_b128 a[20:23], v183 offset:64
    ds_read_b64_tr_b16 a[28:29], v184 offset:25600
    buffer_load_dword v116, v17, s[64:67], s96 offen sc1
    v_mfma_f32_16x16x32_bf16 v[22:25], a[8:11], a[4:7], v[22:25]
    s_waitcnt lgkmcnt(4)
    ds_read_b64_tr_b16 a[30:31], v184 offset:26880
    ds_read_b128 a[24:27], v183 offset:2240
    v_mfma_f32_16x16x32_bf16 v[30:33], a[12:15], a[4:7], v[30:33]
    ds_read_b64_tr_b16 a[32:33], v184 offset:25640
    ds_read_b64_tr_b16 a[34:35], v184 offset:26920
    v_mfma_f32_16x16x32_bf16 v[26:29], a[12:15], a[0:3], v[26:29]
    s_waitcnt lgkmcnt(6)
    ds_read_b64_tr_b16 a[36:37], v190 offset:25600
    ds_read_b64_tr_b16 a[38:39], v190 offset:26880
    v_mfma_f32_16x16x32_bf16 v[34:37], a[16:19], a[0:3], v[34:37]
    v_mfma_f32_16x16x32_bf16 v[38:41], a[16:19], a[4:7], v[38:41]
    s_waitcnt lgkmcnt(5)
    v_mfma_f32_16x16x32_bf16 v[18:21], a[28:31], a[20:23], v[18:21]
    s_mov_b32 s37, 1
    s_cmp_eq_u32 s84, 1
    s_cbranch_scc1 L_pad_n0
    s_cmp_eq_u32 s84, 2
    s_cbranch_scc1 L_pad_n1
    s_cmp_eq_u32 s84, 3
    s_cbranch_scc1 L_pad_n2
    s_mov_b32 s6, 0
    s_waitcnt vmcnt(0)
L_poll_4:
    v_cmp_eq_u32 vcc, 0, v116
    s_add_u32 s6, s6, 1
    s_nop 2
    s_cbranch_vccz L_seen_5
    s_sleep 1
    buffer_load_dword v116, v17, s[64:67], s96 offen sc1
    s_cmp_lt_u32 s6, 0x40000
    s_waitcnt vmcnt(0)
    s_cbranch_scc1 L_poll_4
L_seen_5:
    ds_write_b32 v16, v116
    s_waitcnt lgkmcnt(0)
L_ret_n:
    s_mov_b32 s37, 0
    s_waitcnt vmcnt(0)
    s_waitcnt vmcnt(1)
    s_barrier
    ds_read_b128 a[0:3], v183 offset:8704
    ds_read_b64_tr_b16 a[8:9], v184 offset:30720
    ds_read_b32 v4, v16
    s_add_u32 m0, s21, 126976
    s_waitcnt lgkmcnt(7)
    v_mfma_f32_16x16x32_bf16 v[22:25], a[28:31], a[24:27], v[22:25]
    s_waitcnt lgkmcnt(5)
    s_add_u32 s68, s64, 262144
    s_addc_u32 s69, s65, 0
    ds_read_b64_tr_b16 a[10:11], v184 offset:32000
    ds_read_b128 a[4:7], v183 offset:10880
    global_load_lds_dwordx4 v119, s[68:69] offset:0 sc1
    v_mfma_f32_16x16x32_bf16 v[30:33], a[32:35], a[24:27], v[30:33]
    ds_read_b64_tr_b16 a[12:13], v184 offset:30760
    ds_read_b64_tr_b16 a[14:15], v184 offset:32040
    global_load_lds_dwordx4 v119, s[68:69] offset:1024 sc1
    v_mfma_f32_16x16x32_bf16 v[26:29], a[32:35], a[20:23], v[26:29]
    s_waitcnt lgkmcnt(7)
    ds_read_b64_tr_b16 a[16:17], v190 offset:30720
    ds_read_b64_tr_b16 a[18:19], v190 offset:32000
    global_load_lds_dwordx4 v119, s[68:69] offset:2048 sc1
    v_mfma_f32_16x16x32_bf16 v[34:37], a[36:39], a[20:23], v[34:37]
    s_add_u32 m0, s21, 139264
    v_mfma_f32_16x16x32_bf16 v[38:41], a[36:39], a[24:27], v[38:41]
    s_waitcnt lgkmcnt(5)
    s_add_u32 s68, s64, 274432
    s_addc_u32 s69, s65, 0
    v_mfma_f32_16x16x32_bf16 v[18:21], a[8:11], a[0:3], v[18:21]
    s_waitcnt lgkmcnt(4)
    ds_read_b128 a[20:23], v183 offset:8768
    ds_read_b64_tr_b16 a[28:29], v184 offset:35840
    global_load_lds_dwordx4 v119, s[68:69] offset:0 sc1
    global_load_lds_dwordx4 v119, s[68:69] offset:1024 sc1
    v_mfma_f32_16x16x32_bf16 v[22:25], a[8:11], a[4:7], v[22:25]
    s_waitcnt lgkmcnt(4)
    ds_read_b64_tr_b16 a[30:31], v184 offset:37120
    ds_read_b128 a[24:27], v183 offset:10944
    global_load_lds_dwordx4 v119, s[68:69] offset:2048 sc1
    s_add_u32 m0, s21, 151552
    v_mfma_f32_16x16x32_bf16 v[30:33], a[12:15], a[4:7], v[30:33]
    s_add_u32 s68, s64, 286720
    s_addc_u32 s69, s65, 0
    ds_read_b64_tr_b16 a[32:33], v184 offset:35880
    ds_read_b64_tr_b16 a[34:35], v184 offset:37160
    v_mfma_f32_16x16x32_bf16 v[26:29], a[12:15], a[0:3], v[26:29]
    s_waitcnt lgkmcnt(6)
    ds_read_b64_tr_b16 a[36:37], v190 offset:35840
    ds_read_b64_tr_b16 a[38:39], v190 offset:37120
    global_load_lds_dwordx4 v119, s[68:69] offset:0 sc1
    v_mfma_f32_16x16x32_bf16 v[34:37], a[16:19], a[0:3], v[34:37]
    global_load_lds_dwordx4 v119, s[68:69] offset:1024 sc1
    v_mfma_f32_16x16x32_bf16 v[38:41], a[16:19], a[4:7], v[38:41]
    s_waitcnt lgkmcnt(5)
    global_load_lds_dwordx4 v119, s[68:69] offset:2048 sc1
    v_mfma_f32_16x16x32_bf16 v[18:21], a[28:31], a[20:23], v[18:21]
    s_waitcnt lgkmcnt(4)
    v_max_f32_dpp v4, v4, v4 row_ror:1 row_mask:0xf bank_mask:0xf
    s_nop 1
    v_max_f32_dpp v4, v4, v4 row_ror:2 row_mask:0xf bank_mask:0xf
    v_mfma_f32_16x16x32_bf16 v[22:25], a[28:31], a[24:27], v[22:25]
    s_waitcnt lgkmcnt(2)
    v_max_f32_dpp v4, v4, v4 row_ror:4 row_mask:0xf bank_mask:0xf
    v_mfma_f32_16x16x32_bf16 v[30:33], a[32:35], a[24:27], v[30:33]
    s_nop 0
    v_max_f32_dpp v4, v4, v4 row_ror:8 row_mask:0xf bank_mask:0xf
    v_mfma_f32_16x16x32_bf16 v[26:29], a[32:35], a[20:23], v[26:29]
    s_waitcnt lgkmcnt(0)
    v_mov_b32 v5, v4
    v_mfma_f32_16x16x32_bf16 v[34:37], a[36:39], a[20:23], v[34:37]
    s_nop 0
    v_permlane16_swap_b32 v4, v5
    v_mfma_f32_16x16x32_bf16 v[38:41], a[36:39], a[24:27], v[38:41]
    v_max_f32 v4, v4, v5
    v_cvt_pk_bf16_f32 v98, v18, v19
    v_cvt_pk_bf16_f32 v99, v20, v21
    v_cvt_pk_bf16_f32 v100, v22, v23
    v_cvt_pk_bf16_f32 v101, v24, v25
    v_cvt_pk_bf16_f32 v102, v26, v27
    v_cvt_pk_bf16_f32 v103, v28, v29
    v_cvt_pk_bf16_f32 v104, v30, v31
    v_cvt_pk_bf16_f32 v105, v32, v33
    v_cvt_pk_bf16_f32 v106, v34, v35
    v_cvt_pk_bf16_f32 v107, v36, v37
    v_cvt_pk_bf16_f32 v108, v38, v39
    v_cvt_pk_bf16_f32 v109, v40, v41
    v_permlane16_swap_b32 v98, v100
    v_permlane16_swap_b32 v99, v101
    v_permlane16_swap_b32 v102, v104
    v_permlane16_swap_b32 v103, v105
    v_permlane16_swap_b32 v106, v108
    v_permlane16_swap_b32 v107, v109
    v_dot2_f32_bf16 v114, v98, v98, 0
    v_dot2_f32_bf16 v115, v102, v102, 0
    v_dot2_f32_bf16 v114, v99, v99, v114
    v_dot2_f32_bf16 v115, v103, v103, v115
    v_dot2_f32_bf16 v114, v100, v100, v114
    v_dot2_f32_bf16 v115, v104, v104, v115
    v_dot2_f32_bf16 v114, v101, v101, v114
    v_dot2_f32_bf16 v115, v105, v105, v115
    v_dot2_f32_bf16 v114, v106, v106, v114
    v_dot2_f32_bf16 v115, v108, v108, v115
    v_dot2_f32_bf16 v114, v107, v107, v114
    v_dot2_f32_bf16 v115, v109, v109, v115
    s_nop 1
    v_mov_b32 v2, v114
    v_mov_b32 v3, v115
    s_nop 0
    v_permlane32_swap_b32 v2, v114
    v_permlane32_swap_b32 v3, v115
    v_add_f32 v114, v114, v2
    v_add_f32 v115, v115, v3
    v_mul_f32 v114, v114, v4
    v_mul_f32 v115, v115, v4
    v_sqrt_f32 v114, v114
    v_sqrt_f32 v115, v115
    s_mov_b32 s99, 0x42200000
    v_cmp_nge_f32 vcc, s99, v114
    v_cmp_nge_f32 s[12:13], s99, v115
    s_nop 3
    s_or_b64 vcc, vcc, s[12:13]
    v_cvt_pk_bf16_f32 v2, -v114, 0
L_pad_n0:
    s_cmp_eq_u32 s37, 1
    s_cbranch_scc1 L_pad_n3
    v_cvt_pk_bf16_f32 v3, -v115, 0
    s_cbranch_vccnz L_truemax_n
    v_cndmask_b32 v106, v106, v2, s[22:23]
    v_cndmask_b32 v108, v108, v3, s[22:23]
L_havemax_n:
    s_waitcnt vmcnt(6)
    s_barrier
    ds_read_b128 a[240:243], v118
    ds_read2st64_b64 a[244:247], v121 offset0:4 offset1:5
    s_waitcnt lgkmcnt(1)
    v_mfma_f32_32x32x16_bf16 v[18:33], a[240:243], v[98:101], 0
    s_waitcnt lgkmcnt(0)
    v_mfma_f32_32x32x8_bf16 v[18:33], a[244:245], v[106:107], v[18:33]
    v_mfma_f32_32x32x8_bf16 v[34:49], a[244:245], v[108:109], 0
    s_nop 10
    v_exp_f32 v18, v18
    v_exp_f32 v19, v19
    v_exp_f32 v20, v20
    v_exp_f32 v21, v21
    v_exp_f32 v22, v22
    v_exp_f32 v23, v23
    v_exp_f32 v24, v24
    v_exp_f32 v25, v25
    v_exp_f32 v26, v26
    v_mfma_f32_32x32x16_bf16 v[34:49], a[240:243], v[102:105], v[34:49]
    s_add_u32 m0, s7, 0
    s_add_u32 s54, s52, s36
    s_addc_u32 s55, s53, 0
    ds_read_b128 a[240:243], v118 offset:1024
    ds_read_b128 a[248:251], v120 offset:0
    ds_read_b128 a[252:255], v120 offset:768
    global_load_lds_dwordx4 v123, s[54:55] offset:0 sc0
    global_load_lds_dwordx4 v124, s[54:55] offset:1088 sc0
    v_exp_f32 v27, v27
    v_exp_f32 v28, v28
    v_exp_f32 v29, v29
    v_exp_f32 v30, v30
    v_exp_f32 v31, v31
    v_exp_f32 v32, v32
    v_exp_f32 v33, v33
    v_mfma_f32_32x32x8_bf16 v[50:65], a[246:247], v[106:107], 0
    v_exp_f32 v34, v34
    v_exp_f32 v35, v35
    v_exp_f32 v36, v36
    v_exp_f32 v37, v37
    v_exp_f32 v38, v38
    s_waitcnt lgkmcnt(2)
    v_mfma_f32_32x32x16_bf16 v[50:65], a[240:243], v[98:101], v[50:65]
    s_waitcnt lgkmcnt(1)
    global_load_lds_dwordx4 v125, s[54:55] offset:2176 sc0
    v_exp_f32 v39, v39
    v_exp_f32 v40, v40
    v_exp_f32 v41, v41
    v_exp_f32 v42, v42
    v_smfmac_f32_32x32x32_bf16 v[66:81], a[248:251], v[18:25], v253
    s_waitcnt lgkmcnt(0)
    s_add_u32 m0, s4, 13056
    s_add_u32 s99, s91, s92
    s_add_u32 s14, s14, s99
    s_addc_u32 s15, s15, 0
    v_exp_f32 v43, v43
    v_exp_f32 v44, v44
    v_exp_f32 v45, v45
    v_exp_f32 v46, v46
    v_smfmac_f32_32x32x32_bf16 v[66:81], a[252:255], v[26:33], v253
    s_add_u32 s58, s56, s36
    s_addc_u32 s59, s57, 0
    global_load_lds_dwordx4 v112, s[58:59] offset:0 sc0
    v_exp_f32 v47, v47
    v_exp_f32 v48, v48
    v_exp_f32 v49, v49
    v_mfma_f32_32x32x8_bf16 v[18:33], a[246:247], v[108:109], 0
    v_exp_f32 v50, v50
    v_exp_f32 v51, v51
    v_exp_f32 v52, v52
    v_exp_f32 v53, v53
    v_exp_f32 v54, v54
    v_mfma_f32_32x32x16_bf16 v[18:33], a[240:243], v[102:105], v[18:33]
    s_add_u32 s30, s30, s92
    s_addc_u32 s31, s31, 0
    ds_read2st64_b64 a[244:247], v121 offset0:16 offset1:17
    ds_read_b128 a[240:243], v118 offset:6144
    global_load_lds_dwordx4 v113, s[58:59] offset:1088 sc0
    v_exp_f32 v55, v55
    v_exp_f32 v56, v56
    v_exp_f32 v57, v57
    v_smfmac_f32_32x32x32_bf16 v[82:97], a[248:251], v[34:41], v253
    s_add_u32 m0, s4, 15232
    s_add_u32 s62, s60, s36
    s_addc_u32 s63, s61, 0
    ds_read_b128 a[248:251], v120 offset:1536
    global_load_lds_dwordx4 v112, s[62:63] offset:0 sc0
    v_exp_f32 v58, v58
    v_exp_f32 v59, v59
    v_exp_f32 v60, v60
    v_exp_f32 v61, v61
    v_smfmac_f32_32x32x32_bf16 v[82:97], a[252:255], v[42:49], v253
    s_waitcnt lgkmcnt(1)
    s_sub_u32 s36, s36, 128
    s_cselect_b32 s36, 1152, s36
    s_cmp_eq_u32 s86, 0
    s_cselect_b64 s[72:73], s[24:25], s[26:27]
    ds_read_b128 a[252:255], v120 offset:2304
    v_exp_f32 v62, v62
    v_exp_f32 v63, v63
    v_exp_f32 v64, v64
    v_exp_f32 v65, v65
    v_mfma_f32_32x32x8_bf16 v[34:49], a[244:245], v[106:107], 0
    v_exp_f32 v18, v18
    v_exp_f32 v19, v19
    v_exp_f32 v20, v20
    v_exp_f32 v21, v21
    v_exp_f32 v22, v22
    v_mfma_f32_32x32x16_bf16 v[34:49], a[240:243], v[98:101], v[34:49]
    s_waitcnt lgkmcnt(1)
    v_exp_f32 v23, v23
    v_exp_f32 v24, v24
    v_exp_f32 v25, v25
    v_exp_f32 v26, v26
    v_smfmac_f32_32x32x32_bf16 v[66:81], a[248:251], v[50:57], v253
    s_waitcnt vmcnt(9) lgkmcnt(0)
    s_mov_b32 s74, 819200
    s_mov_b32 s75, 0x00020000
    s_barrier
    v_exp_f32 v27, v27
    v_exp_f32 v28, v28
    v_exp_f32 v29, v29
    v_smfmac_f32_32x32x32_bf16 v[66:81], a[252:255], v[58:65], v253
    global_load_lds_dwordx4 v113, s[62:63] offset:1088 sc0
    v_exp_f32 v30, v30
    v_exp_f32 v31, v31
    v_exp_f32 v32, v32
    v_exp_f32 v33, v33
    v_mfma_f32_32x32x8_bf16 v[50:65], a[244:245], v[108:109], 0
    v_exp_f32 v34, v34
    v_exp_f32 v35, v35
    v_exp_f32 v36, v36
    v_exp_f32 v37, v37
    v_exp_f32 v38, v38
    v_mfma_f32_32x32x16_bf16 v[50:65], a[240:243], v[102:105], v[50:65]
    ds_read_b128 a[240:243], v118 offset:7168
    v_exp_f32 v39, v39
    v_exp_f32 v40, v40
    v_exp_f32 v41, v41
    v_exp_f32 v42, v42
    v_smfmac_f32_32x32x32_bf16 v[82:97], a[248:251], v[18:25], v253
    s_mul_i32 s34, s88, 102400
    s_and_b32 s99, s87, 3
    ds_read_b128 a[248:251], v120 offset:6144
    v_exp_f32 v43, v43
    v_exp_f32 v44, v44
    v_exp_f32 v45, v45
    v_smfmac_f32_32x32x32_bf16 v[82:97], a[252:255], v[26:33], v253
    s_waitcnt lgkmcnt(1)
    ds_read_b128 a[252:255], v120 offset:6912
    v_exp_f32 v46, v46
    v_exp_f32 v47, v47
    v_exp_f32 v48, v48
    v_exp_f32 v49, v49
    v_mfma_f32_32x32x8_bf16 v[18:33], a[246:247], v[106:107], 0
    v_exp_f32 v50, v50
    v_exp_f32 v51, v51
    v_exp_f32 v52, v52
    v_exp_f32 v53, v53
    v_mfma_f32_32x32x16_bf16 v[18:33], a[240:243], v[98:101], v[18:33]
    s_waitcnt lgkmcnt(1)
    v_exp_f32 v54, v54
    v_exp_f32 v55, v55
    v_exp_f32 v56, v56
    v_exp_f32 v57, v57
    v_smfmac_f32_32x32x32_bf16 v[66:81], a[248:251], v[34:41], v253
    s_waitcnt lgkmcnt(0)
    s_lshl_b32 s99, s99, 1
    s_add_u32 s99, s99, s85
    v_exp_f32 v58, v58
    v_exp_f32 v59, v59
    v_exp_f32 v60, v60
    v_exp_f32 v61, v61
    v_smfmac_f32_32x32x32_bf16 v[66:81], a[252:255], v[42:49], v253
    v_exp_f32 v62, v62
    v_exp_f32 v63, v63
    v_exp_f32 v64, v64
    v_exp_f32 v65, v65
    v_mfma_f32_32x32x8_bf16 v[34:49], a[246:247], v[108:109], 0
    v_exp_f32 v18, v18
    v_exp_f32 v19, v19
    v_exp_f32 v20, v20
    v_exp_f32 v21, v21
    v_exp_f32 v22, v22
    v_mfma_f32_32x32x16_bf16 v[34:49], a[240:243], v[102:105], v[34:49]
    ds_read2st64_b64 a[244:247], v121 offset0:28 offset1:29
    ds_read_b128 a[240:243], v118 offset:12288
    v_exp_f32 v23, v23
    v_exp_f32 v24, v24
    v_exp_f32 v25, v25
    v_exp_f32 v26, v26
    v_smfmac_f32_32x32x32_bf16 v[82:97], a[248:251], v[50:57], v253
    s_mul_i32 s99, s99, 12800
    s_add_u32 s43, s99, s34
    ds_read_b128 a[248:251], v120 offset:7680
    v_exp_f32 v27, v27
    v_exp_f32 v28, v28
    v_exp_f32 v29, v29
    v_smfmac_f32_32x32x32_bf16 v[82:97], a[252:255], v[58:65], v253
    s_waitcnt lgkmcnt(1)
    ds_read_b128 a[252:255], v120 offset:8448
    v_exp_f32 v30, v30
    v_exp_f32 v31, v31
    v_exp_f32 v32, v32
    v_exp_f32 v33, v33
    v_mfma_f32_32x32x8_bf16 v[50:65], a[244:245], v[106:107], 0
    v_exp_f32 v34, v34
    v_exp_f32 v35, v35
    v_exp_f32 v36, v36
    v_exp_f32 v37, v37
    v_mfma_f32_32x32x16_bf16 v[50:65], a[240:243], v[98:101], v[50:65]
    s_waitcnt lgkmcnt(1)
    v_exp_f32 v38, v38
    v_exp_f32 v39, v39
    v_exp_f32 v40, v40
    v_exp_f32 v41, v41
    v_smfmac_f32_32x32x32_bf16 v[66:81], a[248:251], v[18:25], v253
    s_waitcnt lgkmcnt(0)
    s_mul_i32 s5, s84, 5120
    s_lshl_b32 s50, s84, 10
    v_exp_f32 v42, v42
    v_exp_f32 v43, v43
    v_exp_f32 v44, v44
    v_exp_f32 v45, v45
    v_smfmac_f32_32x32x32_bf16 v[66:81], a[252:255], v[26:33], v253
    v_exp_f32 v46, v46
    v_exp_f32 v47, v47
    v_exp_f32 v48, v48
    v_exp_f32 v49, v49
    v_mfma_f32_32x32x8_bf16 v[18:33], a[244:245], v[108:109], 0
    v_exp_f32 v50, v50
    v_exp_f32 v51, v51
    v_exp_f32 v52, v52
    v_exp_f32 v53, v53
    v_exp_f32 v54, v54
    v_mfma_f32_32x32x16_bf16 v[18:33], a[240:243], v[102:105], v[18:33]
    s_add_u32 m0, s7, 30464
    ds_read_b128 a[240:243], v118 offset:13312
    v_exp_f32 v55, v55
    v_exp_f32 v56, v56
    v_exp_f32 v57, v57
    v_exp_f32 v58, v58
    v_smfmac_f32_32x32x32_bf16 v[82:97], a[248:251], v[34:41], v253
    s_add_u32 s54, s52, s36
    s_addc_u32 s55, s53, 0
    ds_read_b128 a[248:251], v120 offset:12288
    global_load_lds_dwordx4 v123, s[54:55] offset:0 sc0
    v_exp_f32 v59, v59
    v_exp_f32 v60, v60
    v_exp_f32 v61, v61
    v_smfmac_f32_32x32x32_bf16 v[82:97], a[252:255], v[42:49], v253
    s_waitcnt lgkmcnt(1)
    s_add_u32 s99, s34, 786432
    s_add_u32 s44, s64, s99
    s_addc_u32 s45, s65, 0
    ds_read_b128 a[252:255], v120 offset:13056
    global_load_lds_dwordx4 v124, s[54:55] offset:1088 sc0
    v_exp_f32 v62, v62
    v_exp_f32 v63, v63
    v_exp_f32 v64, v64
    v_exp_f32 v65, v65
    v_mfma_f32_32x32x8_bf16 v[34:49], a[246:247], v[106:107], 0
    v_exp_f32 v18, v18
    v_exp_f32 v19, v19
    v_exp_f32 v20, v20
    v_exp_f32 v21, v21
    v_exp_f32 v22, v22
    v_mfma_f32_32x32x16_bf16 v[34:49], a[240:243], v[98:101], v[34:49]
    s_waitcnt lgkmcnt(1)
    global_load_lds_dwordx4 v125, s[54:55] offset:2176 sc0
    v_exp_f32 v23, v23
    v_exp_f32 v24, v24
    v_exp_f32 v25, v25
    v_exp_f32 v26, v26
    v_smfmac_f32_32x32x32_bf16 v[66:81], a[248:251], v[50:57], v253
    s_waitcnt lgkmcnt(0)
    s_add_u32 m0, s4, 43520
    s_lshr_b32 s99, s88, 2
    s_lshl_b32 s99, s99, 7
    v_exp_f32 v27, v27
    v_exp_f32 v28, v28
    v_exp_f32 v29, v29
    v_exp_f32 v30, v30
    v_smfmac_f32_32x32x32_bf16 v[66:81], a[252:255], v[58:65], v253
    s_add_u32 s58, s56, s36
    s_addc_u32 s59, s57, 0
    global_load_lds_dwordx4 v112, s[58:59] offset:0 sc0
    v_exp_f32 v31, v31
    v_exp_f32 v32, v32
    v_exp_f32 v33, v33
    v_mfma_f32_32x32x8_bf16 v[50:65], a[246:247], v[108:109], 0
    v_exp_f32 v34, v34
    v_exp_f32 v35, v35
    v_exp_f32 v36, v36
    v_exp_f32 v37, v37
    v_exp_f32 v38, v38
    v_mfma_f32_32x32x16_bf16 v[50:65], a[240:243], v[102:105], v[50:65]
    s_add_u32 s42, s99, 196608
    ds_read2st64_b64 a[244:247], v121 offset0:40 offset1:41
    ds_read_b128 a[240:243], v118 offset:18432
    global_load_lds_dwordx4 v113, s[58:59] offset:1088 sc0
    v_exp_f32 v39, v39
    v_exp_f32 v40, v40
    v_exp_f32 v41, v41
    v_smfmac_f32_32x32x32_bf16 v[82:97], a[248:251], v[18:25], v253
    s_add_u32 m0, s4, 45696
    s_add_u32 s62, s60, s36
    s_addc_u32 s63, s61, 0
    ds_read_b128 a[248:251], v120 offset:13824
    global_load_lds_dwordx4 v112, s[62:63] offset:0 sc0
    v_exp_f32 v42, v42
    v_exp_f32 v43, v43
    v_exp_f32 v44, v44
    v_exp_f32 v45, v45
    v_smfmac_f32_32x32x32_bf16 v[82:97], a[252:255], v[26:33], v253
    s_waitcnt lgkmcnt(1)
    s_sub_u32 s36, s36, 128
    s_cselect_b32 s36, 1152, s36
    s_and_b32 s99, s88, 1
    ds_read_b128 a[252:255], v120 offset:14592
    v_exp_f32 v46, v46
    v_exp_f32 v47, v47
    v_exp_f32 v48, v48
    v_exp_f32 v49, v49
    v_mfma_f32_32x32x8_bf16 v[18:33], a[244:245], v[106:107], 0
    v_exp_f32 v50, v50
    v_exp_f32 v51, v51
    v_exp_f32 v52, v52
    v_exp_f32 v53, v53
    v_exp_f32 v54, v54
    v_mfma_f32_32x32x16_bf16 v[18:33], a[240:243], v[98:101], v[18:33]
    s_waitcnt lgkmcnt(1)
    v_exp_f32 v55, v55
    v_exp_f32 v56, v56
    v_exp_f32 v57, v57
    v_exp_f32 v58, v58
    v_smfmac_f32_32x32x32_bf16 v[66:81], a[248:251], v[34:41], v253
    s_waitcnt vmcnt(13) lgkmcnt(0)
    s_lshl_b32 s28, s99, 5
    s_xor_b32 s99, s99, 1
    s_barrier
    v_exp_f32 v59, v59
    v_exp_f32 v60, v60
    v_exp_f32 v61, v61
    v_smfmac_f32_32x32x32_bf16 v[66:81], a[252:255], v[42:49], v253
    global_load_lds_dwordx4 v113, s[62:63] offset:1088 sc0
    v_exp_f32 v62, v62
    v_exp_f32 v63, v63
    v_exp_f32 v64, v64
    v_exp_f32 v65, v65
    v_mfma_f32_32x32x8_bf16 v[34:49], a[244:245], v[108:109], 0
    v_exp_f32 v18, v18
    v_exp_f32 v19, v19
    v_exp_f32 v20, v20
    v_exp_f32 v21, v21
    v_exp_f32 v22, v22
    v_mfma_f32_32x32x16_bf16 v[34:49], a[240:243], v[102:105], v[34:49]
    s_add_u32 m0, s21, 126976
    ds_read_b128 a[240:243], v118 offset:19456
    v_exp_f32 v23, v23
    v_exp_f32 v24, v24
    v_exp_f32 v25, v25
    v_exp_f32 v26, v26
    v_smfmac_f32_32x32x32_bf16 v[82:97], a[248:251], v[50:57], v253
    s_add_u32 s68, s64, 299008
    s_addc_u32 s69, s65, 0
    ds_read_b128 a[248:251], v120 offset:18432
    global_load_lds_dwordx4 v119, s[68:69] offset:0 sc1
    v_exp_f32 v27, v27
    v_exp_f32 v28, v28
    v_exp_f32 v29, v29
    v_smfmac_f32_32x32x32_bf16 v[82:97], a[252:255], v[58:65], v253
    s_waitcnt lgkmcnt(1)
    s_lshl_b32 s29, s99, 7
    s_mul_i32 s99, s28, 640
    ds_read_b128 a[252:255], v120 offset:19200
    global_load_lds_dwordx4 v119, s[68:69] offset:1024 sc1
    v_exp_f32 v30, v30
    v_exp_f32 v31, v31
    v_exp_f32 v32, v32
    v_exp_f32 v33, v33
    v_mfma_f32_32x32x8_bf16 v[50:65], a[246:247], v[106:107], 0
    v_exp_f32 v34, v34
    v_exp_f32 v35, v35
    v_exp_f32 v36, v36
    v_exp_f32 v37, v37
    v_exp_f32 v38, v38
    v_mfma_f32_32x32x16_bf16 v[50:65], a[240:243], v[98:101], v[50:65]
    s_waitcnt lgkmcnt(1)
    v_exp_f32 v39, v39
    v_exp_f32 v40, v40
    v_exp_f32 v41, v41
    v_exp_f32 v42, v42
    v_smfmac_f32_32x32x32_bf16 v[66:81], a[248:251], v[18:25], v253
    s_waitcnt lgkmcnt(0)
    s_add_u32 s99, s99, s34
    s_add_u32 s18, s72, s99
    s_addc_u32 s19, s73, 0
    v_exp_f32 v43, v43
    v_exp_f32 v44, v44
    v_exp_f32 v45, v45
    v_exp_f32 v46, v46
    v_smfmac_f32_32x32x32_bf16 v[66:81], a[252:255], v[26:33], v253
    s_waitcnt vmcnt(9)
    global_load_lds_dwordx4 v119, s[68:69] offset:2048 sc1
    v_exp_f32 v47, v47
    v_exp_f32 v48, v48
    v_exp_f32 v49, v49
    v_mfma_f32_32x32x8_bf16 v[18:33], a[246:247], v[108:109], 0
    s_barrier
    v_exp_f32 v50, v50
    v_exp_f32 v51, v51
    v_exp_f32 v52, v52
    v_exp_f32 v53, v53
    v_exp_f32 v54, v54
    v_mfma_f32_32x32x16_bf16 v[18:33], a[240:243], v[102:105], v[18:33]
    ds_read2st64_b64 a[244:247], v121 offset0:52 offset1:53
    ds_read_b128 a[240:243], v118 offset:24576
    ds_read_b128 a[0:3], v127 offset:0
    ds_read_b128 a[8:11], v111 offset:0
    v_exp_f32 v55, v55
    v_exp_f32 v56, v56
    v_exp_f32 v57, v57
    v_smfmac_f32_32x32x32_bf16 v[82:97], a[248:251], v[34:41], v253
    s_mul_i32 s99, s29, 640
    s_add_u32 s99, s99, s34
    ds_read_b128 a[248:251], v120 offset:19968
    ds_read_b128 a[4:7], v127 offset:2176
    ds_read_b128 a[12:15], v111 offset:2176
    v_exp_f32 v58, v58
    v_exp_f32 v59, v59
    v_exp_f32 v60, v60
    v_exp_f32 v61, v61
    v_smfmac_f32_32x32x32_bf16 v[82:97], a[252:255], v[42:49], v253
    s_waitcnt lgkmcnt(5)
    ds_read_b128 a[252:255], v120 offset:20736
    ds_read_b128 a[16:19], v111 offset:4352
    v_exp_f32 v62, v62
    v_exp_f32 v63, v63
    v_exp_f32 v64, v64
    v_exp_f32 v65, v65
    v_mfma_f32_32x32x8_bf16 v[34:49], a[244:245], v[106:107], 0
    v_exp_f32 v18, v18
    v_exp_f32 v19, v19
    v_exp_f32 v20, v20
    v_exp_f32 v21, v21
    v_exp_f32 v22, v22
    v_mfma_f32_32x32x16_bf16 v[34:49], a[240:243], v[98:101], v[34:49]
    s_waitcnt lgkmcnt(2)
    s_add_u32 m0, s7, 60928
    s_add_u32 s54, s52, s36
    s_addc_u32 s55, s53, 0
    global_load_lds_dwordx4 v123, s[54:55] offset:0 sc0
    ds_read_b128 a[20:23], v111 offset:6528
    v_exp_f32 v23, v23
    v_exp_f32 v24, v24
    v_exp_f32 v25, v25
    v_exp_f32 v26, v26
    v_smfmac_f32_32x32x32_bf16 v[66:81], a[248:251], v[50:57], v253
    s_waitcnt lgkmcnt(1)
    s_add_u32 s32, s72, s99
    s_addc_u32 s33, s73, 0
    s_mul_i32 s47, s3, 2816
    global_load_lds_dwordx4 v124, s[54:55] offset:1088 sc0
    ds_read_b128 a[24:27], v111 offset:8704
    v_exp_f32 v27, v27
    v_exp_f32 v28, v28
    v_exp_f32 v29, v29
    v_smfmac_f32_32x32x32_bf16 v[66:81], a[252:255], v[58:65], v253
    global_load_lds_dwordx4 v125, s[54:55] offset:2176 sc0
    ds_read_b128 a[28:31], v111 offset:10880
    v_exp_f32 v30, v30
    v_exp_f32 v31, v31
    v_exp_f32 v32, v32
    v_exp_f32 v33, v33
    v_mfma_f32_32x32x8_bf16 v[50:65], a[244:245], v[108:109], 0
    v_exp_f32 v34, v34
    v_exp_f32 v35, v35
    v_exp_f32 v36, v36
    v_exp_f32 v37, v37
    v_mfma_f32_32x32x16_bf16 v[50:65], a[240:243], v[102:105], v[50:65]
    ds_read_b128 a[240:243], v118 offset:25600
    v_exp_f32 v38, v38
    v_exp_f32 v39, v39
    v_exp_f32 v40, v40
    v_mfma_f32_16x16x32_bf16 v[130:133], a[8:11], a[0:3], 0
    v_exp_f32 v41, v41
    v_mfma_f32_16x16x32_bf16 v[134:137], a[8:11], a[4:7], 0
    ds_read_b128 a[32:35], v127 offset:64
    v_exp_f32 v42, v42
    v_mfma_f32_16x16x32_bf16 v[142:145], a[12:15], a[4:7], 0
    ds_read_b128 a[40:43], v111 offset:64
    v_exp_f32 v43, v43
    v_smfmac_f32_32x32x32_bf16 v[82:97], a[248:251], v[18:25], v253
    s_add_u32 m0, s4, 73984
    s_lshl_b32 s99, s89, 7
    ds_read_b128 a[248:251], v120 offset:24576
    v_exp_f32 v44, v44
    v_exp_f32 v45, v45
    v_smfmac_f32_32x32x32_bf16 v[82:97], a[252:255], v[26:33], v253
    s_add_u32 s58, s56, s36
    s_addc_u32 s59, s57, 0
    ds_read_b128 a[252:255], v120 offset:25344
    global_load_lds_dwordx4 v112, s[58:59] offset:0 sc0
    v_exp_f32 v46, v46
    v_exp_f32 v47, v47
    v_mfma_f32_16x16x32_bf16 v[138:141], a[12:15], a[0:3], 0
    s_add_u32 s35, s47, s99
    ds_read_b128 a[36:39], v127 offset:2240
    global_load_lds_dwordx4 v113, s[58:59] offset:1088 sc0
    v_mfma_f32_16x16x32_bf16 v[146:149], a[16:19], a[0:3], 0
    s_add_u32 m0, s4, 76160
    v_exp_f32 v48, v48
    v_mfma_f32_16x16x32_bf16 v[150:153], a[16:19], a[4:7], 0
    s_waitcnt lgkmcnt(3)
    s_add_u32 s62, s60, s36
    s_addc_u32 s63, s61, 0
    ds_read_b128 a[44:47], v111 offset:2240
    global_load_lds_dwordx4 v112, s[62:63] offset:0 sc0
    v_exp_f32 v49, v49
    v_mfma_f32_32x32x8_bf16 v[18:33], a[246:247], v[106:107], 0
    v_exp_f32 v50, v50
    v_exp_f32 v51, v51
    v_exp_f32 v52, v52
    v_mfma_f32_32x32x16_bf16 v[18:33], a[240:243], v[98:101], v[18:33]
    s_sub_u32 s41, s99, 3072
    v_exp_f32 v53, v53
    v_exp_f32 v54, v54
    v_exp_f32 v55, v55
    v_mfma_f32_16x16x32_bf16 v[158:161], a[20:23], a[4:7], 0
    s_lshl_b32 s100, s89, 4
    ds_read_b128 a[48:51], v111 offset:4416
    v_exp_f32 v56, v56
    v_mfma_f32_16x16x32_bf16 v[154:157], a[20:23], a[0:3], 0
    ds_read_b128 a[52:55], v111 offset:6592
    v_exp_f32 v57, v57
    v_mfma_f32_16x16x32_bf16 v[162:165], a[24:27], a[0:3], 0
    s_waitcnt lgkmcnt(2)
    v_exp_f32 v58, v58
    v_smfmac_f32_32x32x32_bf16 v[66:81], a[248:251], v[34:41], v253
    s_sub_u32 s36, s36, 128
    s_cselect_b32 s36, 1152, s36
    v_exp_f32 v59, v59
    v_exp_f32 v60, v60
    v_exp_f32 v61, v61
    v_smfmac_f32_32x32x32_bf16 v[66:81], a[252:255], v[42:49], v253
    global_load_lds_dwordx4 v113, s[62:63] offset:1088 sc0
    v_exp_f32 v62, v62
    v_exp_f32 v63, v63
    v_mfma_f32_16x16x32_bf16 v[166:169], a[24:27], a[4:7], 0
    ds_read_b128 a[56:59], v111 offset:8768
    v_exp_f32 v64, v64
    v_mfma_f32_16x16x32_bf16 v[174:177], a[28:31], a[4:7], 0
    ds_read_b128 a[60:63], v111 offset:10944
    v_exp_f32 v65, v65
    v_mfma_f32_32x32x8_bf16 v[34:49], a[246:247], v[108:109], 0
    v_exp_f32 v18, v18
    v_exp_f32 v19, v19
    v_exp_f32 v20, v20
    v_exp_f32 v21, v21
    v_mfma_f32_32x32x16_bf16 v[34:49], a[240:243], v[102:105], v[34:49]
    ds_read2st64_b64 a[244:247], v121 offset0:64 offset1:65
    ds_read_b128 a[240:243], v118 offset:30720
    v_exp_f32 v22, v22
    v_exp_f32 v23, v23
    v_mfma_f32_16x16x32_bf16 v[170:173], a[28:31], a[0:3], 0
    v_exp_f32 v24, v24
    v_mfma_f32_16x16x32_bf16 v[130:133], a[40:43], a[32:35], v[130:133]
    s_waitcnt vmcnt(7) lgkmcnt(2)
    s_barrier
    v_mfma_f32_16x16x32_bf16 v[134:137], a[40:43], a[36:39], v[134:137]
    ds_read_b128 a[0:3], v127 offset:30464
    v_exp_f32 v25, v25
    v_smfmac_f32_32x32x32_bf16 v[82:97], a[248:251], v[50:57], v253
    s_add_u32 s100, s100, s90
    s_lshl_b32 s100, s100, 7
    ds_read_b128 a[248:251], v120 offset:26112
    v_exp_f32 v26, v26
    v_exp_f32 v27, v27
    v_exp_f32 v28, v28
    v_smfmac_f32_32x32x32_bf16 v[82:97], a[252:255], v[58:65], v253
    ds_read_b128 a[252:255], v120 offset:26880
    v_exp_f32 v29, v29
    v_exp_f32 v30, v30
    v_exp_f32 v31, v31
    v_mfma_f32_16x16x32_bf16 v[142:145], a[44:47], a[36:39], v[142:145]
    ds_read_b128 a[8:11], v111 offset:30464
    v_exp_f32 v32, v32
    v_mfma_f32_16x16x32_bf16 v[138:141], a[44:47], a[32:35], v[138:141]
    s_waitcnt lgkmcnt(3)
    ds_read_b128 a[4:7], v127 offset:32640
    v_exp_f32 v33, v33
    v_mfma_f32_32x32x8_bf16 v[50:65], a[244:245], v[106:107], 0
    v_exp_f32 v34, v34
    v_exp_f32 v35, v35
    v_exp_f32 v36, v36
    v_mfma_f32_32x32x16_bf16 v[50:65], a[240:243], v[98:101], v[50:65]
    v_exp_f32 v37, v37
    v_exp_f32 v38, v38
    v_exp_f32 v39, v39
    v_mfma_f32_16x16x32_bf16 v[146:149], a[48:51], a[32:35], v[146:149]
    v_exp_f32 v40, v40
    v_mfma_f32_16x16x32_bf16 v[150:153], a[48:51], a[36:39], v[150:153]
    ds_read_b128 a[12:15], v111 offset:32640
    v_exp_f32 v41, v41
    v_mfma_f32_16x16x32_bf16 v[158:161], a[52:55], a[36:39], v[158:161]
    s_waitcnt lgkmcnt(2)
    ds_read_b128 a[16:19], v111 offset:34816
    v_exp_f32 v42, v42
    v_smfmac_f32_32x32x32_bf16 v[66:81], a[248:251], v[18:25], v253
    s_add_u32 m0, s21, 139264
    s_add_u32 s8, s100, 114688
    v_exp_f32 v43, v43
    v_exp_f32 v44, v44
    v_exp_f32 v45, v45
    v_smfmac_f32_32x32x32_bf16 v[66:81], a[252:255], v[26:33], v253
    s_add_u32 s68, s64, 311296
    s_addc_u32 s69, s65, 0
    v_exp_f32 v46, v46
    v_exp_f32 v47, v47
    v_exp_f32 v48, v48
    v_mfma_f32_16x16x32_bf16 v[154:157], a[52:55], a[32:35], v[154:157]
    s_cmp_gt_u32 s38, s84
    s_cselect_b32 s8, s8, 2130706432
    ds_read_b128 a[20:23], v111 offset:36992
    v_exp_f32 v49, v49
    v_mfma_f32_16x16x32_bf16 v[162:165], a[56:59], a[32:35], v[162:165]
    global_load_lds_dwordx4 v119, s[68:69] offset:0 sc1
    v_mfma_f32_16x16x32_bf16 v[166:169], a[56:59], a[36:39], v[166:169]
    ds_read_b128 a[24:27], v111 offset:39168
    global_load_lds_dwordx4 v119, s[68:69] offset:1024 sc1
    v_mfma_f32_32x32x8_bf16 v[18:33], a[244:245], v[108:109], 0
    v_exp_f32 v50, v50
    v_exp_f32 v51, v51
    v_exp_f32 v52, v52
    v_exp_f32 v53, v53
    v_mfma_f32_32x32x16_bf16 v[18:33], a[240:243], v[102:105], v[18:33]
    ds_read_b128 a[240:243], v118 offset:31744
    v_exp_f32 v54, v54
    v_exp_f32 v55, v55
    v_exp_f32 v56, v56
    v_mfma_f32_16x16x32_bf16 v[174:177], a[60:63], a[36:39], v[174:177]
    ds_read_b128 a[28:31], v111 offset:41344
    v_exp_f32 v57, v57
    v_mfma_f32_16x16x32_bf16 v[170:173], a[60:63], a[32:35], v[170:173]
    v_exp_f32 v58, v58
    v_mfma_f32_16x16x32_bf16 v[130:133], a[8:11], a[0:3], v[130:133]
    global_load_lds_dwordx4 v119, s[68:69] offset:2048 sc1
    v_exp_f32 v59, v59
    v_smfmac_f32_32x32x32_bf16 v[82:97], a[248:251], v[34:41], v253
    s_add_u32 m0, s7, 0
    s_cmp_eq_u32 s38, 0
    s_cselect_b32 s35, 2130706432, s35
    s_cselect_b32 s47, 2130706432, s47
    ds_read_b128 a[248:251], v120 offset:30720
    v_exp_f32 v60, v60
    v_exp_f32 v61, v61
    v_smfmac_f32_32x32x32_bf16 v[82:97], a[252:255], v[42:49], v253
    s_waitcnt lgkmcnt(2)
    s_add_u32 s54, s52, s36
    s_addc_u32 s55, s53, 0
    ds_read_b128 a[252:255], v120 offset:31488
    global_load_lds_dwordx4 v123, s[54:55] offset:0 sc0
    v_exp_f32 v62, v62
    v_exp_f32 v63, v63
    v_mfma_f32_16x16x32_bf16 v[134:137], a[8:11], a[4:7], v[134:137]
    s_mul_i32 s46, s89, 245760
    ds_read_b128 a[32:35], v127 offset:30528
    v_exp_f32 v64, v64
    v_mfma_f32_16x16x32_bf16 v[142:145], a[12:15], a[4:7], v[142:145]
    ds_read_b128 a[40:43], v111 offset:30528
    global_load_lds_dwordx4 v124, s[54:55] offset:1088 sc0
    v_exp_f32 v65, v65
    v_mfma_f32_32x32x8_bf16 v[34:49], a[246:247], v[106:107], 0
    v_exp_f32 v18, v18
    v_exp_f32 v19, v19
    v_exp_f32 v20, v20
    v_exp_f32 v21, v21
    v_mfma_f32_32x32x16_bf16 v[34:49], a[240:243], v[98:101], v[34:49]
    global_load_lds_dwordx4 v125, s[54:55] offset:2176 sc0
    v_exp_f32 v22, v22
    v_exp_f32 v23, v23
    v_exp_f32 v24, v24
    v_mfma_f32_16x16x32_bf16 v[138:141], a[12:15], a[0:3], v[138:141]
    ds_read_b128 a[36:39], v127 offset:32704
    v_exp_f32 v25, v25
    v_mfma_f32_16x16x32_bf16 v[146:149], a[16:19], a[0:3], v[146:149]
    v_exp_f32 v26, v26
    v_mfma_f32_16x16x32_bf16 v[150:153], a[16:19], a[4:7], v[150:153]
    s_waitcnt lgkmcnt(1)
    ds_read_b128 a[44:47], v111 offset:32704
    v_exp_f32 v27, v27
    v_smfmac_f32_32x32x32_bf16 v[66:81], a[248:251], v[50:57], v253
    s_add_u32 m0, s4, 13056
    s_lshl_b32 s100, s3, 10
    v_exp_f32 v28, v28
    v_exp_f32 v29, v29
    v_exp_f32 v30, v30
    v_smfmac_f32_32x32x32_bf16 v[66:81], a[252:255], v[58:65], v253
    s_add_u32 s58, s56, s36
    s_addc_u32 s59, s57, 0
    v_exp_f32 v31, v31
    v_exp_f32 v32, v32
    v_exp_f32 v33, v33
    v_mfma_f32_16x16x32_bf16 v[158:161], a[20:23], a[4:7], v[158:161]
    s_add_u32 s46, s46, s100
    ds_read_b128 a[48:51], v111 offset:34880
    global_load_lds_dwordx4 v112, s[58:59] offset:0 sc0
    v_mfma_f32_16x16x32_bf16 v[154:157], a[20:23], a[0:3], v[154:157]
    ds_read_b128 a[52:55], v111 offset:37056
    global_load_lds_dwordx4 v113, s[58:59] offset:1088 sc0
    v_mfma_f32_32x32x8_bf16 v[50:65], a[246:247], v[108:109], 0
    v_exp_f32 v34, v34
    v_exp_f32 v35, v35
    v_exp_f32 v36, v36
    v_exp_f32 v37, v37
    v_mfma_f32_32x32x16_bf16 v[50:65], a[240:243], v[102:105], v[50:65]
    s_add_u32 s46, s46, 4227072
    ds_read2st64_b64 a[244:247], v121 offset0:4 offset1:5
    ds_read_b128 a[240:243], v118 offset:0
    v_exp_f32 v38, v38
    v_exp_f32 v39, v39
    v_mfma_f32_16x16x32_bf16 v[162:165], a[24:27], a[0:3], v[162:165]
    s_lshl_b32 s100, s87, 2
    v_exp_f32 v40, v40
    v_exp_f32 v41, v41
    v_mfma_f32_16x16x32_bf16 v[166:169], a[24:27], a[4:7], v[166:169]
    ds_read_b128 a[56:59], v111 offset:39232
    v_exp_f32 v42, v42
    v_mfma_f32_16x16x32_bf16 v[174:177], a[28:31], a[4:7], v[174:177]
    s_add_u32 m0, s4, 15232
    ds_read_b128 a[60:63], v111 offset:41408
    v_exp_f32 v43, v43
    v_smfmac_f32_32x32x32_bf16 v[82:97], a[248:251], v[18:25], v253
    s_add_u32 s62, s60, s36
    s_addc_u32 s63, s61, 0
    ds_read_b128 a[248:251], v120 offset:32256
    global_load_lds_dwordx4 v112, s[62:63] offset:0 sc0
    v_exp_f32 v44, v44
    v_exp_f32 v45, v45
    v_smfmac_f32_32x32x32_bf16 v[82:97], a[252:255], v[26:33], v253
L_pad_n1:
    s_cmp_eq_u32 s37, 1
    s_cbranch_scc1 L_pad_n4
    s_sub_u32 s36, s36, 128
    s_cselect_b32 s36, 1152, s36
    ds_read_b128 a[252:255], v120 offset:33024
    v_exp_f32 v46, v46
    v_exp_f32 v47, v47
    v_mfma_f32_16x16x32_bf16 v[170:173], a[28:31], a[0:3], v[170:173]
    global_load_lds_dwordx4 v113, s[62:63] offset:1088 sc0
    v_exp_f32 v48, v48
    v_mfma_f32_16x16x32_bf16 v[130:133], a[40:43], a[32:35], v[130:133]
    s_waitcnt vmcnt(10) lgkmcnt(2)
    s_barrier
    v_mfma_f32_16x16x32_bf16 v[134:137], a[40:43], a[36:39], v[134:137]
    ds_read_b128 a[0:3], v127 offset:60928
    v_exp_f32 v49, v49
    v_mfma_f32_32x32x8_bf16 v[18:33], a[244:245], v[106:107], 0
    v_exp_f32 v50, v50
    v_exp_f32 v51, v51
    v_exp_f32 v52, v52
    v_exp_f32 v53, v53
    v_mfma_f32_32x32x16_bf16 v[18:33], a[240:243], v[98:101], v[18:33]
    s_add_u32 s100, s100, s84
    v_exp_f32 v54, v54
    v_exp_f32 v55, v55
    v_exp_f32 v56, v56
    v_exp_f32 v57, v57
    v_mfma_f32_16x16x32_bf16 v[142:145], a[44:47], a[36:39], v[142:145]
    s_mul_i32 s10, s100, 40960
    ds_read_b128 a[8:11], v126 offset:0
    v_exp_f32 v58, v58
    v_mfma_f32_16x16x32_bf16 v[138:141], a[44:47], a[32:35], v[138:141]
    ds_read_b128 a[4:7], v127 offset:63104
    v_exp_f32 v59, v59
    v_mfma_f32_16x16x32_bf16 v[146:149], a[48:51], a[32:35], v[146:149]
    s_waitcnt lgkmcnt(2)
    s_add_u32 m0, s7, 30464
    v_exp_f32 v60, v60
    v_smfmac_f32_32x32x32_bf16 v[66:81], a[248:251], v[34:41], v253
    s_add_u32 s54, s52, s36
    s_addc_u32 s55, s53, 0
    v_exp_f32 v61, v61
    v_exp_f32 v62, v62
    v_exp_f32 v63, v63
    v_smfmac_f32_32x32x32_bf16 v[66:81], a[252:255], v[42:49], v253
    global_load_lds_dwordx4 v123, s[54:55] offset:0 sc0
    v_exp_f32 v64, v64
    v_exp_f32 v65, v65
    v_mfma_f32_16x16x32_bf16 v[150:153], a[48:51], a[36:39], v[150:153]
    ds_read_b128 a[12:15], v126 offset:2176
    global_load_lds_dwordx4 v124, s[54:55] offset:1088 sc0
    v_mfma_f32_16x16x32_bf16 v[158:161], a[52:55], a[36:39], v[158:161]
    ds_read_b128 a[16:19], v126 offset:4352
    global_load_lds_dwordx4 v125, s[54:55] offset:2176 sc0
    v_mfma_f32_32x32x8_bf16 v[34:49], a[244:245], v[108:109], 0
    v_exp_f32 v18, v18
    v_exp_f32 v19, v19
    v_exp_f32 v20, v20
    v_exp_f32 v21, v21
    v_mfma_f32_32x32x16_bf16 v[34:49], a[240:243], v[102:105], v[34:49]
    s_add_u32 m0, s4, 43520
    ds_read_b128 a[240:243], v118 offset:1024
    v_exp_f32 v22, v22
    v_exp_f32 v23, v23
    v_exp_f32 v24, v24
    v_mfma_f32_16x16x32_bf16 v[154:157], a[52:55], a[32:35], v[154:157]
    s_add_u32 s58, s56, s36
    s_addc_u32 s59, s57, 0
    ds_read_b128 a[20:23], v126 offset:6528
    v_exp_f32 v25, v25
    v_mfma_f32_16x16x32_bf16 v[162:165], a[56:59], a[32:35], v[162:165]
    global_load_lds_dwordx4 v112, s[58:59] offset:0 sc0
    v_exp_f32 v26, v26
    v_mfma_f32_16x16x32_bf16 v[166:169], a[56:59], a[36:39], v[166:169]
    ds_read_b128 a[24:27], v126 offset:8704
    global_load_lds_dwordx4 v113, s[58:59] offset:1088 sc0
    v_smfmac_f32_32x32x32_bf16 v[82:97], a[248:251], v[50:57], v253
    s_add_u32 m0, s4, 45696
    s_mul_i32 s99, s85, 38912
    ds_read_b128 a[248:251], v120 offset:0
    v_exp_f32 v27, v27
    v_exp_f32 v28, v28
    v_smfmac_f32_32x32x32_bf16 v[82:97], a[252:255], v[58:65], v253
    s_add_u32 s62, s60, s36
    s_addc_u32 s63, s61, 0
    ds_read_b128 a[252:255], v120 offset:768
    v_exp_f32 v29, v29
    v_exp_f32 v30, v30
    v_exp_f32 v31, v31
    v_mfma_f32_16x16x32_bf16 v[174:177], a[60:63], a[36:39], v[174:177]
    s_sub_u32 s10, s10, s99
    ds_read_b128 a[28:31], v126 offset:10880
    v_exp_f32 v32, v32
    v_mfma_f32_16x16x32_bf16 v[170:173], a[60:63], a[32:35], v[170:173]
    s_waitcnt lgkmcnt(3)
    global_load_lds_dwordx4 v112, s[62:63] offset:0 sc0
    v_exp_f32 v33, v33
    v_mfma_f32_32x32x8_bf16 v[50:65], a[246:247], v[106:107], 0
    v_exp_f32 v34, v34
    v_exp_f32 v35, v35
    v_exp_f32 v36, v36
    v_mfma_f32_32x32x16_bf16 v[50:65], a[240:243], v[98:101], v[50:65]
    s_add_u32 s10, s10, 4231168
    v_exp_f32 v37, v37
    v_exp_f32 v38, v38
    v_exp_f32 v39, v39
    v_mfma_f32_16x16x32_bf16 v[130:133], a[8:11], a[0:3], v[130:133]
    s_mul_i32 s27, s100, 20480
    v_exp_f32 v40, v40
    v_mfma_f32_16x16x32_bf16 v[134:137], a[8:11], a[4:7], v[134:137]
    ds_read_b128 a[32:35], v127 offset:60992
    v_exp_f32 v41, v41
    v_mfma_f32_16x16x32_bf16 v[142:145], a[12:15], a[4:7], v[142:145]
    s_waitcnt lgkmcnt(1)
    ds_read_b128 a[40:43], v126 offset:64
    v_exp_f32 v42, v42
    v_smfmac_f32_32x32x32_bf16 v[66:81], a[248:251], v[18:25], v253
    s_sub_u32 s36, s36, 128
    s_cselect_b32 s36, 1152, s36
    v_exp_f32 v43, v43
    v_exp_f32 v44, v44
    v_smfmac_f32_32x32x32_bf16 v[66:81], a[252:255], v[26:33], v253
    global_load_lds_dwordx4 v113, s[62:63] offset:1088 sc0
    v_exp_f32 v45, v45
    v_exp_f32 v46, v46
    v_mfma_f32_16x16x32_bf16 v[138:141], a[12:15], a[0:3], v[138:141]
    ds_read_b128 a[36:39], v127 offset:63168
    v_exp_f32 v47, v47
    v_mfma_f32_16x16x32_bf16 v[146:149], a[16:19], a[0:3], v[146:149]
    v_exp_f32 v48, v48
    v_mfma_f32_16x16x32_bf16 v[150:153], a[16:19], a[4:7], v[150:153]
    ds_read_b128 a[44:47], v126 offset:2240
    v_exp_f32 v49, v49
    v_mfma_f32_32x32x8_bf16 v[18:33], a[246:247], v[108:109], 0
    v_exp_f32 v50, v50
    v_exp_f32 v51, v51
    v_exp_f32 v52, v52
    v_exp_f32 v53, v53
    v_mfma_f32_32x32x16_bf16 v[18:33], a[240:243], v[102:105], v[18:33]
    ds_read2st64_b64 a[244:247], v121 offset0:16 offset1:17
    ds_read_b128 a[240:243], v118 offset:6144
    v_exp_f32 v54, v54
    v_exp_f32 v55, v55
    v_exp_f32 v56, v56
    v_mfma_f32_16x16x32_bf16 v[158:161], a[20:23], a[4:7], v[158:161]
    ds_read_b128 a[48:51], v126 offset:4416
    v_exp_f32 v57, v57
    v_mfma_f32_16x16x32_bf16 v[154:157], a[20:23], a[0:3], v[154:157]
    ds_read_b128 a[52:55], v126 offset:6592
    v_exp_f32 v58, v58
    v_mfma_f32_16x16x32_bf16 v[162:165], a[24:27], a[0:3], v[162:165]
    v_exp_f32 v59, v59
    v_smfmac_f32_32x32x32_bf16 v[82:97], a[248:251], v[34:41], v253
    s_mul_i32 s99, s85, 12288
    s_sub_u32 s27, s27, s99
    ds_read_b128 a[248:251], v120 offset:1536
    v_exp_f32 v60, v60
    v_exp_f32 v61, v61
    v_smfmac_f32_32x32x32_bf16 v[82:97], a[252:255], v[42:49], v253
    s_add_u32 s93, s43, 0
    ds_read_b128 a[252:255], v120 offset:2304
    buffer_load_dword v252, v128, s[72:75], s93 offen
    v_exp_f32 v62, v62
    v_exp_f32 v63, v63
    v_mfma_f32_16x16x32_bf16 v[166:169], a[24:27], a[4:7], v[166:169]
    ds_read_b128 a[56:59], v126 offset:8768
    v_exp_f32 v64, v64
    v_mfma_f32_16x16x32_bf16 v[174:177], a[28:31], a[4:7], v[174:177]
    s_waitcnt lgkmcnt(3)
    ds_read_b128 a[60:63], v126 offset:10944
    v_exp_f32 v65, v65
    v_mfma_f32_32x32x8_bf16 v[34:49], a[244:245], v[106:107], 0
    v_exp_f32 v18, v18
    v_exp_f32 v19, v19
    v_exp_f32 v20, v20
    v_mfma_f32_32x32x16_bf16 v[34:49], a[240:243], v[98:101], v[34:49]
    v_exp_f32 v21, v21
    v_exp_f32 v22, v22
    v_exp_f32 v23, v23
    v_mfma_f32_16x16x32_bf16 v[170:173], a[28:31], a[0:3], v[170:173]
    v_exp_f32 v24, v24
    v_mfma_f32_16x16x32_bf16 v[130:133], a[40:43], a[32:35], v[130:133]
    s_waitcnt vmcnt(8) lgkmcnt(0)
    s_barrier
    v_mfma_f32_16x16x32_bf16 v[134:137], a[40:43], a[36:39], v[134:137]
    ds_read_b128 a[0:3], v127 offset:0
    v_exp_f32 v25, v25
    v_smfmac_f32_32x32x32_bf16 v[66:81], a[248:251], v[50:57], v253
    s_add_u32 s27, s27, 1609728
    s_mul_i32 s99, s100, 171
    v_exp_f32 v26, v26
    v_exp_f32 v27, v27
    v_exp_f32 v28, v28
    v_smfmac_f32_32x32x32_bf16 v[66:81], a[252:255], v[58:65], v253
    v_exp_f32 v29, v29
    v_exp_f32 v30, v30
    v_exp_f32 v31, v31
    v_mfma_f32_16x16x32_bf16 v[142:145], a[44:47], a[36:39], v[142:145]
    ds_read_b128 a[8:11], v111 offset:0
    v_exp_f32 v32, v32
    v_mfma_f32_16x16x32_bf16 v[138:141], a[44:47], a[32:35], v[138:141]
    ds_read_b128 a[4:7], v127 offset:2176
    v_exp_f32 v33, v33
    v_mfma_f32_32x32x8_bf16 v[50:65], a[244:245], v[108:109], 0
    v_exp_f32 v34, v34
    v_exp_f32 v35, v35
    v_exp_f32 v36, v36
    v_mfma_f32_32x32x16_bf16 v[50:65], a[240:243], v[102:105], v[50:65]
    ds_read_b128 a[240:243], v118 offset:7168
    v_exp_f32 v37, v37
    v_exp_f32 v38, v38
    v_exp_f32 v39, v39
    v_mfma_f32_16x16x32_bf16 v[146:149], a[48:51], a[32:35], v[146:149]
    v_exp_f32 v40, v40
    v_mfma_f32_16x16x32_bf16 v[150:153], a[48:51], a[36:39], v[150:153]
    ds_read_b128 a[12:15], v111 offset:2176
    v_exp_f32 v41, v41
    v_mfma_f32_16x16x32_bf16 v[158:161], a[52:55], a[36:39], v[158:161]
    ds_read_b128 a[16:19], v111 offset:4352
    v_exp_f32 v42, v42
    v_smfmac_f32_32x32x32_bf16 v[82:97], a[248:251], v[18:25], v253
    s_add_u32 m0, s21, 151552
    s_lshr_b32 s99, s99, 10
    ds_read_b128 a[248:251], v120 offset:6144
    v_exp_f32 v43, v43
    v_exp_f32 v44, v44
    v_smfmac_f32_32x32x32_bf16 v[82:97], a[252:255], v[26:33], v253
    s_add_u32 s68, s64, 323584
    s_addc_u32 s69, s65, 0
    ds_read_b128 a[252:255], v120 offset:6912
    global_load_lds_dwordx4 v119, s[68:69] offset:0 sc1
    v_exp_f32 v45, v45
    v_exp_f32 v46, v46
    v_mfma_f32_16x16x32_bf16 v[154:157], a[52:55], a[32:35], v[154:157]
    s_lshl_b32 s99, s99, 11
    ds_read_b128 a[20:23], v111 offset:6528
    v_exp_f32 v47, v47
    v_mfma_f32_16x16x32_bf16 v[162:165], a[56:59], a[32:35], v[162:165]
    global_load_lds_dwordx4 v119, s[68:69] offset:1024 sc1
    v_exp_f32 v48, v48
    v_mfma_f32_16x16x32_bf16 v[166:169], a[56:59], a[36:39], v[166:169]
    s_waitcnt lgkmcnt(3)
    ds_read_b128 a[24:27], v111 offset:8704
    v_exp_f32 v49, v49
    v_mfma_f32_32x32x8_bf16 v[18:33], a[246:247], v[106:107], 0
    v_exp_f32 v50, v50
    v_exp_f32 v51, v51
    v_exp_f32 v52, v52
    v_exp_f32 v53, v53
    v_mfma_f32_32x32x16_bf16 v[18:33], a[240:243], v[98:101], v[18:33]
    global_load_lds_dwordx4 v119, s[68:69] offset:2048 sc1
    v_exp_f32 v54, v54
    v_exp_f32 v55, v55
    v_exp_f32 v56, v56
    v_mfma_f32_16x16x32_bf16 v[174:177], a[60:63], a[36:39], v[174:177]
    ds_read_b128 a[28:31], v111 offset:10880
    v_exp_f32 v57, v57
    v_mfma_f32_16x16x32_bf16 v[170:173], a[60:63], a[32:35], v[170:173]
    v_exp_f32 v58, v58
    v_mfma_f32_16x16x32_bf16 v[130:133], a[8:11], a[0:3], v[130:133]
    s_waitcnt lgkmcnt(1)
    v_exp_f32 v59, v59
    v_smfmac_f32_32x32x32_bf16 v[66:81], a[248:251], v[34:41], v253
    s_add_u32 m0, s7, 60928
    s_add_u32 s9, s99, 114688
    v_exp_f32 v60, v60
    v_exp_f32 v61, v61
    v_exp_f32 v62, v62
    v_smfmac_f32_32x32x32_bf16 v[66:81], a[252:255], v[42:49], v253
    s_add_u32 s54, s52, s36
    s_addc_u32 s55, s53, 0
    v_exp_f32 v63, v63
    v_exp_f32 v64, v64
    v_exp_f32 v65, v65
    v_mfma_f32_16x16x32_bf16 v[134:137], a[8:11], a[4:7], v[134:137]
    s_lshl_b32 s99, s87, 10
    ds_read_b128 a[32:35], v127 offset:64
    global_load_lds_dwordx4 v123, s[54:55] offset:0 sc0
    v_mfma_f32_16x16x32_bf16 v[142:145], a[12:15], a[4:7], v[142:145]
    ds_read_b128 a[40:43], v111 offset:64
    global_load_lds_dwordx4 v124, s[54:55] offset:1088 sc0
    v_mfma_f32_32x32x8_bf16 v[34:49], a[246:247], v[108:109], 0
    v_exp_f32 v18, v18
    v_exp_f32 v19, v19
    v_exp_f32 v20, v20
    v_exp_f32 v21, v21
    v_mfma_f32_32x32x16_bf16 v[34:49], a[240:243], v[102:105], v[34:49]
    ds_read2st64_b64 a[244:247], v121 offset0:28 offset1:29
    ds_read_b128 a[240:243], v118 offset:12288
    v_exp_f32 v22, v22
    v_exp_f32 v23, v23
    v_exp_f32 v24, v24
    v_mfma_f32_16x16x32_bf16 v[138:141], a[12:15], a[0:3], v[138:141]
    ds_read_b128 a[36:39], v127 offset:2240
    v_exp_f32 v25, v25
    v_mfma_f32_16x16x32_bf16 v[146:149], a[16:19], a[0:3], v[146:149]
    global_load_lds_dwordx4 v125, s[54:55] offset:2176 sc0
    v_exp_f32 v26, v26
    v_mfma_f32_16x16x32_bf16 v[150:153], a[16:19], a[4:7], v[150:153]
    ds_read_b128 a[44:47], v111 offset:2240
    v_exp_f32 v27, v27
    v_smfmac_f32_32x32x32_bf16 v[82:97], a[248:251], v[50:57], v253
    s_add_u32 m0, s4, 73984
    s_add_u32 s99, s99, 163840
    ds_read_b128 a[248:251], v120 offset:7680
    v_exp_f32 v28, v28
    v_exp_f32 v29, v29
    v_smfmac_f32_32x32x32_bf16 v[82:97], a[252:255], v[58:65], v253
    s_add_u32 s58, s56, s36
    s_addc_u32 s59, s57, 0
    ds_read_b128 a[252:255], v120 offset:8448
    global_load_lds_dwordx4 v112, s[58:59] offset:0 sc0
    v_exp_f32 v30, v30
    v_exp_f32 v31, v31
    v_mfma_f32_16x16x32_bf16 v[158:161], a[20:23], a[4:7], v[158:161]
    s_lshl_b32 s95, s85, 9
    ds_read_b128 a[48:51], v111 offset:4416
    v_exp_f32 v32, v32
    v_mfma_f32_16x16x32_bf16 v[154:157], a[20:23], a[0:3], v[154:157]
    s_waitcnt lgkmcnt(3)
    ds_read_b128 a[52:55], v111 offset:6592
    global_load_lds_dwordx4 v113, s[58:59] offset:1088 sc0
    v_exp_f32 v33, v33
    v_mfma_f32_32x32x8_bf16 v[50:65], a[244:245], v[106:107], 0
    v_exp_f32 v34, v34
    v_exp_f32 v35, v35
    v_exp_f32 v36, v36
    v_mfma_f32_32x32x16_bf16 v[50:65], a[240:243], v[98:101], v[50:65]
    v_exp_f32 v37, v37
    v_exp_f32 v38, v38
    v_exp_f32 v39, v39
    v_mfma_f32_16x16x32_bf16 v[162:165], a[24:27], a[0:3], v[162:165]
    v_exp_f32 v40, v40
    v_mfma_f32_16x16x32_bf16 v[166:169], a[24:27], a[4:7], v[166:169]
    ds_read_b128 a[56:59], v111 offset:8768
    v_exp_f32 v41, v41
    v_mfma_f32_16x16x32_bf16 v[174:177], a[28:31], a[4:7], v[174:177]
    s_waitcnt lgkmcnt(1)
    ds_read_b128 a[60:63], v111 offset:10944
    v_exp_f32 v42, v42
    v_smfmac_f32_32x32x32_bf16 v[66:81], a[248:251], v[18:25], v253
    s_add_u32 m0, s4, 76160
    s_add_u32 s26, s99, s95
    v_exp_f32 v43, v43
    v_exp_f32 v44, v44
    v_exp_f32 v45, v45
    v_smfmac_f32_32x32x32_bf16 v[66:81], a[252:255], v[26:33], v253
    s_add_u32 s62, s60, s36
    s_addc_u32 s63, s61, 0
    v_exp_f32 v46, v46
    v_exp_f32 v47, v47
    v_exp_f32 v48, v48
    v_mfma_f32_16x16x32_bf16 v[170:173], a[28:31], a[0:3], v[170:173]
    global_load_lds_dwordx4 v112, s[62:63] offset:0 sc0
    v_exp_f32 v49, v49
    v_mfma_f32_16x16x32_bf16 v[130:133], a[40:43], a[32:35], v[130:133]
    s_waitcnt vmcnt(10) lgkmcnt(0)
    s_lshl_b32 s95, s88, 7
    s_barrier
    v_mfma_f32_16x16x32_bf16 v[134:137], a[40:43], a[36:39], v[134:137]
    s_sub_u32 s36, s36, 128
    s_cselect_b32 s36, 1152, s36
    ds_read_b128 a[0:3], v127 offset:30464
    global_load_lds_dwordx4 v113, s[62:63] offset:1088 sc0
    v_mfma_f32_32x32x8_bf16 v[18:33], a[244:245], v[108:109], 0
    v_exp_f32 v50, v50
    v_exp_f32 v51, v51
    v_exp_f32 v52, v52
    v_exp_f32 v53, v53
    v_mfma_f32_32x32x16_bf16 v[18:33], a[240:243], v[102:105], v[18:33]
    ds_read_b128 a[240:243], v118 offset:13312
    v_exp_f32 v54, v54
    v_exp_f32 v55, v55
    v_exp_f32 v56, v56
    v_mfma_f32_16x16x32_bf16 v[142:145], a[44:47], a[36:39], v[142:145]
    ds_read_b128 a[8:11], v111 offset:30464
    v_exp_f32 v57, v57
    v_mfma_f32_16x16x32_bf16 v[138:141], a[44:47], a[32:35], v[138:141]
    ds_read_b128 a[4:7], v127 offset:32640
    v_exp_f32 v58, v58
    v_mfma_f32_16x16x32_bf16 v[146:149], a[48:51], a[32:35], v[146:149]
    v_exp_f32 v59, v59
    v_smfmac_f32_32x32x32_bf16 v[82:97], a[248:251], v[34:41], v253
    s_add_u32 m0, s7, 0
    s_add_u32 s25, s99, s95
    ds_read_b128 a[248:251], v120 offset:12288
    v_exp_f32 v60, v60
    v_exp_f32 v61, v61
    v_smfmac_f32_32x32x32_bf16 v[82:97], a[252:255], v[42:49], v253
    s_add_u32 s54, s52, s36
    s_addc_u32 s55, s53, 0
    ds_read_b128 a[252:255], v120 offset:13056
    global_load_lds_dwordx4 v123, s[54:55] offset:0 sc0
    v_exp_f32 v62, v62
    v_exp_f32 v63, v63
    v_mfma_f32_16x16x32_bf16 v[150:153], a[48:51], a[36:39], v[150:153]
    s_cmp_eq_u32 s84, 0
    s_cselect_b32 s25, s25, 2130706432
    ds_read_b128 a[12:15], v111 offset:32640
    global_load_lds_dwordx4 v124, s[54:55] offset:1088 sc0
    v_exp_f32 v64, v64
    v_mfma_f32_16x16x32_bf16 v[158:161], a[52:55], a[36:39], v[158:161]
    s_waitcnt lgkmcnt(3)
    ds_read_b128 a[16:19], v111 offset:34816
    global_load_lds_dwordx4 v125, s[54:55] offset:2176 sc0
    v_exp_f32 v65, v65
    v_mfma_f32_32x32x8_bf16 v[34:49], a[246:247], v[106:107], 0
    v_exp_f32 v18, v18
    v_exp_f32 v19, v19
    v_exp_f32 v20, v20
    v_mfma_f32_32x32x16_bf16 v[34:49], a[240:243], v[98:101], v[34:49]
    s_add_u32 m0, s4, 13056
    v_exp_f32 v21, v21
    v_exp_f32 v22, v22
    v_exp_f32 v23, v23
    v_mfma_f32_16x16x32_bf16 v[154:157], a[52:55], a[32:35], v[154:157]
    s_add_u32 s58, s56, s36
    s_addc_u32 s59, s57, 0
    ds_read_b128 a[20:23], v111 offset:36992
    v_exp_f32 v24, v24
    v_mfma_f32_16x16x32_bf16 v[162:165], a[56:59], a[32:35], v[162:165]
    global_load_lds_dwordx4 v112, s[58:59] offset:0 sc0
    v_exp_f32 v25, v25
    v_mfma_f32_16x16x32_bf16 v[166:169], a[56:59], a[36:39], v[166:169]
    s_waitcnt lgkmcnt(1)
    ds_read_b128 a[24:27], v111 offset:39168
    global_load_lds_dwordx4 v113, s[58:59] offset:1088 sc0
    v_smfmac_f32_32x32x32_bf16 v[66:81], a[248:251], v[50:57], v253
    s_add_u32 m0, s4, 15232
    s_lshl_b32 s99, s87, 1
    v_exp_f32 v26, v26
    v_exp_f32 v27, v27
    v_exp_f32 v28, v28
    v_smfmac_f32_32x32x32_bf16 v[66:81], a[252:255], v[58:65], v253
    s_add_u32 s62, s60, s36
    s_addc_u32 s63, s61, 0
    v_exp_f32 v29, v29
    v_exp_f32 v30, v30
    v_exp_f32 v31, v31
    v_mfma_f32_16x16x32_bf16 v[174:177], a[60:63], a[36:39], v[174:177]
    s_add_u32 s99, s99, s85
    ds_read_b128 a[28:31], v111 offset:41344
    v_exp_f32 v32, v32
    v_mfma_f32_16x16x32_bf16 v[170:173], a[60:63], a[32:35], v[170:173]
    global_load_lds_dwordx4 v112, s[62:63] offset:0 sc0
    v_exp_f32 v33, v33
    v_mfma_f32_32x32x8_bf16 v[50:65], a[246:247], v[108:109], 0
    v_exp_f32 v34, v34
    v_exp_f32 v35, v35
    v_exp_f32 v36, v36
    v_exp_f32 v37, v37
    v_mfma_f32_32x32x16_bf16 v[50:65], a[240:243], v[102:105], v[50:65]
    ds_read2st64_b64 a[244:247], v121 offset0:40 offset1:41
    ds_read_b128 a[240:243], v118 offset:18432
    v_exp_f32 v38, v38
    v_exp_f32 v39, v39
    v_mfma_f32_16x16x32_bf16 v[130:133], a[8:11], a[0:3], v[130:133]
    v_exp_f32 v40, v40
    v_mfma_f32_16x16x32_bf16 v[134:137], a[8:11], a[4:7], v[134:137]
    ds_read_b128 a[32:35], v127 offset:30528
    v_exp_f32 v41, v41
    v_mfma_f32_16x16x32_bf16 v[142:145], a[12:15], a[4:7], v[142:145]
    ds_read_b128 a[40:43], v111 offset:30528
    v_exp_f32 v42, v42
    v_smfmac_f32_32x32x32_bf16 v[82:97], a[248:251], v[18:25], v253
    s_sub_u32 s36, s36, 128
    s_cselect_b32 s36, 1152, s36
    ds_read_b128 a[248:251], v120 offset:13824
    global_load_lds_dwordx4 v113, s[62:63] offset:1088 sc0
    v_exp_f32 v43, v43
    v_exp_f32 v44, v44
    v_smfmac_f32_32x32x32_bf16 v[82:97], a[252:255], v[26:33], v253
    s_add_u32 s93, s43, 2048
    s_lshl_b32 s100, s88, 1
    ds_read_b128 a[252:255], v120 offset:14592
    v_exp_f32 v45, v45
    v_exp_f32 v46, v46
    v_mfma_f32_16x16x32_bf16 v[138:141], a[12:15], a[0:3], v[138:141]
    s_add_u32 s100, s100, s86
    ds_read_b128 a[36:39], v127 offset:32704
    v_exp_f32 v47, v47
    v_mfma_f32_16x16x32_bf16 v[146:149], a[16:19], a[0:3], v[146:149]
    buffer_load_dword v252, v128, s[72:75], s93 offen
    v_exp_f32 v48, v48
    v_mfma_f32_16x16x32_bf16 v[150:153], a[16:19], a[4:7], v[150:153]
    s_waitcnt lgkmcnt(3)
    ds_read_b128 a[44:47], v111 offset:32704
    v_exp_f32 v49, v49
    v_mfma_f32_32x32x8_bf16 v[18:33], a[244:245], v[106:107], 0
    v_exp_f32 v50, v50
    v_exp_f32 v51, v51
    v_exp_f32 v52, v52
    v_mfma_f32_32x32x16_bf16 v[18:33], a[240:243], v[98:101], v[18:33]
    v_exp_f32 v53, v53
    v_exp_f32 v54, v54
    v_exp_f32 v55, v55
    v_mfma_f32_16x16x32_bf16 v[158:161], a[20:23], a[4:7], v[158:161]
    ds_read_b128 a[48:51], v111 offset:34880
    v_exp_f32 v56, v56
    v_mfma_f32_16x16x32_bf16 v[154:157], a[20:23], a[0:3], v[154:157]
    ds_read_b128 a[52:55], v111 offset:37056
    v_exp_f32 v57, v57
    v_mfma_f32_16x16x32_bf16 v[162:165], a[24:27], a[0:3], v[162:165]
    s_waitcnt lgkmcnt(2)
    v_exp_f32 v58, v58
    v_smfmac_f32_32x32x32_bf16 v[66:81], a[248:251], v[34:41], v253
    s_mul_i32 s99, s99, 40960
    s_add_u32 s99, s99, 1605632
    v_exp_f32 v59, v59
    v_exp_f32 v60, v60
    v_exp_f32 v61, v61
    v_smfmac_f32_32x32x32_bf16 v[66:81], a[252:255], v[42:49], v253
    v_exp_f32 v62, v62
    v_exp_f32 v63, v63
    v_exp_f32 v64, v64
    v_mfma_f32_16x16x32_bf16 v[166:169], a[24:27], a[4:7], v[166:169]
    ds_read_b128 a[56:59], v111 offset:39232
    v_exp_f32 v65, v65
    v_mfma_f32_16x16x32_bf16 v[174:177], a[28:31], a[4:7], v[174:177]
    ds_read_b128 a[60:63], v111 offset:41408
    v_mfma_f32_32x32x8_bf16 v[34:49], a[244:245], v[108:109], 0
    v_exp_f32 v18, v18
    v_exp_f32 v19, v19
    v_exp_f32 v20, v20
    v_exp_f32 v21, v21
    v_mfma_f32_32x32x16_bf16 v[34:49], a[240:243], v[102:105], v[34:49]
    ds_read_b128 a[240:243], v118 offset:19456
    v_exp_f32 v22, v22
    v_exp_f32 v23, v23
    v_exp_f32 v24, v24
    v_mfma_f32_16x16x32_bf16 v[170:173], a[28:31], a[0:3], v[170:173]
    v_exp_f32 v25, v25
    v_mfma_f32_16x16x32_bf16 v[130:133], a[40:43], a[32:35], v[130:133]
    s_waitcnt vmcnt(8) lgkmcnt(1)
    s_barrier
    v_mfma_f32_16x16x32_bf16 v[134:137], a[40:43], a[36:39], v[134:137]
    ds_read_b128 a[0:3], v127 offset:60928
    v_exp_f32 v26, v26
    v_smfmac_f32_32x32x32_bf16 v[82:97], a[248:251], v[50:57], v253
    s_lshl_b32 s11, s100, 10
    s_add_u32 s11, s11, s99
    ds_read_b128 a[248:251], v120 offset:18432
    v_exp_f32 v27, v27
    v_exp_f32 v28, v28
    v_smfmac_f32_32x32x32_bf16 v[82:97], a[252:255], v[58:65], v253
    ds_read_b128 a[252:255], v120 offset:19200
    v_exp_f32 v29, v29
    v_exp_f32 v30, v30
    v_exp_f32 v31, v31
    v_mfma_f32_16x16x32_bf16 v[142:145], a[44:47], a[36:39], v[142:145]
    ds_read_b128 a[8:11], v126 offset:0
    v_exp_f32 v32, v32
    v_mfma_f32_16x16x32_bf16 v[138:141], a[44:47], a[32:35], v[138:141]
    s_waitcnt lgkmcnt(4)
    ds_read_b128 a[4:7], v127 offset:63104
    v_exp_f32 v33, v33
    v_mfma_f32_32x32x8_bf16 v[50:65], a[246:247], v[106:107], 0
    v_exp_f32 v34, v34
    v_exp_f32 v35, v35
    v_exp_f32 v36, v36
    v_mfma_f32_32x32x16_bf16 v[50:65], a[240:243], v[98:101], v[50:65]
    v_exp_f32 v37, v37
    v_exp_f32 v38, v38
    v_exp_f32 v39, v39
    v_mfma_f32_16x16x32_bf16 v[146:149], a[48:51], a[32:35], v[146:149]
    v_exp_f32 v40, v40
    v_mfma_f32_16x16x32_bf16 v[150:153], a[48:51], a[36:39], v[150:153]
    ds_read_b128 a[12:15], v126 offset:2176
    v_exp_f32 v41, v41
    v_mfma_f32_16x16x32_bf16 v[158:161], a[52:55], a[36:39], v[158:161]
    s_waitcnt lgkmcnt(2)
    ds_read_b128 a[16:19], v126 offset:4352
    v_exp_f32 v42, v42
    v_smfmac_f32_32x32x32_bf16 v[66:81], a[248:251], v[18:25], v253
    s_add_u32 m0, s21, 126976
    s_lshl_b32 s24, s100, 8
    v_exp_f32 v43, v43
    v_exp_f32 v44, v44
    v_exp_f32 v45, v45
    v_smfmac_f32_32x32x32_bf16 v[66:81], a[252:255], v[26:33], v253
    s_add_u32 s68, s64, 335872
    s_addc_u32 s69, s65, 0
    v_exp_f32 v46, v46
    v_exp_f32 v47, v47
    v_exp_f32 v48, v48
    v_mfma_f32_16x16x32_bf16 v[154:157], a[52:55], a[32:35], v[154:157]
    s_add_u32 s24, s24, s99
    ds_read_b128 a[20:23], v126 offset:6528
    v_exp_f32 v49, v49
    v_mfma_f32_16x16x32_bf16 v[162:165], a[56:59], a[32:35], v[162:165]
    global_load_lds_dwordx4 v119, s[68:69] offset:0 sc1
    v_mfma_f32_16x16x32_bf16 v[166:169], a[56:59], a[36:39], v[166:169]
    ds_read_b128 a[24:27], v126 offset:8704
    global_load_lds_dwordx4 v119, s[68:69] offset:1024 sc1
    v_mfma_f32_32x32x8_bf16 v[18:33], a[246:247], v[108:109], 0
    v_exp_f32 v50, v50
    v_exp_f32 v51, v51
    v_exp_f32 v52, v52
    v_exp_f32 v53, v53
    v_mfma_f32_32x32x16_bf16 v[18:33], a[240:243], v[102:105], v[18:33]
    ds_read2st64_b64 a[244:247], v121 offset0:52 offset1:53
    ds_read_b128 a[240:243], v118 offset:24576
    v_exp_f32 v54, v54
    v_exp_f32 v55, v55
    v_exp_f32 v56, v56
    v_mfma_f32_16x16x32_bf16 v[174:177], a[60:63], a[36:39], v[174:177]
    ds_read_b128 a[28:31], v126 offset:10880
    v_exp_f32 v57, v57
    v_mfma_f32_16x16x32_bf16 v[170:173], a[60:63], a[32:35], v[170:173]
    v_exp_f32 v58, v58
    v_mfma_f32_16x16x32_bf16 v[130:133], a[8:11], a[0:3], v[130:133]
    global_load_lds_dwordx4 v119, s[68:69] offset:2048 sc1
    v_exp_f32 v59, v59
    v_smfmac_f32_32x32x32_bf16 v[82:97], a[248:251], v[34:41], v253
    s_add_u32 m0, s7, 30464
    s_add_u32 s24, s24, 16384
    ds_read_b128 a[248:251], v120 offset:19968
    v_exp_f32 v60, v60
    v_exp_f32 v61, v61
    v_smfmac_f32_32x32x32_bf16 v[82:97], a[252:255], v[42:49], v253
    s_waitcnt lgkmcnt(2)
    s_add_u32 s54, s52, s36
    s_addc_u32 s55, s53, 0
    ds_read_b128 a[252:255], v120 offset:20736
    global_load_lds_dwordx4 v123, s[54:55] offset:0 sc0
    v_exp_f32 v62, v62
    v_exp_f32 v63, v63
    v_mfma_f32_16x16x32_bf16 v[134:137], a[8:11], a[4:7], v[134:137]
    s_mov_b32 s82, 10485760
    ds_read_b128 a[32:35], v127 offset:60992
    v_exp_f32 v64, v64
    v_mfma_f32_16x16x32_bf16 v[142:145], a[12:15], a[4:7], v[142:145]
    ds_read_b128 a[40:43], v126 offset:64
    global_load_lds_dwordx4 v124, s[54:55] offset:1088 sc0
    v_exp_f32 v65, v65
    v_mfma_f32_32x32x8_bf16 v[34:49], a[244:245], v[106:107], 0
    v_exp_f32 v18, v18
    v_exp_f32 v19, v19
    v_exp_f32 v20, v20
    v_exp_f32 v21, v21
    v_mfma_f32_32x32x16_bf16 v[34:49], a[240:243], v[98:101], v[34:49]
    global_load_lds_dwordx4 v125, s[54:55] offset:2176 sc0
    v_exp_f32 v22, v22
    v_exp_f32 v23, v23
    v_exp_f32 v24, v24
    v_mfma_f32_16x16x32_bf16 v[138:141], a[12:15], a[0:3], v[138:141]
    ds_read_b128 a[36:39], v127 offset:63168
    v_exp_f32 v25, v25
    v_mfma_f32_16x16x32_bf16 v[146:149], a[16:19], a[0:3], v[146:149]
    v_exp_f32 v26, v26
    v_mfma_f32_16x16x32_bf16 v[150:153], a[16:19], a[4:7], v[150:153]
    s_waitcnt lgkmcnt(1)
    ds_read_b128 a[44:47], v126 offset:2240
    v_exp_f32 v27, v27
    v_smfmac_f32_32x32x32_bf16 v[66:81], a[248:251], v[50:57], v253
    s_add_u32 m0, s4, 43520
    s_mov_b32 s83, 0x00020000
    v_exp_f32 v28, v28
    v_exp_f32 v29, v29
    v_exp_f32 v30, v30
    v_smfmac_f32_32x32x32_bf16 v[66:81], a[252:255], v[58:65], v253
    s_add_u32 s58, s56, s36
    s_addc_u32 s59, s57, 0
    v_exp_f32 v31, v31
    v_exp_f32 v32, v32
    v_exp_f32 v33, v33
    v_mfma_f32_16x16x32_bf16 v[158:161], a[20:23], a[4:7], v[158:161]
    s_lshl_b32 s99, s91, 1
    ds_read_b128 a[48:51], v126 offset:4416
    global_load_lds_dwordx4 v112, s[58:59] offset:0 sc0
    v_mfma_f32_16x16x32_bf16 v[154:157], a[20:23], a[0:3], v[154:157]
    ds_read_b128 a[52:55], v126 offset:6592
    global_load_lds_dwordx4 v113, s[58:59] offset:1088 sc0
    v_mfma_f32_32x32x8_bf16 v[50:65], a[244:245], v[108:109], 0
    v_exp_f32 v34, v34
    v_exp_f32 v35, v35
    v_exp_f32 v36, v36
    v_exp_f32 v37, v37
    v_mfma_f32_32x32x16_bf16 v[50:65], a[240:243], v[102:105], v[50:65]
    s_add_u32 s99, s99, s92
    ds_read_b128 a[240:243], v118 offset:25600
    v_exp_f32 v38, v38
    v_exp_f32 v39, v39
    v_exp_f32 v40, v40
    v_mfma_f32_16x16x32_bf16 v[162:165], a[24:27], a[0:3], v[162:165]
    s_add_u32 s100, s99, s28
    v_exp_f32 v41, v41
    v_mfma_f32_16x16x32_bf16 v[166:169], a[24:27], a[4:7], v[166:169]
    ds_read_b128 a[56:59], v126 offset:8768
    v_exp_f32 v42, v42
    v_mfma_f32_16x16x32_bf16 v[174:177], a[28:31], a[4:7], v[174:177]
L_pad_n2:
    s_cmp_eq_u32 s37, 1
    s_cbranch_scc1 L_pad_n5
    s_add_u32 m0, s4, 45696
    ds_read_b128 a[60:63], v126 offset:10944
    v_exp_f32 v43, v43
    v_smfmac_f32_32x32x32_bf16 v[82:97], a[248:251], v[18:25], v253
    s_add_u32 s62, s60, s36
    s_addc_u32 s63, s61, 0
    ds_read_b128 a[248:251], v120 offset:24576
    global_load_lds_dwordx4 v112, s[62:63] offset:0 sc0
    v_exp_f32 v44, v44
    v_exp_f32 v45, v45
    v_smfmac_f32_32x32x32_bf16 v[82:97], a[252:255], v[26:33], v253
    s_sub_u32 s36, s36, 128
    s_cselect_b32 s36, 1152, s36
    ds_read_b128 a[252:255], v120 offset:25344
    v_exp_f32 v46, v46
    v_exp_f32 v47, v47
    v_mfma_f32_16x16x32_bf16 v[170:173], a[28:31], a[0:3], v[170:173]
    global_load_lds_dwordx4 v113, s[62:63] offset:1088 sc0
    v_exp_f32 v48, v48
    v_mfma_f32_16x16x32_bf16 v[130:133], a[40:43], a[32:35], v[130:133]
    s_waitcnt vmcnt(11) lgkmcnt(2)
    s_barrier
    v_mfma_f32_16x16x32_bf16 v[134:137], a[40:43], a[36:39], v[134:137]
    ds_read_b128 a[0:3], v127 offset:0
    v_exp_f32 v49, v49
    v_mfma_f32_32x32x8_bf16 v[18:33], a[246:247], v[106:107], 0
    v_exp_f32 v50, v50
    v_exp_f32 v51, v51
    v_exp_f32 v52, v52
    v_exp_f32 v53, v53
    v_mfma_f32_32x32x16_bf16 v[18:33], a[240:243], v[98:101], v[18:33]
    s_lshl_b32 s16, s100, 1
    v_exp_f32 v54, v54
    v_exp_f32 v55, v55
    v_exp_f32 v56, v56
    v_mfma_f32_16x16x32_bf16 v[142:145], a[44:47], a[36:39], v[142:145]
    s_add_u32 s17, s16, 40960
    ds_read_b128 a[8:11], v111 offset:0
    v_exp_f32 v57, v57
    v_mfma_f32_16x16x32_bf16 v[138:141], a[44:47], a[32:35], v[138:141]
    ds_read_b128 a[4:7], v127 offset:2176
    v_exp_f32 v58, v58
    v_mfma_f32_16x16x32_bf16 v[146:149], a[48:51], a[32:35], v[146:149]
    s_waitcnt lgkmcnt(2)
    v_exp_f32 v59, v59
    v_smfmac_f32_32x32x32_bf16 v[66:81], a[248:251], v[34:41], v253
    global_load_dwordx4 v[224:227], v110, s[48:49] offset:-4096
    v_exp_f32 v60, v60
    v_exp_f32 v61, v61
    v_smfmac_f32_32x32x32_bf16 v[66:81], a[252:255], v[42:49], v253
    global_load_dwordx4 v[228:231], v110, s[48:49] offset:-3072
    v_exp_f32 v62, v62
    v_exp_f32 v63, v63
    v_mfma_f32_16x16x32_bf16 v[150:153], a[48:51], a[36:39], v[150:153]
    ds_read_b128 a[12:15], v111 offset:2176
    v_exp_f32 v64, v64
    v_mfma_f32_16x16x32_bf16 v[158:161], a[52:55], a[36:39], v[158:161]
    ds_read_b128 a[16:19], v111 offset:4352
    v_exp_f32 v65, v65
    v_mfma_f32_32x32x8_bf16 v[34:49], a[246:247], v[108:109], 0
    v_exp_f32 v18, v18
    v_exp_f32 v19, v19
    v_exp_f32 v20, v20
    v_exp_f32 v21, v21
    v_mfma_f32_32x32x16_bf16 v[34:49], a[240:243], v[102:105], v[34:49]
    ds_read2st64_b64 a[244:247], v121 offset0:64 offset1:65
    ds_read_b128 a[240:243], v118 offset:30720
    v_exp_f32 v22, v22
    v_exp_f32 v23, v23
    v_exp_f32 v24, v24
    v_mfma_f32_16x16x32_bf16 v[154:157], a[52:55], a[32:35], v[154:157]
    ds_read_b128 a[20:23], v111 offset:6528
    v_exp_f32 v25, v25
    v_mfma_f32_16x16x32_bf16 v[162:165], a[56:59], a[32:35], v[162:165]
    v_exp_f32 v26, v26
    v_mfma_f32_16x16x32_bf16 v[166:169], a[56:59], a[36:39], v[166:169]
    ds_read_b128 a[24:27], v111 offset:8704
    v_exp_f32 v27, v27
    v_smfmac_f32_32x32x32_bf16 v[82:97], a[248:251], v[50:57], v253
    s_add_u32 s100, s99, s29
    s_lshl_b32 s40, s100, 1
    ds_read_b128 a[248:251], v120 offset:26112
    v_exp_f32 v28, v28
    v_exp_f32 v29, v29
    v_smfmac_f32_32x32x32_bf16 v[82:97], a[252:255], v[58:65], v253
    ds_read_b128 a[252:255], v120 offset:26880
    global_load_dwordx4 v[232:235], v110, s[48:49] offset:-2048
    v_exp_f32 v30, v30
    v_exp_f32 v31, v31
    v_mfma_f32_16x16x32_bf16 v[174:177], a[60:63], a[36:39], v[174:177]
    ds_read_b128 a[28:31], v111 offset:10880
    v_exp_f32 v32, v32
    v_mfma_f32_16x16x32_bf16 v[170:173], a[60:63], a[32:35], v[170:173]
    s_waitcnt lgkmcnt(4)
    global_load_dwordx4 v[236:239], v110, s[48:49] offset:-1024
    v_exp_f32 v33, v33
    v_mfma_f32_32x32x8_bf16 v[50:65], a[244:245], v[106:107], 0
    v_exp_f32 v34, v34
    v_exp_f32 v35, v35
    v_exp_f32 v36, v36
    v_mfma_f32_32x32x16_bf16 v[50:65], a[240:243], v[98:101], v[50:65]
    global_load_dwordx4 v[240:243], v110, s[48:49] offset:0
    v_exp_f32 v37, v37
    v_exp_f32 v38, v38
    v_exp_f32 v39, v39
    v_mfma_f32_16x16x32_bf16 v[130:133], a[8:11], a[0:3], v[130:133]
    global_load_dwordx4 v[244:247], v110, s[48:49] offset:1024
    v_exp_f32 v40, v40
    v_mfma_f32_16x16x32_bf16 v[134:137], a[8:11], a[4:7], v[134:137]
    ds_read_b128 a[32:35], v127 offset:64
    v_exp_f32 v41, v41
    v_mfma_f32_16x16x32_bf16 v[142:145], a[12:15], a[4:7], v[142:145]
    s_waitcnt lgkmcnt(1)
    ds_read_b128 a[40:43], v111 offset:64
    v_exp_f32 v42, v42
    v_smfmac_f32_32x32x32_bf16 v[66:81], a[248:251], v[18:25], v253
    s_add_u32 m0, s7, 60928
    v_exp_f32 v43, v43
    v_exp_f32 v44, v44
    v_exp_f32 v45, v45
    v_smfmac_f32_32x32x32_bf16 v[66:81], a[252:255], v[26:33], v253
    s_add_u32 s54, s52, s36
    s_addc_u32 s55, s53, 0
    v_exp_f32 v46, v46
    v_exp_f32 v47, v47
    v_exp_f32 v48, v48
    v_mfma_f32_16x16x32_bf16 v[138:141], a[12:15], a[0:3], v[138:141]
    ds_read_b128 a[36:39], v127 offset:2240
    v_mfma_f32_16x16x32_bf16 v[146:149], a[16:19], a[0:3], v[146:149]
    global_load_lds_dwordx4 v123, s[54:55] offset:0 sc0
    v_mfma_f32_16x16x32_bf16 v[150:153], a[16:19], a[4:7], v[150:153]
    ds_read_b128 a[44:47], v111 offset:2240
    v_exp_f32 v49, v49
    v_mfma_f32_32x32x8_bf16 v[18:33], a[244:245], v[108:109], 0
    v_exp_f32 v50, v50
    v_exp_f32 v51, v51
    v_exp_f32 v52, v52
    v_exp_f32 v53, v53
    v_mfma_f32_32x32x16_bf16 v[18:33], a[240:243], v[102:105], v[18:33]
    ds_read_b128 a[240:243], v118 offset:31744
    global_load_lds_dwordx4 v124, s[54:55] offset:1088 sc0
    v_exp_f32 v54, v54
    v_exp_f32 v55, v55
    v_exp_f32 v56, v56
    v_mfma_f32_16x16x32_bf16 v[158:161], a[20:23], a[4:7], v[158:161]
    ds_read_b128 a[48:51], v111 offset:4416
    v_exp_f32 v57, v57
    v_mfma_f32_16x16x32_bf16 v[154:157], a[20:23], a[0:3], v[154:157]
    ds_read_b128 a[52:55], v111 offset:6592
    v_exp_f32 v58, v58
    v_mfma_f32_16x16x32_bf16 v[162:165], a[24:27], a[0:3], v[162:165]
    global_load_lds_dwordx4 v125, s[54:55] offset:2176 sc0
    v_exp_f32 v59, v59
    v_smfmac_f32_32x32x32_bf16 v[82:97], a[248:251], v[34:41], v253
    s_add_u32 m0, s4, 73984
    ds_read_b128 a[248:251], v120 offset:30720
    v_exp_f32 v60, v60
    v_exp_f32 v61, v61
    v_smfmac_f32_32x32x32_bf16 v[82:97], a[252:255], v[42:49], v253
    s_add_u32 s58, s56, s36
    s_addc_u32 s59, s57, 0
    ds_read_b128 a[252:255], v120 offset:31488
    global_load_lds_dwordx4 v112, s[58:59] offset:0 sc0
    v_exp_f32 v62, v62
    v_exp_f32 v63, v63
    v_mfma_f32_16x16x32_bf16 v[166:169], a[24:27], a[4:7], v[166:169]
    ds_read_b128 a[56:59], v111 offset:8768
    v_exp_f32 v64, v64
    v_mfma_f32_16x16x32_bf16 v[174:177], a[28:31], a[4:7], v[174:177]
    s_waitcnt lgkmcnt(3)
    ds_read_b128 a[60:63], v111 offset:10944
    v_exp_f32 v65, v65
    v_mfma_f32_32x32x8_bf16 v[34:49], a[246:247], v[106:107], 0
    v_exp_f32 v18, v18
    v_exp_f32 v19, v19
    v_exp_f32 v20, v20
    v_exp_f32 v21, v21
    v_mfma_f32_32x32x16_bf16 v[34:49], a[240:243], v[98:101], v[34:49]
    global_load_lds_dwordx4 v113, s[58:59] offset:1088 sc0
    v_exp_f32 v22, v22
    v_exp_f32 v23, v23
    v_exp_f32 v24, v24
    v_mfma_f32_16x16x32_bf16 v[170:173], a[28:31], a[0:3], v[170:173]
    v_exp_f32 v25, v25
    v_mfma_f32_16x16x32_bf16 v[130:133], a[40:43], a[32:35], v[130:133]
    s_waitcnt vmcnt(11) lgkmcnt(0)
    s_barrier
    v_mfma_f32_16x16x32_bf16 v[134:137], a[40:43], a[36:39], v[134:137]
    ds_read_b128 a[0:3], v127 offset:30464
    v_exp_f32 v26, v26
    v_smfmac_f32_32x32x32_bf16 v[66:81], a[248:251], v[50:57], v253
    s_add_u32 m0, s4, 76160
    v_exp_f32 v27, v27
    v_exp_f32 v28, v28
    v_exp_f32 v29, v29
    v_smfmac_f32_32x32x32_bf16 v[66:81], a[252:255], v[58:65], v253
    s_add_u32 s62, s60, s36
    s_addc_u32 s63, s61, 0
    v_exp_f32 v30, v30
    v_exp_f32 v31, v31
    v_exp_f32 v32, v32
    v_mfma_f32_16x16x32_bf16 v[142:145], a[44:47], a[36:39], v[142:145]
    ds_read_b128 a[8:11], v111 offset:30464
    global_load_lds_dwordx4 v112, s[62:63] offset:0 sc0
    v_mfma_f32_16x16x32_bf16 v[138:141], a[44:47], a[32:35], v[138:141]
    s_sub_u32 s36, s36, 128
    s_cselect_b32 s36, 1152, s36
    ds_read_b128 a[4:7], v127 offset:32640
    global_load_lds_dwordx4 v113, s[62:63] offset:1088 sc0
    v_exp_f32 v33, v33
    v_mfma_f32_32x32x8_bf16 v[50:65], a[246:247], v[108:109], 0
    v_exp_f32 v34, v34
    v_exp_f32 v35, v35
    v_exp_f32 v36, v36
    v_exp_f32 v37, v37
    v_mfma_f32_32x32x16_bf16 v[50:65], a[240:243], v[102:105], v[50:65]
    s_add_u32 s93, s43, 4096
    ds_read2st64_b64 a[244:247], v121 offset0:4 offset1:5
    ds_read_b128 a[240:243], v118 offset:0
    v_exp_f32 v38, v38
    v_exp_f32 v39, v39
    v_mfma_f32_16x16x32_bf16 v[146:149], a[48:51], a[32:35], v[146:149]
    buffer_load_dword v252, v128, s[72:75], s93 offen
    v_exp_f32 v40, v40
    v_mfma_f32_16x16x32_bf16 v[150:153], a[48:51], a[36:39], v[150:153]
    ds_read_b128 a[12:15], v111 offset:32640
    v_exp_f32 v41, v41
    v_mfma_f32_16x16x32_bf16 v[158:161], a[52:55], a[36:39], v[158:161]
    ds_read_b128 a[16:19], v111 offset:34816
    v_exp_f32 v42, v42
    v_smfmac_f32_32x32x32_bf16 v[82:97], a[248:251], v[18:25], v253
    s_add_u32 m0, s21, 139264
    ds_read_b128 a[248:251], v120 offset:32256
    v_exp_f32 v43, v43
    v_exp_f32 v44, v44
    v_smfmac_f32_32x32x32_bf16 v[82:97], a[252:255], v[26:33], v253
    s_add_u32 s68, s64, 348160
    s_addc_u32 s69, s65, 0
    ds_read_b128 a[252:255], v120 offset:33024
    v_exp_f32 v45, v45
    v_exp_f32 v46, v46
    v_mfma_f32_16x16x32_bf16 v[154:157], a[52:55], a[32:35], v[154:157]
    ds_read_b128 a[20:23], v111 offset:36992
    v_exp_f32 v47, v47
    v_mfma_f32_16x16x32_bf16 v[162:165], a[56:59], a[32:35], v[162:165]
    global_load_lds_dwordx4 v119, s[68:69] offset:0 sc1
    v_exp_f32 v48, v48
    v_mfma_f32_16x16x32_bf16 v[166:169], a[56:59], a[36:39], v[166:169]
    s_waitcnt lgkmcnt(3)
    ds_read_b128 a[24:27], v111 offset:39168
    v_exp_f32 v49, v49
    v_mfma_f32_32x32x8_bf16 v[18:33], a[244:245], v[106:107], 0
    v_exp_f32 v50, v50
    v_exp_f32 v51, v51
    v_exp_f32 v52, v52
    v_mfma_f32_32x32x16_bf16 v[18:33], a[240:243], v[98:101], v[18:33]
    global_load_lds_dwordx4 v119, s[68:69] offset:1024 sc1
    v_exp_f32 v53, v53
    v_exp_f32 v54, v54
    v_exp_f32 v55, v55
    v_mfma_f32_16x16x32_bf16 v[174:177], a[60:63], a[36:39], v[174:177]
    ds_read_b128 a[28:31], v111 offset:41344
    v_exp_f32 v56, v56
    v_mfma_f32_16x16x32_bf16 v[170:173], a[60:63], a[32:35], v[170:173]
    v_exp_f32 v57, v57
    v_mfma_f32_16x16x32_bf16 v[130:133], a[8:11], a[0:3], v[130:133]
    s_waitcnt lgkmcnt(1)
    global_load_lds_dwordx4 v119, s[68:69] offset:2048 sc1
    v_exp_f32 v58, v58
    v_smfmac_f32_32x32x32_bf16 v[66:81], a[248:251], v[34:41], v253
    s_add_u32 m0, s7, 0
    v_exp_f32 v59, v59
    v_exp_f32 v60, v60
    v_exp_f32 v61, v61
    v_smfmac_f32_32x32x32_bf16 v[66:81], a[252:255], v[42:49], v253
    s_add_u32 s54, s52, s36
    s_addc_u32 s55, s53, 0
    v_exp_f32 v62, v62
    v_exp_f32 v63, v63
    v_exp_f32 v64, v64
    v_mfma_f32_16x16x32_bf16 v[134:137], a[8:11], a[4:7], v[134:137]
    ds_read_b128 a[32:35], v127 offset:30528
    v_exp_f32 v65, v65
    v_mfma_f32_16x16x32_bf16 v[142:145], a[12:15], a[4:7], v[142:145]
    ds_read_b128 a[40:43], v111 offset:30528
    global_load_lds_dwordx4 v123, s[54:55] offset:0 sc0
    v_mfma_f32_32x32x8_bf16 v[34:49], a[244:245], v[108:109], 0
    v_exp_f32 v18, v18
    v_exp_f32 v19, v19
    v_exp_f32 v20, v20
    v_exp_f32 v21, v21
    v_mfma_f32_32x32x16_bf16 v[34:49], a[240:243], v[102:105], v[34:49]
    ds_read_b128 a[240:243], v118 offset:1024
    global_load_lds_dwordx4 v124, s[54:55] offset:1088 sc0
    v_exp_f32 v22, v22
    v_exp_f32 v23, v23
    v_exp_f32 v24, v24
    v_mfma_f32_16x16x32_bf16 v[138:141], a[12:15], a[0:3], v[138:141]
    ds_read_b128 a[36:39], v127 offset:32704
    v_exp_f32 v25, v25
    v_mfma_f32_16x16x32_bf16 v[146:149], a[16:19], a[0:3], v[146:149]
    global_load_lds_dwordx4 v125, s[54:55] offset:2176 sc0
    v_exp_f32 v26, v26
    v_mfma_f32_16x16x32_bf16 v[150:153], a[16:19], a[4:7], v[150:153]
    ds_read_b128 a[44:47], v111 offset:32704
    v_exp_f32 v27, v27
    v_smfmac_f32_32x32x32_bf16 v[82:97], a[248:251], v[50:57], v253
    s_add_u32 m0, s4, 13056
    ds_read_b128 a[248:251], v120 offset:0
    v_exp_f32 v28, v28
    v_exp_f32 v29, v29
    v_smfmac_f32_32x32x32_bf16 v[82:97], a[252:255], v[58:65], v253
    s_add_u32 s58, s56, s36
    s_addc_u32 s59, s57, 0
    ds_read_b128 a[252:255], v120 offset:768
    global_load_lds_dwordx4 v112, s[58:59] offset:0 sc0
    v_exp_f32 v30, v30
    v_exp_f32 v31, v31
    v_mfma_f32_16x16x32_bf16 v[158:161], a[20:23], a[4:7], v[158:161]
    ds_read_b128 a[48:51], v111 offset:34880
    v_exp_f32 v32, v32
    v_mfma_f32_16x16x32_bf16 v[154:157], a[20:23], a[0:3], v[154:157]
    s_waitcnt lgkmcnt(4)
    ds_read_b128 a[52:55], v111 offset:37056
    v_exp_f32 v33, v33
    v_mfma_f32_32x32x8_bf16 v[50:65], a[246:247], v[106:107], 0
    v_exp_f32 v34, v34
    v_exp_f32 v35, v35
    v_exp_f32 v36, v36
    v_mfma_f32_32x32x16_bf16 v[50:65], a[240:243], v[98:101], v[50:65]
    global_load_lds_dwordx4 v113, s[58:59] offset:1088 sc0
    v_exp_f32 v37, v37
    v_exp_f32 v38, v38
    v_exp_f32 v39, v39
    v_mfma_f32_16x16x32_bf16 v[162:165], a[24:27], a[0:3], v[162:165]
    v_exp_f32 v40, v40
    v_mfma_f32_16x16x32_bf16 v[166:169], a[24:27], a[4:7], v[166:169]
    ds_read_b128 a[56:59], v111 offset:39232
    v_exp_f32 v41, v41
    v_mfma_f32_16x16x32_bf16 v[174:177], a[28:31], a[4:7], v[174:177]
    s_waitcnt lgkmcnt(1)
    ds_read_b128 a[60:63], v111 offset:41408
    v_exp_f32 v42, v42
    v_smfmac_f32_32x32x32_bf16 v[66:81], a[248:251], v[18:25], v253
    s_add_u32 m0, s4, 15232
    v_exp_f32 v43, v43
    v_exp_f32 v44, v44
    v_exp_f32 v45, v45
    v_smfmac_f32_32x32x32_bf16 v[66:81], a[252:255], v[26:33], v253
    s_add_u32 s62, s60, s36
    s_addc_u32 s63, s61, 0
    v_exp_f32 v46, v46
    v_exp_f32 v47, v47
    v_exp_f32 v48, v48
    v_mfma_f32_16x16x32_bf16 v[170:173], a[28:31], a[0:3], v[170:173]
    global_load_lds_dwordx4 v112, s[62:63] offset:0 sc0
    v_exp_f32 v49, v49
    v_mfma_f32_16x16x32_bf16 v[130:133], a[40:43], a[32:35], v[130:133]
    s_waitcnt vmcnt(6) lgkmcnt(0)
    s_barrier
    v_mfma_f32_16x16x32_bf16 v[134:137], a[40:43], a[36:39], v[134:137]
    s_sub_u32 s36, s36, 128
    s_cselect_b32 s36, 1152, s36
    ds_read_b128 a[0:3], v127 offset:60928
    global_load_lds_dwordx4 v113, s[62:63] offset:1088 sc0
    v_mfma_f32_32x32x8_bf16 v[18:33], a[246:247], v[108:109], 0
    v_exp_f32 v50, v50
    v_exp_f32 v51, v51
    v_exp_f32 v52, v52
    v_exp_f32 v53, v53
    v_mfma_f32_32x32x16_bf16 v[18:33], a[240:243], v[102:105], v[18:33]
    ds_read2st64_b64 a[244:247], v121 offset0:16 offset1:17
    ds_read_b128 a[240:243], v118 offset:6144
    v_exp_f32 v54, v54
    v_exp_f32 v55, v55
    v_exp_f32 v56, v56
    v_mfma_f32_16x16x32_bf16 v[142:145], a[44:47], a[36:39], v[142:145]
    ds_read_b128 a[8:11], v126 offset:0
    v_exp_f32 v57, v57
    v_mfma_f32_16x16x32_bf16 v[138:141], a[44:47], a[32:35], v[138:141]
    ds_read_b128 a[4:7], v127 offset:63104
    v_exp_f32 v58, v58
    v_mfma_f32_16x16x32_bf16 v[146:149], a[48:51], a[32:35], v[146:149]
    v_exp_f32 v59, v59
    v_smfmac_f32_32x32x32_bf16 v[82:97], a[248:251], v[34:41], v253
    s_add_u32 m0, s21, 151552
    ds_read_b128 a[248:251], v120 offset:1536
    v_exp_f32 v60, v60
    v_exp_f32 v61, v61
    v_smfmac_f32_32x32x32_bf16 v[82:97], a[252:255], v[42:49], v253
    s_add_u32 s68, s64, 360448
    s_addc_u32 s69, s65, 0
    ds_read_b128 a[252:255], v120 offset:2304
    global_load_lds_dwordx4 v119, s[68:69] offset:0 sc1
    v_exp_f32 v62, v62
    v_exp_f32 v63, v63
    v_mfma_f32_16x16x32_bf16 v[150:153], a[48:51], a[36:39], v[150:153]
    ds_read_b128 a[12:15], v126 offset:2176
    v_exp_f32 v64, v64
    v_mfma_f32_16x16x32_bf16 v[158:161], a[52:55], a[36:39], v[158:161]
    s_waitcnt lgkmcnt(3)
    ds_read_b128 a[16:19], v126 offset:4352
    global_load_lds_dwordx4 v119, s[68:69] offset:1024 sc1
    v_exp_f32 v65, v65
    v_mfma_f32_32x32x8_bf16 v[34:49], a[244:245], v[106:107], 0
    v_exp_f32 v18, v18
    v_exp_f32 v19, v19
    v_exp_f32 v20, v20
    v_mfma_f32_32x32x16_bf16 v[34:49], a[240:243], v[98:101], v[34:49]
    global_load_lds_dwordx4 v119, s[68:69] offset:2048 sc1
    v_exp_f32 v21, v21
    v_exp_f32 v22, v22
    v_exp_f32 v23, v23
    v_mfma_f32_16x16x32_bf16 v[154:157], a[52:55], a[32:35], v[154:157]
    ds_read_b128 a[20:23], v126 offset:6528
    v_exp_f32 v24, v24
    v_mfma_f32_16x16x32_bf16 v[162:165], a[56:59], a[32:35], v[162:165]
    v_exp_f32 v25, v25
    v_mfma_f32_16x16x32_bf16 v[166:169], a[56:59], a[36:39], v[166:169]
    s_waitcnt lgkmcnt(1)
    ds_read_b128 a[24:27], v126 offset:8704
    v_exp_f32 v26, v26
    v_smfmac_f32_32x32x32_bf16 v[66:81], a[248:251], v[50:57], v253
    s_add_u32 s93, s43, 6144
    v_exp_f32 v27, v27
    v_exp_f32 v28, v28
    v_exp_f32 v29, v29
    v_smfmac_f32_32x32x32_bf16 v[66:81], a[252:255], v[58:65], v253
    buffer_load_dword v252, v128, s[72:75], s93 offen
    v_exp_f32 v30, v30
    v_exp_f32 v31, v31
    v_mfma_f32_16x16x32_bf16 v[174:177], a[60:63], a[36:39], v[174:177]
    ds_read_b128 a[28:31], v126 offset:10880
    v_exp_f32 v32, v32
    v_mfma_f32_16x16x32_bf16 v[170:173], a[60:63], a[32:35], v[170:173]
    v_exp_f32 v33, v33
    v_mfma_f32_32x32x8_bf16 v[50:65], a[244:245], v[108:109], 0
    v_exp_f32 v34, v34
    v_exp_f32 v35, v35
    v_exp_f32 v36, v36
    v_mfma_f32_32x32x16_bf16 v[50:65], a[240:243], v[102:105], v[50:65]
    ds_read_b128 a[240:243], v118 offset:7168
    v_exp_f32 v37, v37
    v_exp_f32 v38, v38
    v_exp_f32 v39, v39
    v_mfma_f32_16x16x32_bf16 v[130:133], a[8:11], a[0:3], v[130:133]
    v_exp_f32 v40, v40
    v_mfma_f32_16x16x32_bf16 v[134:137], a[8:11], a[4:7], v[134:137]
    ds_read_b128 a[32:35], v127 offset:60992
    v_exp_f32 v41, v41
    v_mfma_f32_16x16x32_bf16 v[142:145], a[12:15], a[4:7], v[142:145]
    ds_read_b128 a[40:43], v126 offset:64
    v_exp_f32 v42, v42
    v_smfmac_f32_32x32x32_bf16 v[82:97], a[248:251], v[18:25], v253
    ds_read_b128 a[248:251], v120 offset:6144
    v_exp_f32 v43, v43
    v_exp_f32 v44, v44
    v_smfmac_f32_32x32x32_bf16 v[82:97], a[252:255], v[26:33], v253
    ds_read_b128 a[252:255], v120 offset:6912
    v_exp_f32 v45, v45
    v_exp_f32 v46, v46
    v_mfma_f32_16x16x32_bf16 v[138:141], a[12:15], a[0:3], v[138:141]
    ds_read_b128 a[36:39], v127 offset:63168
    v_exp_f32 v47, v47
    v_mfma_f32_16x16x32_bf16 v[146:149], a[16:19], a[0:3], v[146:149]
    v_exp_f32 v48, v48
    v_mfma_f32_16x16x32_bf16 v[150:153], a[16:19], a[4:7], v[150:153]
    s_waitcnt lgkmcnt(4)
    ds_read_b128 a[44:47], v126 offset:2240
    v_exp_f32 v49, v49
    v_mfma_f32_32x32x8_bf16 v[18:33], a[246:247], v[106:107], 0
    v_exp_f32 v50, v50
    v_exp_f32 v51, v51
    v_exp_f32 v52, v52
    v_mfma_f32_32x32x16_bf16 v[18:33], a[240:243], v[98:101], v[18:33]
    v_exp_f32 v53, v53
    v_exp_f32 v54, v54
    v_exp_f32 v55, v55
    v_mfma_f32_16x16x32_bf16 v[158:161], a[20:23], a[4:7], v[158:161]
    ds_read_b128 a[48:51], v126 offset:4416
    v_exp_f32 v56, v56
    v_mfma_f32_16x16x32_bf16 v[154:157], a[20:23], a[0:3], v[154:157]
    ds_read_b128 a[52:55], v126 offset:6592
    v_exp_f32 v57, v57
    v_mfma_f32_16x16x32_bf16 v[162:165], a[24:27], a[0:3], v[162:165]
    s_waitcnt lgkmcnt(2)
    v_exp_f32 v58, v58
    v_smfmac_f32_32x32x32_bf16 v[66:81], a[248:251], v[34:41], v253
    v_exp_f32 v59, v59
    v_exp_f32 v60, v60
    v_exp_f32 v61, v61
    v_smfmac_f32_32x32x32_bf16 v[66:81], a[252:255], v[42:49], v253
    v_exp_f32 v62, v62
    v_exp_f32 v63, v63
    v_exp_f32 v64, v64
    v_mfma_f32_16x16x32_bf16 v[166:169], a[24:27], a[4:7], v[166:169]
    ds_read_b128 a[56:59], v126 offset:8768
    v_exp_f32 v65, v65
    v_mfma_f32_16x16x32_bf16 v[174:177], a[28:31], a[4:7], v[174:177]
    ds_read_b128 a[60:63], v126 offset:10944
    v_mfma_f32_32x32x8_bf16 v[34:49], a[246:247], v[108:109], 0
    v_exp_f32 v18, v18
    v_exp_f32 v19, v19
    v_exp_f32 v20, v20
    v_exp_f32 v21, v21
    v_mfma_f32_32x32x16_bf16 v[34:49], a[240:243], v[102:105], v[34:49]
    ds_read2st64_b64 a[244:247], v121 offset0:28 offset1:29
    ds_read_b128 a[240:243], v118 offset:12288
    v_exp_f32 v22, v22
    v_exp_f32 v23, v23
    v_mfma_f32_16x16x32_bf16 v[170:173], a[28:31], a[0:3], v[170:173]
    v_exp_f32 v24, v24
    v_exp_f32 v25, v25
    v_mfma_f32_16x16x32_bf16 v[130:133], a[40:43], a[32:35], v[130:133]
    s_waitcnt vmcnt(4) lgkmcnt(2)
    s_barrier
    v_mfma_f32_16x16x32_bf16 v[134:137], a[40:43], a[36:39], v[134:137]
    ds_read_b128 a[0:3], v127 offset:0
    v_exp_f32 v26, v26
    v_smfmac_f32_32x32x32_bf16 v[82:97], a[248:251], v[50:57], v253
    ds_read_b128 a[248:251], v120 offset:7680
    v_exp_f32 v27, v27
    v_exp_f32 v28, v28
    v_exp_f32 v29, v29
    v_smfmac_f32_32x32x32_bf16 v[82:97], a[252:255], v[58:65], v253
    ds_read_b128 a[252:255], v120 offset:8448
    buffer_load_dword v116, v242, s[64:67], s42 offen sc1
    v_exp_f32 v30, v30
    v_exp_f32 v31, v31
    v_mfma_f32_16x16x32_bf16 v[142:145], a[44:47], a[36:39], v[142:145]
    ds_read_b128 a[8:11], v111 offset:0
    v_exp_f32 v32, v32
    v_mfma_f32_16x16x32_bf16 v[138:141], a[44:47], a[32:35], v[138:141]
    s_waitcnt lgkmcnt(4)
    ds_read_b128 a[4:7], v127 offset:2176
    v_exp_f32 v33, v33
    v_mfma_f32_32x32x8_bf16 v[50:65], a[244:245], v[106:107], 0
    v_exp_f32 v34, v34
    v_exp_f32 v35, v35
    v_exp_f32 v36, v36
    v_mfma_f32_32x32x16_bf16 v[50:65], a[240:243], v[98:101], v[50:65]
    v_exp_f32 v37, v37
    v_exp_f32 v38, v38
    v_exp_f32 v39, v39
    v_mfma_f32_16x16x32_bf16 v[146:149], a[48:51], a[32:35], v[146:149]
    v_exp_f32 v40, v40
    v_mfma_f32_16x16x32_bf16 v[150:153], a[48:51], a[36:39], v[150:153]
    ds_read_b128 a[12:15], v111 offset:2176
    v_exp_f32 v41, v41
    v_mfma_f32_16x16x32_bf16 v[158:161], a[52:55], a[36:39], v[158:161]
    s_waitcnt lgkmcnt(2)
    ds_read_b128 a[16:19], v111 offset:4352
    v_smfmac_f32_32x32x32_bf16 v[66:81], a[248:251], v[18:25], v253
    v_exp_f32 v42, v42
    v_exp_f32 v43, v43
    v_smfmac_f32_32x32x32_bf16 v[66:81], a[252:255], v[26:33], v253
    v_exp_f32 v44, v44
    v_exp_f32 v45, v45
    v_exp_f32 v46, v46
    v_mfma_f32_16x16x32_bf16 v[154:157], a[52:55], a[32:35], v[154:157]
    ds_read_b128 a[20:23], v111 offset:6528
    v_exp_f32 v47, v47
    v_mfma_f32_16x16x32_bf16 v[162:165], a[56:59], a[32:35], v[162:165]
    v_exp_f32 v48, v48
    v_mfma_f32_16x16x32_bf16 v[166:169], a[56:59], a[36:39], v[166:169]
    ds_read_b128 a[24:27], v111 offset:8704
    v_exp_f32 v49, v49
    v_mfma_f32_32x32x8_bf16 v[18:33], a[244:245], v[108:109], 0
    v_exp_f32 v50, v50
    v_exp_f32 v51, v51
    v_exp_f32 v52, v52
    v_exp_f32 v53, v53
    v_mfma_f32_32x32x16_bf16 v[18:33], a[240:243], v[102:105], v[18:33]
    ds_read_b128 a[240:243], v118 offset:13312
    v_exp_f32 v54, v54
    v_exp_f32 v55, v55
    v_exp_f32 v56, v56
    v_mfma_f32_16x16x32_bf16 v[174:177], a[60:63], a[36:39], v[174:177]
    ds_read_b128 a[28:31], v111 offset:10880
    v_exp_f32 v57, v57
    v_mfma_f32_16x16x32_bf16 v[170:173], a[60:63], a[32:35], v[170:173]
    v_exp_f32 v58, v58
    v_mfma_f32_16x16x32_bf16 v[130:133], a[8:11], a[0:3], v[130:133]
    v_exp_f32 v59, v59
    v_smfmac_f32_32x32x32_bf16 v[82:97], a[248:251], v[34:41], v253
    ds_read_b128 a[248:251], v120 offset:12288
    v_exp_f32 v60, v60
    v_exp_f32 v61, v61
    v_smfmac_f32_32x32x32_bf16 v[82:97], a[252:255], v[42:49], v253
    s_waitcnt lgkmcnt(2)
    ds_read_b128 a[252:255], v120 offset:13056
    v_exp_f32 v62, v62
    v_exp_f32 v63, v63
    v_mfma_f32_16x16x32_bf16 v[134:137], a[8:11], a[4:7], v[134:137]
    ds_read_b128 a[32:35], v127 offset:64
    v_exp_f32 v64, v64
    v_mfma_f32_16x16x32_bf16 v[142:145], a[12:15], a[4:7], v[142:145]
    ds_read_b128 a[40:43], v111 offset:64
    v_exp_f32 v65, v65
    v_mfma_f32_32x32x8_bf16 v[34:49], a[246:247], v[106:107], 0
    v_exp_f32 v18, v18
    v_exp_f32 v19, v19
    v_exp_f32 v20, v20
    v_mfma_f32_32x32x16_bf16 v[34:49], a[240:243], v[98:101], v[34:49]
    v_exp_f32 v21, v21
    v_exp_f32 v22, v22
    v_exp_f32 v23, v23
    v_mfma_f32_16x16x32_bf16 v[138:141], a[12:15], a[0:3], v[138:141]
    ds_read_b128 a[36:39], v127 offset:2240
    v_exp_f32 v24, v24
    v_mfma_f32_16x16x32_bf16 v[146:149], a[16:19], a[0:3], v[146:149]
    v_exp_f32 v25, v25
    v_mfma_f32_16x16x32_bf16 v[150:153], a[16:19], a[4:7], v[150:153]
    s_waitcnt lgkmcnt(2)
    ds_read_b128 a[44:47], v111 offset:2240
    v_exp_f32 v26, v26
    v_smfmac_f32_32x32x32_bf16 v[66:81], a[248:251], v[50:57], v253
    v_exp_f32 v27, v27
    v_exp_f32 v28, v28
    v_exp_f32 v29, v29
    v_smfmac_f32_32x32x32_bf16 v[66:81], a[252:255], v[58:65], v253
    v_exp_f32 v30, v30
    v_exp_f32 v31, v31
    v_exp_f32 v32, v32
    v_mfma_f32_16x16x32_bf16 v[158:161], a[20:23], a[4:7], v[158:161]
    ds_read_b128 a[48:51], v111 offset:4416
    v_exp_f32 v33, v33
    v_mfma_f32_16x16x32_bf16 v[154:157], a[20:23], a[0:3], v[154:157]
    s_waitcnt vmcnt(0) lgkmcnt(2)
    ds_read_b128 a[52:55], v111 offset:6592
    v_mfma_f32_32x32x8_bf16 v[50:65], a[246:247], v[108:109], 0
    v_exp_f32 v34, v34
    v_exp_f32 v35, v35
    v_exp_f32 v36, v36
    v_cmp_eq_u32 vcc, -1, v116
    v_mfma_f32_32x32x16_bf16 v[50:65], a[240:243], v[102:105], v[50:65]
    ds_read2st64_b64 a[244:247], v121 offset0:40 offset1:41
    ds_read_b128 a[240:243], v118 offset:18432
    s_nop 0
    s_cbranch_vccnz L_retry_9
L_ok_10:
    v_exp_f32 v37, v37
    v_exp_f32 v38, v38
    v_mfma_f32_16x16x32_bf16 v[162:165], a[24:27], a[0:3], v[162:165]
    v_exp_f32 v39, v39
    v_exp_f32 v40, v40
    v_mfma_f32_16x16x32_bf16 v[166:169], a[24:27], a[4:7], v[166:169]
    ds_read_b128 a[56:59], v111 offset:8768
    v_exp_f32 v41, v41
    v_mfma_f32_16x16x32_bf16 v[174:177], a[28:31], a[4:7], v[174:177]
    ds_read_b128 a[60:63], v111 offset:10944
    v_exp_f32 v42, v42
    v_smfmac_f32_32x32x32_bf16 v[82:97], a[248:251], v[18:25], v253
    ds_read_b128 a[248:251], v120 offset:13824
    v_exp_f32 v43, v43
    v_exp_f32 v44, v44
    v_smfmac_f32_32x32x32_bf16 v[82:97], a[252:255], v[26:33], v253
    s_add_u32 s93, s43, 8192
    ds_read_b128 a[252:255], v120 offset:14592
    v_exp_f32 v45, v45
    v_exp_f32 v46, v46
    v_mfma_f32_16x16x32_bf16 v[170:173], a[28:31], a[0:3], v[170:173]
    v_exp_f32 v47, v47
    v_exp_f32 v48, v48
    v_mfma_f32_16x16x32_bf16 v[130:133], a[40:43], a[32:35], v[130:133]
    s_waitcnt lgkmcnt(2)
    s_barrier
    v_mfma_f32_16x16x32_bf16 v[134:137], a[40:43], a[36:39], v[134:137]
    buffer_load_dword v252, v128, s[72:75], s93 offen
    v_exp_f32 v49, v49
    v_mfma_f32_32x32x8_bf16 v[18:33], a[244:245], v[106:107], 0
    v_exp_f32 v50, v50
    v_exp_f32 v51, v51
    v_exp_f32 v52, v52
    v_mfma_f32_32x32x16_bf16 v[18:33], a[240:243], v[98:101], v[18:33]
    v_exp_f32 v53, v53
    v_exp_f32 v54, v54
    v_exp_f32 v55, v55
    v_mfma_f32_16x16x32_bf16 v[142:145], a[44:47], a[36:39], v[142:145]
    v_exp_f32 v56, v56
    v_mfma_f32_16x16x32_bf16 v[138:141], a[44:47], a[32:35], v[138:141]
    v_exp_f32 v57, v57
    v_mfma_f32_16x16x32_bf16 v[146:149], a[48:51], a[32:35], v[146:149]
    s_waitcnt lgkmcnt(0)
    v_exp_f32 v58, v58
    v_smfmac_f32_32x32x32_bf16 v[66:81], a[248:251], v[34:41], v253
    s_add_u32 m0, s21, 126976
    v_exp_f32 v59, v59
    v_exp_f32 v60, v60
    v_exp_f32 v61, v61
    v_smfmac_f32_32x32x32_bf16 v[66:81], a[252:255], v[42:49], v253
L_pad_n3:
    s_cmp_eq_u32 s37, 1
    s_cbranch_scc1 L_pad_n6
    s_add_u32 s68, s64, 372736
    s_addc_u32 s69, s65, 0
    v_exp_f32 v62, v62
    v_exp_f32 v63, v63
    v_exp_f32 v64, v64
    v_mfma_f32_16x16x32_bf16 v[150:153], a[48:51], a[36:39], v[150:153]
    global_load_lds_dwordx4 v119, s[68:69] offset:0 sc1
    v_mfma_f32_16x16x32_bf16 v[158:161], a[52:55], a[36:39], v[158:161]
    global_load_lds_dwordx4 v119, s[68:69] offset:1024 sc1
    v_exp_f32 v65, v65
    v_mfma_f32_32x32x8_bf16 v[34:49], a[244:245], v[108:109], 0
    v_exp_f32 v18, v18
    v_exp_f32 v19, v19
    v_exp_f32 v20, v20
    v_exp_f32 v21, v21
    v_mfma_f32_32x32x16_bf16 v[34:49], a[240:243], v[102:105], v[34:49]
    ds_read_b128 a[240:243], v118 offset:19456
    v_exp_f32 v22, v22
    v_exp_f32 v23, v23
    v_exp_f32 v24, v24
    v_mfma_f32_16x16x32_bf16 v[154:157], a[52:55], a[32:35], v[154:157]
    v_exp_f32 v25, v25
    v_mfma_f32_16x16x32_bf16 v[162:165], a[56:59], a[32:35], v[162:165]
    global_load_lds_dwordx4 v119, s[68:69] offset:2048 sc1
    v_exp_f32 v26, v26
    v_mfma_f32_16x16x32_bf16 v[166:169], a[56:59], a[36:39], v[166:169]
    s_add_u32 m0, s50, 0
    v_exp_f32 v27, v27
    v_smfmac_f32_32x32x32_bf16 v[82:97], a[248:251], v[50:57], v253
    s_add_u32 s76, s32, 384
    s_addc_u32 s77, s33, 0
    ds_read_b128 a[248:251], v120 offset:18432
    global_load_lds_dwordx4 v228, s[76:77] sc0
    v_exp_f32 v28, v28
    v_exp_f32 v29, v29
    v_smfmac_f32_32x32x32_bf16 v[82:97], a[252:255], v[58:65], v253
    s_add_u32 m0, s50, 4096
    ds_read_b128 a[252:255], v120 offset:19200
    v_exp_f32 v30, v30
    v_exp_f32 v31, v31
    v_mfma_f32_16x16x32_bf16 v[174:177], a[60:63], a[36:39], v[174:177]
    s_add_u32 s76, s32, 512
    s_addc_u32 s77, s33, 0
    v_exp_f32 v32, v32
    v_mfma_f32_16x16x32_bf16 v[170:173], a[60:63], a[32:35], v[170:173]
    s_waitcnt lgkmcnt(2)
    global_load_lds_dwordx4 v228, s[76:77] sc0
    v_exp_f32 v33, v33
    v_mfma_f32_32x32x8_bf16 v[50:65], a[246:247], v[106:107], 0
    v_exp_f32 v34, v34
    v_exp_f32 v35, v35
    v_exp_f32 v36, v36
    v_exp_f32 v37, v37
    v_exp_f32 v38, v38
    v_pk_mul_f32 v[6:7], v[204:205], v[134:135] op_sel:[1,0] op_sel_hi:[1,1] neg_lo:[1,0] neg_hi:[1,0]
    v_pk_mul_f32 v[8:9], v[204:205], v[130:131] op_sel:[1,0] op_sel_hi:[1,1]
    v_pk_fma_f32 v[130:131], v[204:205], v[130:131], v[6:7] op_sel:[0,0,0] op_sel_hi:[0,1,1]
    v_pk_fma_f32 v[134:135], v[204:205], v[134:135], v[8:9] op_sel:[0,0,0] op_sel_hi:[0,1,1]
    v_pk_mul_f32 v[6:7], v[204:205], v[136:137] op_sel:[1,0] op_sel_hi:[1,1] neg_lo:[1,0] neg_hi:[1,0]
    v_pk_mul_f32 v[8:9], v[204:205], v[132:133] op_sel:[1,0] op_sel_hi:[1,1]
    v_pk_fma_f32 v[132:133], v[204:205], v[132:133], v[6:7] op_sel:[0,0,0] op_sel_hi:[0,1,1]
    v_pk_fma_f32 v[136:137], v[204:205], v[136:137], v[8:9] op_sel:[0,0,0] op_sel_hi:[0,1,1]
    v_pk_mul_f32 v[6:7], v[204:205], v[142:143] op_sel:[1,0] op_sel_hi:[1,1] neg_lo:[1,0] neg_hi:[1,0]
    v_pk_mul_f32 v[8:9], v[204:205], v[138:139] op_sel:[1,0] op_sel_hi:[1,1]
    v_mfma_f32_32x32x16_bf16 v[50:65], a[240:243], v[98:101], v[50:65]
    s_waitcnt lgkmcnt(0)
    s_add_u32 m0, s50, 8192
    s_add_u32 s76, s18, 40960
    s_addc_u32 s77, s19, 0
    global_load_lds_dwordx4 v228, s[76:77] sc0
    v_exp_f32 v39, v39
    v_exp_f32 v40, v40
    v_exp_f32 v41, v41
    v_exp_f32 v42, v42
    v_pk_fma_f32 v[138:139], v[204:205], v[138:139], v[6:7] op_sel:[0,0,0] op_sel_hi:[0,1,1]
    v_pk_fma_f32 v[142:143], v[204:205], v[142:143], v[8:9] op_sel:[0,0,0] op_sel_hi:[0,1,1]
    v_pk_fma_f32 v[10:11], v[202:203], v[134:135], v[132:133] op_sel:[1,0,0] op_sel_hi:[1,1,1] neg_lo:[1,0,0] neg_hi:[1,0,0]
    v_pk_fma_f32 v[12:13], v[202:203], v[130:131], v[136:137] op_sel:[1,0,0] op_sel_hi:[1,1,1]
    v_pk_fma_f32 v[2:3], v[202:203], v[130:131], v[10:11] op_sel:[0,0,0] op_sel_hi:[0,1,1]
    v_pk_fma_f32 v[4:5], v[202:203], v[134:135], v[12:13] op_sel:[0,0,0] op_sel_hi:[0,1,1]
    v_pk_mul_f32 v[6:7], v[204:205], v[144:145] op_sel:[1,0] op_sel_hi:[1,1] neg_lo:[1,0] neg_hi:[1,0]
    v_pk_mul_f32 v[8:9], v[204:205], v[140:141] op_sel:[1,0] op_sel_hi:[1,1]
    v_pk_fma_f32 v[140:141], v[204:205], v[140:141], v[6:7] op_sel:[0,0,0] op_sel_hi:[0,1,1]
    v_pk_fma_f32 v[144:145], v[204:205], v[144:145], v[8:9] op_sel:[0,0,0] op_sel_hi:[0,1,1]
    v_smfmac_f32_32x32x32_bf16 v[66:81], a[248:251], v[18:25], v253
    s_add_u32 m0, s50, 12288
    s_add_u32 s76, s18, 41088
    s_addc_u32 s77, s19, 0
    global_load_lds_dwordx4 v228, s[76:77] sc0
    v_exp_f32 v43, v43
    v_exp_f32 v44, v44
    v_exp_f32 v45, v45
    v_pk_fma_f32 v[10:11], v[202:203], v[4:5], v[138:139] op_sel:[1,0,0] op_sel_hi:[1,1,1] neg_lo:[1,0,0] neg_hi:[1,0,0]
    v_pk_fma_f32 v[12:13], v[202:203], v[2:3], v[142:143] op_sel:[1,0,0] op_sel_hi:[1,1,1]
    v_pk_fma_f32 v[2:3], v[202:203], v[2:3], v[10:11] op_sel:[0,0,0] op_sel_hi:[0,1,1]
    v_pk_fma_f32 v[4:5], v[202:203], v[4:5], v[12:13] op_sel:[0,0,0] op_sel_hi:[0,1,1]
    v_pk_mul_f32 v[6:7], v[204:205], v[150:151] op_sel:[1,0] op_sel_hi:[1,1] neg_lo:[1,0] neg_hi:[1,0]
    v_pk_mul_f32 v[8:9], v[204:205], v[146:147] op_sel:[1,0] op_sel_hi:[1,1]
    v_pk_fma_f32 v[146:147], v[204:205], v[146:147], v[6:7] op_sel:[0,0,0] op_sel_hi:[0,1,1]
    v_pk_fma_f32 v[150:151], v[204:205], v[150:151], v[8:9] op_sel:[0,0,0] op_sel_hi:[0,1,1]
    v_pk_fma_f32 v[10:11], v[202:203], v[4:5], v[140:141] op_sel:[1,0,0] op_sel_hi:[1,1,1] neg_lo:[1,0,0] neg_hi:[1,0,0]
    v_smfmac_f32_32x32x32_bf16 v[66:81], a[252:255], v[26:33], v253
    s_add_u32 m0, s50, 16384
    s_add_u32 s76, s18, 41216
    s_addc_u32 s77, s19, 0
    global_load_lds_dwordx4 v228, s[76:77] sc0
    v_exp_f32 v46, v46
    v_exp_f32 v47, v47
    v_exp_f32 v48, v48
    v_exp_f32 v49, v49
    v_pk_fma_f32 v[12:13], v[202:203], v[2:3], v[144:145] op_sel:[1,0,0] op_sel_hi:[1,1,1]
    v_pk_fma_f32 v[2:3], v[202:203], v[2:3], v[10:11] op_sel:[0,0,0] op_sel_hi:[0,1,1]
    v_pk_fma_f32 v[4:5], v[202:203], v[4:5], v[12:13] op_sel:[0,0,0] op_sel_hi:[0,1,1]
    v_pk_mul_f32 v[6:7], v[204:205], v[152:153] op_sel:[1,0] op_sel_hi:[1,1] neg_lo:[1,0] neg_hi:[1,0]
    v_pk_mul_f32 v[8:9], v[204:205], v[148:149] op_sel:[1,0] op_sel_hi:[1,1]
    v_pk_fma_f32 v[148:149], v[204:205], v[148:149], v[6:7] op_sel:[0,0,0] op_sel_hi:[0,1,1]
    v_pk_fma_f32 v[152:153], v[204:205], v[152:153], v[8:9] op_sel:[0,0,0] op_sel_hi:[0,1,1]
    v_pk_fma_f32 v[10:11], v[202:203], v[4:5], v[146:147] op_sel:[1,0,0] op_sel_hi:[1,1,1] neg_lo:[1,0,0] neg_hi:[1,0,0]
    v_pk_fma_f32 v[12:13], v[202:203], v[2:3], v[150:151] op_sel:[1,0,0] op_sel_hi:[1,1,1]
    v_mfma_f32_32x32x8_bf16 v[18:33], a[246:247], v[108:109], 0
    v_exp_f32 v50, v50
    v_exp_f32 v51, v51
    v_exp_f32 v52, v52
    v_exp_f32 v53, v53
    v_exp_f32 v54, v54
    v_pk_fma_f32 v[2:3], v[202:203], v[2:3], v[10:11] op_sel:[0,0,0] op_sel_hi:[0,1,1]
    v_pk_fma_f32 v[4:5], v[202:203], v[4:5], v[12:13] op_sel:[0,0,0] op_sel_hi:[0,1,1]
    v_pk_mul_f32 v[6:7], v[204:205], v[158:159] op_sel:[1,0] op_sel_hi:[1,1] neg_lo:[1,0] neg_hi:[1,0]
    v_pk_mul_f32 v[8:9], v[204:205], v[154:155] op_sel:[1,0] op_sel_hi:[1,1]
    v_pk_fma_f32 v[154:155], v[204:205], v[154:155], v[6:7] op_sel:[0,0,0] op_sel_hi:[0,1,1]
    v_pk_fma_f32 v[158:159], v[204:205], v[158:159], v[8:9] op_sel:[0,0,0] op_sel_hi:[0,1,1]
    v_pk_fma_f32 v[10:11], v[202:203], v[4:5], v[148:149] op_sel:[1,0,0] op_sel_hi:[1,1,1] neg_lo:[1,0,0] neg_hi:[1,0,0]
    v_pk_fma_f32 v[12:13], v[202:203], v[2:3], v[152:153] op_sel:[1,0,0] op_sel_hi:[1,1,1]
    v_pk_fma_f32 v[2:3], v[202:203], v[2:3], v[10:11] op_sel:[0,0,0] op_sel_hi:[0,1,1]
    v_pk_fma_f32 v[4:5], v[202:203], v[4:5], v[12:13] op_sel:[0,0,0] op_sel_hi:[0,1,1]
    v_mfma_f32_32x32x16_bf16 v[18:33], a[240:243], v[102:105], v[18:33]
    s_add_u32 m0, s5, 40960
    s_add_u32 s70, s44, 40960
    s_addc_u32 s71, s45, 0
    ds_read2st64_b64 a[244:247], v121 offset0:52 offset1:53
    ds_read_b128 a[240:243], v118 offset:24576
    global_load_lds_dwordx4 v232, s[70:71] offset:0 sc1
    v_exp_f32 v55, v55
    v_exp_f32 v56, v56
    v_exp_f32 v57, v57
    v_pk_mul_f32 v[6:7], v[204:205], v[160:161] op_sel:[1,0] op_sel_hi:[1,1] neg_lo:[1,0] neg_hi:[1,0]
    v_pk_mul_f32 v[8:9], v[204:205], v[156:157] op_sel:[1,0] op_sel_hi:[1,1]
    v_pk_fma_f32 v[156:157], v[204:205], v[156:157], v[6:7] op_sel:[0,0,0] op_sel_hi:[0,1,1]
    v_pk_fma_f32 v[160:161], v[204:205], v[160:161], v[8:9] op_sel:[0,0,0] op_sel_hi:[0,1,1]
    v_pk_fma_f32 v[10:11], v[202:203], v[4:5], v[154:155] op_sel:[1,0,0] op_sel_hi:[1,1,1] neg_lo:[1,0,0] neg_hi:[1,0,0]
    v_pk_fma_f32 v[12:13], v[202:203], v[2:3], v[158:159] op_sel:[1,0,0] op_sel_hi:[1,1,1]
    v_pk_fma_f32 v[2:3], v[202:203], v[2:3], v[10:11] op_sel:[0,0,0] op_sel_hi:[0,1,1]
    v_pk_fma_f32 v[4:5], v[202:203], v[4:5], v[12:13] op_sel:[0,0,0] op_sel_hi:[0,1,1]
    v_pk_mul_f32 v[6:7], v[204:205], v[166:167] op_sel:[1,0] op_sel_hi:[1,1] neg_lo:[1,0] neg_hi:[1,0]
    v_pk_mul_f32 v[8:9], v[204:205], v[162:163] op_sel:[1,0] op_sel_hi:[1,1]
    v_smfmac_f32_32x32x32_bf16 v[82:97], a[248:251], v[34:41], v253
    ds_read_b128 a[248:251], v120 offset:19968
    global_load_lds_dwordx4 v232, s[70:71] offset:1024 sc1
    v_exp_f32 v58, v58
    v_exp_f32 v59, v59
    v_exp_f32 v60, v60
    v_exp_f32 v61, v61
    v_pk_fma_f32 v[162:163], v[204:205], v[162:163], v[6:7] op_sel:[0,0,0] op_sel_hi:[0,1,1]
    v_pk_fma_f32 v[166:167], v[204:205], v[166:167], v[8:9] op_sel:[0,0,0] op_sel_hi:[0,1,1]
    v_pk_fma_f32 v[10:11], v[202:203], v[4:5], v[156:157] op_sel:[1,0,0] op_sel_hi:[1,1,1] neg_lo:[1,0,0] neg_hi:[1,0,0]
    v_pk_fma_f32 v[12:13], v[202:203], v[2:3], v[160:161] op_sel:[1,0,0] op_sel_hi:[1,1,1]
    v_pk_fma_f32 v[2:3], v[202:203], v[2:3], v[10:11] op_sel:[0,0,0] op_sel_hi:[0,1,1]
    v_pk_fma_f32 v[4:5], v[202:203], v[4:5], v[12:13] op_sel:[0,0,0] op_sel_hi:[0,1,1]
    v_pk_mul_f32 v[6:7], v[204:205], v[168:169] op_sel:[1,0] op_sel_hi:[1,1] neg_lo:[1,0] neg_hi:[1,0]
    v_pk_mul_f32 v[8:9], v[204:205], v[164:165] op_sel:[1,0] op_sel_hi:[1,1]
    v_pk_fma_f32 v[164:165], v[204:205], v[164:165], v[6:7] op_sel:[0,0,0] op_sel_hi:[0,1,1]
    v_smfmac_f32_32x32x32_bf16 v[82:97], a[252:255], v[42:49], v253
    s_waitcnt lgkmcnt(1)
    ds_read_b128 a[252:255], v120 offset:20736
    global_load_lds_dwordx4 v232, s[70:71] offset:2048 sc1
    v_exp_f32 v62, v62
    v_exp_f32 v63, v63
    v_exp_f32 v64, v64
    v_exp_f32 v65, v65
    v_pk_fma_f32 v[168:169], v[204:205], v[168:169], v[8:9] op_sel:[0,0,0] op_sel_hi:[0,1,1]
    v_pk_fma_f32 v[10:11], v[202:203], v[4:5], v[162:163] op_sel:[1,0,0] op_sel_hi:[1,1,1] neg_lo:[1,0,0] neg_hi:[1,0,0]
    v_pk_fma_f32 v[12:13], v[202:203], v[2:3], v[166:167] op_sel:[1,0,0] op_sel_hi:[1,1,1]
    v_pk_fma_f32 v[2:3], v[202:203], v[2:3], v[10:11] op_sel:[0,0,0] op_sel_hi:[0,1,1]
    v_pk_fma_f32 v[4:5], v[202:203], v[4:5], v[12:13] op_sel:[0,0,0] op_sel_hi:[0,1,1]
    v_pk_mul_f32 v[6:7], v[204:205], v[174:175] op_sel:[1,0] op_sel_hi:[1,1] neg_lo:[1,0] neg_hi:[1,0]
    v_pk_mul_f32 v[8:9], v[204:205], v[170:171] op_sel:[1,0] op_sel_hi:[1,1]
    v_pk_fma_f32 v[170:171], v[204:205], v[170:171], v[6:7] op_sel:[0,0,0] op_sel_hi:[0,1,1]
    v_pk_fma_f32 v[174:175], v[204:205], v[174:175], v[8:9] op_sel:[0,0,0] op_sel_hi:[0,1,1]
    v_mfma_f32_32x32x8_bf16 v[34:49], a[244:245], v[106:107], 0
    v_exp_f32 v18, v18
    v_exp_f32 v19, v19
    v_exp_f32 v20, v20
    v_exp_f32 v21, v21
    v_exp_f32 v22, v22
    v_pk_fma_f32 v[10:11], v[202:203], v[4:5], v[164:165] op_sel:[1,0,0] op_sel_hi:[1,1,1] neg_lo:[1,0,0] neg_hi:[1,0,0]
    v_pk_fma_f32 v[12:13], v[202:203], v[2:3], v[168:169] op_sel:[1,0,0] op_sel_hi:[1,1,1]
    v_pk_fma_f32 v[2:3], v[202:203], v[2:3], v[10:11] op_sel:[0,0,0] op_sel_hi:[0,1,1]
    v_pk_fma_f32 v[4:5], v[202:203], v[4:5], v[12:13] op_sel:[0,0,0] op_sel_hi:[0,1,1]
    v_pk_mul_f32 v[6:7], v[204:205], v[176:177] op_sel:[1,0] op_sel_hi:[1,1] neg_lo:[1,0] neg_hi:[1,0]
    v_pk_mul_f32 v[8:9], v[204:205], v[172:173] op_sel:[1,0] op_sel_hi:[1,1]
    v_pk_fma_f32 v[172:173], v[204:205], v[172:173], v[6:7] op_sel:[0,0,0] op_sel_hi:[0,1,1]
    v_pk_fma_f32 v[176:177], v[204:205], v[176:177], v[8:9] op_sel:[0,0,0] op_sel_hi:[0,1,1]
    v_pk_fma_f32 v[10:11], v[202:203], v[4:5], v[170:171] op_sel:[1,0,0] op_sel_hi:[1,1,1] neg_lo:[1,0,0] neg_hi:[1,0,0]
    v_pk_fma_f32 v[12:13], v[202:203], v[2:3], v[174:175] op_sel:[1,0,0] op_sel_hi:[1,1,1]
    v_mfma_f32_32x32x16_bf16 v[34:49], a[240:243], v[98:101], v[34:49]
    s_waitcnt lgkmcnt(0)
    global_load_lds_dwordx4 v232, s[70:71] offset:3072 sc1
    v_exp_f32 v23, v23
    v_exp_f32 v24, v24
    v_exp_f32 v25, v25
    v_exp_f32 v26, v26
    v_pk_fma_f32 v[2:3], v[202:203], v[2:3], v[10:11] op_sel:[0,0,0] op_sel_hi:[0,1,1]
    v_pk_fma_f32 v[4:5], v[202:203], v[4:5], v[12:13] op_sel:[0,0,0] op_sel_hi:[0,1,1]
    v_pk_fma_f32 v[10:11], v[202:203], v[4:5], v[172:173] op_sel:[1,0,0] op_sel_hi:[1,1,1] neg_lo:[1,0,0] neg_hi:[1,0,0]
    v_pk_fma_f32 v[12:13], v[202:203], v[2:3], v[176:177] op_sel:[1,0,0] op_sel_hi:[1,1,1]
    v_pk_fma_f32 v[2:3], v[202:203], v[2:3], v[10:11] op_sel:[0,0,0] op_sel_hi:[0,1,1]
    v_pk_fma_f32 v[4:5], v[202:203], v[4:5], v[12:13] op_sel:[0,0,0] op_sel_hi:[0,1,1]
    v_swap_b32 v3, v4
    v_mov_b64 v[114:115], v[2:3]
    v_pk_fma_f32 v[6:7], v[250:251], v[2:3], v[4:5] op_sel:[1,1,0] op_sel_hi:[1,0,1] neg_lo:[1,0,0]
    v_pk_fma_f32 v[2:3], v[250:251], v[2:3], v[6:7] op_sel:[0,0,0] op_sel_hi:[0,1,1]
    v_smfmac_f32_32x32x32_bf16 v[66:81], a[248:251], v[50:57], v253
    s_add_u32 m0, s5, 45056
    s_add_u32 s70, s44, 45056
    s_addc_u32 s71, s45, 0
    global_load_lds_dwordx4 v232, s[70:71] offset:0 sc1
    v_exp_f32 v27, v27
    v_exp_f32 v28, v28
    v_exp_f32 v29, v29
    v_and_b32 v10, 16, v1
    v_cmp_ne_u32 vcc, 0, v10
    v_mov_b64 v[4:5], v[2:3]
    s_nop 1
    v_permlane16_swap_b32 v4, v2
    v_permlane16_swap_b32 v5, v3
    v_pk_fma_f32 v[8:9], v[206:207], v[4:5], v[2:3] op_sel:[1,1,0] op_sel_hi:[1,0,1] neg_lo:[1,0,0]
    v_pk_fma_f32 v[2:3], v[206:207], v[4:5], v[8:9] op_sel:[0,0,0] op_sel_hi:[0,1,1]
    v_cndmask_b32 v220, 0, v4, vcc
    v_cndmask_b32 v221, 0, v5, vcc
    v_smfmac_f32_32x32x32_bf16 v[66:81], a[252:255], v[58:65], v253
    s_add_u32 m0, s5, 61440
    s_add_u32 s70, s44, 61440
    s_addc_u32 s71, s45, 0
    global_load_lds_dwordx4 v232, s[70:71] offset:0 sc1
    v_exp_f32 v30, v30
    v_exp_f32 v31, v31
    v_exp_f32 v32, v32
    v_exp_f32 v33, v33
    v_mov_b64 v[4:5], v[2:3]
    s_nop 1
    v_permlane32_swap_b32 v4, v2
    v_permlane32_swap_b32 v5, v3
    v_pk_fma_f32 v[8:9], v[208:209], v[4:5], v[2:3] op_sel:[1,1,0] op_sel_hi:[1,0,1] neg_lo:[1,0,0]
    v_pk_fma_f32 v[2:3], v[208:209], v[4:5], v[8:9] op_sel:[0,0,0] op_sel_hi:[0,1,1]
    v_cndmask_b32 v222, 0, v4, s[22:23]
    v_cndmask_b32 v223, 0, v5, s[22:23]
    v_min_u32 v2, -2, v2
    v_min_u32 v3, -2, v3
    v_mfma_f32_32x32x8_bf16 v[50:65], a[244:245], v[108:109], 0
    v_exp_f32 v34, v34
    v_exp_f32 v35, v35
    v_exp_f32 v36, v36
    v_exp_f32 v37, v37
    v_exp_f32 v38, v38
    v_add_u32 v227, s41, v227
    v_add_u32 v190, 128, v227
    v_mfma_f32_32x32x16_bf16 v[50:65], a[240:243], v[102:105], v[50:65]
    ds_read_b128 a[240:243], v118 offset:25600
    global_load_lds_dwordx4 v232, s[70:71] offset:1024 sc1
    v_exp_f32 v39, v39
    v_exp_f32 v40, v40
    v_exp_f32 v41, v41
    v_add_u32 v191, 256, v227
    v_add_u32 v192, 384, v227
    v_smfmac_f32_32x32x32_bf16 v[82:97], a[248:251], v[18:25], v253
    ds_read_b128 a[248:251], v120 offset:24576
    global_load_lds_dwordx4 v232, s[70:71] offset:2048 sc1
    v_exp_f32 v42, v42
    v_exp_f32 v43, v43
    v_exp_f32 v44, v44
    v_exp_f32 v45, v45
    v_add_u32 v193, 512, v227
    v_smfmac_f32_32x32x32_bf16 v[82:97], a[252:255], v[26:33], v253
    s_waitcnt lgkmcnt(1)
    ds_read_b128 a[252:255], v120 offset:25344
    global_load_lds_dwordx4 v232, s[70:71] offset:3072 sc1
    v_exp_f32 v46, v46
    v_exp_f32 v47, v47
    v_exp_f32 v48, v48
    v_exp_f32 v49, v49
    v_add_u32 v194, 640, v227
    v_mfma_f32_32x32x8_bf16 v[18:33], a[246:247], v[106:107], 0
    v_exp_f32 v50, v50
    v_exp_f32 v51, v51
    v_exp_f32 v52, v52
    v_exp_f32 v53, v53
    v_exp_f32 v54, v54
    v_mfma_f32_32x32x16_bf16 v[18:33], a[240:243], v[98:101], v[18:33]
    s_waitcnt lgkmcnt(1)
    buffer_store_dwordx2 v[2:3], v226, s[64:67], s35 offen sc1
    v_exp_f32 v55, v55
    v_exp_f32 v56, v56
    v_exp_f32 v57, v57
    v_exp_f32 v58, v58
    v_smfmac_f32_32x32x32_bf16 v[66:81], a[248:251], v[34:41], v253
    s_waitcnt lgkmcnt(0)
    s_add_u32 m0, s5, 65536
    v_exp_f32 v59, v59
    v_exp_f32 v60, v60
    v_exp_f32 v61, v61
    v_exp_f32 v62, v62
    v_smfmac_f32_32x32x32_bf16 v[66:81], a[252:255], v[42:49], v253
    s_add_u32 s70, s44, 65536
    s_addc_u32 s71, s45, 0
    global_load_lds_dwordx4 v232, s[70:71] offset:0 sc1
    v_exp_f32 v63, v63
    v_exp_f32 v64, v64
    v_exp_f32 v65, v65
    v_mfma_f32_32x32x8_bf16 v[34:49], a[246:247], v[108:109], 0
    v_exp_f32 v18, v18
    v_exp_f32 v19, v19
    v_exp_f32 v20, v20
    v_exp_f32 v21, v21
    v_exp_f32 v22, v22
    v_mfma_f32_32x32x16_bf16 v[34:49], a[240:243], v[102:105], v[34:49]
    ds_read2st64_b64 a[244:247], v121 offset0:64 offset1:65
    ds_read_b128 a[240:243], v118 offset:30720
    v_exp_f32 v23, v23
    v_exp_f32 v24, v24
    v_exp_f32 v25, v25
    v_exp_f32 v26, v26
    v_smfmac_f32_32x32x32_bf16 v[82:97], a[248:251], v[50:57], v253
    ds_read_b128 a[248:251], v120 offset:26112
    v_exp_f32 v27, v27
    v_exp_f32 v28, v28
    v_exp_f32 v29, v29
    v_exp_f32 v30, v30
    v_smfmac_f32_32x32x32_bf16 v[82:97], a[252:255], v[58:65], v253
    s_waitcnt lgkmcnt(1)
    s_add_u32 s93, s43, 10240
    ds_read_b128 a[252:255], v120 offset:26880
    buffer_load_dword v252, v128, s[72:75], s93 offen
    v_exp_f32 v31, v31
    v_exp_f32 v32, v32
    v_exp_f32 v33, v33
    v_mfma_f32_32x32x8_bf16 v[50:65], a[244:245], v[106:107], 0
    v_exp_f32 v34, v34
    v_exp_f32 v35, v35
    v_exp_f32 v36, v36
    v_exp_f32 v37, v37
    v_exp_f32 v38, v38
    v_mfma_f32_32x32x16_bf16 v[50:65], a[240:243], v[98:101], v[50:65]
    s_waitcnt lgkmcnt(1)
    v_exp_f32 v39, v39
    v_exp_f32 v40, v40
    v_exp_f32 v41, v41
    v_exp_f32 v42, v42
    v_smfmac_f32_32x32x32_bf16 v[66:81], a[248:251], v[18:25], v253
    s_waitcnt vmcnt(12) lgkmcnt(0)
    s_barrier
    v_exp_f32 v43, v43
    v_exp_f32 v44, v44
    v_exp_f32 v45, v45
    v_smfmac_f32_32x32x32_bf16 v[66:81], a[252:255], v[26:33], v253
    v_exp_f32 v46, v46
    v_exp_f32 v47, v47
    v_exp_f32 v48, v48
    v_exp_f32 v49, v49
    v_mfma_f32_32x32x8_bf16 v[18:33], a[244:245], v[108:109], 0
    v_exp_f32 v50, v50
    v_exp_f32 v51, v51
    v_exp_f32 v52, v52
    v_exp_f32 v53, v53
    v_exp_f32 v54, v54
    v_subrev_u32 v14, 102400, v229
    v_mfma_f32_32x32x16_bf16 v[18:33], a[240:243], v[102:105], v[18:33]
    s_add_u32 m0, s21, 139264
    ds_read_b128 a[240:243], v118 offset:31744
    v_exp_f32 v55, v55
    v_exp_f32 v56, v56
    v_exp_f32 v57, v57
    v_exp_f32 v58, v58
    v_subrev_u32 v15, 102400, v230
    v_smfmac_f32_32x32x32_bf16 v[82:97], a[248:251], v[34:41], v253
    s_add_u32 s68, s64, 385024
    s_addc_u32 s69, s65, 0
    ds_read_b128 a[248:251], v120 offset:30720
    global_load_lds_dwordx4 v119, s[68:69] offset:0 sc1
    ds_read_b128 a[160:163], v14 offset:0
    v_exp_f32 v59, v59
    v_exp_f32 v60, v60
    v_exp_f32 v61, v61
    v_smfmac_f32_32x32x32_bf16 v[82:97], a[252:255], v[42:49], v253
    s_waitcnt lgkmcnt(2)
    ds_read_b128 a[252:255], v120 offset:31488
    global_load_lds_dwordx4 v119, s[68:69] offset:1024 sc1
    v_exp_f32 v62, v62
    v_exp_f32 v63, v63
    v_exp_f32 v64, v64
    v_exp_f32 v65, v65
    v_mfma_f32_32x32x8_bf16 v[34:49], a[246:247], v[106:107], 0
    v_exp_f32 v18, v18
    v_exp_f32 v19, v19
    v_exp_f32 v20, v20
    v_exp_f32 v21, v21
    v_exp_f32 v22, v22
    v_mfma_f32_32x32x16_bf16 v[34:49], a[240:243], v[98:101], v[34:49]
    s_waitcnt lgkmcnt(1)
    ds_read_b128 a[164:167], v15 offset:0
    v_exp_f32 v23, v23
    v_exp_f32 v24, v24
    v_exp_f32 v25, v25
    v_exp_f32 v26, v26
    v_smfmac_f32_32x32x32_bf16 v[66:81], a[248:251], v[50:57], v253
    s_waitcnt lgkmcnt(1)
    ds_read_b128 a[168:171], v14 offset:4096
    v_exp_f32 v27, v27
    v_exp_f32 v28, v28
    v_exp_f32 v29, v29
    v_smfmac_f32_32x32x32_bf16 v[66:81], a[252:255], v[58:65], v253
    global_load_lds_dwordx4 v119, s[68:69] offset:2048 sc1
    v_exp_f32 v30, v30
    v_exp_f32 v31, v31
    v_exp_f32 v32, v32
    v_exp_f32 v33, v33
    v_mfma_f32_32x32x8_bf16 v[50:65], a[246:247], v[108:109], 0
    v_exp_f32 v34, v34
    v_exp_f32 v35, v35
    v_exp_f32 v36, v36
    v_exp_f32 v37, v37
    v_exp_f32 v38, v38
    v_mfma_f32_32x32x16_bf16 v[50:65], a[240:243], v[102:105], v[50:65]
    ds_read2st64_b64 a[244:247], v121 offset0:4 offset1:5
    ds_read_b128 a[240:243], v118 offset:0
    ds_read_b128 a[172:175], v15 offset:4096
    v_exp_f32 v39, v39
    v_exp_f32 v40, v40
    v_exp_f32 v41, v41
    v_smfmac_f32_32x32x32_bf16 v[82:97], a[248:251], v[18:25], v253
    ds_read_b128 a[248:251], v120 offset:32256
    ds_read_b128 a[176:179], v14 offset:8192
    v_exp_f32 v42, v42
    v_exp_f32 v43, v43
    v_exp_f32 v44, v44
    v_exp_f32 v45, v45
    v_smfmac_f32_32x32x32_bf16 v[82:97], a[252:255], v[26:33], v253
    s_waitcnt lgkmcnt(3)
    ds_read_b128 a[252:255], v120 offset:33024
    ds_read_b128 a[180:183], v15 offset:8192
    v_exp_f32 v46, v46
    v_exp_f32 v47, v47
    v_exp_f32 v48, v48
    v_exp_f32 v49, v49
    v_mfma_f32_32x32x8_bf16 v[18:33], a[244:245], v[106:107], 0
    v_exp_f32 v50, v50
    v_exp_f32 v51, v51
    v_exp_f32 v52, v52
    v_exp_f32 v53, v53
    v_exp_f32 v54, v54
    v_mfma_f32_32x32x16_bf16 v[18:33], a[240:243], v[98:101], v[18:33]
    s_waitcnt lgkmcnt(2)
    ds_read_b128 a[184:187], v14 offset:12288
    v_exp_f32 v55, v55
    v_exp_f32 v56, v56
    v_exp_f32 v57, v57
    v_exp_f32 v58, v58
    v_smfmac_f32_32x32x32_bf16 v[66:81], a[248:251], v[34:41], v253
    s_waitcnt lgkmcnt(1)
    ds_read_b128 a[188:191], v15 offset:12288
    v_exp_f32 v59, v59
    v_exp_f32 v60, v60
    v_exp_f32 v61, v61
    v_smfmac_f32_32x32x32_bf16 v[66:81], a[252:255], v[42:49], v253
    v_exp_f32 v62, v62
    v_exp_f32 v63, v63
    v_exp_f32 v64, v64
    v_exp_f32 v65, v65
    v_mfma_f32_32x32x8_bf16 v[34:49], a[244:245], v[108:109], 0
    v_exp_f32 v18, v18
    v_exp_f32 v19, v19
    v_exp_f32 v20, v20
    v_exp_f32 v21, v21
    v_exp_f32 v22, v22
    v_mfma_f32_32x32x16_bf16 v[34:49], a[240:243], v[102:105], v[34:49]
    ds_read_b128 a[240:243], v118 offset:1024
    ds_read_b128 a[192:195], v14 offset:16384
    v_exp_f32 v23, v23
    v_exp_f32 v24, v24
    v_exp_f32 v25, v25
    v_exp_f32 v26, v26
    v_smfmac_f32_32x32x32_bf16 v[82:97], a[248:251], v[50:57], v253
    ds_read_b128 a[248:251], v120 offset:0
    ds_read_b128 a[196:199], v15 offset:16384
    v_exp_f32 v27, v27
    v_exp_f32 v28, v28
    v_exp_f32 v29, v29
    v_smfmac_f32_32x32x32_bf16 v[82:97], a[252:255], v[58:65], v253
    s_waitcnt lgkmcnt(3)
    ds_read_b128 a[252:255], v120 offset:768
    v_exp_f32 v30, v30
    v_exp_f32 v31, v31
    v_exp_f32 v32, v32
    v_exp_f32 v33, v33
    v_mfma_f32_32x32x8_bf16 v[50:65], a[246:247], v[106:107], 0
    v_exp_f32 v34, v34
    v_exp_f32 v35, v35
    v_exp_f32 v36, v36
    v_exp_f32 v37, v37
    v_exp_f32 v38, v38
    v_mfma_f32_32x32x16_bf16 v[50:65], a[240:243], v[98:101], v[50:65]
    s_waitcnt lgkmcnt(1)
    buffer_load_dwordx2 v[178:179], v227, s[64:67], s47 offen sc1
    v_exp_f32 v39, v39
    v_exp_f32 v40, v40
    v_exp_f32 v41, v41
    v_exp_f32 v42, v42
    v_smfmac_f32_32x32x32_bf16 v[66:81], a[248:251], v[18:25], v253
    s_waitcnt lgkmcnt(0)
    buffer_load_dwordx2 v[180:181], v190, s[64:67], s47 offen sc1
    v_exp_f32 v43, v43
    v_exp_f32 v44, v44
    v_exp_f32 v45, v45
    v_smfmac_f32_32x32x32_bf16 v[66:81], a[252:255], v[26:33], v253
    buffer_load_dwordx2 v[182:183], v191, s[64:67], s47 offen sc1
    v_exp_f32 v46, v46
    v_exp_f32 v47, v47
    v_exp_f32 v48, v48
    v_exp_f32 v49, v49
    v_mfma_f32_32x32x8_bf16 v[18:33], a[246:247], v[108:109], 0
    v_exp_f32 v50, v50
    v_exp_f32 v51, v51
    v_exp_f32 v52, v52
    v_exp_f32 v53, v53
    v_exp_f32 v54, v54
    v_mfma_f32_32x32x16_bf16 v[18:33], a[240:243], v[102:105], v[18:33]
    ds_read2st64_b64 a[244:247], v121 offset0:16 offset1:17
    ds_read_b128 a[240:243], v118 offset:6144
    buffer_load_dwordx2 v[184:185], v192, s[64:67], s47 offen sc1
    v_exp_f32 v55, v55
    v_exp_f32 v56, v56
    v_exp_f32 v57, v57
    v_smfmac_f32_32x32x32_bf16 v[82:97], a[248:251], v[34:41], v253
    ds_read_b128 a[248:251], v120 offset:1536
    buffer_load_dwordx2 v[186:187], v193, s[64:67], s47 offen sc1
    v_exp_f32 v58, v58
    v_exp_f32 v59, v59
    v_exp_f32 v60, v60
    v_exp_f32 v61, v61
    v_smfmac_f32_32x32x32_bf16 v[82:97], a[252:255], v[42:49], v253
    s_waitcnt lgkmcnt(1)
    ds_read_b128 a[252:255], v120 offset:2304
    buffer_load_dwordx2 v[188:189], v194, s[64:67], s47 offen sc1
    v_exp_f32 v62, v62
    v_exp_f32 v63, v63
    v_exp_f32 v64, v64
    v_exp_f32 v65, v65
    v_mfma_f32_32x32x8_bf16 v[34:49], a[244:245], v[106:107], 0
    v_exp_f32 v18, v18
    v_exp_f32 v19, v19
    v_exp_f32 v20, v20
    v_exp_f32 v21, v21
    v_exp_f32 v22, v22
    v_mfma_f32_32x32x16_bf16 v[34:49], a[240:243], v[98:101], v[34:49]
    s_waitcnt lgkmcnt(1)
    v_exp_f32 v23, v23
    v_exp_f32 v24, v24
    v_exp_f32 v25, v25
    v_exp_f32 v26, v26
    v_smfmac_f32_32x32x32_bf16 v[66:81], a[248:251], v[50:57], v253
    s_waitcnt vmcnt(6) lgkmcnt(0)
    s_add_u32 s93, s43, 12288
    s_barrier
    v_exp_f32 v27, v27
    v_exp_f32 v28, v28
    v_exp_f32 v29, v29
    v_smfmac_f32_32x32x32_bf16 v[66:81], a[252:255], v[58:65], v253
    buffer_load_dword v252, v128, s[72:75], s93 offen
    v_exp_f32 v30, v30
    v_exp_f32 v31, v31
    v_exp_f32 v32, v32
    v_exp_f32 v33, v33
    v_mfma_f32_32x32x8_bf16 v[50:65], a[244:245], v[108:109], 0
    v_exp_f32 v34, v34
    v_exp_f32 v35, v35
    v_exp_f32 v36, v36
    v_exp_f32 v37, v37
    v_exp_f32 v38, v38
    v_mfma_f32_32x32x16_bf16 v[50:65], a[240:243], v[102:105], v[50:65]
    s_add_u32 m0, s21, 151552
    ds_read_b128 a[240:243], v118 offset:7168
    v_exp_f32 v39, v39
    v_exp_f32 v40, v40
    v_exp_f32 v41, v41
    v_exp_f32 v42, v42
    v_smfmac_f32_32x32x32_bf16 v[82:97], a[248:251], v[18:25], v253
    s_add_u32 s68, s64, 397312
    s_addc_u32 s69, s65, 0
    ds_read_b128 a[248:251], v120 offset:6144
    global_load_lds_dwordx4 v119, s[68:69] offset:0 sc1
    v_exp_f32 v43, v43
    v_exp_f32 v44, v44
    v_exp_f32 v45, v45
    v_smfmac_f32_32x32x32_bf16 v[82:97], a[252:255], v[26:33], v253
    s_waitcnt lgkmcnt(1)
    ds_read_b128 a[252:255], v120 offset:6912
    global_load_lds_dwordx4 v119, s[68:69] offset:1024 sc1
    v_exp_f32 v46, v46
    v_exp_f32 v47, v47
    v_exp_f32 v48, v48
    v_exp_f32 v49, v49
    v_mfma_f32_32x32x8_bf16 v[18:33], a[246:247], v[106:107], 0
    v_exp_f32 v50, v50
    v_exp_f32 v51, v51
    v_exp_f32 v52, v52
    v_exp_f32 v53, v53
    v_exp_f32 v54, v54
    v_mfma_f32_32x32x16_bf16 v[18:33], a[240:243], v[98:101], v[18:33]
    s_waitcnt lgkmcnt(1)
    global_load_lds_dwordx4 v119, s[68:69] offset:2048 sc1
    v_exp_f32 v55, v55
    v_exp_f32 v56, v56
    v_exp_f32 v57, v57
    v_exp_f32 v58, v58
    v_smfmac_f32_32x32x32_bf16 v[66:81], a[248:251], v[34:41], v253
    s_waitcnt lgkmcnt(0)
    s_add_u32 m0, s5, 0
    s_add_u32 s70, s44, 0
    s_addc_u32 s71, s45, 0
    global_load_lds_dwordx4 v232, s[70:71] offset:0 sc1
    v_exp_f32 v59, v59
    v_exp_f32 v60, v60
    v_exp_f32 v61, v61
    v_smfmac_f32_32x32x32_bf16 v[66:81], a[252:255], v[42:49], v253
    s_waitcnt vmcnt(5)
    global_load_lds_dwordx4 v232, s[70:71] offset:1024 sc1
    v_exp_f32 v62, v62
    v_exp_f32 v63, v63
    v_exp_f32 v64, v64
    v_exp_f32 v65, v65
    v_mfma_f32_32x32x8_bf16 v[34:49], a[246:247], v[108:109], 0
    global_load_lds_dwordx4 v232, s[70:71] offset:2048 sc1
    v_exp_f32 v18, v18
    v_exp_f32 v19, v19
    v_max3_u32 v2, v178, v179, v180
    v_max3_u32 v2, v2, v181, v182
    v_max3_u32 v2, v2, v183, v184
    v_max3_u32 v2, v2, v185, v186
    v_max3_u32 v2, v2, v187, v188
    v_max_u32 v2, v2, v189
    v_cmp_eq_u32 vcc, -1, v2
    v_mfma_f32_32x32x16_bf16 v[34:49], a[240:243], v[102:105], v[34:49]
    ds_read2st64_b64 a[244:247], v121 offset0:28 offset1:29
    ds_read_b128 a[240:243], v118 offset:12288
    global_load_lds_dwordx4 v232, s[70:71] offset:3072 sc1
    s_cbranch_vccnz L_retry_7
L_ok_8:
    v_exp_f32 v20, v20
    v_exp_f32 v21, v21
    v_exp_f32 v22, v22
    v_exp_f32 v23, v23
    v_pk_fma_f32 v[10:11], v[210:211], v[178:179], v[180:181] op_sel:[1,1,0] op_sel_hi:[1,0,1] neg_lo:[1,0,0]
    v_pk_fma_f32 v[2:3], v[210:211], v[178:179], v[10:11] op_sel:[0,0,0] op_sel_hi:[0,1,1]
    v_pk_fma_f32 v[10:11], v[210:211], v[2:3], v[182:183] op_sel:[1,1,0] op_sel_hi:[1,0,1] neg_lo:[1,0,0]
    v_pk_fma_f32 v[2:3], v[210:211], v[2:3], v[10:11] op_sel:[0,0,0] op_sel_hi:[0,1,1]
    v_pk_fma_f32 v[10:11], v[210:211], v[2:3], v[184:185] op_sel:[1,1,0] op_sel_hi:[1,0,1] neg_lo:[1,0,0]
    v_pk_fma_f32 v[2:3], v[210:211], v[2:3], v[10:11] op_sel:[0,0,0] op_sel_hi:[0,1,1]
    v_pk_fma_f32 v[10:11], v[210:211], v[2:3], v[186:187] op_sel:[1,1,0] op_sel_hi:[1,0,1] neg_lo:[1,0,0]
    v_pk_fma_f32 v[2:3], v[210:211], v[2:3], v[10:11] op_sel:[0,0,0] op_sel_hi:[0,1,1]
    v_pk_fma_f32 v[10:11], v[210:211], v[2:3], v[188:189] op_sel:[1,1,0] op_sel_hi:[1,0,1] neg_lo:[1,0,0]
    v_smfmac_f32_32x32x32_bf16 v[82:97], a[248:251], v[50:57], v253
    s_add_u32 m0, s5, 4096
    ds_read_b128 a[248:251], v120 offset:7680
    v_exp_f32 v24, v24
    v_exp_f32 v25, v25
    v_exp_f32 v26, v26
    v_exp_f32 v27, v27
    v_exp_f32 v28, v28
    v_pk_fma_f32 v[2:3], v[210:211], v[2:3], v[10:11] op_sel:[0,0,0] op_sel_hi:[0,1,1]
    v_mov_b64 v[4:5], v[2:3]
    s_nop 1
    v_permlane16_swap_b32 v4, v2
    v_permlane16_swap_b32 v5, v3
    v_pk_fma_f32 v[8:9], v[212:213], v[4:5], v[2:3] op_sel:[1,1,0] op_sel_hi:[1,0,1] neg_lo:[1,0,0]
    v_pk_fma_f32 v[2:3], v[212:213], v[4:5], v[8:9] op_sel:[0,0,0] op_sel_hi:[0,1,1]
    v_mov_b64 v[4:5], v[2:3]
    s_nop 1
    v_permlane32_swap_b32 v4, v2
    v_permlane32_swap_b32 v5, v3
    v_pk_fma_f32 v[8:9], v[214:215], v[4:5], v[2:3] op_sel:[1,1,0] op_sel_hi:[1,0,1] neg_lo:[1,0,0]
    v_smfmac_f32_32x32x32_bf16 v[82:97], a[252:255], v[58:65], v253
    s_waitcnt lgkmcnt(1)
    s_add_u32 s70, s44, 4096
    s_addc_u32 s71, s45, 0
    ds_read_b128 a[252:255], v120 offset:8448
    global_load_lds_dwordx4 v232, s[70:71] offset:0 sc1
    v_exp_f32 v29, v29
    v_exp_f32 v30, v30
    v_exp_f32 v31, v31
    v_exp_f32 v32, v32
    v_exp_f32 v33, v33
    v_pk_fma_f32 v[2:3], v[214:215], v[4:5], v[8:9] op_sel:[0,0,0] op_sel_hi:[0,1,1]
    v_pk_fma_f32 v[10:11], v[218:219], v[2:3], v[222:223] op_sel:[1,1,0] op_sel_hi:[1,0,1] neg_lo:[1,0,0]
    v_pk_fma_f32 v[2:3], v[218:219], v[2:3], v[10:11] op_sel:[0,0,0] op_sel_hi:[0,1,1]
    v_pk_fma_f32 v[10:11], v[216:217], v[2:3], v[220:221] op_sel:[1,1,0] op_sel_hi:[1,0,1] neg_lo:[1,0,0]
L_pad_n4:
    s_cmp_eq_u32 s37, 1
    s_cbranch_scc1 L_pad_n7
    v_pk_fma_f32 v[2:3], v[216:217], v[2:3], v[10:11] op_sel:[0,0,0] op_sel_hi:[0,1,1]
    v_pk_fma_f32 v[10:11], v[250:251], v[2:3], v[114:115] op_sel:[1,1,0] op_sel_hi:[1,0,1] neg_lo:[1,0,0]
    v_pk_fma_f32 v[4:5], v[250:251], v[2:3], v[10:11] op_sel:[0,0,0] op_sel_hi:[0,1,1]
    v_swap_b32 v3, v4
    v_pk_fma_f32 v[130:131], v[202:203], v[4:5], v[130:131] op_sel:[1,0,0] op_sel_hi:[1,1,1] neg_lo:[1,0,0] neg_hi:[1,0,0]
    v_mfma_f32_32x32x8_bf16 v[50:65], a[244:245], v[106:107], 0
    v_exp_f32 v34, v34
    v_exp_f32 v35, v35
    v_exp_f32 v36, v36
    v_exp_f32 v37, v37
    v_exp_f32 v38, v38
    v_pk_fma_f32 v[134:135], v[202:203], v[2:3], v[134:135] op_sel:[1,0,0] op_sel_hi:[1,1,1]
    v_pk_fma_f32 v[130:131], v[202:203], v[2:3], v[130:131] op_sel:[0,0,0] op_sel_hi:[0,1,1]
    v_pk_fma_f32 v[134:135], v[202:203], v[4:5], v[134:135] op_sel:[0,0,0] op_sel_hi:[0,1,1]
    v_pk_fma_f32 v[132:133], v[202:203], v[134:135], v[132:133] op_sel:[1,0,0] op_sel_hi:[1,1,1] neg_lo:[1,0,0] neg_hi:[1,0,0]
    v_pk_fma_f32 v[136:137], v[202:203], v[130:131], v[136:137] op_sel:[1,0,0] op_sel_hi:[1,1,1]
    v_pk_fma_f32 v[132:133], v[202:203], v[130:131], v[132:133] op_sel:[0,0,0] op_sel_hi:[0,1,1]
    v_pk_fma_f32 v[136:137], v[202:203], v[134:135], v[136:137] op_sel:[0,0,0] op_sel_hi:[0,1,1]
    v_cvt_pk_bf16_f32 v178, v130, v132
    v_cvt_pk_bf16_f32 v190, -v134, -v136
    v_mfma_f32_32x32x16_bf16 v[50:65], a[240:243], v[98:101], v[50:65]
    s_waitcnt lgkmcnt(0)
    s_add_u32 m0, s5, 20480
    s_add_u32 s70, s44, 20480
    s_addc_u32 s71, s45, 0
    global_load_lds_dwordx4 v232, s[70:71] offset:0 sc1
    v_exp_f32 v39, v39
    v_exp_f32 v40, v40
    v_exp_f32 v41, v41
    v_exp_f32 v42, v42
    v_cvt_pk_bf16_f32 v184, v131, v133
    v_cvt_pk_bf16_f32 v196, -v135, -v137
    v_pk_fma_f32 v[138:139], v[202:203], v[136:137], v[138:139] op_sel:[1,0,0] op_sel_hi:[1,1,1] neg_lo:[1,0,0] neg_hi:[1,0,0]
    v_pk_fma_f32 v[142:143], v[202:203], v[132:133], v[142:143] op_sel:[1,0,0] op_sel_hi:[1,1,1]
    v_pk_fma_f32 v[138:139], v[202:203], v[132:133], v[138:139] op_sel:[0,0,0] op_sel_hi:[0,1,1]
    v_pk_fma_f32 v[142:143], v[202:203], v[136:137], v[142:143] op_sel:[0,0,0] op_sel_hi:[0,1,1]
    v_pk_fma_f32 v[140:141], v[202:203], v[142:143], v[140:141] op_sel:[1,0,0] op_sel_hi:[1,1,1] neg_lo:[1,0,0] neg_hi:[1,0,0]
    v_pk_fma_f32 v[144:145], v[202:203], v[138:139], v[144:145] op_sel:[1,0,0] op_sel_hi:[1,1,1]
    v_pk_fma_f32 v[140:141], v[202:203], v[138:139], v[140:141] op_sel:[0,0,0] op_sel_hi:[0,1,1]
    v_smfmac_f32_32x32x32_bf16 v[66:81], a[248:251], v[18:25], v253
    global_load_lds_dwordx4 v232, s[70:71] offset:1024 sc1
    v_exp_f32 v43, v43
    v_exp_f32 v44, v44
    v_exp_f32 v45, v45
    v_pk_fma_f32 v[144:145], v[202:203], v[142:143], v[144:145] op_sel:[0,0,0] op_sel_hi:[0,1,1]
    v_cvt_pk_bf16_f32 v179, v138, v140
    v_cvt_pk_bf16_f32 v191, -v142, -v144
    v_cvt_pk_bf16_f32 v185, v139, v141
    v_cvt_pk_bf16_f32 v197, -v143, -v145
    v_pk_fma_f32 v[146:147], v[202:203], v[144:145], v[146:147] op_sel:[1,0,0] op_sel_hi:[1,1,1] neg_lo:[1,0,0] neg_hi:[1,0,0]
    v_pk_fma_f32 v[150:151], v[202:203], v[140:141], v[150:151] op_sel:[1,0,0] op_sel_hi:[1,1,1]
    v_pk_fma_f32 v[146:147], v[202:203], v[140:141], v[146:147] op_sel:[0,0,0] op_sel_hi:[0,1,1]
    v_pk_fma_f32 v[150:151], v[202:203], v[144:145], v[150:151] op_sel:[0,0,0] op_sel_hi:[0,1,1]
    v_smfmac_f32_32x32x32_bf16 v[66:81], a[252:255], v[26:33], v253
    global_load_lds_dwordx4 v232, s[70:71] offset:2048 sc1
    v_exp_f32 v46, v46
    v_exp_f32 v47, v47
    v_exp_f32 v48, v48
    v_exp_f32 v49, v49
    v_pk_fma_f32 v[148:149], v[202:203], v[150:151], v[148:149] op_sel:[1,0,0] op_sel_hi:[1,1,1] neg_lo:[1,0,0] neg_hi:[1,0,0]
    v_pk_fma_f32 v[152:153], v[202:203], v[146:147], v[152:153] op_sel:[1,0,0] op_sel_hi:[1,1,1]
    v_pk_fma_f32 v[148:149], v[202:203], v[146:147], v[148:149] op_sel:[0,0,0] op_sel_hi:[0,1,1]
    v_pk_fma_f32 v[152:153], v[202:203], v[150:151], v[152:153] op_sel:[0,0,0] op_sel_hi:[0,1,1]
    v_cvt_pk_bf16_f32 v180, v146, v148
    v_cvt_pk_bf16_f32 v192, -v150, -v152
    v_cvt_pk_bf16_f32 v186, v147, v149
    v_cvt_pk_bf16_f32 v198, -v151, -v153
    v_pk_fma_f32 v[154:155], v[202:203], v[152:153], v[154:155] op_sel:[1,0,0] op_sel_hi:[1,1,1] neg_lo:[1,0,0] neg_hi:[1,0,0]
    v_mfma_f32_32x32x8_bf16 v[18:33], a[244:245], v[108:109], 0
    v_exp_f32 v50, v50
    v_exp_f32 v51, v51
    v_exp_f32 v52, v52
    v_exp_f32 v53, v53
    v_exp_f32 v54, v54
    v_pk_fma_f32 v[158:159], v[202:203], v[148:149], v[158:159] op_sel:[1,0,0] op_sel_hi:[1,1,1]
    v_pk_fma_f32 v[154:155], v[202:203], v[148:149], v[154:155] op_sel:[0,0,0] op_sel_hi:[0,1,1]
    v_pk_fma_f32 v[158:159], v[202:203], v[152:153], v[158:159] op_sel:[0,0,0] op_sel_hi:[0,1,1]
    v_pk_fma_f32 v[156:157], v[202:203], v[158:159], v[156:157] op_sel:[1,0,0] op_sel_hi:[1,1,1] neg_lo:[1,0,0] neg_hi:[1,0,0]
    v_pk_fma_f32 v[160:161], v[202:203], v[154:155], v[160:161] op_sel:[1,0,0] op_sel_hi:[1,1,1]
    v_pk_fma_f32 v[156:157], v[202:203], v[154:155], v[156:157] op_sel:[0,0,0] op_sel_hi:[0,1,1]
    v_pk_fma_f32 v[160:161], v[202:203], v[158:159], v[160:161] op_sel:[0,0,0] op_sel_hi:[0,1,1]
    v_cvt_pk_bf16_f32 v181, v154, v156
    v_cvt_pk_bf16_f32 v193, -v158, -v160
    v_mfma_f32_32x32x16_bf16 v[18:33], a[240:243], v[102:105], v[18:33]
    ds_read_b128 a[240:243], v118 offset:13312
    global_load_lds_dwordx4 v232, s[70:71] offset:3072 sc1
    v_exp_f32 v55, v55
    v_exp_f32 v56, v56
    v_exp_f32 v57, v57
    v_exp_f32 v58, v58
    v_cvt_pk_bf16_f32 v187, v155, v157
    v_cvt_pk_bf16_f32 v199, -v159, -v161
    v_pk_fma_f32 v[162:163], v[202:203], v[160:161], v[162:163] op_sel:[1,0,0] op_sel_hi:[1,1,1] neg_lo:[1,0,0] neg_hi:[1,0,0]
    v_pk_fma_f32 v[166:167], v[202:203], v[156:157], v[166:167] op_sel:[1,0,0] op_sel_hi:[1,1,1]
    v_pk_fma_f32 v[162:163], v[202:203], v[156:157], v[162:163] op_sel:[0,0,0] op_sel_hi:[0,1,1]
    v_pk_fma_f32 v[166:167], v[202:203], v[160:161], v[166:167] op_sel:[0,0,0] op_sel_hi:[0,1,1]
    v_pk_fma_f32 v[164:165], v[202:203], v[166:167], v[164:165] op_sel:[1,0,0] op_sel_hi:[1,1,1] neg_lo:[1,0,0] neg_hi:[1,0,0]
    v_pk_fma_f32 v[168:169], v[202:203], v[162:163], v[168:169] op_sel:[1,0,0] op_sel_hi:[1,1,1]
    v_pk_fma_f32 v[164:165], v[202:203], v[162:163], v[164:165] op_sel:[0,0,0] op_sel_hi:[0,1,1]
    v_smfmac_f32_32x32x32_bf16 v[82:97], a[248:251], v[34:41], v253
    s_add_u32 m0, s5, 24576
    ds_read_b128 a[248:251], v120 offset:12288
    v_exp_f32 v59, v59
    v_exp_f32 v60, v60
    v_exp_f32 v61, v61
    v_exp_f32 v62, v62
    v_pk_fma_f32 v[168:169], v[202:203], v[166:167], v[168:169] op_sel:[0,0,0] op_sel_hi:[0,1,1]
    v_cvt_pk_bf16_f32 v182, v162, v164
    v_cvt_pk_bf16_f32 v194, -v166, -v168
    v_cvt_pk_bf16_f32 v188, v163, v165
    v_cvt_pk_bf16_f32 v200, -v167, -v169
    v_pk_fma_f32 v[170:171], v[202:203], v[168:169], v[170:171] op_sel:[1,0,0] op_sel_hi:[1,1,1] neg_lo:[1,0,0] neg_hi:[1,0,0]
    v_pk_fma_f32 v[174:175], v[202:203], v[164:165], v[174:175] op_sel:[1,0,0] op_sel_hi:[1,1,1]
    v_pk_fma_f32 v[170:171], v[202:203], v[164:165], v[170:171] op_sel:[0,0,0] op_sel_hi:[0,1,1]
    v_pk_fma_f32 v[174:175], v[202:203], v[168:169], v[174:175] op_sel:[0,0,0] op_sel_hi:[0,1,1]
    v_smfmac_f32_32x32x32_bf16 v[82:97], a[252:255], v[42:49], v253
    s_waitcnt lgkmcnt(1)
    s_add_u32 s70, s44, 24576
    s_addc_u32 s71, s45, 0
    ds_read_b128 a[252:255], v120 offset:13056
    global_load_lds_dwordx4 v232, s[70:71] offset:0 sc1
    v_exp_f32 v63, v63
    v_exp_f32 v64, v64
    v_exp_f32 v65, v65
    v_pk_fma_f32 v[172:173], v[202:203], v[174:175], v[172:173] op_sel:[1,0,0] op_sel_hi:[1,1,1] neg_lo:[1,0,0] neg_hi:[1,0,0]
    v_pk_fma_f32 v[176:177], v[202:203], v[170:171], v[176:177] op_sel:[1,0,0] op_sel_hi:[1,1,1]
    v_pk_fma_f32 v[172:173], v[202:203], v[170:171], v[172:173] op_sel:[0,0,0] op_sel_hi:[0,1,1]
    v_pk_fma_f32 v[176:177], v[202:203], v[174:175], v[176:177] op_sel:[0,0,0] op_sel_hi:[0,1,1]
    v_cvt_pk_bf16_f32 v183, v170, v172
    v_cvt_pk_bf16_f32 v195, -v174, -v176
    v_cvt_pk_bf16_f32 v189, v171, v173
    v_cvt_pk_bf16_f32 v201, -v175, -v177
    v_mfma_f32_32x32x8_bf16 v[34:49], a[246:247], v[106:107], 0
    v_exp_f32 v18, v18
    v_exp_f32 v19, v19
    v_exp_f32 v20, v20
    v_exp_f32 v21, v21
    v_exp_f32 v22, v22
    v_exp_f32 v23, v23
    v_mfma_f32_32x32x16_bf16 v[34:49], a[240:243], v[98:101], v[34:49]
    s_waitcnt lgkmcnt(0)
    ds_write_b128 v224, v[178:181] offset:0
    v_exp_f32 v24, v24
    v_exp_f32 v25, v25
    v_exp_f32 v26, v26
    v_exp_f32 v27, v27
    v_smfmac_f32_32x32x32_bf16 v[66:81], a[248:251], v[50:57], v253
    ds_write_b128 v224, v[190:193] offset:3328
    v_exp_f32 v28, v28
    v_exp_f32 v29, v29
    v_exp_f32 v30, v30
    v_smfmac_f32_32x32x32_bf16 v[66:81], a[252:255], v[58:65], v253
    ds_write_b128 v224, v[182:185] offset:16
    v_exp_f32 v31, v31
    v_exp_f32 v32, v32
    v_exp_f32 v33, v33
    v_mfma_f32_32x32x8_bf16 v[50:65], a[246:247], v[108:109], 0
    v_exp_f32 v34, v34
    v_exp_f32 v35, v35
    v_exp_f32 v36, v36
    v_exp_f32 v37, v37
    v_exp_f32 v38, v38
    v_exp_f32 v39, v39
    v_exp_f32 v40, v40
    v_mfma_f32_32x32x16_bf16 v[50:65], a[240:243], v[102:105], v[50:65]
    ds_read2st64_b64 a[244:247], v121 offset0:40 offset1:41
    ds_read_b128 a[240:243], v118 offset:18432
    ds_write_b128 v224, v[194:197] offset:3344
    v_exp_f32 v41, v41
    v_exp_f32 v42, v42
    v_exp_f32 v43, v43
    v_smfmac_f32_32x32x32_bf16 v[82:97], a[248:251], v[18:25], v253
    ds_read_b128 a[248:251], v120 offset:13824
    ds_write_b128 v224, v[186:189] offset:32
    v_exp_f32 v44, v44
    v_exp_f32 v45, v45
    v_exp_f32 v46, v46
    v_smfmac_f32_32x32x32_bf16 v[82:97], a[252:255], v[26:33], v253
    s_waitcnt vmcnt(10) lgkmcnt(3)
    ds_read_b128 a[252:255], v120 offset:14592
    ds_write_b128 v224, v[198:201] offset:3360
    v_exp_f32 v47, v47
    v_exp_f32 v48, v48
    v_exp_f32 v49, v49
    v_mfma_f32_32x32x8_bf16 v[18:33], a[244:245], v[106:107], 0
    s_barrier
    v_exp_f32 v50, v50
    v_exp_f32 v51, v51
    v_exp_f32 v52, v52
    v_exp_f32 v53, v53
    v_mfma_f32_32x32x16_bf16 v[18:33], a[240:243], v[98:101], v[18:33]
    s_waitcnt lgkmcnt(2)
    ds_read_b64_tr_b16 v[130:131], v225 offset:0
    ds_read_b64_tr_b16 v[132:133], v225 offset:832
    v_exp_f32 v54, v54
    v_exp_f32 v55, v55
    v_exp_f32 v56, v56
    v_exp_f32 v57, v57
    v_smfmac_f32_32x32x32_bf16 v[66:81], a[248:251], v[34:41], v253
    s_waitcnt lgkmcnt(2)
    ds_read_b64_tr_b16 v[134:135], v225 offset:32
    ds_read_b64_tr_b16 v[136:137], v225 offset:864
    v_exp_f32 v58, v58
    v_exp_f32 v59, v59
    v_exp_f32 v60, v60
    v_exp_f32 v61, v61
    v_smfmac_f32_32x32x32_bf16 v[66:81], a[252:255], v[42:49], v253
    ds_read_b64_tr_b16 v[138:139], v225 offset:64
    ds_read_b64_tr_b16 v[140:141], v225 offset:896
    v_exp_f32 v62, v62
    v_exp_f32 v63, v63
    v_exp_f32 v64, v64
    v_exp_f32 v65, v65
    v_mfma_f32_32x32x8_bf16 v[34:49], a[244:245], v[108:109], 0
    v_exp_f32 v18, v18
    v_exp_f32 v19, v19
    v_exp_f32 v20, v20
    v_exp_f32 v21, v21
    v_exp_f32 v22, v22
    v_exp_f32 v23, v23
    v_mfma_f32_32x32x16_bf16 v[34:49], a[240:243], v[102:105], v[34:49]
    s_add_u32 m0, s21, 126976
    ds_read_b128 a[240:243], v118 offset:19456
    ds_read_b64_tr_b16 v[142:143], v225 offset:96
    ds_read_b64_tr_b16 v[144:145], v225 offset:928
    v_exp_f32 v24, v24
    v_exp_f32 v25, v25
    v_exp_f32 v26, v26
    v_exp_f32 v27, v27
    v_smfmac_f32_32x32x32_bf16 v[82:97], a[248:251], v[50:57], v253
    s_add_u32 s68, s64, 409600
    s_addc_u32 s69, s65, 0
    ds_read_b128 a[248:251], v120 offset:18432
    global_load_lds_dwordx4 v119, s[68:69] offset:0 sc1
    ds_read_b64_tr_b16 v[146:147], v225 offset:128
    ds_read_b64_tr_b16 v[148:149], v225 offset:960
    v_exp_f32 v28, v28
    v_exp_f32 v29, v29
    v_exp_f32 v30, v30
    v_smfmac_f32_32x32x32_bf16 v[82:97], a[252:255], v[58:65], v253
    s_waitcnt lgkmcnt(5)
    ds_read_b128 a[252:255], v120 offset:19200
    global_load_lds_dwordx4 v119, s[68:69] offset:1024 sc1
    ds_read_b64_tr_b16 v[150:151], v225 offset:160
    ds_read_b64_tr_b16 v[152:153], v225 offset:992
    v_exp_f32 v31, v31
    v_exp_f32 v32, v32
    v_exp_f32 v33, v33
    v_mfma_f32_32x32x8_bf16 v[50:65], a[246:247], v[106:107], 0
    v_exp_f32 v34, v34
    v_exp_f32 v35, v35
    v_exp_f32 v36, v36
    v_exp_f32 v37, v37
    v_exp_f32 v38, v38
    v_mfma_f32_32x32x16_bf16 v[50:65], a[240:243], v[98:101], v[50:65]
    s_waitcnt lgkmcnt(3)
    global_load_lds_dwordx4 v119, s[68:69] offset:2048 sc1
    v_exp_f32 v39, v39
    v_exp_f32 v40, v40
    v_exp_f32 v41, v41
    v_exp_f32 v42, v42
    v_smfmac_f32_32x32x32_bf16 v[66:81], a[248:251], v[18:25], v253
    s_waitcnt lgkmcnt(0)
    buffer_store_dwordx4 v[130:133], v110, s[64:67], s46 offen sc1
    v_exp_f32 v43, v43
    v_exp_f32 v44, v44
    v_exp_f32 v45, v45
    v_smfmac_f32_32x32x32_bf16 v[66:81], a[252:255], v[26:33], v253
    s_add_u32 s46, s46, 40960
    v_exp_f32 v46, v46
    v_exp_f32 v47, v47
    v_exp_f32 v48, v48
    v_exp_f32 v49, v49
    v_mfma_f32_32x32x8_bf16 v[18:33], a[246:247], v[108:109], 0
    v_exp_f32 v50, v50
    v_exp_f32 v51, v51
    v_exp_f32 v52, v52
    v_exp_f32 v53, v53
    v_exp_f32 v54, v54
    v_mfma_f32_32x32x16_bf16 v[18:33], a[240:243], v[102:105], v[18:33]
    ds_read2st64_b64 a[244:247], v121 offset0:52 offset1:53
    ds_read_b128 a[240:243], v118 offset:24576
    buffer_store_dwordx4 v[134:137], v110, s[64:67], s46 offen sc1
    v_exp_f32 v55, v55
    v_exp_f32 v56, v56
    v_exp_f32 v57, v57
    v_smfmac_f32_32x32x32_bf16 v[82:97], a[248:251], v[34:41], v253
    s_add_u32 s46, s46, 40960
    ds_read_b128 a[248:251], v120 offset:19968
    buffer_store_dwordx4 v[138:141], v110, s[64:67], s46 offen sc1
    v_exp_f32 v58, v58
    v_exp_f32 v59, v59
    v_exp_f32 v60, v60
    v_exp_f32 v61, v61
    v_smfmac_f32_32x32x32_bf16 v[82:97], a[252:255], v[42:49], v253
    s_waitcnt lgkmcnt(1)
    s_add_u32 s46, s46, 40960
    ds_read_b128 a[252:255], v120 offset:20736
    v_exp_f32 v62, v62
    v_exp_f32 v63, v63
    v_exp_f32 v64, v64
    v_exp_f32 v65, v65
    v_mfma_f32_32x32x8_bf16 v[34:49], a[244:245], v[106:107], 0
    v_exp_f32 v18, v18
    v_exp_f32 v19, v19
    v_exp_f32 v20, v20
    v_exp_f32 v21, v21
    v_add_u32 v245, s28, v245
    v_add_u32 v246, s28, v246
    v_mfma_f32_32x32x16_bf16 v[34:49], a[240:243], v[98:101], v[34:49]
    s_waitcnt lgkmcnt(1)
    buffer_store_dwordx4 v[142:145], v110, s[64:67], s46 offen sc1
    v_exp_f32 v22, v22
    v_exp_f32 v23, v23
    v_exp_f32 v24, v24
    v_exp_f32 v25, v25
    v_add_u32 v247, s28, v247
    v_smfmac_f32_32x32x32_bf16 v[66:81], a[248:251], v[50:57], v253
    s_waitcnt lgkmcnt(0)
    s_add_u32 s46, s46, 40960
    buffer_store_dwordx4 v[146:149], v110, s[64:67], s46 offen sc1
    v_exp_f32 v26, v26
    v_exp_f32 v27, v27
    v_exp_f32 v28, v28
    v_exp_f32 v29, v29
    v_add_u32 v240, s29, v240
    v_smfmac_f32_32x32x32_bf16 v[66:81], a[252:255], v[58:65], v253
    s_add_u32 s46, s46, 40960
    v_exp_f32 v30, v30
    v_exp_f32 v31, v31
    v_exp_f32 v32, v32
    v_exp_f32 v33, v33
    v_add_u32 v241, s29, v241
    v_mfma_f32_32x32x8_bf16 v[50:65], a[244:245], v[108:109], 0
    v_exp_f32 v34, v34
    v_exp_f32 v35, v35
    v_exp_f32 v36, v36
    v_exp_f32 v37, v37
    v_exp_f32 v38, v38
    v_mfma_f32_32x32x16_bf16 v[50:65], a[240:243], v[102:105], v[50:65]
    ds_read_b128 a[240:243], v118 offset:25600
    v_exp_f32 v39, v39
    v_exp_f32 v40, v40
    v_exp_f32 v41, v41
    v_exp_f32 v42, v42
    v_smfmac_f32_32x32x32_bf16 v[82:97], a[248:251], v[18:25], v253
    ds_read_b128 a[248:251], v120 offset:24576
    v_exp_f32 v43, v43
    v_exp_f32 v44, v44
    v_exp_f32 v45, v45
    v_exp_f32 v46, v46
    v_smfmac_f32_32x32x32_bf16 v[82:97], a[252:255], v[26:33], v253
    s_waitcnt lgkmcnt(1)
    ds_read_b128 a[252:255], v120 offset:25344
    buffer_store_dwordx4 v[150:153], v110, s[64:67], s46 offen sc1
    v_exp_f32 v47, v47
    v_exp_f32 v48, v48
    v_exp_f32 v49, v49
    v_mfma_f32_32x32x8_bf16 v[18:33], a[246:247], v[106:107], 0
    v_exp_f32 v50, v50
    v_exp_f32 v51, v51
    v_exp_f32 v52, v52
    v_exp_f32 v53, v53
    v_exp_f32 v54, v54
    v_mfma_f32_32x32x16_bf16 v[18:33], a[240:243], v[98:101], v[18:33]
    s_waitcnt lgkmcnt(1)
    v_exp_f32 v55, v55
    v_exp_f32 v56, v56
    v_exp_f32 v57, v57
    v_exp_f32 v58, v58
    v_smfmac_f32_32x32x32_bf16 v[66:81], a[248:251], v[34:41], v253
    s_waitcnt lgkmcnt(0)
    v_exp_f32 v59, v59
    v_exp_f32 v60, v60
    v_exp_f32 v61, v61
    v_exp_f32 v62, v62
    v_smfmac_f32_32x32x32_bf16 v[66:81], a[252:255], v[42:49], v253
    global_load_dwordx2 v[178:179], v245, s[14:15] offset:0
    v_exp_f32 v63, v63
    v_exp_f32 v64, v64
    v_exp_f32 v65, v65
    v_mfma_f32_32x32x8_bf16 v[34:49], a[246:247], v[108:109], 0
    v_exp_f32 v18, v18
    v_exp_f32 v19, v19
    v_exp_f32 v20, v20
    v_exp_f32 v21, v21
    v_exp_f32 v22, v22
    v_mfma_f32_32x32x16_bf16 v[34:49], a[240:243], v[102:105], v[34:49]
    ds_read2st64_b64 a[244:247], v121 offset0:64 offset1:65
    ds_read_b128 a[240:243], v118 offset:30720
    v_exp_f32 v23, v23
    v_exp_f32 v24, v24
    v_exp_f32 v25, v25
    v_exp_f32 v26, v26
    v_smfmac_f32_32x32x32_bf16 v[82:97], a[248:251], v[50:57], v253
    ds_read_b128 a[248:251], v120 offset:26112
    v_exp_f32 v27, v27
    v_exp_f32 v28, v28
    v_exp_f32 v29, v29
    v_exp_f32 v30, v30
    v_smfmac_f32_32x32x32_bf16 v[82:97], a[252:255], v[58:65], v253
    s_waitcnt lgkmcnt(1)
    ds_read_b128 a[252:255], v120 offset:26880
    global_load_dwordx2 v[180:181], v246, s[14:15] offset:0
    v_exp_f32 v31, v31
    v_exp_f32 v32, v32
    v_exp_f32 v33, v33
    v_mfma_f32_32x32x8_bf16 v[50:65], a[244:245], v[106:107], 0
    v_exp_f32 v34, v34
    v_exp_f32 v35, v35
    v_exp_f32 v36, v36
    v_exp_f32 v37, v37
    v_exp_f32 v38, v38
    v_mfma_f32_32x32x16_bf16 v[50:65], a[240:243], v[98:101], v[50:65]
    s_waitcnt lgkmcnt(1)
    v_exp_f32 v39, v39
    v_exp_f32 v40, v40
    v_exp_f32 v41, v41
    v_exp_f32 v42, v42
    v_smfmac_f32_32x32x32_bf16 v[66:81], a[248:251], v[18:25], v253
    s_waitcnt vmcnt(8) lgkmcnt(0)
    s_barrier
    v_exp_f32 v43, v43
    v_exp_f32 v44, v44
    v_exp_f32 v45, v45
    v_smfmac_f32_32x32x32_bf16 v[66:81], a[252:255], v[26:33], v253
    global_load_dwordx2 v[182:183], v240, s[14:15] offset:0
    v_exp_f32 v46, v46
    v_exp_f32 v47, v47
    v_exp_f32 v48, v48
    v_exp_f32 v49, v49
    v_mfma_f32_32x32x8_bf16 v[18:33], a[244:245], v[108:109], 0
    v_exp_f32 v50, v50
    v_exp_f32 v51, v51
    v_exp_f32 v52, v52
    v_exp_f32 v53, v53
    v_exp_f32 v54, v54
    v_mfma_f32_32x32x16_bf16 v[18:33], a[240:243], v[102:105], v[18:33]
    ds_read_b128 a[240:243], v118 offset:31744
    global_load_dwordx2 v[184:185], v245, s[14:15] offset:64
    v_exp_f32 v55, v55
    v_exp_f32 v56, v56
    v_exp_f32 v57, v57
    v_exp_f32 v58, v58
    v_smfmac_f32_32x32x32_bf16 v[82:97], a[248:251], v[34:41], v253
    s_add_u32 m0, s21, 139264
    ds_read_b128 a[248:251], v120 offset:30720
    v_exp_f32 v59, v59
    v_exp_f32 v60, v60
    v_exp_f32 v61, v61
    v_exp_f32 v62, v62
    v_smfmac_f32_32x32x32_bf16 v[82:97], a[252:255], v[42:49], v253
    s_waitcnt lgkmcnt(1)
    s_add_u32 s68, s64, 421888
    s_addc_u32 s69, s65, 0
    ds_read_b128 a[252:255], v120 offset:31488
    global_load_lds_dwordx4 v119, s[68:69] offset:0 sc1
    v_exp_f32 v63, v63
    v_exp_f32 v64, v64
    v_exp_f32 v65, v65
    v_mfma_f32_32x32x8_bf16 v[34:49], a[246:247], v[106:107], 0
    v_exp_f32 v18, v18
    v_exp_f32 v19, v19
    v_exp_f32 v20, v20
    v_exp_f32 v21, v21
    v_exp_f32 v22, v22
    v_mfma_f32_32x32x16_bf16 v[34:49], a[240:243], v[98:101], v[34:49]
    s_waitcnt lgkmcnt(1)
    v_exp_f32 v23, v23
    v_exp_f32 v24, v24
    v_exp_f32 v25, v25
    v_exp_f32 v26, v26
    v_exp_f32 v27, v27
    v_smfmac_f32_32x32x32_bf16 v[66:81], a[248:251], v[50:57], v253
    s_waitcnt lgkmcnt(0)
    global_load_lds_dwordx4 v119, s[68:69] offset:1024 sc1
    v_exp_f32 v28, v28
    v_exp_f32 v29, v29
    v_exp_f32 v30, v30
    v_smfmac_f32_32x32x32_bf16 v[66:81], a[252:255], v[58:65], v253
    global_load_lds_dwordx4 v119, s[68:69] offset:2048 sc1
    v_exp_f32 v31, v31
    v_exp_f32 v32, v32
    v_exp_f32 v33, v33
    v_mfma_f32_32x32x8_bf16 v[50:65], a[246:247], v[108:109], 0
    v_exp_f32 v34, v34
    v_exp_f32 v35, v35
    v_exp_f32 v36, v36
    v_exp_f32 v37, v37
    v_exp_f32 v38, v38
    v_mfma_f32_32x32x16_bf16 v[50:65], a[240:243], v[102:105], v[50:65]
    ds_read2st64_b64 a[244:247], v121 offset0:4 offset1:5
    ds_read_b128 a[240:243], v118 offset:0
    v_exp_f32 v39, v39
    v_exp_f32 v40, v40
    v_exp_f32 v41, v41
    v_exp_f32 v42, v42
    v_smfmac_f32_32x32x32_bf16 v[82:97], a[248:251], v[18:25], v253
    ds_read_b128 a[248:251], v120 offset:32256
    v_exp_f32 v43, v43
    v_exp_f32 v44, v44
    v_exp_f32 v45, v45
    v_exp_f32 v46, v46
    v_smfmac_f32_32x32x32_bf16 v[82:97], a[252:255], v[26:33], v253
    s_waitcnt lgkmcnt(1)
    ds_read_b128 a[252:255], v120 offset:33024
    global_load_dwordx2 v[186:187], v246, s[14:15] offset:64
    v_exp_f32 v47, v47
    v_exp_f32 v48, v48
    v_exp_f32 v49, v49
    v_mfma_f32_32x32x8_bf16 v[18:33], a[244:245], v[106:107], 0
    v_exp_f32 v50, v50
    v_exp_f32 v51, v51
    v_exp_f32 v52, v52
    v_exp_f32 v53, v53
    v_exp_f32 v54, v54
    v_mfma_f32_32x32x16_bf16 v[18:33], a[240:243], v[98:101], v[18:33]
    s_waitcnt lgkmcnt(1)
    v_exp_f32 v55, v55
    v_exp_f32 v56, v56
    v_exp_f32 v57, v57
    v_exp_f32 v58, v58
    v_smfmac_f32_32x32x32_bf16 v[66:81], a[248:251], v[34:41], v253
    s_waitcnt lgkmcnt(0)
    v_exp_f32 v59, v59
    v_exp_f32 v60, v60
    v_exp_f32 v61, v61
    v_exp_f32 v62, v62
    v_smfmac_f32_32x32x32_bf16 v[66:81], a[252:255], v[42:49], v253
    global_load_dwordx2 v[188:189], v247, s[30:31] offset:0
    v_exp_f32 v63, v63
    v_exp_f32 v64, v64
    v_exp_f32 v65, v65
    v_mfma_f32_32x32x8_bf16 v[34:49], a[244:245], v[108:109], 0
    v_exp_f32 v18, v18
    v_exp_f32 v19, v19
    v_exp_f32 v20, v20
    v_exp_f32 v21, v21
    v_exp_f32 v22, v22
    v_mfma_f32_32x32x16_bf16 v[34:49], a[240:243], v[102:105], v[34:49]
    ds_read_b128 a[240:243], v118 offset:1024
    v_exp_f32 v23, v23
    v_exp_f32 v24, v24
    v_exp_f32 v25, v25
    v_exp_f32 v26, v26
    v_smfmac_f32_32x32x32_bf16 v[82:97], a[248:251], v[50:57], v253
    ds_read_b128 a[248:251], v120 offset:0
    v_exp_f32 v27, v27
    v_exp_f32 v28, v28
    v_exp_f32 v29, v29
    v_exp_f32 v30, v30
    v_smfmac_f32_32x32x32_bf16 v[82:97], a[252:255], v[58:65], v253
    s_waitcnt lgkmcnt(1)
    ds_read_b128 a[252:255], v120 offset:768
    global_load_dwordx2 v[190:191], v241, s[30:31] offset:0
    v_exp_f32 v31, v31
    v_exp_f32 v32, v32
    v_exp_f32 v33, v33
    v_mfma_f32_32x32x8_bf16 v[50:65], a[246:247], v[106:107], 0
    v_exp_f32 v34, v34
    v_exp_f32 v35, v35
    v_exp_f32 v36, v36
    v_exp_f32 v37, v37
    v_exp_f32 v38, v38
    v_mfma_f32_32x32x16_bf16 v[50:65], a[240:243], v[98:101], v[50:65]
    s_waitcnt lgkmcnt(1)
    global_load_dwordx2 v[192:193], v247, s[30:31] offset:64
    v_exp_f32 v39, v39
    v_exp_f32 v40, v40
    v_exp_f32 v41, v41
    v_exp_f32 v42, v42
    v_smfmac_f32_32x32x32_bf16 v[66:81], a[248:251], v[18:25], v253
    s_waitcnt vmcnt(11) lgkmcnt(0)
    s_add_u32 m0, s5, 81920
    s_add_u32 s70, s44, 81920
    s_addc_u32 s71, s45, 0
    s_barrier
    global_load_lds_dwordx4 v232, s[70:71] offset:0 sc1
    v_exp_f32 v43, v43
    v_exp_f32 v44, v44
    v_exp_f32 v45, v45
    v_smfmac_f32_32x32x32_bf16 v[66:81], a[252:255], v[26:33], v253
    global_load_lds_dwordx4 v232, s[70:71] offset:1024 sc1
    v_exp_f32 v46, v46
    v_exp_f32 v47, v47
    v_exp_f32 v48, v48
    v_exp_f32 v49, v49
    v_mfma_f32_32x32x8_bf16 v[18:33], a[246:247], v[108:109], 0
    v_exp_f32 v50, v50
    v_exp_f32 v51, v51
    v_exp_f32 v52, v52
    v_exp_f32 v53, v53
    v_exp_f32 v54, v54
    v_mfma_f32_32x32x16_bf16 v[18:33], a[240:243], v[102:105], v[18:33]
    ds_read2st64_b64 a[244:247], v121 offset0:16 offset1:17
    ds_read_b128 a[240:243], v118 offset:6144
    global_load_lds_dwordx4 v232, s[70:71] offset:2048 sc1
    v_exp_f32 v55, v55
    v_exp_f32 v56, v56
    v_exp_f32 v57, v57
    v_smfmac_f32_32x32x32_bf16 v[82:97], a[248:251], v[34:41], v253
    ds_read_b128 a[248:251], v120 offset:1536
    global_load_lds_dwordx4 v232, s[70:71] offset:3072 sc1
    v_exp_f32 v58, v58
    v_exp_f32 v59, v59
    v_exp_f32 v60, v60
    v_exp_f32 v61, v61
    v_smfmac_f32_32x32x32_bf16 v[82:97], a[252:255], v[42:49], v253
    s_waitcnt lgkmcnt(1)
    ds_read_b128 a[252:255], v120 offset:2304
    buffer_store_dword v254, v254, s[64:67], s8 offen sc1
    v_exp_f32 v62, v62
    v_exp_f32 v63, v63
    v_exp_f32 v64, v64
    v_exp_f32 v65, v65
    v_mfma_f32_32x32x8_bf16 v[34:49], a[244:245], v[106:107], 0
    v_exp_f32 v18, v18
    v_exp_f32 v19, v19
    v_exp_f32 v20, v20
    v_exp_f32 v21, v21
    v_exp_f32 v22, v22
    v_mfma_f32_32x32x16_bf16 v[34:49], a[240:243], v[98:101], v[34:49]
    s_waitcnt lgkmcnt(1)
    s_add_u32 m0, s5, 86016
    s_add_u32 s70, s44, 86016
    s_addc_u32 s71, s45, 0
    global_load_lds_dwordx4 v232, s[70:71] offset:0 sc1
    v_exp_f32 v23, v23
    v_exp_f32 v24, v24
    v_exp_f32 v25, v25
    v_exp_f32 v26, v26
    v_smfmac_f32_32x32x32_bf16 v[66:81], a[248:251], v[50:57], v253
    s_waitcnt vmcnt(10) lgkmcnt(0)
    s_add_u32 m0, s50, 102400
    s_barrier
    global_load_lds_dwordx4 v228, s[18:19] offset:0 sc0
    v_exp_f32 v27, v27
    v_exp_f32 v28, v28
    v_exp_f32 v29, v29
    v_smfmac_f32_32x32x32_bf16 v[66:81], a[252:255], v[58:65], v253
    s_add_u32 m0, s50, 106368
    v_exp_f32 v30, v30
    v_exp_f32 v31, v31
    v_exp_f32 v32, v32
    v_exp_f32 v33, v33
    v_mfma_f32_32x32x8_bf16 v[50:65], a[244:245], v[108:109], 0
    v_exp_f32 v34, v34
    v_exp_f32 v35, v35
    v_exp_f32 v36, v36
    v_exp_f32 v37, v37
    v_exp_f32 v38, v38
    v_mfma_f32_32x32x16_bf16 v[50:65], a[240:243], v[102:105], v[50:65]
    ds_read_b128 a[240:243], v118 offset:7168
    global_load_lds_dwordx4 v228, s[18:19] offset:128 sc0
    v_exp_f32 v39, v39
    v_exp_f32 v40, v40
    v_exp_f32 v41, v41
    v_exp_f32 v42, v42
    v_smfmac_f32_32x32x32_bf16 v[82:97], a[248:251], v[18:25], v253
    s_add_u32 m0, s21, 151552
    ds_read_b128 a[248:251], v120 offset:6144
    v_exp_f32 v43, v43
    v_exp_f32 v44, v44
    v_exp_f32 v45, v45
    v_exp_f32 v46, v46
    v_smfmac_f32_32x32x32_bf16 v[82:97], a[252:255], v[26:33], v253
    s_waitcnt lgkmcnt(1)
    s_add_u32 s68, s64, 434176
    s_addc_u32 s69, s65, 0
    ds_read_b128 a[252:255], v120 offset:6912
    global_load_lds_dwordx4 v119, s[68:69] offset:0 sc1
    v_exp_f32 v47, v47
    v_exp_f32 v48, v48
    v_exp_f32 v49, v49
    v_mfma_f32_32x32x8_bf16 v[18:33], a[246:247], v[106:107], 0
    v_exp_f32 v50, v50
    v_exp_f32 v51, v51
    v_exp_f32 v52, v52
    v_exp_f32 v53, v53
    v_exp_f32 v54, v54
    v_mfma_f32_32x32x16_bf16 v[18:33], a[240:243], v[98:101], v[18:33]
    s_waitcnt lgkmcnt(1)
    global_load_lds_dwordx4 v119, s[68:69] offset:1024 sc1
    v_exp_f32 v55, v55
    v_exp_f32 v56, v56
    v_exp_f32 v57, v57
    v_exp_f32 v58, v58
    v_smfmac_f32_32x32x32_bf16 v[66:81], a[248:251], v[34:41], v253
    s_waitcnt lgkmcnt(0)
    global_load_lds_dwordx4 v119, s[68:69] offset:2048 sc1
    v_exp_f32 v59, v59
    v_exp_f32 v60, v60
    v_exp_f32 v61, v61
    v_smfmac_f32_32x32x32_bf16 v[66:81], a[252:255], v[42:49], v253
    s_add_u32 m0, s50, 110336
    v_exp_f32 v62, v62
    v_exp_f32 v63, v63
    v_exp_f32 v64, v64
    v_exp_f32 v65, v65
    v_mfma_f32_32x32x8_bf16 v[34:49], a[246:247], v[108:109], 0
    v_exp_f32 v18, v18
    v_exp_f32 v19, v19
    v_exp_f32 v20, v20
    v_exp_f32 v21, v21
    v_exp_f32 v22, v22
    v_mfma_f32_32x32x16_bf16 v[34:49], a[240:243], v[102:105], v[34:49]
    ds_read2st64_b64 a[244:247], v121 offset0:28 offset1:29
    ds_read_b128 a[240:243], v118 offset:12288
    global_load_lds_dwordx4 v228, s[18:19] offset:256 sc0
    v_exp_f32 v23, v23
    v_exp_f32 v24, v24
    v_exp_f32 v25, v25
    v_smfmac_f32_32x32x32_bf16 v[82:97], a[248:251], v[50:57], v253
    s_add_u32 m0, s50, 114304
    ds_read_b128 a[248:251], v120 offset:7680
    global_load_lds_dwordx4 v228, s[18:19] offset:384 sc0
    v_exp_f32 v26, v26
    v_exp_f32 v27, v27
    v_exp_f32 v28, v28
    v_exp_f32 v29, v29
    v_smfmac_f32_32x32x32_bf16 v[82:97], a[252:255], v[58:65], v253
    s_waitcnt lgkmcnt(1)
    s_add_u32 m0, s50, 118272
    ds_read_b128 a[252:255], v120 offset:8448
    v_exp_f32 v30, v30
    v_exp_f32 v31, v31
    v_exp_f32 v32, v32
    v_exp_f32 v33, v33
    v_mfma_f32_32x32x8_bf16 v[50:65], a[244:245], v[106:107], 0
L_pad_n5:
    s_cmp_eq_u32 s37, 1
    s_cbranch_scc1 L_ret_n
    v_exp_f32 v34, v34
    v_exp_f32 v35, v35
    v_exp_f32 v36, v36
    v_exp_f32 v37, v37
    v_exp_f32 v38, v38
    v_mfma_f32_32x32x16_bf16 v[50:65], a[240:243], v[98:101], v[50:65]
    s_waitcnt lgkmcnt(1)
    v_exp_f32 v39, v39
    v_exp_f32 v40, v40
    v_exp_f32 v41, v41
    v_exp_f32 v42, v42
    v_smfmac_f32_32x32x32_bf16 v[66:81], a[248:251], v[18:25], v253
    s_waitcnt lgkmcnt(0)
    v_exp_f32 v43, v43
    v_exp_f32 v44, v44
    v_exp_f32 v45, v45
    v_exp_f32 v46, v46
    v_smfmac_f32_32x32x32_bf16 v[66:81], a[252:255], v[26:33], v253
    global_load_lds_dwordx4 v228, s[18:19] offset:512 sc0
    v_exp_f32 v47, v47
    v_exp_f32 v48, v48
    v_exp_f32 v49, v49
    v_mfma_f32_32x32x8_bf16 v[18:33], a[244:245], v[108:109], 0
    v_exp_f32 v50, v50
    v_exp_f32 v51, v51
    v_exp_f32 v52, v52
    v_exp_f32 v53, v53
    v_exp_f32 v54, v54
    v_mfma_f32_32x32x16_bf16 v[18:33], a[240:243], v[102:105], v[18:33]
    ds_read_b128 a[240:243], v118 offset:13312
    v_exp_f32 v55, v55
    v_exp_f32 v56, v56
    v_exp_f32 v57, v57
    v_exp_f32 v58, v58
    v_smfmac_f32_32x32x32_bf16 v[82:97], a[248:251], v[34:41], v253
    ds_read_b128 a[248:251], v120 offset:12288
    v_exp_f32 v59, v59
    v_exp_f32 v60, v60
    v_exp_f32 v61, v61
    v_exp_f32 v62, v62
    v_smfmac_f32_32x32x32_bf16 v[82:97], a[252:255], v[42:49], v253
    s_waitcnt lgkmcnt(1)
    ds_read_b128 a[252:255], v120 offset:13056
    buffer_load_dword v116, v129, s[64:67], s9 offen sc1
    v_exp_f32 v63, v63
    v_exp_f32 v64, v64
    v_exp_f32 v65, v65
    v_mfma_f32_32x32x8_bf16 v[34:49], a[246:247], v[106:107], 0
    v_exp_f32 v18, v18
    v_exp_f32 v19, v19
    v_exp_f32 v20, v20
    v_exp_f32 v21, v21
    v_mfma_f32_32x32x16_bf16 v[34:49], a[240:243], v[98:101], v[34:49]
    s_waitcnt lgkmcnt(1)
    v_exp_f32 v22, v22
    v_exp_f32 v23, v23
    v_exp_f32 v24, v24
    v_exp_f32 v25, v25
    v_smfmac_f32_32x32x32_bf16 v[66:81], a[248:251], v[50:57], v253
    s_waitcnt lgkmcnt(0)
    v_exp_f32 v26, v26
    v_exp_f32 v27, v27
    v_exp_f32 v28, v28
    v_exp_f32 v29, v29
    v_smfmac_f32_32x32x32_bf16 v[66:81], a[252:255], v[58:65], v253
    v_exp_f32 v30, v30
    v_exp_f32 v31, v31
    v_exp_f32 v32, v32
    v_exp_f32 v33, v33
    v_mfma_f32_32x32x8_bf16 v[50:65], a[246:247], v[108:109], 0
    v_exp_f32 v34, v34
    v_exp_f32 v35, v35
    v_exp_f32 v36, v36
    v_exp_f32 v37, v37
    v_exp_f32 v38, v38
    v_mfma_f32_32x32x16_bf16 v[50:65], a[240:243], v[102:105], v[50:65]
    ds_read2st64_b64 a[244:247], v121 offset0:40 offset1:41
    ds_read_b128 a[240:243], v118 offset:18432
    v_exp_f32 v39, v39
    v_exp_f32 v40, v40
    v_exp_f32 v41, v41
    v_exp_f32 v42, v42
    v_smfmac_f32_32x32x32_bf16 v[82:97], a[248:251], v[18:25], v253
    ds_read_b128 a[248:251], v120 offset:13824
    v_exp_f32 v43, v43
    v_exp_f32 v44, v44
    v_exp_f32 v45, v45
    v_smfmac_f32_32x32x32_bf16 v[82:97], a[252:255], v[26:33], v253
    s_waitcnt lgkmcnt(1)
    ds_read_b128 a[252:255], v120 offset:14592
    v_exp_f32 v46, v46
    v_exp_f32 v47, v47
    v_exp_f32 v48, v48
    v_exp_f32 v49, v49
    v_mfma_f32_32x32x8_bf16 v[18:33], a[244:245], v[106:107], 0
    v_exp_f32 v50, v50
    v_exp_f32 v51, v51
    v_exp_f32 v52, v52
    v_exp_f32 v53, v53
    v_exp_f32 v54, v54
    v_mfma_f32_32x32x16_bf16 v[18:33], a[240:243], v[98:101], v[18:33]
    s_waitcnt lgkmcnt(1)
    s_mul_i32 s100, s85, 40960
    v_exp_f32 v55, v55
    v_exp_f32 v56, v56
    v_exp_f32 v57, v57
    v_exp_f32 v58, v58
    v_add_u32 v248, s100, v110
    v_smfmac_f32_32x32x32_bf16 v[66:81], a[248:251], v[34:41], v253
    s_waitcnt vmcnt(4) lgkmcnt(0)
    s_barrier
    s_sub_u32 s100, 40960, s100
    v_exp_f32 v59, v59
    v_exp_f32 v60, v60
    v_exp_f32 v61, v61
    v_smfmac_f32_32x32x32_bf16 v[66:81], a[252:255], v[42:49], v253
    s_waitcnt vmcnt(0)
    v_exp_f32 v62, v62
    v_exp_f32 v63, v63
    v_exp_f32 v64, v64
    v_exp_f32 v65, v65
    v_add_u32 v249, s100, v110
    v_mfma_f32_32x32x8_bf16 v[34:49], a[244:245], v[108:109], 0
    v_exp_f32 v18, v18
    v_exp_f32 v19, v19
    v_exp_f32 v20, v20
    v_exp_f32 v21, v21
    v_exp_f32 v22, v22
    v_cmp_eq_u32 vcc, -1, v116
    v_mfma_f32_32x32x16_bf16 v[34:49], a[240:243], v[102:105], v[34:49]
    s_add_u32 m0, s21, 126976
    ds_read_b128 a[240:243], v118 offset:19456
    s_nop 0
    s_cbranch_vccnz L_retry_11
L_ok_12:
    v_exp_f32 v23, v23
    v_exp_f32 v24, v24
    v_exp_f32 v25, v25
    v_exp_f32 v26, v26
    v_smfmac_f32_32x32x32_bf16 v[82:97], a[248:251], v[50:57], v253
    s_add_u32 s68, s64, 446464
    s_addc_u32 s69, s65, 0
    ds_read_b128 a[248:251], v120 offset:18432
    global_load_lds_dwordx4 v119, s[68:69] offset:0 sc1
    v_exp_f32 v27, v27
    v_exp_f32 v28, v28
    v_exp_f32 v29, v29
    v_smfmac_f32_32x32x32_bf16 v[82:97], a[252:255], v[58:65], v253
    s_waitcnt lgkmcnt(1)
    ds_read_b128 a[252:255], v120 offset:19200
    global_load_lds_dwordx4 v119, s[68:69] offset:1024 sc1
    v_exp_f32 v30, v30
    v_exp_f32 v31, v31
    v_exp_f32 v32, v32
    v_exp_f32 v33, v33
    v_mfma_f32_32x32x8_bf16 v[50:65], a[246:247], v[106:107], 0
    v_exp_f32 v34, v34
    v_exp_f32 v35, v35
    v_exp_f32 v36, v36
    v_exp_f32 v37, v37
    v_exp_f32 v38, v38
    v_mfma_f32_32x32x16_bf16 v[50:65], a[240:243], v[98:101], v[50:65]
    s_waitcnt lgkmcnt(1)
    global_load_lds_dwordx4 v119, s[68:69] offset:2048 sc1
    v_exp_f32 v39, v39
    v_exp_f32 v40, v40
    v_exp_f32 v41, v41
    v_exp_f32 v42, v42
    v_smfmac_f32_32x32x32_bf16 v[66:81], a[248:251], v[18:25], v253
    s_waitcnt lgkmcnt(0)
    s_add_u32 s78, s64, s10
    s_addc_u32 s79, s65, 0
    global_load_dwordx4 a[0:3], v248, s[78:79] offset:-4096 sc1
    v_exp_f32 v43, v43
    v_exp_f32 v44, v44
    v_exp_f32 v45, v45
    v_smfmac_f32_32x32x32_bf16 v[66:81], a[252:255], v[26:33], v253
    global_load_dwordx4 a[4:7], v249, s[78:79] offset:-4096 sc1
    v_exp_f32 v46, v46
    v_exp_f32 v47, v47
    v_exp_f32 v48, v48
    v_exp_f32 v49, v49
    v_mfma_f32_32x32x8_bf16 v[18:33], a[246:247], v[108:109], 0
    v_exp_f32 v50, v50
    v_exp_f32 v51, v51
    v_exp_f32 v52, v52
    v_exp_f32 v53, v53
    v_exp_f32 v54, v54
    v_mfma_f32_32x32x16_bf16 v[18:33], a[240:243], v[102:105], v[18:33]
    ds_read2st64_b64 a[244:247], v121 offset0:52 offset1:53
    ds_read_b128 a[240:243], v118 offset:24576
    global_load_dwordx4 a[8:11], v248, s[78:79] offset:-3072 sc1
    v_exp_f32 v55, v55
    v_exp_f32 v56, v56
    v_exp_f32 v57, v57
    v_smfmac_f32_32x32x32_bf16 v[82:97], a[248:251], v[34:41], v253
    ds_read_b128 a[248:251], v120 offset:19968
    global_load_dwordx4 a[12:15], v249, s[78:79] offset:-3072 sc1
    v_exp_f32 v58, v58
    v_exp_f32 v59, v59
    v_exp_f32 v60, v60
    v_exp_f32 v61, v61
    v_smfmac_f32_32x32x32_bf16 v[82:97], a[252:255], v[42:49], v253
    s_waitcnt lgkmcnt(1)
    ds_read_b128 a[252:255], v120 offset:20736
    global_load_dwordx4 a[16:19], v248, s[78:79] offset:0 sc1
    v_exp_f32 v62, v62
    v_exp_f32 v63, v63
    v_exp_f32 v64, v64
    v_exp_f32 v65, v65
    v_mfma_f32_32x32x8_bf16 v[34:49], a[244:245], v[106:107], 0
    v_exp_f32 v18, v18
    v_exp_f32 v19, v19
    v_exp_f32 v20, v20
    v_exp_f32 v21, v21
    v_exp_f32 v22, v22
    v_mfma_f32_32x32x16_bf16 v[34:49], a[240:243], v[98:101], v[34:49]
    s_waitcnt lgkmcnt(1)
    global_load_dwordx4 a[20:23], v249, s[78:79] offset:0 sc1
    v_exp_f32 v23, v23
    v_exp_f32 v24, v24
    v_exp_f32 v25, v25
    v_exp_f32 v26, v26
    v_smfmac_f32_32x32x32_bf16 v[66:81], a[248:251], v[50:57], v253
    s_waitcnt lgkmcnt(0)
    global_load_dwordx4 a[24:27], v248, s[78:79] offset:1024 sc1
    v_exp_f32 v27, v27
    v_exp_f32 v28, v28
    v_exp_f32 v29, v29
    v_smfmac_f32_32x32x32_bf16 v[66:81], a[252:255], v[58:65], v253
    global_load_dwordx4 a[28:31], v249, s[78:79] offset:1024 sc1
    v_exp_f32 v30, v30
    v_exp_f32 v31, v31
    v_exp_f32 v32, v32
    v_exp_f32 v33, v33
    v_mfma_f32_32x32x8_bf16 v[50:65], a[244:245], v[108:109], 0
    v_exp_f32 v34, v34
    v_exp_f32 v35, v35
    v_exp_f32 v36, v36
    v_exp_f32 v37, v37
    v_exp_f32 v38, v38
    v_mfma_f32_32x32x16_bf16 v[50:65], a[240:243], v[102:105], v[50:65]
    s_add_u32 s78, s78, 8192
    s_addc_u32 s79, s79, 0
    ds_read_b128 a[240:243], v118 offset:25600
    global_load_dwordx4 a[32:35], v248, s[78:79] offset:-4096 sc1
    v_exp_f32 v39, v39
    v_exp_f32 v40, v40
    v_exp_f32 v41, v41
    v_exp_f32 v42, v42
    v_smfmac_f32_32x32x32_bf16 v[82:97], a[248:251], v[18:25], v253
    ds_read_b128 a[248:251], v120 offset:24576
    global_load_dwordx4 a[36:39], v249, s[78:79] offset:-4096 sc1
    v_exp_f32 v43, v43
    v_exp_f32 v44, v44
    v_exp_f32 v45, v45
    v_smfmac_f32_32x32x32_bf16 v[82:97], a[252:255], v[26:33], v253
    s_waitcnt lgkmcnt(1)
    ds_read_b128 a[252:255], v120 offset:25344
    global_load_dwordx4 a[40:43], v248, s[78:79] offset:-3072 sc1
    v_exp_f32 v46, v46
    v_exp_f32 v47, v47
    v_exp_f32 v48, v48
    v_exp_f32 v49, v49
    v_mfma_f32_32x32x8_bf16 v[18:33], a[246:247], v[106:107], 0
    v_exp_f32 v50, v50
    v_exp_f32 v51, v51
    v_exp_f32 v52, v52
    v_exp_f32 v53, v53
    v_exp_f32 v54, v54
    v_mfma_f32_32x32x16_bf16 v[18:33], a[240:243], v[98:101], v[18:33]
    s_waitcnt lgkmcnt(1)
    global_load_dwordx4 a[44:47], v249, s[78:79] offset:-3072 sc1
    v_exp_f32 v55, v55
    v_exp_f32 v56, v56
    v_exp_f32 v57, v57
    v_exp_f32 v58, v58
    v_smfmac_f32_32x32x32_bf16 v[66:81], a[248:251], v[34:41], v253
    s_waitcnt lgkmcnt(0)
    global_load_dwordx4 a[48:51], v248, s[78:79] offset:0 sc1
    v_exp_f32 v59, v59
    v_exp_f32 v60, v60
    v_exp_f32 v61, v61
    v_smfmac_f32_32x32x32_bf16 v[66:81], a[252:255], v[42:49], v253
    global_load_dwordx4 a[52:55], v249, s[78:79] offset:0 sc1
    v_exp_f32 v62, v62
    v_exp_f32 v63, v63
    v_exp_f32 v64, v64
    v_exp_f32 v65, v65
    v_mfma_f32_32x32x8_bf16 v[34:49], a[246:247], v[108:109], 0
    v_exp_f32 v18, v18
    v_exp_f32 v19, v19
    v_exp_f32 v20, v20
    v_exp_f32 v21, v21
    v_exp_f32 v22, v22
    v_mfma_f32_32x32x16_bf16 v[34:49], a[240:243], v[102:105], v[34:49]
    ds_read2st64_b64 a[244:247], v121 offset0:64 offset1:65
    ds_read_b128 a[240:243], v118 offset:30720
    global_load_dwordx4 a[56:59], v248, s[78:79] offset:1024 sc1
    v_exp_f32 v23, v23
    v_exp_f32 v24, v24
    v_exp_f32 v25, v25
    v_smfmac_f32_32x32x32_bf16 v[82:97], a[248:251], v[50:57], v253
    ds_read_b128 a[248:251], v120 offset:26112
    global_load_dwordx4 a[60:63], v249, s[78:79] offset:1024 sc1
    v_exp_f32 v26, v26
    v_exp_f32 v27, v27
    v_exp_f32 v28, v28
    v_exp_f32 v29, v29
    v_smfmac_f32_32x32x32_bf16 v[82:97], a[252:255], v[58:65], v253
    s_waitcnt lgkmcnt(1)
    s_add_u32 s78, s78, 8192
    s_addc_u32 s79, s79, 0
    ds_read_b128 a[252:255], v120 offset:26880
    global_load_dwordx4 a[64:67], v248, s[78:79] offset:-4096 sc1
    v_exp_f32 v30, v30
    v_exp_f32 v31, v31
    v_exp_f32 v32, v32
    v_exp_f32 v33, v33
    v_mfma_f32_32x32x8_bf16 v[50:65], a[244:245], v[106:107], 0
    global_load_dwordx4 a[68:71], v249, s[78:79] offset:-4096 sc1
    v_exp_f32 v34, v34
    v_exp_f32 v35, v35
    v_exp_f32 v36, v36
    v_exp_f32 v37, v37
    v_exp_f32 v38, v38
    v_mfma_f32_32x32x16_bf16 v[50:65], a[240:243], v[98:101], v[50:65]
    s_waitcnt lgkmcnt(1)
    global_load_dwordx4 a[72:75], v248, s[78:79] offset:-3072 sc1
    v_exp_f32 v39, v39
    v_exp_f32 v40, v40
    v_exp_f32 v41, v41
    v_exp_f32 v42, v42
    v_smfmac_f32_32x32x32_bf16 v[66:81], a[248:251], v[18:25], v253
    s_waitcnt vmcnt(19) lgkmcnt(0)
    s_barrier
    v_exp_f32 v43, v43
    v_exp_f32 v44, v44
    v_exp_f32 v45, v45
    v_smfmac_f32_32x32x32_bf16 v[66:81], a[252:255], v[26:33], v253
    global_load_dwordx4 a[76:79], v249, s[78:79] offset:-3072 sc1
    v_exp_f32 v46, v46
    v_exp_f32 v47, v47
    v_exp_f32 v48, v48
    v_exp_f32 v49, v49
    v_mfma_f32_32x32x8_bf16 v[18:33], a[244:245], v[108:109], 0
    v_exp_f32 v50, v50
    v_exp_f32 v51, v51
    v_exp_f32 v52, v52
    v_exp_f32 v53, v53
    v_exp_f32 v54, v54
    v_mfma_f32_32x32x16_bf16 v[18:33], a[240:243], v[102:105], v[18:33]
    ds_read_b128 a[240:243], v118 offset:31744
    global_load_dwordx4 a[80:83], v248, s[78:79] offset:0 sc1
    v_exp_f32 v55, v55
    v_exp_f32 v56, v56
    v_exp_f32 v57, v57
    v_exp_f32 v58, v58
    v_smfmac_f32_32x32x32_bf16 v[82:97], a[248:251], v[34:41], v253
    ds_read_b128 a[248:251], v120 offset:30720
    global_load_dwordx4 a[84:87], v249, s[78:79] offset:0 sc1
    v_exp_f32 v59, v59
    v_exp_f32 v60, v60
    v_exp_f32 v61, v61
    v_smfmac_f32_32x32x32_bf16 v[82:97], a[252:255], v[42:49], v253
    s_waitcnt lgkmcnt(1)
    ds_read_b128 a[252:255], v120 offset:31488
    global_load_dwordx4 a[88:91], v248, s[78:79] offset:1024 sc1
    v_exp_f32 v62, v62
    v_exp_f32 v63, v63
    v_exp_f32 v64, v64
    v_exp_f32 v65, v65
    v_mfma_f32_32x32x8_bf16 v[34:49], a[246:247], v[106:107], 0
    v_exp_f32 v18, v18
    v_exp_f32 v19, v19
    v_exp_f32 v20, v20
    v_exp_f32 v21, v21
    v_exp_f32 v22, v22
    v_mfma_f32_32x32x16_bf16 v[34:49], a[240:243], v[98:101], v[34:49]
    s_waitcnt lgkmcnt(1)
    global_load_dwordx4 a[92:95], v249, s[78:79] offset:1024 sc1
    v_exp_f32 v23, v23
    v_exp_f32 v24, v24
    v_exp_f32 v25, v25
    v_exp_f32 v26, v26
    v_smfmac_f32_32x32x32_bf16 v[66:81], a[248:251], v[50:57], v253
    s_waitcnt lgkmcnt(0)
    s_add_u32 s78, s78, 8192
    s_addc_u32 s79, s79, 0
    global_load_dwordx4 a[96:99], v248, s[78:79] offset:-4096 sc1
    v_exp_f32 v27, v27
    v_exp_f32 v28, v28
    v_exp_f32 v29, v29
    v_smfmac_f32_32x32x32_bf16 v[66:81], a[252:255], v[58:65], v253
    global_load_dwordx4 a[100:103], v249, s[78:79] offset:-4096 sc1
    v_exp_f32 v30, v30
    v_exp_f32 v31, v31
    v_exp_f32 v32, v32
    v_exp_f32 v33, v33
    v_mfma_f32_32x32x8_bf16 v[50:65], a[246:247], v[108:109], 0
    v_exp_f32 v34, v34
    v_exp_f32 v35, v35
    v_exp_f32 v36, v36
    v_exp_f32 v37, v37
    v_exp_f32 v38, v38
    v_mfma_f32_32x32x16_bf16 v[50:65], a[240:243], v[102:105], v[50:65]
    ds_read2st64_b64 a[244:247], v121 offset0:4 offset1:5
    ds_read_b128 a[240:243], v118 offset:0
    global_load_dwordx4 a[104:107], v248, s[78:79] offset:-3072 sc1
    v_exp_f32 v39, v39
    v_exp_f32 v40, v40
    v_exp_f32 v41, v41
    v_smfmac_f32_32x32x32_bf16 v[82:97], a[248:251], v[18:25], v253
    ds_read_b128 a[248:251], v120 offset:32256
    global_load_dwordx4 a[108:111], v249, s[78:79] offset:-3072 sc1
    v_exp_f32 v42, v42
    v_exp_f32 v43, v43
    v_exp_f32 v44, v44
    v_exp_f32 v45, v45
    v_smfmac_f32_32x32x32_bf16 v[82:97], a[252:255], v[26:33], v253
    s_waitcnt lgkmcnt(1)
    ds_read_b128 a[252:255], v120 offset:33024
    global_load_dwordx4 a[112:115], v248, s[78:79] offset:0 sc1
    v_exp_f32 v46, v46
    v_exp_f32 v47, v47
    v_exp_f32 v48, v48
    v_exp_f32 v49, v49
    v_mfma_f32_32x32x8_bf16 v[18:33], a[244:245], v[106:107], 0
    v_exp_f32 v50, v50
    v_exp_f32 v51, v51
    v_exp_f32 v52, v52
    v_exp_f32 v53, v53
    v_exp_f32 v54, v54
    v_mfma_f32_32x32x16_bf16 v[18:33], a[240:243], v[98:101], v[18:33]
    s_waitcnt lgkmcnt(1)
    global_load_dwordx4 a[116:119], v249, s[78:79] offset:0 sc1
    v_exp_f32 v55, v55
    v_exp_f32 v56, v56
    v_exp_f32 v57, v57
    v_exp_f32 v58, v58
    v_smfmac_f32_32x32x32_bf16 v[66:81], a[248:251], v[34:41], v253
    s_waitcnt lgkmcnt(0)
    global_load_dwordx4 a[120:123], v248, s[78:79] offset:1024 sc1
    v_exp_f32 v59, v59
    v_exp_f32 v60, v60
    v_exp_f32 v61, v61
    v_smfmac_f32_32x32x32_bf16 v[66:81], a[252:255], v[42:49], v253
    global_load_dwordx4 a[124:127], v249, s[78:79] offset:1024 sc1
    v_exp_f32 v62, v62
    v_exp_f32 v63, v63
    v_exp_f32 v64, v64
    v_exp_f32 v65, v65
    v_mfma_f32_32x32x8_bf16 v[34:49], a[244:245], v[108:109], 0
    v_exp_f32 v18, v18
    v_exp_f32 v19, v19
    v_exp_f32 v20, v20
    v_exp_f32 v21, v21
    v_exp_f32 v22, v22
    v_mfma_f32_32x32x16_bf16 v[34:49], a[240:243], v[102:105], v[34:49]
    ds_read_b128 a[240:243], v118 offset:1024
    v_exp_f32 v23, v23
    v_exp_f32 v24, v24
    v_exp_f32 v25, v25
    v_exp_f32 v26, v26
    v_smfmac_f32_32x32x32_bf16 v[82:97], a[248:251], v[50:57], v253
    ds_read_b128 a[248:251], v120 offset:0
    v_exp_f32 v27, v27
    v_exp_f32 v28, v28
    v_exp_f32 v29, v29
    v_smfmac_f32_32x32x32_bf16 v[82:97], a[252:255], v[58:65], v253
    s_waitcnt lgkmcnt(1)
    ds_read_b128 a[252:255], v120 offset:768
    v_exp_f32 v30, v30
    v_exp_f32 v31, v31
    v_exp_f32 v32, v32
    v_exp_f32 v33, v33
    v_mfma_f32_32x32x8_bf16 v[50:65], a[246:247], v[106:107], 0
    v_exp_f32 v34, v34
    v_exp_f32 v35, v35
    v_exp_f32 v36, v36
    v_exp_f32 v37, v37
    v_exp_f32 v38, v38
    v_mfma_f32_32x32x16_bf16 v[50:65], a[240:243], v[98:101], v[50:65]
    s_waitcnt lgkmcnt(1)
    v_exp_f32 v39, v39
    v_exp_f32 v40, v40
    v_exp_f32 v41, v41
    v_exp_f32 v42, v42
    v_smfmac_f32_32x32x32_bf16 v[66:81], a[248:251], v[18:25], v253
    s_waitcnt lgkmcnt(0)
    s_barrier
    v_exp_f32 v43, v43
    v_exp_f32 v44, v44
    v_exp_f32 v45, v45
    v_smfmac_f32_32x32x32_bf16 v[66:81], a[252:255], v[26:33], v253
    v_exp_f32 v46, v46
    v_exp_f32 v47, v47
    v_exp_f32 v48, v48
    v_exp_f32 v49, v49
    v_mfma_f32_32x32x8_bf16 v[18:33], a[246:247], v[108:109], 0
    v_exp_f32 v50, v50
    v_exp_f32 v51, v51
    v_exp_f32 v52, v52
    v_exp_f32 v53, v53
    v_exp_f32 v54, v54
    v_mfma_f32_32x32x16_bf16 v[18:33], a[240:243], v[102:105], v[18:33]
    s_add_u32 m0, s50, 143360
    s_add_u32 s76, s18, 20480
    s_addc_u32 s77, s19, 0
    ds_read2st64_b64 a[244:247], v121 offset0:16 offset1:17
    ds_read_b128 a[240:243], v118 offset:6144
    global_load_lds_dwordx4 v228, s[76:77] offset:0 sc0
    v_exp_f32 v55, v55
    v_exp_f32 v56, v56
    v_exp_f32 v57, v57
    v_smfmac_f32_32x32x32_bf16 v[82:97], a[248:251], v[34:41], v253
    s_add_u32 m0, s50, 147328
    ds_read_b128 a[248:251], v120 offset:1536
    global_load_lds_dwordx4 v228, s[76:77] offset:128 sc0
    v_exp_f32 v58, v58
    v_exp_f32 v59, v59
    v_exp_f32 v60, v60
    v_exp_f32 v61, v61
    v_smfmac_f32_32x32x32_bf16 v[82:97], a[252:255], v[42:49], v253
    s_waitcnt lgkmcnt(1)
    s_add_u32 m0, s50, 151296
    ds_read_b128 a[252:255], v120 offset:2304
    global_load_lds_dwordx4 v228, s[76:77] offset:256 sc0
    v_exp_f32 v62, v62
    v_exp_f32 v63, v63
    v_exp_f32 v64, v64
    v_exp_f32 v65, v65
    v_mfma_f32_32x32x8_bf16 v[34:49], a[244:245], v[106:107], 0
    v_exp_f32 v18, v18
    v_exp_f32 v19, v19
    v_exp_f32 v20, v20
    v_exp_f32 v21, v21
    v_exp_f32 v22, v22
    v_mfma_f32_32x32x16_bf16 v[34:49], a[240:243], v[98:101], v[34:49]
    s_waitcnt lgkmcnt(1)
    s_add_u32 m0, s50, 155264
    s_nop 0
    global_load_lds_dwordx4 v228, s[76:77] offset:384 sc0
    v_exp_f32 v23, v23
    v_exp_f32 v24, v24
    v_exp_f32 v25, v25
    v_exp_f32 v26, v26
    v_smfmac_f32_32x32x32_bf16 v[66:81], a[248:251], v[50:57], v253
    s_waitcnt lgkmcnt(0)
    s_add_u32 m0, s50, 159232
    s_nop 0
    global_load_lds_dwordx4 v228, s[76:77] offset:512 sc0
    v_exp_f32 v27, v27
    v_exp_f32 v28, v28
    v_exp_f32 v29, v29
    v_smfmac_f32_32x32x32_bf16 v[66:81], a[252:255], v[58:65], v253
    s_add_u32 s78, s78, 8192
    s_addc_u32 s79, s79, 0
    global_load_dwordx4 a[128:131], v248, s[78:79] offset:-4096 sc1
    v_exp_f32 v30, v30
    v_exp_f32 v31, v31
    v_exp_f32 v32, v32
    v_exp_f32 v33, v33
    v_mfma_f32_32x32x8_bf16 v[50:65], a[244:245], v[108:109], 0
    v_exp_f32 v34, v34
    v_exp_f32 v35, v35
    v_exp_f32 v36, v36
    v_exp_f32 v37, v37
    v_exp_f32 v38, v38
    v_mfma_f32_32x32x16_bf16 v[50:65], a[240:243], v[102:105], v[50:65]
    ds_read_b128 a[240:243], v118 offset:7168
    global_load_dwordx4 a[132:135], v249, s[78:79] offset:-4096 sc1
    v_exp_f32 v39, v39
    v_exp_f32 v40, v40
    v_exp_f32 v41, v41
    v_exp_f32 v42, v42
    v_smfmac_f32_32x32x32_bf16 v[82:97], a[248:251], v[18:25], v253
    ds_read_b128 a[248:251], v120 offset:6144
    global_load_dwordx4 a[136:139], v248, s[78:79] offset:-3072 sc1
    v_exp_f32 v43, v43
    v_exp_f32 v44, v44
    v_exp_f32 v45, v45
    v_smfmac_f32_32x32x32_bf16 v[82:97], a[252:255], v[26:33], v253
    s_waitcnt lgkmcnt(1)
    ds_read_b128 a[252:255], v120 offset:6912
    global_load_dwordx4 a[140:143], v249, s[78:79] offset:-3072 sc1
    v_exp_f32 v46, v46
    v_exp_f32 v47, v47
    v_exp_f32 v48, v48
    v_exp_f32 v49, v49
    v_mfma_f32_32x32x8_bf16 v[18:33], a[246:247], v[106:107], 0
    v_exp_f32 v50, v50
    v_exp_f32 v51, v51
    v_exp_f32 v52, v52
    v_exp_f32 v53, v53
    v_exp_f32 v54, v54
    v_mfma_f32_32x32x16_bf16 v[18:33], a[240:243], v[98:101], v[18:33]
    s_waitcnt lgkmcnt(1)
    global_load_dwordx4 a[144:147], v248, s[78:79] offset:0 sc1
    v_exp_f32 v55, v55
    v_exp_f32 v56, v56
    v_exp_f32 v57, v57
    v_exp_f32 v58, v58
    v_smfmac_f32_32x32x32_bf16 v[66:81], a[248:251], v[34:41], v253
    s_waitcnt lgkmcnt(0)
    global_load_dwordx4 a[148:151], v249, s[78:79] offset:0 sc1
    v_exp_f32 v59, v59
    v_exp_f32 v60, v60
    v_exp_f32 v61, v61
    v_smfmac_f32_32x32x32_bf16 v[66:81], a[252:255], v[42:49], v253
    global_load_dwordx4 a[152:155], v248, s[78:79] offset:1024 sc1
    v_exp_f32 v62, v62
    v_exp_f32 v63, v63
    v_exp_f32 v64, v64
    v_exp_f32 v65, v65
    v_mfma_f32_32x32x8_bf16 v[34:49], a[246:247], v[108:109], 0
    v_exp_f32 v18, v18
    v_exp_f32 v19, v19
    v_exp_f32 v20, v20
    v_exp_f32 v21, v21
    v_exp_f32 v22, v22
    v_mfma_f32_32x32x16_bf16 v[34:49], a[240:243], v[102:105], v[34:49]
    global_load_dwordx4 a[156:159], v249, s[78:79] offset:1024 sc1
    v_exp_f32 v23, v23
    v_exp_f32 v24, v24
    v_exp_f32 v25, v25
    v_exp_f32 v26, v26
    v_smfmac_f32_32x32x32_bf16 v[82:97], a[248:251], v[50:57], v253
    ds_read_b128 a[248:251], v120 offset:7680
    v_exp_f32 v27, v27
    v_exp_f32 v28, v28
    v_exp_f32 v29, v29
    v_smfmac_f32_32x32x32_bf16 v[82:97], a[252:255], v[58:65], v253
    s_waitcnt lgkmcnt(0)
    ds_read_b128 a[252:255], v120 offset:8448
    v_exp_f32 v30, v30
    v_exp_f32 v31, v31
    v_exp_f32 v32, v32
    v_exp_f32 v33, v33
    v_smfmac_f32_32x32x32_bf16 v[66:81], a[248:251], v[18:25], v253
    s_waitcnt lgkmcnt(0)
    v_exp_f32 v34, v34
    v_exp_f32 v35, v35
    v_exp_f32 v36, v36
    v_exp_f32 v37, v37
    v_exp_f32 v38, v38
    v_exp_f32 v39, v39
    v_exp_f32 v40, v40
    v_exp_f32 v41, v41
    v_smfmac_f32_32x32x32_bf16 v[66:81], a[252:255], v[26:33], v253
    v_exp_f32 v42, v42
    v_exp_f32 v43, v43
    v_exp_f32 v44, v44
    v_exp_f32 v45, v45
    v_exp_f32 v46, v46
    v_exp_f32 v47, v47
    v_exp_f32 v48, v48
    v_exp_f32 v49, v49
L_back:
    v_smfmac_f32_32x32x32_bf16 v[82:97], a[248:251], v[34:41], v253
    s_waitcnt vmcnt(13) lgkmcnt(0)
    s_barrier
    ds_read_b128 v[18:21], v229 offset:0
    ds_read_b128 v[22:25], v230 offset:0
    ds_read_b128 v[26:29], v229 offset:4096
    ds_read_b128 v[30:33], v230 offset:4096
    v_smfmac_f32_32x32x32_bf16 v[82:97], a[252:255], v[42:49], v253
    s_add_u32 m0, s50, 122880
    s_nop 0
    global_load_lds_dwordx4 v228, s[32:33] offset:0 sc0
    v_mov_b32 v2, v74
    v_mov_b32 v3, v74
    s_nop 1
    v_permlane32_swap_b32 v2, v3
    v_rcp_f32 v3, v3
    s_waitcnt lgkmcnt(3)
    v_mfma_f32_16x16x32_bf16 v[130:133], v[18:21], a[0:3], 0
    s_waitcnt lgkmcnt(2)
    s_add_u32 m0, s50, 126848
    ds_read_b128 v[34:37], v229 offset:8192
    v_mul_f32 v66, v66, v3
    v_mul_f32 v67, v67, v3
    v_mul_f32 v68, v68, v3
    v_mfma_f32_16x16x32_bf16 v[130:133], v[22:25], a[8:11], v[130:133]
    global_load_lds_dwordx4 v228, s[32:33] offset:128 sc0
    v_mul_f32 v69, v69, v3
    v_mul_f32 v70, v70, v3
    v_mul_f32 v71, v71, v3
    v_mfma_f32_16x16x32_bf16 v[134:137], v[22:25], a[12:15], 0
    s_add_u32 m0, s50, 130816
    ds_read_b128 v[38:41], v230 offset:8192
    v_mul_f32 v72, v72, v3
    v_mul_f32 v73, v73, v3
    v_mul_f32 v74, v74, v3
    v_mfma_f32_16x16x32_bf16 v[134:137], v[18:21], a[4:7], v[134:137]
    s_waitcnt lgkmcnt(2)
    v_mul_f32 v75, v75, v3
    v_mul_f32 v76, v76, v3
    v_mul_f32 v77, v77, v3
    v_mfma_f32_16x16x32_bf16 v[134:137], v[26:29], a[20:23], v[134:137]
    ds_read_b128 v[42:45], v229 offset:12288
    v_cvt_pk_bf16_f32 v6, v66, v67
    v_cvt_pk_bf16_f32 v7, v68, v69
    v_cvt_pk_bf16_f32 v8, v70, v71
    v_mfma_f32_16x16x32_bf16 v[134:137], v[30:33], a[28:31], v[134:137]
    global_load_lds_dwordx4 v228, s[32:33] offset:256 sc0
    v_cvt_pk_bf16_f32 v9, v72, v73
    v_cvt_pk_bf16_f32 v14, v74, v75
    v_cvt_pk_bf16_f32 v15, v76, v77
    v_mfma_f32_16x16x32_bf16 v[130:133], v[30:33], a[24:27], v[130:133]
    s_add_u32 m0, s50, 134784
    ds_read_b128 v[46:49], v230 offset:12288
    v_mov_b32 v2, v90
    v_mov_b32 v3, v90
    s_nop 1
    v_permlane32_swap_b32 v2, v3
    v_mfma_f32_16x16x32_bf16 v[130:133], v[26:29], a[16:19], v[130:133]
    s_waitcnt vmcnt(14) lgkmcnt(2)
    s_barrier
    s_add_u32 s76, s18, 40960
    s_addc_u32 s77, s19, 0
    v_rcp_f32 v3, v3
    s_nop 0
    v_mul_f32 v82, v82, v3
    v_mul_f32 v83, v83, v3
    v_mfma_f32_16x16x32_bf16 v[130:133], v[34:37], a[32:35], v[130:133]
    ds_read_b128 v[50:53], v229 offset:16384
    v_mul_f32 v84, v84, v3
    v_mul_f32 v85, v85, v3
    v_mul_f32 v86, v86, v3
    v_mfma_f32_16x16x32_bf16 v[130:133], v[38:41], a[40:43], v[130:133]
    global_load_lds_dwordx4 v228, s[76:77] offset:384 sc0
    v_mul_f32 v87, v87, v3
    v_mul_f32 v88, v88, v3
    v_mul_f32 v89, v89, v3
    v_mfma_f32_16x16x32_bf16 v[134:137], v[38:41], a[44:47], v[134:137]
    s_add_u32 m0, s50, 138752
    ds_read_b128 v[54:57], v230 offset:16384
    v_mul_f32 v90, v90, v3
    v_mul_f32 v91, v91, v3
    v_mul_f32 v92, v92, v3
    v_mfma_f32_16x16x32_bf16 v[134:137], v[34:37], a[36:39], v[134:137]
    s_waitcnt lgkmcnt(2)
    v_mul_f32 v93, v93, v3
    v_cvt_pk_bf16_f32 v10, v82, v83
    v_cvt_pk_bf16_f32 v11, v84, v85
    v_mfma_f32_16x16x32_bf16 v[134:137], v[42:45], a[52:55], v[134:137]
    ds_read_b128 v[18:21], v229 offset:40960
    v_cvt_pk_bf16_f32 v12, v86, v87
    v_cvt_pk_bf16_f32 v13, v88, v89
    v_cvt_pk_bf16_f32 v16, v90, v91
    v_mfma_f32_16x16x32_bf16 v[134:137], v[46:49], a[60:63], v[134:137]
    global_load_lds_dwordx4 v228, s[76:77] offset:512 sc0
    v_cvt_pk_bf16_f32 v17, v92, v93
    v_mfma_f32_16x16x32_bf16 v[130:133], v[46:49], a[56:59], v[130:133]
    s_add_u32 m0, s50, 102400
    ds_read_b128 v[22:25], v230 offset:40960
    v_mfma_f32_16x16x32_bf16 v[130:133], v[42:45], a[48:51], v[130:133]
    s_waitcnt lgkmcnt(3)
    s_add_u32 s76, s18, 61440
    s_addc_u32 s77, s19, 0
    buffer_store_dwordx4 v[6:9], v233, s[64:67], s11 offen offset:0 sc1
    v_mfma_f32_16x16x32_bf16 v[130:133], v[50:53], a[64:67], v[130:133]
L_pad_n6:
    s_cmp_eq_u32 s37, 1
    s_cbranch_scc1 L_ret_n
    s_waitcnt lgkmcnt(2)
    ds_read_b128 v[26:29], v229 offset:45056
    global_load_lds_dwordx4 v228, s[76:77] offset:0 sc0
    v_mfma_f32_16x16x32_bf16 v[130:133], v[54:57], a[72:75], v[130:133]
    buffer_store_dwordx4 v[10:13], v233, s[64:67], s11 offen offset:512 sc1
    v_mfma_f32_16x16x32_bf16 v[134:137], v[54:57], a[76:79], v[134:137]
    s_add_u32 m0, s50, 106368
    ds_read_b128 v[30:33], v230 offset:45056
    v_mfma_f32_16x16x32_bf16 v[134:137], v[50:53], a[68:71], v[134:137]
    s_waitcnt vmcnt(16) lgkmcnt(3)
    s_barrier
    buffer_store_dwordx4 v[14:17], v234, s[64:67], s24 offen sc1
    v_mfma_f32_16x16x32_bf16 v[142:145], v[18:21], a[4:7], 0
    s_waitcnt lgkmcnt(2)
    ds_read_b128 v[34:37], v229 offset:49152
    v_mfma_f32_16x16x32_bf16 v[142:145], v[22:25], a[12:15], v[142:145]
    global_load_lds_dwordx4 v228, s[76:77] offset:128 sc0
    v_mfma_f32_16x16x32_bf16 v[138:141], v[22:25], a[8:11], 0
    s_add_u32 m0, s50, 110336
    ds_read_b128 v[38:41], v230 offset:49152
    v_lshl_add_u32 v170, s29, 5, v231
    v_mfma_f32_16x16x32_bf16 v[138:141], v[18:21], a[0:3], v[138:141]
    s_waitcnt lgkmcnt(3)
    v_lshl_add_u32 v231, s28, 5, v231
    v_mfma_f32_16x16x32_bf16 v[138:141], v[26:29], a[16:19], v[138:141]
    s_waitcnt lgkmcnt(2)
    ds_read_b128 v[42:45], v229 offset:53248
    v_lshlrev_b32 v2, 16, v178
    v_mfma_f32_16x16x32_bf16 v[138:141], v[30:33], a[24:27], v[138:141]
    global_load_lds_dwordx4 v228, s[76:77] offset:256 sc0
    v_mfma_f32_16x16x32_bf16 v[142:145], v[30:33], a[28:31], v[142:145]
    s_add_u32 m0, s50, 114304
    ds_read_b128 v[46:49], v230 offset:53248
    v_lshlrev_b32 v3, 16, v188
    v_mfma_f32_16x16x32_bf16 v[142:145], v[26:29], a[20:23], v[142:145]
    s_waitcnt lgkmcnt(3)
    v_mul_f32 v198, v2, v3
    v_mfma_f32_16x16x32_bf16 v[142:145], v[34:37], a[36:39], v[142:145]
    s_waitcnt lgkmcnt(2)
    ds_read_b128 v[50:53], v229 offset:57344
    v_and_b32 v2, 0xffff0000, v178
    v_mfma_f32_16x16x32_bf16 v[142:145], v[38:41], a[44:47], v[142:145]
    global_load_lds_dwordx4 v228, s[76:77] offset:384 sc0
    v_mfma_f32_16x16x32_bf16 v[138:141], v[38:41], a[40:43], v[138:141]
    s_add_u32 m0, s50, 118272
    ds_read_b128 v[54:57], v230 offset:57344
    v_and_b32 v3, 0xffff0000, v188
    v_mfma_f32_16x16x32_bf16 v[138:141], v[34:37], a[32:35], v[138:141]
    s_waitcnt vmcnt(9) lgkmcnt(3)
    s_barrier
    v_mul_f32 v199, v2, v3
    v_mfma_f32_16x16x32_bf16 v[138:141], v[42:45], a[48:51], v[138:141]
    s_waitcnt lgkmcnt(2)
    ds_read_b128 v[18:21], v229 offset:20480
    v_lshlrev_b32 v2, 16, v179
    v_mfma_f32_16x16x32_bf16 v[138:141], v[46:49], a[56:59], v[138:141]
    global_load_lds_dwordx4 v228, s[76:77] offset:512 sc0
    v_mfma_f32_16x16x32_bf16 v[142:145], v[46:49], a[60:63], v[142:145]
    s_add_u32 m0, s50, 142720
    ds_read_b128 v[22:25], v230 offset:20480
    v_lshlrev_b32 v3, 16, v189
    v_mfma_f32_16x16x32_bf16 v[142:145], v[42:45], a[52:55], v[142:145]
    s_waitcnt lgkmcnt(3)
    v_mul_f32 v200, v2, v3
    v_mfma_f32_16x16x32_bf16 v[142:145], v[50:53], a[68:71], v[142:145]
    s_waitcnt lgkmcnt(2)
    ds_read_b128 v[26:29], v229 offset:24576
    v_and_b32 v2, 0xffff0000, v179
    v_mfma_f32_16x16x32_bf16 v[142:145], v[54:57], a[76:79], v[142:145]
    global_load_lds_dwordx4 v228, s[18:19] offset:640 sc0
    v_mfma_f32_16x16x32_bf16 v[138:141], v[54:57], a[72:75], v[138:141]
    s_add_u32 m0, s50, 146688
    ds_read_b128 v[30:33], v230 offset:24576
    v_and_b32 v3, 0xffff0000, v189
    v_mfma_f32_16x16x32_bf16 v[138:141], v[50:53], a[64:67], v[138:141]
    s_waitcnt lgkmcnt(3)
    v_mul_f32 v201, v2, v3
    v_mfma_f32_16x16x32_bf16 v[146:149], v[18:21], a[0:3], 0
    s_waitcnt lgkmcnt(2)
    ds_read_b128 v[34:37], v229 offset:28672
    v_lshlrev_b32 v2, 16, v180
    v_mfma_f32_16x16x32_bf16 v[146:149], v[22:25], a[8:11], v[146:149]
    global_load_lds_dwordx4 v228, s[18:19] offset:768 sc0
    v_mfma_f32_16x16x32_bf16 v[150:153], v[22:25], a[12:15], 0
    s_add_u32 m0, s50, 150656
    ds_read_b128 v[38:41], v230 offset:28672
    v_lshlrev_b32 v3, 16, v188
    v_mfma_f32_16x16x32_bf16 v[150:153], v[18:21], a[4:7], v[150:153]
    s_waitcnt lgkmcnt(3)
    s_barrier
    v_mul_f32 v202, v2, v3
    v_mfma_f32_16x16x32_bf16 v[150:153], v[26:29], a[20:23], v[150:153]
    s_waitcnt lgkmcnt(2)
    global_load_lds_dwordx4 v228, s[18:19] offset:896 sc0
    v_mfma_f32_16x16x32_bf16 v[150:153], v[30:33], a[28:31], v[150:153]
    v_and_b32 v2, 0xffff0000, v180
    v_mfma_f32_16x16x32_bf16 v[146:149], v[30:33], a[24:27], v[146:149]
    s_add_u32 m0, s50, 154624
    v_and_b32 v3, 0xffff0000, v188
    v_mfma_f32_16x16x32_bf16 v[146:149], v[26:29], a[16:19], v[146:149]
    s_waitcnt lgkmcnt(1)
    global_load_lds_dwordx4 v228, s[18:19] offset:1024 sc0
    v_mfma_f32_16x16x32_bf16 v[146:149], v[34:37], a[32:35], v[146:149]
    s_waitcnt lgkmcnt(0)
    s_add_u32 m0, s50, 158592
    v_mul_f32 v203, v2, v3
    v_mfma_f32_16x16x32_bf16 v[146:149], v[38:41], a[40:43], v[146:149]
    v_lshlrev_b32 v2, 16, v181
    v_mfma_f32_16x16x32_bf16 v[150:153], v[38:41], a[44:47], v[150:153]
    global_load_lds_dwordx4 v228, s[18:19] offset:1152 sc0
    v_mfma_f32_16x16x32_bf16 v[150:153], v[34:37], a[36:39], v[150:153]
    s_add_u32 s76, s18, 20480
    s_addc_u32 s77, s19, 0
    v_lshlrev_b32 v3, 16, v189
    v_mfma_f32_16x16x32_bf16 v[150:153], a[160:163], a[52:55], v[150:153]
    s_add_u32 m0, s50, 122240
    v_mul_f32 v204, v2, v3
    v_mfma_f32_16x16x32_bf16 v[150:153], a[164:167], a[60:63], v[150:153]
    global_load_lds_dwordx4 v228, s[76:77] offset:640 sc0
    v_mfma_f32_16x16x32_bf16 v[146:149], a[164:167], a[56:59], v[146:149]
    v_and_b32 v2, 0xffff0000, v181
    v_mfma_f32_16x16x32_bf16 v[146:149], a[160:163], a[48:51], v[146:149]
    s_waitcnt vmcnt(15)
    s_barrier
    v_and_b32 v3, 0xffff0000, v189
    v_mfma_f32_16x16x32_bf16 v[146:149], a[168:171], a[64:67], v[146:149]
    s_add_u32 m0, s50, 126208
    v_mul_f32 v205, v2, v3
    v_mfma_f32_16x16x32_bf16 v[146:149], a[172:175], a[72:75], v[146:149]
    global_load_lds_dwordx4 v228, s[76:77] offset:768 sc0
    v_mfma_f32_16x16x32_bf16 v[150:153], a[172:175], a[76:79], v[150:153]
    s_add_u32 m0, s50, 130176
    v_lshlrev_b32 v2, 16, v182
    v_mfma_f32_16x16x32_bf16 v[150:153], a[168:171], a[68:71], v[150:153]
    v_lshlrev_b32 v3, 16, v190
    v_mfma_f32_16x16x32_bf16 v[158:161], a[176:179], a[4:7], 0
    global_load_lds_dwordx4 v228, s[76:77] offset:896 sc0
    v_mfma_f32_16x16x32_bf16 v[158:161], a[180:183], a[12:15], v[158:161]
    v_mul_f32 v206, v2, v3
    v_mfma_f32_16x16x32_bf16 v[154:157], a[180:183], a[8:11], 0
    v_and_b32 v2, 0xffff0000, v182
    v_mfma_f32_16x16x32_bf16 v[154:157], a[176:179], a[0:3], v[154:157]
    v_and_b32 v3, 0xffff0000, v190
    v_mfma_f32_16x16x32_bf16 v[154:157], a[184:187], a[16:19], v[154:157]
    ds_read_b128 v[42:45], v229 offset:32768
    v_mul_f32 v207, v2, v3
    v_mfma_f32_16x16x32_bf16 v[154:157], a[188:191], a[24:27], v[154:157]
    v_lshlrev_b32 v2, 16, v183
    v_mfma_f32_16x16x32_bf16 v[158:161], a[188:191], a[28:31], v[158:161]
    ds_read_b128 v[46:49], v230 offset:32768
    v_lshlrev_b32 v3, 16, v191
    v_mfma_f32_16x16x32_bf16 v[158:161], a[184:187], a[20:23], v[158:161]
    s_waitcnt vmcnt(11)
    s_barrier
    buffer_store_dword v254, v254, s[64:67], s25 offen sc1
    v_mfma_f32_16x16x32_bf16 v[158:161], a[192:195], a[36:39], v[158:161]
    ds_read_b128 v[50:53], v229 offset:36864
    v_mul_f32 v208, v2, v3
    v_mfma_f32_16x16x32_bf16 v[158:161], a[196:199], a[44:47], v[158:161]
    v_and_b32 v2, 0xffff0000, v183
    v_mfma_f32_16x16x32_bf16 v[154:157], a[196:199], a[40:43], v[154:157]
    ds_read_b128 v[54:57], v230 offset:36864
    v_and_b32 v3, 0xffff0000, v191
    v_mfma_f32_16x16x32_bf16 v[154:157], a[192:195], a[32:35], v[154:157]
    s_waitcnt lgkmcnt(3)
    v_mul_f32 v209, v2, v3
    v_mfma_f32_16x16x32_bf16 v[154:157], v[42:45], a[48:51], v[154:157]
    s_waitcnt lgkmcnt(2)
    ds_read_b128 v[18:21], v229 offset:0
    v_lshlrev_b32 v2, 16, v184
    v_mfma_f32_16x16x32_bf16 v[154:157], v[46:49], a[56:59], v[154:157]
    v_lshlrev_b32 v3, 16, v192
    v_mfma_f32_16x16x32_bf16 v[158:161], v[46:49], a[60:63], v[158:161]
    ds_read_b128 v[22:25], v230 offset:0
    v_mul_f32 v210, v2, v3
    v_mfma_f32_16x16x32_bf16 v[158:161], v[42:45], a[52:55], v[158:161]
    s_waitcnt lgkmcnt(3)
    v_and_b32 v2, 0xffff0000, v184
    v_mfma_f32_16x16x32_bf16 v[158:161], v[50:53], a[68:71], v[158:161]
    s_waitcnt lgkmcnt(2)
    ds_read_b128 v[26:29], v229 offset:4096
    v_and_b32 v3, 0xffff0000, v192
    v_mfma_f32_16x16x32_bf16 v[158:161], v[54:57], a[76:79], v[158:161]
    v_mul_f32 v211, v2, v3
    v_mfma_f32_16x16x32_bf16 v[154:157], v[54:57], a[72:75], v[154:157]
    ds_read_b128 v[30:33], v230 offset:4096
    v_lshlrev_b32 v2, 16, v185
    v_mfma_f32_16x16x32_bf16 v[154:157], v[50:53], a[64:67], v[154:157]
    s_waitcnt vmcnt(9) lgkmcnt(3)
    s_barrier
    v_lshlrev_b32 v3, 16, v193
    v_mfma_f32_16x16x32_bf16 v[162:165], v[18:21], a[0:3], 0
    s_waitcnt lgkmcnt(2)
    s_add_u32 m0, s50, 134144
    ds_read_b128 v[34:37], v229 offset:8192
    v_mul_f32 v212, v2, v3
    v_mfma_f32_16x16x32_bf16 v[162:165], v[22:25], a[8:11], v[162:165]
    global_load_lds_dwordx4 v228, s[76:77] offset:1024 sc0
    v_mfma_f32_16x16x32_bf16 v[166:169], v[22:25], a[12:15], 0
    s_add_u32 m0, s50, 138112
    ds_read_b128 v[38:41], v230 offset:8192
    v_and_b32 v2, 0xffff0000, v185
    v_mfma_f32_16x16x32_bf16 v[166:169], v[18:21], a[4:7], v[166:169]
    s_waitcnt lgkmcnt(3)
    v_and_b32 v3, 0xffff0000, v193
    v_mfma_f32_16x16x32_bf16 v[166:169], v[26:29], a[20:23], v[166:169]
    s_waitcnt lgkmcnt(2)
    ds_read_b128 v[42:45], v229 offset:12288
    v_mul_f32 v213, v2, v3
    v_mfma_f32_16x16x32_bf16 v[166:169], v[30:33], a[28:31], v[166:169]
    global_load_lds_dwordx4 v228, s[76:77] offset:1152 sc0
    v_mfma_f32_16x16x32_bf16 v[162:165], v[30:33], a[24:27], v[162:165]
    ds_read_b128 v[46:49], v230 offset:12288
    v_lshlrev_b32 v2, 16, v186
    v_mfma_f32_16x16x32_bf16 v[162:165], v[26:29], a[16:19], v[162:165]
    s_waitcnt lgkmcnt(3)
    v_lshlrev_b32 v3, 16, v192
    v_mfma_f32_16x16x32_bf16 v[162:165], v[34:37], a[32:35], v[162:165]
    s_waitcnt lgkmcnt(2)
    ds_read_b128 v[50:53], v229 offset:16384
    v_mul_f32 v214, v2, v3
    v_mfma_f32_16x16x32_bf16 v[162:165], v[38:41], a[40:43], v[162:165]
    v_and_b32 v2, 0xffff0000, v186
    v_mfma_f32_16x16x32_bf16 v[166:169], v[38:41], a[44:47], v[166:169]
    ds_read_b128 v[54:57], v230 offset:16384
    v_and_b32 v3, 0xffff0000, v192
    v_mfma_f32_16x16x32_bf16 v[166:169], v[34:37], a[36:39], v[166:169]
    s_waitcnt vmcnt(8) lgkmcnt(3)
    s_barrier
    v_mul_f32 v215, v2, v3
    v_mfma_f32_16x16x32_bf16 v[166:169], v[42:45], a[52:55], v[166:169]
    s_waitcnt lgkmcnt(2)
    s_add_u32 m0, s50, 101760
    ds_read_b128 v[18:21], v229 offset:40960
    v_lshlrev_b32 v2, 16, v187
    v_mfma_f32_16x16x32_bf16 v[166:169], v[46:49], a[60:63], v[166:169]
    global_load_lds_dwordx4 v228, s[32:33] offset:640 sc0
    v_mfma_f32_16x16x32_bf16 v[162:165], v[46:49], a[56:59], v[162:165]
    s_add_u32 m0, s50, 105728
    ds_read_b128 v[22:25], v230 offset:40960
    v_lshlrev_b32 v3, 16, v193
    v_mfma_f32_16x16x32_bf16 v[162:165], v[42:45], a[48:51], v[162:165]
    s_waitcnt lgkmcnt(3)
    v_mul_f32 v216, v2, v3
    v_mfma_f32_16x16x32_bf16 v[162:165], v[50:53], a[64:67], v[162:165]
    s_waitcnt lgkmcnt(2)
    s_mul_i32 s100, s85, 20480
    ds_read_b128 v[26:29], v229 offset:45056
    v_add_u32 v171, s100, v110
    v_mfma_f32_16x16x32_bf16 v[162:165], v[54:57], a[72:75], v[162:165]
    global_load_lds_dwordx4 v228, s[32:33] offset:768 sc0
    v_and_b32 v2, 0xffff0000, v187
    v_mfma_f32_16x16x32_bf16 v[166:169], v[54:57], a[76:79], v[166:169]
    s_add_u32 m0, s50, 109696
    ds_read_b128 v[30:33], v230 offset:45056
    v_and_b32 v3, 0xffff0000, v193
    v_mfma_f32_16x16x32_bf16 v[166:169], v[50:53], a[68:71], v[166:169]
    s_waitcnt lgkmcnt(3)
    v_mul_f32 v217, v2, v3
    v_mfma_f32_16x16x32_bf16 v[134:137], v[18:21], a[84:87], v[134:137]
    s_waitcnt lgkmcnt(2)
    s_sub_u32 s100, 20480, s100
    ds_read_b128 v[34:37], v229 offset:49152
    v_add_u32 v172, s100, v110
    v_mfma_f32_16x16x32_bf16 v[134:137], v[22:25], a[92:95], v[134:137]
    global_load_lds_dwordx4 v228, s[32:33] offset:896 sc0
    v_mfma_f32_16x16x32_bf16 v[130:133], v[22:25], a[88:91], v[130:133]
    s_mul_i32 s100, s85, 6144
    ds_read_b128 v[38:41], v230 offset:49152
    v_mfma_f32_16x16x32_bf16 v[130:133], v[18:21], a[80:83], v[130:133]
    s_waitcnt vmcnt(8) lgkmcnt(3)
    s_barrier
    v_mfma_f32_16x16x32_bf16 v[130:133], v[26:29], a[96:99], v[130:133]
    s_waitcnt lgkmcnt(2)
    s_add_u32 m0, s50, 113664
    ds_read_b128 v[42:45], v229 offset:53248
    v_mfma_f32_16x16x32_bf16 v[130:133], v[30:33], a[104:107], v[130:133]
    global_load_lds_dwordx4 v228, s[32:33] offset:1024 sc0
    v_mfma_f32_16x16x32_bf16 v[134:137], v[30:33], a[108:111], v[134:137]
    s_add_u32 m0, s50, 117632
    ds_read_b128 v[46:49], v230 offset:53248
    v_mfma_f32_16x16x32_bf16 v[134:137], v[26:29], a[100:103], v[134:137]
    s_waitcnt lgkmcnt(3)
    v_mfma_f32_16x16x32_bf16 v[134:137], v[34:37], a[116:119], v[134:137]
    s_waitcnt lgkmcnt(2)
    s_sub_u32 s100, 12288, s100
    ds_read_b128 v[50:53], v229 offset:57344
    v_mfma_f32_16x16x32_bf16 v[134:137], v[38:41], a[124:127], v[134:137]
    global_load_lds_dwordx4 v228, s[32:33] offset:1152 sc0
    v_mfma_f32_16x16x32_bf16 v[130:133], v[38:41], a[120:123], v[130:133]
    s_add_u32 m0, s50, 142720
    ds_read_b128 v[54:57], v230 offset:57344
    v_mfma_f32_16x16x32_bf16 v[130:133], v[34:37], a[112:115], v[130:133]
    s_waitcnt lgkmcnt(3)
    s_add_u32 s76, s18, 40960
    s_addc_u32 s77, s19, 0
    v_mfma_f32_16x16x32_bf16 v[130:133], v[42:45], a[128:131], v[130:133]
    s_waitcnt lgkmcnt(2)
    s_add_u32 s78, s64, s27
    s_addc_u32 s79, s65, 0
    ds_read_b128 v[18:21], v229 offset:20480
    v_mfma_f32_16x16x32_bf16 v[130:133], v[46:49], a[136:139], v[130:133]
    global_load_lds_dwordx4 v228, s[76:77] offset:640 sc0
    v_mfma_f32_16x16x32_bf16 v[134:137], v[46:49], a[140:143], v[134:137]
    ds_read_b128 v[22:25], v230 offset:20480
    v_mfma_f32_16x16x32_bf16 v[134:137], v[42:45], a[132:135], v[134:137]
    s_waitcnt vmcnt(7) lgkmcnt(3)
    s_barrier
    v_mfma_f32_16x16x32_bf16 v[134:137], v[50:53], a[148:151], v[134:137]
    s_waitcnt lgkmcnt(2)
    s_add_u32 m0, s50, 146688
    ds_read_b128 v[26:29], v229 offset:24576
    v_mfma_f32_16x16x32_bf16 v[134:137], v[54:57], a[156:159], v[134:137]
    global_load_lds_dwordx4 v228, s[76:77] offset:768 sc0
    v_mfma_f32_16x16x32_bf16 v[130:133], v[54:57], a[152:155], v[130:133]
    s_add_u32 m0, s50, 150656
    ds_read_b128 v[30:33], v230 offset:24576
    v_mfma_f32_16x16x32_bf16 v[130:133], v[50:53], a[144:147], v[130:133]
    s_waitcnt lgkmcnt(3)
    v_mfma_f32_16x16x32_bf16 v[138:141], v[18:21], a[80:83], v[138:141]
    s_waitcnt lgkmcnt(2)
    ds_read_b128 v[34:37], v229 offset:28672
    v_mfma_f32_16x16x32_bf16 v[138:141], v[22:25], a[88:91], v[138:141]
    global_load_lds_dwordx4 v228, s[76:77] offset:896 sc0
    v_mfma_f32_16x16x32_bf16 v[142:145], v[22:25], a[92:95], v[142:145]
    s_add_u32 m0, s50, 154624
    ds_read_b128 v[38:41], v230 offset:28672
    v_mfma_f32_16x16x32_bf16 v[142:145], v[18:21], a[84:87], v[142:145]
    s_waitcnt lgkmcnt(3)
    v_mfma_f32_16x16x32_bf16 v[142:145], v[26:29], a[100:103], v[142:145]
    s_waitcnt lgkmcnt(2)
    ds_read_b128 v[42:45], v229 offset:32768
    v_mfma_f32_16x16x32_bf16 v[142:145], v[30:33], a[108:111], v[142:145]
    global_load_lds_dwordx4 v228, s[76:77] offset:1024 sc0
    v_mfma_f32_16x16x32_bf16 v[138:141], v[30:33], a[104:107], v[138:141]
    ds_read_b128 v[46:49], v230 offset:32768
    v_mfma_f32_16x16x32_bf16 v[138:141], v[26:29], a[96:99], v[138:141]
    s_waitcnt vmcnt(7) lgkmcnt(3)
    s_barrier
    v_mfma_f32_16x16x32_bf16 v[138:141], v[34:37], a[112:115], v[138:141]
    s_waitcnt lgkmcnt(2)
    s_add_u32 m0, s50, 158592
    ds_read_b128 v[50:53], v229 offset:36864
    v_mfma_f32_16x16x32_bf16 v[138:141], v[38:41], a[120:123], v[138:141]
    global_load_lds_dwordx4 v228, s[76:77] offset:1152 sc0
    v_mfma_f32_16x16x32_bf16 v[142:145], v[38:41], a[124:127], v[142:145]
    s_add_u32 m0, s50, 122240
    ds_read_b128 v[54:57], v230 offset:36864
    v_mfma_f32_16x16x32_bf16 v[142:145], v[34:37], a[116:119], v[142:145]
    s_waitcnt lgkmcnt(3)
    s_add_u32 s76, s18, 61440
    s_addc_u32 s77, s19, 0
    buffer_load_dword v116, v235, s[64:67], s26 offen sc1
    v_mfma_f32_16x16x32_bf16 v[142:145], v[42:45], a[132:135], v[142:145]
    s_waitcnt lgkmcnt(2)
    ds_read_b128 v[18:21], v229 offset:0
    v_mfma_f32_16x16x32_bf16 v[142:145], v[46:49], a[140:143], v[142:145]
    global_load_lds_dwordx4 v228, s[76:77] offset:640 sc0
    v_mfma_f32_16x16x32_bf16 v[138:141], v[46:49], a[136:139], v[138:141]
    s_add_u32 m0, s50, 126208
    ds_read_b128 v[22:25], v230 offset:0
    v_mfma_f32_16x16x32_bf16 v[138:141], v[42:45], a[128:131], v[138:141]
    s_waitcnt lgkmcnt(3)
    v_mfma_f32_16x16x32_bf16 v[138:141], v[50:53], a[144:147], v[138:141]
    s_waitcnt lgkmcnt(2)
    ds_read_b128 v[26:29], v229 offset:4096
    v_mfma_f32_16x16x32_bf16 v[138:141], v[54:57], a[152:155], v[138:141]
    global_load_lds_dwordx4 v228, s[76:77] offset:768 sc0
    v_mfma_f32_16x16x32_bf16 v[142:145], v[54:57], a[156:159], v[142:145]
    ds_read_b128 v[30:33], v230 offset:4096
    v_mfma_f32_16x16x32_bf16 v[142:145], v[50:53], a[148:151], v[142:145]
    s_waitcnt vmcnt(8) lgkmcnt(3)
    s_barrier
    v_mfma_f32_16x16x32_bf16 v[150:153], v[18:21], a[84:87], v[150:153]
    s_waitcnt lgkmcnt(2)
    s_add_u32 m0, s50, 130176
    ds_read_b128 v[34:37], v229 offset:8192
    v_mfma_f32_16x16x32_bf16 v[150:153], v[22:25], a[92:95], v[150:153]
    global_load_lds_dwordx4 v228, s[76:77] offset:896 sc0
    v_mfma_f32_16x16x32_bf16 v[146:149], v[22:25], a[88:91], v[146:149]
    s_add_u32 m0, s50, 134144
    ds_read_b128 v[38:41], v230 offset:8192
    v_mfma_f32_16x16x32_bf16 v[146:149], v[18:21], a[80:83], v[146:149]
    s_waitcnt lgkmcnt(3)
    v_mfma_f32_16x16x32_bf16 v[146:149], v[26:29], a[96:99], v[146:149]
    s_waitcnt lgkmcnt(2)
    ds_read_b128 v[42:45], v229 offset:12288
    v_mfma_f32_16x16x32_bf16 v[146:149], v[30:33], a[104:107], v[146:149]
    global_load_lds_dwordx4 v228, s[76:77] offset:1024 sc0
    v_mfma_f32_16x16x32_bf16 v[150:153], v[30:33], a[108:111], v[150:153]
    s_add_u32 m0, s50, 138112
    ds_read_b128 v[46:49], v230 offset:12288
    v_mfma_f32_16x16x32_bf16 v[150:153], v[26:29], a[100:103], v[150:153]
    s_waitcnt lgkmcnt(3)
    v_mfma_f32_16x16x32_bf16 v[150:153], v[34:37], a[116:119], v[150:153]
    s_waitcnt lgkmcnt(2)
    ds_read_b128 v[50:53], v229 offset:16384
    v_mfma_f32_16x16x32_bf16 v[150:153], v[38:41], a[124:127], v[150:153]
    global_load_lds_dwordx4 v228, s[76:77] offset:1152 sc0
    v_mfma_f32_16x16x32_bf16 v[146:149], v[38:41], a[120:123], v[146:149]
    ds_read_b128 v[54:57], v230 offset:16384
    v_mfma_f32_16x16x32_bf16 v[146:149], v[34:37], a[112:115], v[146:149]
    s_waitcnt vmcnt(8) lgkmcnt(3)
    s_barrier
    v_mfma_f32_16x16x32_bf16 v[146:149], v[42:45], a[128:131], v[146:149]
    s_waitcnt vmcnt(5) lgkmcnt(2)
    ds_read_b128 v[18:21], v229 offset:40960
    v_cmp_eq_u32 vcc, -1, v116
    v_mfma_f32_16x16x32_bf16 v[146:149], v[46:49], a[136:139], v[146:149]
    v_mfma_f32_16x16x32_bf16 v[150:153], v[46:49], a[140:143], v[150:153]
    ds_read_b128 v[22:25], v230 offset:40960
    v_mfma_f32_16x16x32_bf16 v[150:153], v[42:45], a[132:135], v[150:153]
    s_cbranch_vccnz L_retry_13
L_ok_14:
    s_waitcnt lgkmcnt(3)
    v_mfma_f32_16x16x32_bf16 v[150:153], v[50:53], a[148:151], v[150:153]
    s_waitcnt lgkmcnt(2)
    ds_read_b128 v[26:29], v229 offset:45056
    v_mfma_f32_16x16x32_bf16 v[150:153], v[54:57], a[156:159], v[150:153]
    global_load_dwordx4 a[160:163], v171, s[78:79] offset:-4096 sc1
    v_mfma_f32_16x16x32_bf16 v[146:149], v[54:57], a[152:155], v[146:149]
    ds_read_b128 v[30:33], v230 offset:45056
    v_mfma_f32_16x16x32_bf16 v[146:149], v[50:53], a[144:147], v[146:149]
    s_waitcnt lgkmcnt(3)
    global_load_dwordx4 a[164:167], v172, s[78:79] offset:-4096 sc1
    v_mfma_f32_16x16x32_bf16 v[154:157], v[18:21], a[80:83], v[154:157]
    s_waitcnt lgkmcnt(2)
    ds_read_b128 v[34:37], v229 offset:49152
    v_mfma_f32_16x16x32_bf16 v[154:157], v[22:25], a[88:91], v[154:157]
    global_load_dwordx4 a[168:171], v171, s[78:79] offset:-3072 sc1
    v_mfma_f32_16x16x32_bf16 v[158:161], v[22:25], a[92:95], v[158:161]
    ds_read_b128 v[38:41], v230 offset:49152
    v_mfma_f32_16x16x32_bf16 v[158:161], v[18:21], a[84:87], v[158:161]
    s_waitcnt vmcnt(7) lgkmcnt(3)
    s_barrier
    global_load_dwordx4 a[172:175], v172, s[78:79] offset:-3072 sc1
    v_mfma_f32_16x16x32_bf16 v[158:161], v[26:29], a[100:103], v[158:161]
    s_waitcnt lgkmcnt(2)
    ds_read_b128 v[42:45], v229 offset:53248
    ds_write_b128 v238, v[134:137] offset:1024
    v_mfma_f32_16x16x32_bf16 v[158:161], v[30:33], a[108:111], v[158:161]
    global_load_dwordx4 a[176:179], v171, s[78:79] offset:-2048 sc1
    v_mfma_f32_16x16x32_bf16 v[154:157], v[30:33], a[104:107], v[154:157]
    ds_read_b128 v[46:49], v230 offset:53248
    v_mfma_f32_16x16x32_bf16 v[154:157], v[26:29], a[96:99], v[154:157]
    s_waitcnt lgkmcnt(4)
    global_load_dwordx4 a[180:183], v172, s[78:79] offset:-2048 sc1
    v_mfma_f32_16x16x32_bf16 v[154:157], v[34:37], a[112:115], v[154:157]
    s_waitcnt lgkmcnt(3)
    ds_read_b128 v[50:53], v229 offset:57344
    ds_write_b128 v237, v[130:133] offset:0
    v_mfma_f32_16x16x32_bf16 v[154:157], v[38:41], a[120:123], v[154:157]
    global_load_dwordx4 a[184:187], v171, s[78:79] offset:-1024 sc1
    v_mfma_f32_16x16x32_bf16 v[158:161], v[38:41], a[124:127], v[158:161]
    ds_read_b128 v[54:57], v230 offset:57344
    v_mfma_f32_16x16x32_bf16 v[158:161], v[34:37], a[116:119], v[158:161]
    s_waitcnt lgkmcnt(4)
    global_load_dwordx4 a[188:191], v172, s[78:79] offset:-1024 sc1
    v_mfma_f32_16x16x32_bf16 v[158:161], v[42:45], a[132:135], v[158:161]
    s_waitcnt lgkmcnt(3)
    ds_read_b128 v[18:21], v229 offset:20480
    ds_write_b128 v238, v[142:145] offset:9216
    v_mfma_f32_16x16x32_bf16 v[158:161], v[46:49], a[140:143], v[158:161]
    global_load_dwordx4 a[192:195], v171, s[78:79] offset:0 sc1
    v_mfma_f32_16x16x32_bf16 v[154:157], v[46:49], a[136:139], v[154:157]
    ds_read_b128 v[22:25], v230 offset:20480
    v_mfma_f32_16x16x32_bf16 v[154:157], v[42:45], a[128:131], v[154:157]
    s_waitcnt vmcnt(10) lgkmcnt(4)
    s_barrier
    global_load_dwordx4 a[196:199], v172, s[78:79] offset:0 sc1
    v_mfma_f32_16x16x32_bf16 v[154:157], v[50:53], a[144:147], v[154:157]
    s_waitcnt lgkmcnt(3)
    ds_read_b128 v[26:29], v229 offset:24576
    ds_write_b128 v237, v[138:141] offset:8192
    v_mfma_f32_16x16x32_bf16 v[154:157], v[54:57], a[152:155], v[154:157]
    global_load_dwordx4 a[200:203], v171, s[78:79] offset:1024 sc1
    v_mfma_f32_16x16x32_bf16 v[158:161], v[54:57], a[156:159], v[158:161]
    ds_read_b128 v[30:33], v230 offset:24576
    v_mfma_f32_16x16x32_bf16 v[158:161], v[50:53], a[148:151], v[158:161]
    s_waitcnt lgkmcnt(4)
    global_load_dwordx4 a[204:207], v172, s[78:79] offset:1024 sc1
    v_mfma_f32_16x16x32_bf16 v[166:169], v[18:21], a[84:87], v[166:169]
    s_waitcnt lgkmcnt(3)
    ds_read_b128 v[34:37], v229 offset:28672
    v_mfma_f32_16x16x32_bf16 v[166:169], v[22:25], a[92:95], v[166:169]
    global_load_dwordx4 a[208:211], v171, s[78:79] offset:2048 sc1
    v_mfma_f32_16x16x32_bf16 v[162:165], v[22:25], a[88:91], v[162:165]
    ds_read_b128 v[38:41], v230 offset:28672
    v_mfma_f32_16x16x32_bf16 v[162:165], v[18:21], a[80:83], v[162:165]
    s_waitcnt lgkmcnt(4)
    global_load_dwordx4 a[212:215], v172, s[78:79] offset:2048 sc1
    v_mfma_f32_16x16x32_bf16 v[162:165], v[26:29], a[96:99], v[162:165]
    s_waitcnt lgkmcnt(2)
    ds_read_b128 v[42:45], v229 offset:32768
    v_mfma_f32_16x16x32_bf16 v[162:165], v[30:33], a[104:107], v[162:165]
    global_load_dwordx4 a[216:219], v171, s[78:79] offset:3072 sc1
    v_mfma_f32_16x16x32_bf16 v[166:169], v[30:33], a[108:111], v[166:169]
    ds_read_b128 v[46:49], v230 offset:32768
    v_mfma_f32_16x16x32_bf16 v[166:169], v[26:29], a[100:103], v[166:169]
    s_waitcnt vmcnt(15) lgkmcnt(3)
    s_barrier
    global_load_dwordx4 a[220:223], v172, s[78:79] offset:3072 sc1
    ds_read_b128 v[130:133], v243 offset:0
    v_mfma_f32_16x16x32_bf16 v[166:169], v[34:37], a[116:119], v[166:169]
    s_waitcnt lgkmcnt(3)
    s_add_u32 s78, s78, s100
    s_addc_u32 s79, s79, 0
    ds_read_b128 v[50:53], v229 offset:36864
    ds_write_b128 v238, v[150:153] offset:41984
    v_mfma_f32_16x16x32_bf16 v[166:169], v[38:41], a[124:127], v[166:169]
    global_load_dwordx4 a[224:227], v171, s[78:79] offset:0 sc1
    ds_read_b128 v[134:137], v243 offset:1024
    v_mfma_f32_16x16x32_bf16 v[162:165], v[38:41], a[120:123], v[162:165]
    ds_read_b128 v[54:57], v230 offset:36864
    ds_read_b128 v[138:141], v243 offset:512
    v_mfma_f32_16x16x32_bf16 v[162:165], v[34:37], a[112:115], v[162:165]
    s_waitcnt lgkmcnt(7)
    global_load_dwordx4 a[228:231], v172, s[78:79] offset:0 sc1
    ds_read_b128 v[142:145], v243 offset:1536
    v_mfma_f32_16x16x32_bf16 v[162:165], v[42:45], a[128:131], v[162:165]
    s_waitcnt lgkmcnt(7)
    ds_read_b128 v[18:21], v231 offset:0
    ds_write_b128 v237, v[146:149] offset:40960
    v_mfma_f32_16x16x32_bf16 v[162:165], v[46:49], a[136:139], v[162:165]
    global_load_dwordx4 a[232:235], v171, s[78:79] offset:1024 sc1
    v_mfma_f32_16x16x32_bf16 v[166:169], v[46:49], a[140:143], v[166:169]
    ds_read_b128 v[22:25], v231 offset:1024
    v_mfma_f32_16x16x32_bf16 v[166:169], v[42:45], a[132:135], v[166:169]
    s_waitcnt lgkmcnt(7)
    global_load_dwordx4 a[236:239], v172, s[78:79] offset:1024 sc1
    v_mfma_f32_16x16x32_bf16 v[166:169], v[50:53], a[148:151], v[166:169]
    s_waitcnt lgkmcnt(5)
    ds_read_b128 v[26:29], v231 offset:5120
    v_add_f32 v130, v130, v134
    v_mfma_f32_16x16x32_bf16 v[166:169], v[54:57], a[156:159], v[166:169]
    v_add_f32 v131, v131, v135
    v_mfma_f32_16x16x32_bf16 v[162:165], v[54:57], a[152:155], v[162:165]
    ds_read_b128 v[30:33], v231 offset:6144
    v_add_f32 v132, v132, v136
    v_mfma_f32_16x16x32_bf16 v[162:165], v[50:53], a[144:147], v[162:165]
    s_waitcnt vmcnt(19) lgkmcnt(4)
    s_barrier
    ds_write_b128 v238, v[158:161] offset:21504
    v_add_f32 v133, v133, v137
    v_mfma_f32_16x16x32_bf16 v[58:61], v[18:21], a[160:163], 0
    s_waitcnt vmcnt(18) lgkmcnt(4)
    ds_read_b128 v[34:37], v231 offset:10240
    v_add_f32 v130, v130, v198
    v_mfma_f32_16x16x32_bf16 v[62:65], v[18:21], a[164:167], 0
    s_waitcnt lgkmcnt(4)
    ds_read_b128 v[146:149], v236 offset:40960
    ds_read_b128 v[150:153], v236 offset:41984
    v_add_f32 v131, v131, v199
    v_mfma_f32_16x16x32_bf16 v[70:73], v[22:25], a[164:167], 0
    ds_read_b128 v[38:41], v231 offset:11264
    v_add_f32 v132, v132, v200
    v_mfma_f32_16x16x32_bf16 v[66:69], v[22:25], a[160:163], 0
    s_waitcnt vmcnt(17) lgkmcnt(6)
    ds_write_b128 v237, v[154:157] offset:20480
    v_add_f32 v133, v133, v201
    v_mfma_f32_16x16x32_bf16 v[58:61], v[26:29], a[168:171], v[58:61]
    s_waitcnt vmcnt(16) lgkmcnt(6)
    ds_read_b128 v[42:45], v231 offset:15360
    v_add_f32 v138, v138, v142
    v_mfma_f32_16x16x32_bf16 v[62:65], v[26:29], a[172:175], v[62:65]
    v_add_f32 v139, v139, v143
    v_mfma_f32_16x16x32_bf16 v[70:73], v[30:33], a[172:175], v[70:73]
    ds_read_b128 v[46:49], v231 offset:16384
    v_add_f32 v140, v140, v144
    v_mfma_f32_16x16x32_bf16 v[66:69], v[30:33], a[168:171], v[66:69]
    s_waitcnt vmcnt(15) lgkmcnt(6)
    ds_write_b128 v238, v[166:169] offset:29696
    v_add_f32 v141, v141, v145
    v_mfma_f32_16x16x32_bf16 v[58:61], v[34:37], a[176:179], v[58:61]
    s_waitcnt vmcnt(14) lgkmcnt(4)
    ds_read_b128 v[50:53], v231 offset:20480
    v_add_f32 v138, v138, v202
    v_mfma_f32_16x16x32_bf16 v[62:65], v[34:37], a[180:183], v[62:65]
    v_add_f32 v139, v139, v203
    v_mfma_f32_16x16x32_bf16 v[70:73], v[38:41], a[180:183], v[70:73]
    ds_read_b128 v[54:57], v231 offset:21504
    v_add_f32 v140, v140, v204
    v_mfma_f32_16x16x32_bf16 v[66:69], v[38:41], a[176:179], v[66:69]
    s_waitcnt vmcnt(13) lgkmcnt(4)
    ds_write_b128 v237, v[162:165] offset:28672
    v_add_f32 v141, v141, v205
    v_mfma_f32_16x16x32_bf16 v[58:61], v[42:45], a[184:187], v[58:61]
    s_waitcnt vmcnt(12) lgkmcnt(4)
    ds_read_b128 v[18:21], v231 offset:25600
    v_add_f32 v146, v146, v150
    v_mfma_f32_16x16x32_bf16 v[62:65], v[42:45], a[188:191], v[62:65]
    v_add_f32 v147, v147, v151
    v_mfma_f32_16x16x32_bf16 v[70:73], v[46:49], a[188:191], v[70:73]
    ds_read_b128 v[22:25], v231 offset:26624
    v_add_f32 v148, v148, v152
    v_mfma_f32_16x16x32_bf16 v[66:69], v[46:49], a[184:187], v[66:69]
    s_waitcnt vmcnt(11) lgkmcnt(4)
    s_barrier
    buffer_store_dwordx4 v[130:133], v244, s[80:83], s16 offen offset:2560 sc1
    v_add_f32 v149, v149, v153
    v_mfma_f32_16x16x32_bf16 v[58:61], v[50:53], a[192:195], v[58:61]
L_pad_n7:
    s_cmp_eq_u32 s37, 1
    s_cbranch_scc1 L_ret_n
    s_waitcnt vmcnt(11)
    ds_read_b128 v[26:29], v231 offset:30720
    v_add_f32 v146, v146, v206
    v_mfma_f32_16x16x32_bf16 v[62:65], v[50:53], a[196:199], v[62:65]
    s_waitcnt lgkmcnt(4)
    ds_read_b128 v[154:157], v243 offset:20480
    ds_read_b128 v[158:161], v243 offset:21504
    v_add_f32 v147, v147, v207
    v_mfma_f32_16x16x32_bf16 v[70:73], v[54:57], a[196:199], v[70:73]
    ds_read_b128 v[30:33], v231 offset:31744
    ds_read_b128 v[162:165], v243 offset:20992
    v_add_f32 v148, v148, v208
    v_mfma_f32_16x16x32_bf16 v[66:69], v[54:57], a[192:195], v[66:69]
    s_waitcnt vmcnt(10) lgkmcnt(6)
    buffer_store_dwordx4 v[138:141], v244, s[80:83], s17 offen offset:2560 sc1
    v_add_f32 v149, v149, v209
    v_mfma_f32_16x16x32_bf16 v[58:61], v[18:21], a[200:203], v[58:61]
    s_waitcnt vmcnt(10)
    ds_read_b128 v[34:37], v231 offset:35840
    v_mfma_f32_16x16x32_bf16 v[62:65], v[18:21], a[204:207], v[62:65]
    s_waitcnt lgkmcnt(6)
    ds_read_b128 v[166:169], v243 offset:22016
    v_mfma_f32_16x16x32_bf16 v[70:73], v[22:25], a[204:207], v[70:73]
    ds_read_b128 v[38:41], v231 offset:36864
    v_mfma_f32_16x16x32_bf16 v[66:69], v[22:25], a[200:203], v[66:69]
    s_waitcnt vmcnt(9) lgkmcnt(7)
    buffer_store_dwordx4 v[146:149], v239, s[80:83], s40 offen offset:2560 sc1
    v_mfma_f32_16x16x32_bf16 v[58:61], v[26:29], a[208:211], v[58:61]
    s_waitcnt vmcnt(9) lgkmcnt(5)
    ds_read_b128 v[42:45], v231 offset:40960
    v_add_f32 v154, v154, v158
    v_mfma_f32_16x16x32_bf16 v[62:65], v[26:29], a[212:215], v[62:65]
    s_waitcnt lgkmcnt(5)
    v_add_f32 v155, v155, v159
    v_mfma_f32_16x16x32_bf16 v[70:73], v[30:33], a[212:215], v[70:73]
    ds_read_b128 v[46:49], v231 offset:41984
    v_add_f32 v156, v156, v160
    v_mfma_f32_16x16x32_bf16 v[66:69], v[30:33], a[208:211], v[66:69]
    s_waitcnt vmcnt(8) lgkmcnt(4)
    v_add_f32 v157, v157, v161
    v_mfma_f32_16x16x32_bf16 v[58:61], v[34:37], a[216:219], v[58:61]
    s_waitcnt vmcnt(7)
    ds_read_b128 v[50:53], v231 offset:46080
    v_add_f32 v154, v154, v210
    v_mfma_f32_16x16x32_bf16 v[62:65], v[34:37], a[220:223], v[62:65]
    s_waitcnt lgkmcnt(3)
    v_add_f32 v155, v155, v211
    v_mfma_f32_16x16x32_bf16 v[70:73], v[38:41], a[220:223], v[70:73]
    ds_read_b128 v[54:57], v231 offset:47104
    v_add_f32 v156, v156, v212
    v_mfma_f32_16x16x32_bf16 v[66:69], v[38:41], a[216:219], v[66:69]
    s_waitcnt vmcnt(6) lgkmcnt(3)
    v_add_f32 v157, v157, v213
    v_mfma_f32_16x16x32_bf16 v[58:61], v[42:45], a[224:227], v[58:61]
    s_waitcnt vmcnt(5)
    ds_read_b128 v[18:21], v170 offset:0
    v_add_f32 v162, v162, v166
    v_mfma_f32_16x16x32_bf16 v[62:65], v[42:45], a[228:231], v[62:65]
    s_waitcnt lgkmcnt(3)
    buffer_store_dwordx4 v[154:157], v244, s[80:83], s16 offen offset:2688 sc1
    v_add_f32 v163, v163, v167
    v_mfma_f32_16x16x32_bf16 v[70:73], v[46:49], a[228:231], v[70:73]
    ds_read_b128 v[22:25], v170 offset:5120
    v_add_f32 v164, v164, v168
    v_mfma_f32_16x16x32_bf16 v[66:69], v[46:49], a[224:227], v[66:69]
    s_waitcnt vmcnt(5) lgkmcnt(3)
    v_add_f32 v165, v165, v169
    v_mfma_f32_16x16x32_bf16 v[58:61], v[50:53], a[232:235], v[58:61]
    s_waitcnt vmcnt(4)
    ds_read_b128 v[26:29], v170 offset:10240
    v_add_f32 v162, v162, v214
    v_mfma_f32_16x16x32_bf16 v[62:65], v[50:53], a[236:239], v[62:65]
    s_waitcnt lgkmcnt(3)
    v_add_f32 v163, v163, v215
    v_mfma_f32_16x16x32_bf16 v[70:73], v[54:57], a[236:239], v[70:73]
    ds_read_b128 v[30:33], v170 offset:15360
    v_add_f32 v164, v164, v216
    v_mfma_f32_16x16x32_bf16 v[66:69], v[54:57], a[232:235], v[66:69]
    s_waitcnt lgkmcnt(3)
    v_add_f32 v165, v165, v217
    v_mfma_f32_16x16x32_bf16 v[74:77], v[18:21], a[160:163], 0
    s_waitcnt lgkmcnt(2)
    ds_read_b128 v[34:37], v170 offset:20480
    v_mfma_f32_16x16x32_bf16 v[74:77], v[22:25], a[168:171], v[74:77]
    ds_write_b128 v238, v[62:65] offset:1024
    v_mfma_f32_16x16x32_bf16 v[78:81], v[22:25], a[172:175], 0
    ds_read_b128 v[38:41], v170 offset:25600
    v_mfma_f32_16x16x32_bf16 v[78:81], v[18:21], a[164:167], v[78:81]
    s_waitcnt lgkmcnt(4)
    v_mfma_f32_16x16x32_bf16 v[78:81], v[26:29], a[180:183], v[78:81]
    s_waitcnt lgkmcnt(3)
    ds_read_b128 v[42:45], v170 offset:30720
    v_mfma_f32_16x16x32_bf16 v[78:81], v[30:33], a[188:191], v[78:81]
    ds_write_b128 v237, v[58:61] offset:0
    v_mfma_f32_16x16x32_bf16 v[74:77], v[30:33], a[184:187], v[74:77]
    ds_read_b128 v[46:49], v170 offset:35840
    v_mfma_f32_16x16x32_bf16 v[74:77], v[26:29], a[176:179], v[74:77]
    s_waitcnt lgkmcnt(5)
    v_mfma_f32_16x16x32_bf16 v[74:77], v[34:37], a[192:195], v[74:77]
    s_waitcnt lgkmcnt(3)
    ds_read_b128 v[50:53], v170 offset:40960
    v_mfma_f32_16x16x32_bf16 v[74:77], v[38:41], a[200:203], v[74:77]
    ds_write_b128 v238, v[70:73] offset:9216
    v_mfma_f32_16x16x32_bf16 v[78:81], v[38:41], a[204:207], v[78:81]
    ds_read_b128 v[54:57], v170 offset:46080
    v_mfma_f32_16x16x32_bf16 v[78:81], v[34:37], a[196:199], v[78:81]
    s_waitcnt lgkmcnt(5)
    v_mfma_f32_16x16x32_bf16 v[78:81], v[42:45], a[212:215], v[78:81]
    s_waitcnt lgkmcnt(3)
    ds_read_b128 v[18:21], v231 offset:2048
    v_mfma_f32_16x16x32_bf16 v[78:81], v[46:49], a[220:223], v[78:81]
    ds_write_b128 v237, v[66:69] offset:8192
    v_mfma_f32_16x16x32_bf16 v[74:77], v[46:49], a[216:219], v[74:77]
    ds_read_b128 v[22:25], v231 offset:7168
    v_mfma_f32_16x16x32_bf16 v[74:77], v[42:45], a[208:211], v[74:77]
    s_waitcnt lgkmcnt(5)
    v_mfma_f32_16x16x32_bf16 v[74:77], v[50:53], a[224:227], v[74:77]
    s_waitcnt lgkmcnt(3)
    ds_read_b128 v[26:29], v231 offset:12288
    v_mfma_f32_16x16x32_bf16 v[74:77], v[54:57], a[232:235], v[74:77]
    s_barrier
    buffer_store_dwordx4 v[162:165], v244, s[80:83], s17 offen offset:2688 sc1
    v_mfma_f32_16x16x32_bf16 v[78:81], v[54:57], a[236:239], v[78:81]
    ds_read_b128 v[30:33], v231 offset:17408
    v_mfma_f32_16x16x32_bf16 v[78:81], v[50:53], a[228:231], v[78:81]
    s_waitcnt lgkmcnt(4)
    ds_read_b128 v[58:61], v243 offset:0
    v_mfma_f32_16x16x32_bf16 v[86:89], v[18:21], a[164:167], 0
    s_waitcnt lgkmcnt(3)
    ds_read_b128 v[34:37], v231 offset:22528
    v_mfma_f32_16x16x32_bf16 v[86:89], v[22:25], a[172:175], v[86:89]
    ds_read_b128 v[62:65], v243 offset:1024
    v_mfma_f32_16x16x32_bf16 v[82:85], v[22:25], a[168:171], 0
    ds_read_b128 v[38:41], v231 offset:27648
    ds_read_b128 v[66:69], v243 offset:512
    v_mfma_f32_16x16x32_bf16 v[82:85], v[18:21], a[160:163], v[82:85]
    s_waitcnt lgkmcnt(6)
    ds_write_b128 v238, v[78:81] offset:50176
    v_mfma_f32_16x16x32_bf16 v[82:85], v[26:29], a[176:179], v[82:85]
    s_waitcnt lgkmcnt(6)
    ds_read_b128 v[42:45], v231 offset:32768
    v_mfma_f32_16x16x32_bf16 v[82:85], v[30:33], a[184:187], v[82:85]
    ds_read_b128 v[70:73], v243 offset:1536
    v_mfma_f32_16x16x32_bf16 v[86:89], v[30:33], a[188:191], v[86:89]
    ds_read_b128 v[46:49], v231 offset:37888
    v_mfma_f32_16x16x32_bf16 v[86:89], v[26:29], a[180:183], v[86:89]
    s_waitcnt lgkmcnt(7)
    ds_write_b128 v237, v[74:77] offset:49152
    v_mfma_f32_16x16x32_bf16 v[86:89], v[34:37], a[196:199], v[86:89]
    s_waitcnt lgkmcnt(6)
    ds_read_b128 v[50:53], v231 offset:43008
    v_add_f32 v58, v58, v62
    v_mfma_f32_16x16x32_bf16 v[86:89], v[38:41], a[204:207], v[86:89]
    v_add_f32 v59, v59, v63
    v_mfma_f32_16x16x32_bf16 v[82:85], v[38:41], a[200:203], v[82:85]
    ds_read_b128 v[54:57], v231 offset:48128
    v_add_f32 v60, v60, v64
    v_mfma_f32_16x16x32_bf16 v[82:85], v[34:37], a[192:195], v[82:85]
    s_waitcnt lgkmcnt(5)
    s_barrier
    ds_read_b128 v[74:77], v236 offset:49152
    ds_read_b128 v[78:81], v236 offset:50176
    v_add_f32 v61, v61, v65
    v_mfma_f32_16x16x32_bf16 v[82:85], v[42:45], a[208:211], v[82:85]
    s_waitcnt lgkmcnt(5)
    ds_read_b128 v[18:21], v231 offset:3072
    v_add_f32 v66, v66, v70
    v_mfma_f32_16x16x32_bf16 v[82:85], v[46:49], a[216:219], v[82:85]
    buffer_store_dwordx4 v[58:61], v244, s[80:83], s16 offen offset:0 sc1
    v_add_f32 v67, v67, v71
    v_mfma_f32_16x16x32_bf16 v[86:89], v[46:49], a[220:223], v[86:89]
    ds_read_b128 v[22:25], v231 offset:8192
    v_add_f32 v68, v68, v72
    v_mfma_f32_16x16x32_bf16 v[86:89], v[42:45], a[212:215], v[86:89]
    s_waitcnt lgkmcnt(5)
    v_add_f32 v69, v69, v73
    v_mfma_f32_16x16x32_bf16 v[86:89], v[50:53], a[228:231], v[86:89]
    s_waitcnt lgkmcnt(4)
    ds_read_b128 v[26:29], v231 offset:13312
    v_mfma_f32_16x16x32_bf16 v[86:89], v[54:57], a[236:239], v[86:89]
    buffer_store_dwordx4 v[66:69], v244, s[80:83], s17 offen offset:0 sc1
    v_mfma_f32_16x16x32_bf16 v[82:85], v[54:57], a[232:235], v[82:85]
    s_waitcnt lgkmcnt(3)
    ds_read_b128 v[30:33], v231 offset:18432
    v_add_f32 v74, v74, v78
    v_mfma_f32_16x16x32_bf16 v[82:85], v[50:53], a[224:227], v[82:85]
    s_waitcnt lgkmcnt(3)
    v_add_f32 v75, v75, v79
    v_mfma_f32_16x16x32_bf16 v[90:93], v[18:21], a[160:163], 0
    s_waitcnt lgkmcnt(2)
    ds_read_b128 v[34:37], v231 offset:23552
    v_add_f32 v76, v76, v80
    v_mfma_f32_16x16x32_bf16 v[90:93], v[22:25], a[168:171], v[90:93]
    v_add_f32 v77, v77, v81
    v_mfma_f32_16x16x32_bf16 v[94:97], v[22:25], a[172:175], 0
    ds_read_b128 v[38:41], v231 offset:28672
    v_mfma_f32_16x16x32_bf16 v[94:97], v[18:21], a[164:167], v[94:97]
    s_waitcnt lgkmcnt(3)
    ds_write_b128 v238, v[86:89] offset:21504
    v_mfma_f32_16x16x32_bf16 v[94:97], v[26:29], a[180:183], v[94:97]
    s_waitcnt lgkmcnt(3)
    ds_read_b128 v[42:45], v231 offset:33792
    v_mfma_f32_16x16x32_bf16 v[94:97], v[30:33], a[188:191], v[94:97]
    v_mfma_f32_16x16x32_bf16 v[90:93], v[30:33], a[184:187], v[90:93]
    ds_read_b128 v[46:49], v231 offset:38912
    v_mfma_f32_16x16x32_bf16 v[90:93], v[26:29], a[176:179], v[90:93]
    s_waitcnt lgkmcnt(4)
    ds_write_b128 v237, v[82:85] offset:20480
    v_mfma_f32_16x16x32_bf16 v[90:93], v[34:37], a[192:195], v[90:93]
    s_waitcnt lgkmcnt(4)
    ds_read_b128 v[50:53], v231 offset:44032
    v_mfma_f32_16x16x32_bf16 v[90:93], v[38:41], a[200:203], v[90:93]
    v_mfma_f32_16x16x32_bf16 v[94:97], v[38:41], a[204:207], v[94:97]
    ds_read_b128 v[54:57], v231 offset:49152
    v_mfma_f32_16x16x32_bf16 v[94:97], v[34:37], a[196:199], v[94:97]
    s_waitcnt lgkmcnt(4)
    buffer_store_dwordx4 v[74:77], v239, s[80:83], s40 offen offset:0 sc1
    v_mfma_f32_16x16x32_bf16 v[94:97], v[42:45], a[212:215], v[94:97]
    s_waitcnt lgkmcnt(3)
    v_mfma_f32_16x16x32_bf16 v[94:97], v[46:49], a[220:223], v[94:97]
    v_mfma_f32_16x16x32_bf16 v[90:93], v[46:49], a[216:219], v[90:93]
    v_mfma_f32_16x16x32_bf16 v[90:93], v[42:45], a[208:211], v[90:93]
    s_waitcnt lgkmcnt(1)
    v_mfma_f32_16x16x32_bf16 v[90:93], v[50:53], a[224:227], v[90:93]
    s_waitcnt lgkmcnt(0)
    v_mfma_f32_16x16x32_bf16 v[90:93], v[54:57], a[232:235], v[90:93]
    v_mfma_f32_16x16x32_bf16 v[94:97], v[54:57], a[236:239], v[94:97]
    v_mfma_f32_16x16x32_bf16 v[94:97], v[50:53], a[228:231], v[94:97]
    s_nop 7
    ds_write_b128 v238, v[94:97] offset:29696
    ds_write_b128 v237, v[90:93] offset:28672
    s_waitcnt lgkmcnt(1)
    s_barrier
    ds_read_b128 v[82:85], v243 offset:20480
    ds_read_b128 v[86:89], v243 offset:21504
    ds_read_b128 v[90:93], v243 offset:20992
    ds_read_b128 v[94:97], v243 offset:22016
    s_waitcnt lgkmcnt(2)
    v_add_f32 v82, v82, v86
    v_add_f32 v83, v83, v87
    v_add_f32 v84, v84, v88
    v_add_f32 v85, v85, v89
    buffer_store_dwordx4 v[82:85], v244, s[80:83], s16 offen offset:128 sc1
    s_waitcnt lgkmcnt(0)
    v_add_f32 v90, v90, v94
    v_add_f32 v91, v91, v95
    v_add_f32 v92, v92, v96
    v_add_f32 v93, v93, v97
    buffer_store_dwordx4 v[90:93], v244, s[80:83], s17 offen offset:128 sc1
    s_endpgm
.p2align 12
L_producer:
    s_mov_b32 s93, 0
    s_mov_b32 s92, 0
    s_mov_b32 s95, 0
    s_mov_b32 s37, 0
    s_mul_i32 s21, s84, 3072
    s_lshl_b32 s39, s84, 11
    s_mov_b32 s46, 819200
    s_mov_b32 s47, 0x00020000
    s_mov_b32 s66, 9469952
    s_mov_b32 s67, 0x00020000
    v_bfe_u32 v2, v1, 3, 2
    v_mul_u32_u24 v2, 1056, v2
    v_and_b32 v3, 7, v1
    v_lshl_add_u32 v2, v3, 7, v2
    v_lshrrev_b32 v3, 5, v1
    v_bfe_u32 v4, v1, 1, 1
    v_xor_b32 v4, v3, v4
    v_lshl_add_u32 v111, v4, 4, v2
    s_mul_i32 s99, s85, 4224
    v_add_u32 v183, s99, v111
    v_bfe_u32 v4, v1, 2, 2
    v_and_b32 v5, 3, v1
    v_lshlrev_b32 v5, 3, v5
    v_and_b32 v6, 16, v1
    v_cmp_ne_u32 vcc, 0, v6
    v_lshl_add_u32 v6, v5, 15, 32
    s_nop 0
    v_cndmask_b32 v5, v5, v6, vcc
    v_lshl_add_u32 v6, v3, 2, v4
    v_mul_u32_u24 v6, 320, v6
    s_mul_i32 s99, s86, 80
    s_add_u32 s99, s99, 84480
    v_add3_u32 v185, v6, v5, s99
    v_add_u32 v184, 42240, v183
    v_lshl_add_u32 v6, v3, 3, v4
    v_mul_u32_u24 v6, 40, v6
    s_mul_i32 s99, s86, 26624
    s_add_u32 s99, s99, 104960
    v_add3_u32 v186, v6, v5, s99
    s_mov_b32 s22, 0
    s_mov_b32 s23, -1
    s_mov_b32 s70, 256
    s_mov_b32 s71, 0x00020000
    v_and_b32 v192, 3, v1
    v_lshlrev_b32 v192, 2, v192
    v_lshlrev_b32 v117, 25, v1
    v_lshlrev_b32 v254, 30, v3
    v_lshl_add_u32 v254, v1, 2, v254
    v_bfe_u32 v2, v1, 2, 1
    v_bfe_u32 v3, v1, 3, 1
    v_sub_u32 v2, v2, v3
    v_mul_i32_i24 v2, 544, v2
    v_add_u32 v190, v183, v2
    v_add_u32 v191, v184, v2
    s_add_u32 m0, s98, 109056
    s_nop 0
    buffer_load_dwordx4 v110, s[48:51], s96 offen offset:2048 sc0 lds
    s_add_u32 m0, s20, 16640
    s_nop 0
    buffer_load_dwordx4 v112, s[40:43], s91 offen offset:256 sc0 lds
    buffer_load_dwordx4 v113, s[40:43], s91 offen offset:1312 sc0 lds
    s_add_u32 m0, s98, 113152
    s_add_u32 s96, s97, 8192
    buffer_load_dwordx4 v110, s[48:51], s96 offen offset:0 sc0 lds
    s_add_u32 m0, s20, 24960
    s_nop 0
    buffer_load_dwordx4 v112, s[40:43], s91 offen offset:384 sc0 lds
    buffer_load_dwordx4 v113, s[40:43], s91 offen offset:1440 sc0 lds
    s_mul_i32 s99, s84, 192
    s_add_u32 s99, s99, 0
    v_add_u32 v6, s99, v1
    v_mul_u32_u24 v7, 6554, v6
    v_lshrrev_b32 v7, 16, v7
    v_mul_u32_u24 v8, 10, v7
    v_sub_u32 v6, v6, v8
    v_and_b32 v8, 1, v7
    v_bfe_u32 v9, v7, 1, 2
    v_lshl_add_u32 v8, v8, 2, v9
    v_and_or_b32 v7, v7, -8, v8
    v_mul_u32_u24 v7, 1280, v7
    v_lshl_add_u32 v7, v6, 4, v7
    v_subrev_u32 v178, 0, v7
    s_mul_i32 s99, s84, 192
    s_add_u32 s99, s99, 64
    v_add_u32 v6, s99, v1
    v_mul_u32_u24 v7, 6554, v6
    v_lshrrev_b32 v7, 16, v7
    v_mul_u32_u24 v8, 10, v7
    v_sub_u32 v6, v6, v8
    v_and_b32 v8, 1, v7
    v_bfe_u32 v9, v7, 1, 2
    v_lshl_add_u32 v8, v8, 2, v9
    v_and_or_b32 v7, v7, -8, v8
    v_mul_u32_u24 v7, 1280, v7
    v_lshl_add_u32 v7, v6, 4, v7
    v_subrev_u32 v179, 1024, v7
    s_mul_i32 s99, s84, 192
    s_add_u32 s99, s99, 128
    v_add_u32 v6, s99, v1
    v_mul_u32_u24 v7, 6554, v6
    v_lshrrev_b32 v7, 16, v7
    v_mul_u32_u24 v8, 10, v7
    v_sub_u32 v6, v6, v8
    v_and_b32 v8, 1, v7
    v_bfe_u32 v9, v7, 1, 2
    v_lshl_add_u32 v8, v8, 2, v9
    v_and_or_b32 v7, v7, -8, v8
    v_mul_u32_u24 v7, 1280, v7
    v_lshl_add_u32 v7, v6, 4, v7
    v_subrev_u32 v180, 2048, v7
    s_mul_i32 s99, s84, 128
    s_add_u32 s99, s99, 768
    v_add_u32 v6, s99, v1
    v_mul_u32_u24 v7, 6554, v6
    v_lshrrev_b32 v7, 16, v7
    v_mul_u32_u24 v8, 10, v7
    v_sub_u32 v6, v6, v8
    v_and_b32 v8, 1, v7
    v_bfe_u32 v9, v7, 1, 2
    v_lshl_add_u32 v8, v8, 2, v9
    v_and_or_b32 v7, v7, -8, v8
    v_mul_u32_u24 v7, 1280, v7
    v_lshl_add_u32 v7, v6, 4, v7
    v_subrev_u32 v181, 0, v7
    s_mul_i32 s99, s84, 128
    s_add_u32 s99, s99, 832
    v_add_u32 v6, s99, v1
    v_mul_u32_u24 v7, 6554, v6
    v_lshrrev_b32 v7, 16, v7
    v_mul_u32_u24 v8, 10, v7
    v_sub_u32 v6, v6, v8
    v_and_b32 v8, 1, v7
    v_bfe_u32 v9, v7, 1, 2
    v_lshl_add_u32 v8, v8, 2, v9
    v_and_or_b32 v7, v7, -8, v8
    v_mul_u32_u24 v7, 1280, v7
    v_lshl_add_u32 v7, v6, 4, v7
    v_subrev_u32 v182, 1024, v7
    v_mov_b32 v248, -1
    v_mov_b32 v249, -1
    v_mov_b32 v250, -1
    v_mov_b32 v251, -1
    s_lshl_b32 s90, s87, 2
    s_add_u32 s90, s90, s84
    s_lshl_b32 s90, s90, 11
    s_waitcnt lgkmcnt(0)
    s_cmp_eq_u32 s86, 0
    s_cbranch_scc0 L_v_15
    s_mul_i32 s99, s87, 6144
    s_add_u32 s99, s99, 262144
    s_lshl_b32 s100, s85, 10
    s_add_u32 s100, s100, s99
    s_lshl_b32 s101, s85, 9
    s_add_u32 s101, s101, s99
    v_lshlrev_b32 v15, 3, v1
    v_mov_b32 v16, 0x3f803f80
    v_mov_b32 v17, 0x00003f80
    v_mov_b32 v4, 0x3ea52b5c
    s_waitcnt vmcnt(9)
    s_barrier
    ds_read_b128 v[50:53], v183 offset:0
    ds_read_b64_tr_b16 v[54:55], v186 offset:0
    ds_read_b64_tr_b16 v[56:57], v186 offset:160
    ds_read_b128 v[58:61], v183 offset:32
    ds_read_b64_tr_b16 v[62:63], v186 offset:640
    ds_read_b64_tr_b16 v[64:65], v186 offset:800
    ds_read_b128 v[66:69], v183 offset:64
    ds_read_b64_tr_b16 v[70:71], v186 offset:1280
    ds_read_b64_tr_b16 v[72:73], v186 offset:1440
    ds_read_b128 v[74:77], v183 offset:96
    ds_read_b64_tr_b16 v[78:79], v186 offset:1920
    ds_read_b64_tr_b16 v[80:81], v186 offset:2080
    s_add_u32 m0, s98, 113152
    s_nop 0
    buffer_load_dwordx4 v110, s[48:51], s96 offen offset:2048 sc0 lds
    s_add_u32 m0, s98, 117248
    s_add_u32 s96, s97, 12288
    buffer_load_dwordx4 v110, s[48:51], s96 offen offset:0 sc0 lds
    s_add_u32 m0, s20, 33280
    s_nop 0
    buffer_load_dwordx4 v112, s[40:43], s91 offen offset:512 sc0 lds
    buffer_load_dwordx4 v113, s[40:43], s91 offen offset:1568 sc0 lds
    s_waitcnt lgkmcnt(9)
    v_mfma_f32_32x32x16_bf16 v[130:145], v[54:57], v[50:53], 0
    s_waitcnt vmcnt(10) lgkmcnt(6)
    s_barrier
    s_add_u32 m0, s98, 117248
    ds_read_b128 v[82:85], v183 offset:8448
    ds_read_b64_tr_b16 v[86:87], v186 offset:2560
    ds_read_b64_tr_b16 v[88:89], v186 offset:2720
    buffer_load_dwordx4 v110, s[48:51], s96 offen offset:2048 sc0 lds
    v_mfma_f32_32x32x16_bf16 v[130:145], v[62:65], v[58:61], v[130:145]
    s_waitcnt lgkmcnt(6)
    s_add_u32 m0, s20, 41600
    ds_read_b128 v[50:53], v183 offset:8480
    ds_read_b64_tr_b16 v[54:55], v186 offset:3200
    ds_read_b64_tr_b16 v[56:57], v186 offset:3360
    v_mfma_f32_32x32x16_bf16 v[130:145], v[70:73], v[66:69], v[130:145]
    s_waitcnt lgkmcnt(6)
    ds_read_b128 v[58:61], v183 offset:8512
    ds_read_b64_tr_b16 v[62:63], v186 offset:3840
    ds_read_b64_tr_b16 v[64:65], v186 offset:4000
    buffer_load_dwordx4 v112, s[40:43], s91 offen offset:640 sc0 lds
    v_mfma_f32_32x32x16_bf16 v[130:145], v[78:81], v[74:77], v[130:145]
    s_waitcnt lgkmcnt(6)
    ds_read_b128 v[66:69], v183 offset:8544
    ds_read_b64_tr_b16 v[70:71], v186 offset:4480
    ds_read_b64_tr_b16 v[72:73], v186 offset:4640
    buffer_load_dwordx4 v113, s[40:43], s91 offen offset:1696 sc0 lds
    v_mfma_f32_32x32x16_bf16 v[130:145], v[86:89], v[82:85], v[130:145]
    s_waitcnt vmcnt(10) lgkmcnt(6)
    s_barrier
    s_add_u32 m0, s98, 121344
    ds_read_b128 v[74:77], v183 offset:16896
    ds_read_b64_tr_b16 v[78:79], v186 offset:5120
    ds_read_b64_tr_b16 v[80:81], v186 offset:5280
    s_add_u32 s96, s97, 16384
    v_mfma_f32_32x32x16_bf16 v[130:145], v[54:57], v[50:53], v[130:145]
    s_waitcnt lgkmcnt(6)
    ds_read_b128 v[82:85], v183 offset:16928
    ds_read_b64_tr_b16 v[86:87], v186 offset:5760
    ds_read_b64_tr_b16 v[88:89], v186 offset:5920
    buffer_load_dwordx4 v110, s[48:51], s96 offen offset:0 sc0 lds
    s_add_u32 m0, s20, 49920
    v_mfma_f32_32x32x16_bf16 v[130:145], v[62:65], v[58:61], v[130:145]
    s_waitcnt lgkmcnt(6)
    ds_read_b128 v[50:53], v183 offset:16960
    ds_read_b64_tr_b16 v[54:55], v186 offset:6400
    ds_read_b64_tr_b16 v[56:57], v186 offset:6560
    buffer_load_dwordx4 v112, s[40:43], s91 offen offset:768 sc0 lds
    v_mfma_f32_32x32x16_bf16 v[130:145], v[70:73], v[66:69], v[130:145]
    s_waitcnt lgkmcnt(6)
    ds_read_b128 v[58:61], v183 offset:16992
    ds_read_b64_tr_b16 v[62:63], v186 offset:7040
    ds_read_b64_tr_b16 v[64:65], v186 offset:7200
    buffer_load_dwordx4 v113, s[40:43], s91 offen offset:1824 sc0 lds
    v_mfma_f32_32x32x16_bf16 v[130:145], v[78:81], v[74:77], v[130:145]
    s_waitcnt vmcnt(10) lgkmcnt(6)
    s_barrier
    s_add_u32 m0, s98, 121344
    ds_read_b128 v[66:69], v183 offset:25344
    ds_read_b64_tr_b16 v[70:71], v186 offset:7680
    ds_read_b64_tr_b16 v[72:73], v186 offset:7840
    buffer_load_dwordx4 v110, s[48:51], s96 offen offset:2048 sc0 lds
    v_mfma_f32_32x32x16_bf16 v[130:145], v[86:89], v[82:85], v[130:145]
    s_waitcnt lgkmcnt(6)
    s_add_u32 m0, s20, 58240
    ds_read_b128 v[74:77], v183 offset:25376
    ds_read_b64_tr_b16 v[78:79], v186 offset:8320
    ds_read_b64_tr_b16 v[80:81], v186 offset:8480
    v_mfma_f32_32x32x16_bf16 v[130:145], v[54:57], v[50:53], v[130:145]
    s_waitcnt lgkmcnt(6)
    ds_read_b128 v[82:85], v183 offset:25408
    ds_read_b64_tr_b16 v[86:87], v186 offset:8960
    ds_read_b64_tr_b16 v[88:89], v186 offset:9120
    buffer_load_dwordx4 v112, s[40:43], s91 offen offset:896 sc0 lds
    v_mfma_f32_32x32x16_bf16 v[130:145], v[62:65], v[58:61], v[130:145]
    s_waitcnt lgkmcnt(6)
    ds_read_b128 v[50:53], v183 offset:25440
    ds_read_b64_tr_b16 v[54:55], v186 offset:9600
    ds_read_b64_tr_b16 v[56:57], v186 offset:9760
    buffer_load_dwordx4 v113, s[40:43], s91 offen offset:1952 sc0 lds
    v_mfma_f32_32x32x16_bf16 v[130:145], v[70:73], v[66:69], v[130:145]
    s_waitcnt vmcnt(9) lgkmcnt(6)
    s_barrier
    s_add_u32 m0, s98, 125440
    ds_read_b128 v[58:61], v183 offset:33792
    ds_read_b64_tr_b16 v[62:63], v186 offset:10240
    ds_read_b64_tr_b16 v[64:65], v186 offset:10400
    s_add_u32 s96, s97, 20480
    v_mfma_f32_32x32x16_bf16 v[130:145], v[78:81], v[74:77], v[130:145]
    s_waitcnt lgkmcnt(6)
    ds_read_b128 v[66:69], v183 offset:33824
    ds_read_b64_tr_b16 v[70:71], v186 offset:10880
    ds_read_b64_tr_b16 v[72:73], v186 offset:11040
    buffer_load_dwordx4 v110, s[48:51], s96 offen offset:0 sc0 lds
    s_add_u32 m0, s98, 125440
    v_mfma_f32_32x32x16_bf16 v[130:145], v[86:89], v[82:85], v[130:145]
    s_waitcnt lgkmcnt(6)
    ds_read_b128 v[74:77], v183 offset:33856
    ds_read_b64_tr_b16 v[78:79], v186 offset:11520
    ds_read_b64_tr_b16 v[80:81], v186 offset:11680
    buffer_load_dwordx4 v110, s[48:51], s96 offen offset:2048 sc0 lds
    s_add_u32 m0, s20, 66560
    v_mfma_f32_32x32x16_bf16 v[130:145], v[54:57], v[50:53], v[130:145]
    s_waitcnt lgkmcnt(6)
    ds_read_b128 v[82:85], v183 offset:33888
    ds_read_b64_tr_b16 v[86:87], v186 offset:12160
    ds_read_b64_tr_b16 v[88:89], v186 offset:12320
    buffer_load_dwordx4 v112, s[40:43], s91 offen offset:1024 sc0 lds
    buffer_load_dwordx4 v113, s[40:43], s91 offen offset:2080 sc0 lds
    v_mfma_f32_32x32x16_bf16 v[130:145], v[62:65], v[58:61], v[130:145]
    s_waitcnt vmcnt(10) lgkmcnt(6)
    s_barrier
    s_add_u32 m0, s98, 129536
    ds_read_b128 v[50:53], v184 offset:0
    ds_read_b64_tr_b16 v[54:55], v186 offset:12800
    ds_read_b64_tr_b16 v[56:57], v186 offset:12960
    s_add_u32 s96, s97, 24576
    v_mfma_f32_32x32x16_bf16 v[130:145], v[70:73], v[66:69], v[130:145]
    s_waitcnt lgkmcnt(6)
    ds_read_b128 v[58:61], v184 offset:32
    ds_read_b64_tr_b16 v[62:63], v186 offset:13440
    ds_read_b64_tr_b16 v[64:65], v186 offset:13600
    buffer_load_dwordx4 v110, s[48:51], s96 offen offset:0 sc0 lds
    s_add_u32 m0, s20, 74880
    v_mfma_f32_32x32x16_bf16 v[130:145], v[78:81], v[74:77], v[130:145]
    s_waitcnt lgkmcnt(6)
    ds_read_b128 v[66:69], v184 offset:64
    ds_read_b64_tr_b16 v[70:71], v186 offset:14080
    ds_read_b64_tr_b16 v[72:73], v186 offset:14240
    buffer_load_dwordx4 v112, s[40:43], s91 offen offset:1152 sc0 lds
    v_mfma_f32_32x32x16_bf16 v[130:145], v[86:89], v[82:85], v[130:145]
    s_waitcnt lgkmcnt(6)
    ds_read_b128 v[74:77], v184 offset:96
    ds_read_b64_tr_b16 v[78:79], v186 offset:14720
    ds_read_b64_tr_b16 v[80:81], v186 offset:14880
    buffer_load_dwordx4 v113, s[40:43], s91 offen offset:2208 sc0 lds
    v_mfma_f32_32x32x16_bf16 v[130:145], v[54:57], v[50:53], v[130:145]
    s_waitcnt vmcnt(10) lgkmcnt(6)
    s_barrier
    ds_read_b128 v[82:85], v184 offset:8448
    ds_read_b64_tr_b16 v[86:87], v186 offset:15360
    ds_read_b64_tr_b16 v[88:89], v186 offset:15520
    buffer_store_dwordx4 v[248:251], v110, s[64:67], s90 offen offset:0 sc1
    v_mfma_f32_32x32x16_bf16 v[130:145], v[62:65], v[58:61], v[130:145]
    s_waitcnt lgkmcnt(6)
    ds_read_b128 v[50:53], v184 offset:8480
    ds_read_b64_tr_b16 v[54:55], v186 offset:16000
    ds_read_b64_tr_b16 v[56:57], v186 offset:16160
    buffer_store_dwordx4 v[248:251], v110, s[64:67], s90 offen offset:1024 sc1
    v_mfma_f32_32x32x16_bf16 v[130:145], v[70:73], v[66:69], v[130:145]
    s_waitcnt lgkmcnt(6)
    ds_read_b128 v[58:61], v184 offset:8512
    ds_read_b64_tr_b16 v[62:63], v186 offset:16640
    ds_read_b64_tr_b16 v[64:65], v186 offset:16800
    v_mfma_f32_32x32x16_bf16 v[130:145], v[78:81], v[74:77], v[130:145]
    s_waitcnt lgkmcnt(6)
    ds_read_b128 v[66:69], v184 offset:8544
    ds_read_b64_tr_b16 v[70:71], v186 offset:17280
    ds_read_b64_tr_b16 v[72:73], v186 offset:17440
    v_mfma_f32_32x32x16_bf16 v[130:145], v[86:89], v[82:85], v[130:145]
    s_waitcnt vmcnt(9) lgkmcnt(6)
    s_barrier
    ds_read_b128 v[74:77], v184 offset:16896
    ds_read_b64_tr_b16 v[78:79], v186 offset:17920
    ds_read_b64_tr_b16 v[80:81], v186 offset:18080
    v_mfma_f32_32x32x16_bf16 v[130:145], v[54:57], v[50:53], v[130:145]
    s_waitcnt lgkmcnt(6)
    ds_read_b128 v[82:85], v184 offset:16928
    ds_read_b64_tr_b16 v[86:87], v186 offset:18560
    ds_read_b64_tr_b16 v[88:89], v186 offset:18720
    v_mfma_f32_32x32x16_bf16 v[130:145], v[62:65], v[58:61], v[130:145]
    s_waitcnt lgkmcnt(6)
    ds_read_b128 v[50:53], v184 offset:16960
    ds_read_b64_tr_b16 v[54:55], v186 offset:19200
    ds_read_b64_tr_b16 v[56:57], v186 offset:19360
    v_mfma_f32_32x32x16_bf16 v[130:145], v[70:73], v[66:69], v[130:145]
    s_waitcnt lgkmcnt(6)
    ds_read_b128 v[58:61], v184 offset:16992
    ds_read_b64_tr_b16 v[62:63], v186 offset:19840
    ds_read_b64_tr_b16 v[64:65], v186 offset:20000
    v_mfma_f32_32x32x16_bf16 v[130:145], v[78:81], v[74:77], v[130:145]
    s_waitcnt vmcnt(5) lgkmcnt(6)
    s_barrier
    ds_read_b128 v[66:69], v184 offset:25344
    ds_read_b64_tr_b16 v[70:71], v186 offset:20480
    ds_read_b64_tr_b16 v[72:73], v186 offset:20640
    v_mfma_f32_32x32x16_bf16 v[130:145], v[86:89], v[82:85], v[130:145]
    s_waitcnt lgkmcnt(6)
    ds_read_b128 v[74:77], v184 offset:25376
    ds_read_b64_tr_b16 v[78:79], v186 offset:21120
    ds_read_b64_tr_b16 v[80:81], v186 offset:21280
    v_mfma_f32_32x32x16_bf16 v[130:145], v[54:57], v[50:53], v[130:145]
    s_waitcnt lgkmcnt(6)
    ds_read_b128 v[82:85], v184 offset:25408
    ds_read_b64_tr_b16 v[86:87], v186 offset:21760
    ds_read_b64_tr_b16 v[88:89], v186 offset:21920
    v_mfma_f32_32x32x16_bf16 v[130:145], v[62:65], v[58:61], v[130:145]
    s_waitcnt lgkmcnt(6)
    ds_read_b128 v[50:53], v184 offset:25440
    ds_read_b64_tr_b16 v[54:55], v186 offset:22400
    ds_read_b64_tr_b16 v[56:57], v186 offset:22560
    v_mfma_f32_32x32x16_bf16 v[130:145], v[70:73], v[66:69], v[130:145]
    s_waitcnt vmcnt(2) lgkmcnt(6)
    s_barrier
    ds_read_b128 v[58:61], v184 offset:33792
    ds_read_b64_tr_b16 v[62:63], v186 offset:23040
    ds_read_b64_tr_b16 v[64:65], v186 offset:23200
    v_mfma_f32_32x32x16_bf16 v[130:145], v[78:81], v[74:77], v[130:145]
    s_waitcnt lgkmcnt(6)
    ds_read_b128 v[66:69], v184 offset:33824
    ds_read_b64_tr_b16 v[70:71], v186 offset:23680
    ds_read_b64_tr_b16 v[72:73], v186 offset:23840
    v_mfma_f32_32x32x16_bf16 v[130:145], v[86:89], v[82:85], v[130:145]
    s_waitcnt lgkmcnt(6)
    ds_read_b128 v[74:77], v184 offset:33856
    ds_read_b64_tr_b16 v[78:79], v186 offset:24320
    ds_read_b64_tr_b16 v[80:81], v186 offset:24480
    v_mfma_f32_32x32x16_bf16 v[130:145], v[54:57], v[50:53], v[130:145]
    s_waitcnt lgkmcnt(6)
    ds_read_b128 v[82:85], v184 offset:33888
    ds_read_b64_tr_b16 v[86:87], v186 offset:24960
    ds_read_b64_tr_b16 v[88:89], v186 offset:25120
    v_mfma_f32_32x32x16_bf16 v[130:145], v[62:65], v[58:61], v[130:145]
    s_waitcnt lgkmcnt(6)
    v_mfma_f32_32x32x16_bf16 v[130:145], v[70:73], v[66:69], v[130:145]
    s_waitcnt lgkmcnt(3)
    v_mfma_f32_32x32x16_bf16 v[130:145], v[78:81], v[74:77], v[130:145]
    s_waitcnt lgkmcnt(0)
    v_mfma_f32_32x32x16_bf16 v[130:145], v[86:89], v[82:85], v[130:145]
    s_nop 11
    v_pk_mul_f32 v[130:131], v[130:131], v[4:5] op_sel_hi:[1,0]
    v_cvt_pk_bf16_f32 v6, v130, v131
    v_pk_mul_f32 v[132:133], v[132:133], v[4:5] op_sel_hi:[1,0]
    v_cvt_pk_bf16_f32 v7, v132, v133
    v_pk_mul_f32 v[134:135], v[134:135], v[4:5] op_sel_hi:[1,0]
    v_cvt_pk_bf16_f32 v8, v134, v135
    v_pk_mul_f32 v[136:137], v[136:137], v[4:5] op_sel_hi:[1,0]
    v_cvt_pk_bf16_f32 v9, v136, v137
    v_pk_mul_f32 v[138:139], v[138:139], v[4:5] op_sel_hi:[1,0]
    v_cvt_pk_bf16_f32 v10, v138, v139
    v_pk_mul_f32 v[140:141], v[140:141], v[4:5] op_sel_hi:[1,0]
    v_cvt_pk_bf16_f32 v11, v140, v141
    v_cndmask_b32 v10, v10, v16, s[22:23]
    v_cndmask_b32 v11, v11, v17, s[22:23]
    buffer_store_dwordx4 v[6:9], v110, s[64:67], s100 offen sc1
    buffer_store_dwordx2 v[10:11], v15, s[64:67], s101 offen offset:2048 sc1
    v_pk_mul_f32 v[2:3], v[130:131], v[130:131]
    v_pk_fma_f32 v[2:3], v[132:133], v[132:133], v[2:3]
    v_pk_fma_f32 v[2:3], v[134:135], v[134:135], v[2:3]
    v_pk_fma_f32 v[2:3], v[136:137], v[136:137], v[2:3]
    v_pk_fma_f32 v[2:3], v[138:139], v[138:139], v[2:3]
    v_pk_fma_f32 v[2:3], v[140:141], v[140:141], v[2:3]
    v_add_f32 v4, v2, v3
    v_add_f32 v2, v2, v3
    s_nop 1
    v_permlane32_swap_b32 v2, v4
    v_add_f32 v4, v4, v2
    s_nop 1
    v_max_f32_dpp v4, v4, v4 row_ror:1 row_mask:0xf bank_mask:0xf
    s_nop 1
    v_max_f32_dpp v4, v4, v4 row_ror:2 row_mask:0xf bank_mask:0xf
    s_nop 1
    v_max_f32_dpp v4, v4, v4 row_ror:4 row_mask:0xf bank_mask:0xf
    s_nop 1
    v_max_f32_dpp v4, v4, v4 row_ror:8 row_mask:0xf bank_mask:0xf
    v_mov_b32 v5, v4
    s_nop 1
    v_permlane16_swap_b32 v4, v5
    v_max_f32 v4, v4, v5
    v_mul_f32 v4, 0x3f83d70a, v4
    v_or_b32 v14, 1, v4
    s_branch L_kvj_16
.p2align 12
L_v_15:
    s_mul_i32 s99, s87, 6144
    s_mul_i32 s100, s85, 1536
    s_add_u32 s99, s99, s100
    s_add_u32 s99, s99, 265216
    v_and_b32 v2, 31, v1
    v_lshrrev_b32 v3, 5, v1
    v_mul_u32_u24 v3, 384, v3
    v_lshl_add_u32 v3, v2, 4, v3
    v_mov_b32 v4, 2130706432
    v_cmp_lt_u32 vcc, 23, v2
    s_nop 1
    v_cndmask_b32 v3, v3, v4, vcc
    v_mov_b32 v16, 0x3f803f80
    v_cmp_eq_u32 vcc, 20, v2
    s_waitcnt vmcnt(9)
    s_barrier
    ds_read_b128 v[50:53], v190 offset:0
    ds_read_b64_tr_b16 v[54:55], v186 offset:0
    ds_read_b64_tr_b16 v[56:57], v186 offset:160
    ds_read_b128 v[58:61], v190 offset:32
    ds_read_b64_tr_b16 v[62:63], v186 offset:640
    ds_read_b64_tr_b16 v[64:65], v186 offset:800
    ds_read_b128 v[66:69], v190 offset:64
    ds_read_b64_tr_b16 v[70:71], v186 offset:1280
    ds_read_b64_tr_b16 v[72:73], v186 offset:1440
    ds_read_b128 v[74:77], v190 offset:96
    ds_read_b64_tr_b16 v[78:79], v186 offset:1920
    ds_read_b64_tr_b16 v[80:81], v186 offset:2080
    s_add_u32 m0, s98, 113152
    s_nop 0
    buffer_load_dwordx4 v110, s[48:51], s96 offen offset:2048 sc0 lds
    s_add_u32 m0, s98, 117248
    s_add_u32 s96, s97, 12288
    buffer_load_dwordx4 v110, s[48:51], s96 offen offset:0 sc0 lds
    s_add_u32 m0, s20, 33280
    s_nop 0
    buffer_load_dwordx4 v112, s[40:43], s91 offen offset:512 sc0 lds
    buffer_load_dwordx4 v113, s[40:43], s91 offen offset:1568 sc0 lds
    s_waitcnt lgkmcnt(9)
    v_mfma_f32_32x32x16_bf16 v[130:145], v[50:53], v[54:57], 0
    s_waitcnt vmcnt(10) lgkmcnt(6)
    s_barrier
    s_add_u32 m0, s98, 117248
    ds_read_b128 v[82:85], v190 offset:8448
    ds_read_b64_tr_b16 v[86:87], v186 offset:2560
    ds_read_b64_tr_b16 v[88:89], v186 offset:2720
    buffer_load_dwordx4 v110, s[48:51], s96 offen offset:2048 sc0 lds
    v_mfma_f32_32x32x16_bf16 v[130:145], v[58:61], v[62:65], v[130:145]
    s_waitcnt lgkmcnt(6)
    s_add_u32 m0, s20, 41600
    ds_read_b128 v[50:53], v190 offset:8480
    ds_read_b64_tr_b16 v[54:55], v186 offset:3200
    ds_read_b64_tr_b16 v[56:57], v186 offset:3360
    v_mfma_f32_32x32x16_bf16 v[130:145], v[66:69], v[70:73], v[130:145]
    s_waitcnt lgkmcnt(6)
    ds_read_b128 v[58:61], v190 offset:8512
    ds_read_b64_tr_b16 v[62:63], v186 offset:3840
    ds_read_b64_tr_b16 v[64:65], v186 offset:4000
    buffer_load_dwordx4 v112, s[40:43], s91 offen offset:640 sc0 lds
    v_mfma_f32_32x32x16_bf16 v[130:145], v[74:77], v[78:81], v[130:145]
    s_waitcnt lgkmcnt(6)
    ds_read_b128 v[66:69], v190 offset:8544
    ds_read_b64_tr_b16 v[70:71], v186 offset:4480
    ds_read_b64_tr_b16 v[72:73], v186 offset:4640
    buffer_load_dwordx4 v113, s[40:43], s91 offen offset:1696 sc0 lds
    v_mfma_f32_32x32x16_bf16 v[130:145], v[82:85], v[86:89], v[130:145]
    s_waitcnt vmcnt(10) lgkmcnt(6)
    s_barrier
    s_add_u32 m0, s98, 121344
    ds_read_b128 v[74:77], v190 offset:16896
    ds_read_b64_tr_b16 v[78:79], v186 offset:5120
    ds_read_b64_tr_b16 v[80:81], v186 offset:5280
    s_add_u32 s96, s97, 16384
    v_mfma_f32_32x32x16_bf16 v[130:145], v[50:53], v[54:57], v[130:145]
    s_waitcnt lgkmcnt(6)
    ds_read_b128 v[82:85], v190 offset:16928
    ds_read_b64_tr_b16 v[86:87], v186 offset:5760
    ds_read_b64_tr_b16 v[88:89], v186 offset:5920
    buffer_load_dwordx4 v110, s[48:51], s96 offen offset:0 sc0 lds
    s_add_u32 m0, s20, 49920
    v_mfma_f32_32x32x16_bf16 v[130:145], v[58:61], v[62:65], v[130:145]
    s_waitcnt lgkmcnt(6)
    ds_read_b128 v[50:53], v190 offset:16960
    ds_read_b64_tr_b16 v[54:55], v186 offset:6400
    ds_read_b64_tr_b16 v[56:57], v186 offset:6560
    buffer_load_dwordx4 v112, s[40:43], s91 offen offset:768 sc0 lds
    v_mfma_f32_32x32x16_bf16 v[130:145], v[66:69], v[70:73], v[130:145]
    s_waitcnt lgkmcnt(6)
    ds_read_b128 v[58:61], v190 offset:16992
    ds_read_b64_tr_b16 v[62:63], v186 offset:7040
    ds_read_b64_tr_b16 v[64:65], v186 offset:7200
    buffer_load_dwordx4 v113, s[40:43], s91 offen offset:1824 sc0 lds
    v_mfma_f32_32x32x16_bf16 v[130:145], v[74:77], v[78:81], v[130:145]
    s_waitcnt vmcnt(10) lgkmcnt(6)
    s_barrier
    s_add_u32 m0, s98, 121344
    ds_read_b128 v[66:69], v190 offset:25344
    ds_read_b64_tr_b16 v[70:71], v186 offset:7680
    ds_read_b64_tr_b16 v[72:73], v186 offset:7840
    buffer_load_dwordx4 v110, s[48:51], s96 offen offset:2048 sc0 lds
    v_mfma_f32_32x32x16_bf16 v[130:145], v[82:85], v[86:89], v[130:145]
    s_waitcnt lgkmcnt(6)
    s_add_u32 m0, s20, 58240
    ds_read_b128 v[74:77], v190 offset:25376
    ds_read_b64_tr_b16 v[78:79], v186 offset:8320
    ds_read_b64_tr_b16 v[80:81], v186 offset:8480
    v_mfma_f32_32x32x16_bf16 v[130:145], v[50:53], v[54:57], v[130:145]
    s_waitcnt lgkmcnt(6)
    ds_read_b128 v[82:85], v190 offset:25408
    ds_read_b64_tr_b16 v[86:87], v186 offset:8960
    ds_read_b64_tr_b16 v[88:89], v186 offset:9120
    buffer_load_dwordx4 v112, s[40:43], s91 offen offset:896 sc0 lds
    v_mfma_f32_32x32x16_bf16 v[130:145], v[58:61], v[62:65], v[130:145]
    s_waitcnt lgkmcnt(6)
    ds_read_b128 v[50:53], v190 offset:25440
    ds_read_b64_tr_b16 v[54:55], v186 offset:9600
    ds_read_b64_tr_b16 v[56:57], v186 offset:9760
    buffer_load_dwordx4 v113, s[40:43], s91 offen offset:1952 sc0 lds
    v_mfma_f32_32x32x16_bf16 v[130:145], v[66:69], v[70:73], v[130:145]
    s_waitcnt vmcnt(9) lgkmcnt(6)
    s_barrier
    s_add_u32 m0, s98, 125440
    ds_read_b128 v[58:61], v190 offset:33792
    ds_read_b64_tr_b16 v[62:63], v186 offset:10240
    ds_read_b64_tr_b16 v[64:65], v186 offset:10400
    s_add_u32 s96, s97, 20480
    v_mfma_f32_32x32x16_bf16 v[130:145], v[74:77], v[78:81], v[130:145]
    s_waitcnt lgkmcnt(6)
    ds_read_b128 v[66:69], v190 offset:33824
    ds_read_b64_tr_b16 v[70:71], v186 offset:10880
    ds_read_b64_tr_b16 v[72:73], v186 offset:11040
    buffer_load_dwordx4 v110, s[48:51], s96 offen offset:0 sc0 lds
    s_add_u32 m0, s98, 125440
    v_mfma_f32_32x32x16_bf16 v[130:145], v[82:85], v[86:89], v[130:145]
    s_waitcnt lgkmcnt(6)
    ds_read_b128 v[74:77], v190 offset:33856
    ds_read_b64_tr_b16 v[78:79], v186 offset:11520
    ds_read_b64_tr_b16 v[80:81], v186 offset:11680
    buffer_load_dwordx4 v110, s[48:51], s96 offen offset:2048 sc0 lds
    s_add_u32 m0, s20, 66560
    v_mfma_f32_32x32x16_bf16 v[130:145], v[50:53], v[54:57], v[130:145]
    s_waitcnt lgkmcnt(6)
    ds_read_b128 v[82:85], v190 offset:33888
    ds_read_b64_tr_b16 v[86:87], v186 offset:12160
    ds_read_b64_tr_b16 v[88:89], v186 offset:12320
    buffer_load_dwordx4 v112, s[40:43], s91 offen offset:1024 sc0 lds
    buffer_load_dwordx4 v113, s[40:43], s91 offen offset:2080 sc0 lds
    v_mfma_f32_32x32x16_bf16 v[130:145], v[58:61], v[62:65], v[130:145]
    s_waitcnt vmcnt(10) lgkmcnt(6)
    s_barrier
    s_add_u32 m0, s98, 129536
    ds_read_b128 v[50:53], v191 offset:0
    ds_read_b64_tr_b16 v[54:55], v186 offset:12800
    ds_read_b64_tr_b16 v[56:57], v186 offset:12960
    s_add_u32 s96, s97, 24576
    v_mfma_f32_32x32x16_bf16 v[130:145], v[66:69], v[70:73], v[130:145]
    s_waitcnt lgkmcnt(6)
    ds_read_b128 v[58:61], v191 offset:32
    ds_read_b64_tr_b16 v[62:63], v186 offset:13440
    ds_read_b64_tr_b16 v[64:65], v186 offset:13600
    buffer_load_dwordx4 v110, s[48:51], s96 offen offset:0 sc0 lds
    s_add_u32 m0, s20, 74880
    v_mfma_f32_32x32x16_bf16 v[130:145], v[74:77], v[78:81], v[130:145]
    s_waitcnt lgkmcnt(6)
    ds_read_b128 v[66:69], v191 offset:64
    ds_read_b64_tr_b16 v[70:71], v186 offset:14080
    ds_read_b64_tr_b16 v[72:73], v186 offset:14240
    buffer_load_dwordx4 v112, s[40:43], s91 offen offset:1152 sc0 lds
    v_mfma_f32_32x32x16_bf16 v[130:145], v[82:85], v[86:89], v[130:145]
    s_waitcnt lgkmcnt(6)
    ds_read_b128 v[74:77], v191 offset:96
    ds_read_b64_tr_b16 v[78:79], v186 offset:14720
    ds_read_b64_tr_b16 v[80:81], v186 offset:14880
    buffer_load_dwordx4 v113, s[40:43], s91 offen offset:2208 sc0 lds
    v_mfma_f32_32x32x16_bf16 v[130:145], v[50:53], v[54:57], v[130:145]
    s_waitcnt vmcnt(10) lgkmcnt(6)
    s_barrier
    ds_read_b128 v[82:85], v191 offset:8448
    ds_read_b64_tr_b16 v[86:87], v186 offset:15360
    ds_read_b64_tr_b16 v[88:89], v186 offset:15520
    buffer_store_dwordx4 v[248:251], v110, s[64:67], s90 offen offset:0 sc1
    v_mfma_f32_32x32x16_bf16 v[130:145], v[58:61], v[62:65], v[130:145]
    s_waitcnt lgkmcnt(6)
    ds_read_b128 v[50:53], v191 offset:8480
    ds_read_b64_tr_b16 v[54:55], v186 offset:16000
    ds_read_b64_tr_b16 v[56:57], v186 offset:16160
    buffer_store_dwordx4 v[248:251], v110, s[64:67], s90 offen offset:1024 sc1
    v_mfma_f32_32x32x16_bf16 v[130:145], v[66:69], v[70:73], v[130:145]
    s_waitcnt lgkmcnt(6)
    ds_read_b128 v[58:61], v191 offset:8512
    ds_read_b64_tr_b16 v[62:63], v186 offset:16640
    ds_read_b64_tr_b16 v[64:65], v186 offset:16800
    v_mfma_f32_32x32x16_bf16 v[130:145], v[74:77], v[78:81], v[130:145]
    s_waitcnt lgkmcnt(6)
    ds_read_b128 v[66:69], v191 offset:8544
    ds_read_b64_tr_b16 v[70:71], v186 offset:17280
    ds_read_b64_tr_b16 v[72:73], v186 offset:17440
    v_mfma_f32_32x32x16_bf16 v[130:145], v[82:85], v[86:89], v[130:145]
    s_waitcnt vmcnt(9) lgkmcnt(6)
    s_barrier
    ds_read_b128 v[74:77], v191 offset:16896
    ds_read_b64_tr_b16 v[78:79], v186 offset:17920
    ds_read_b64_tr_b16 v[80:81], v186 offset:18080
    v_mfma_f32_32x32x16_bf16 v[130:145], v[50:53], v[54:57], v[130:145]
    s_waitcnt lgkmcnt(6)
    ds_read_b128 v[82:85], v191 offset:16928
    ds_read_b64_tr_b16 v[86:87], v186 offset:18560
    ds_read_b64_tr_b16 v[88:89], v186 offset:18720
    v_mfma_f32_32x32x16_bf16 v[130:145], v[58:61], v[62:65], v[130:145]
    s_waitcnt lgkmcnt(6)
    ds_read_b128 v[50:53], v191 offset:16960
    ds_read_b64_tr_b16 v[54:55], v186 offset:19200
    ds_read_b64_tr_b16 v[56:57], v186 offset:19360
    v_mfma_f32_32x32x16_bf16 v[130:145], v[66:69], v[70:73], v[130:145]
    s_waitcnt lgkmcnt(6)
    ds_read_b128 v[58:61], v191 offset:16992
    ds_read_b64_tr_b16 v[62:63], v186 offset:19840
    ds_read_b64_tr_b16 v[64:65], v186 offset:20000
    v_mfma_f32_32x32x16_bf16 v[130:145], v[74:77], v[78:81], v[130:145]
    s_waitcnt vmcnt(5) lgkmcnt(6)
    s_barrier
    ds_read_b128 v[66:69], v191 offset:25344
    ds_read_b64_tr_b16 v[70:71], v186 offset:20480
    ds_read_b64_tr_b16 v[72:73], v186 offset:20640
    v_mfma_f32_32x32x16_bf16 v[130:145], v[82:85], v[86:89], v[130:145]
    s_waitcnt lgkmcnt(6)
    ds_read_b128 v[74:77], v191 offset:25376
    ds_read_b64_tr_b16 v[78:79], v186 offset:21120
    ds_read_b64_tr_b16 v[80:81], v186 offset:21280
    v_mfma_f32_32x32x16_bf16 v[130:145], v[50:53], v[54:57], v[130:145]
    s_waitcnt lgkmcnt(6)
    ds_read_b128 v[82:85], v191 offset:25408
    ds_read_b64_tr_b16 v[86:87], v186 offset:21760
    ds_read_b64_tr_b16 v[88:89], v186 offset:21920
    v_mfma_f32_32x32x16_bf16 v[130:145], v[58:61], v[62:65], v[130:145]
    s_waitcnt lgkmcnt(6)
    ds_read_b128 v[50:53], v191 offset:25440
    ds_read_b64_tr_b16 v[54:55], v186 offset:22400
    ds_read_b64_tr_b16 v[56:57], v186 offset:22560
    v_mfma_f32_32x32x16_bf16 v[130:145], v[66:69], v[70:73], v[130:145]
    s_waitcnt vmcnt(2) lgkmcnt(6)
    s_barrier
    ds_read_b128 v[58:61], v191 offset:33792
    ds_read_b64_tr_b16 v[62:63], v186 offset:23040
    ds_read_b64_tr_b16 v[64:65], v186 offset:23200
    v_mfma_f32_32x32x16_bf16 v[130:145], v[74:77], v[78:81], v[130:145]
    s_waitcnt lgkmcnt(6)
    ds_read_b128 v[66:69], v191 offset:33824
    ds_read_b64_tr_b16 v[70:71], v186 offset:23680
    ds_read_b64_tr_b16 v[72:73], v186 offset:23840
    v_mfma_f32_32x32x16_bf16 v[130:145], v[82:85], v[86:89], v[130:145]
    s_waitcnt lgkmcnt(6)
    ds_read_b128 v[74:77], v191 offset:33856
    ds_read_b64_tr_b16 v[78:79], v186 offset:24320
    ds_read_b64_tr_b16 v[80:81], v186 offset:24480
    v_mfma_f32_32x32x16_bf16 v[130:145], v[50:53], v[54:57], v[130:145]
    s_waitcnt lgkmcnt(6)
    ds_read_b128 v[82:85], v191 offset:33888
    ds_read_b64_tr_b16 v[86:87], v186 offset:24960
    ds_read_b64_tr_b16 v[88:89], v186 offset:25120
    v_mfma_f32_32x32x16_bf16 v[130:145], v[58:61], v[62:65], v[130:145]
    s_waitcnt lgkmcnt(6)
    v_mfma_f32_32x32x16_bf16 v[130:145], v[66:69], v[70:73], v[130:145]
    s_waitcnt lgkmcnt(3)
    v_mfma_f32_32x32x16_bf16 v[130:145], v[74:77], v[78:81], v[130:145]
    s_waitcnt lgkmcnt(0)
    v_mfma_f32_32x32x16_bf16 v[130:145], v[82:85], v[86:89], v[130:145]
    s_nop 11
    v_cvt_pk_bf16_f32 v6, v130, v131
    v_cndmask_b32 v6, v6, v16, vcc
    v_cvt_pk_bf16_f32 v7, v132, v133
    v_cndmask_b32 v7, v7, v16, vcc
    v_cvt_pk_bf16_f32 v8, v134, v135
    v_cndmask_b32 v8, v8, v16, vcc
    v_cvt_pk_bf16_f32 v9, v136, v137
    v_cndmask_b32 v9, v9, v16, vcc
    v_cvt_pk_bf16_f32 v10, v138, v139
    v_cndmask_b32 v10, v10, v16, vcc
    v_cvt_pk_bf16_f32 v11, v140, v141
    v_cndmask_b32 v11, v11, v16, vcc
    v_cvt_pk_bf16_f32 v12, v142, v143
    v_cndmask_b32 v12, v12, v16, vcc
    v_cvt_pk_bf16_f32 v13, v144, v145
    v_cndmask_b32 v13, v13, v16, vcc
    buffer_store_dwordx4 v[6:9], v3, s[64:67], s99 offen sc1
    buffer_store_dwordx4 v[10:13], v3, s[64:67], s99 offen offset:768 sc1
    v_mov_b32 v14, 1
L_kvj_16:
    buffer_load_dword v255, v192, s[68:71], s39 offen sc1
    s_lshl_b32 s99, s84, 2
    s_add_u32 s99, s99, 158208
    v_mov_b32 v15, s99
    ds_write_b32 v15, v14
    v_mov_b32 v15, 158208
    s_lshl_b32 s99, s87, 7
    s_add_u32 s99, s99, 458752
    s_cmp_eq_u32 s84, 0
    s_cselect_b32 s99, s99, 2130706432
    s_waitcnt lgkmcnt(0)
    s_barrier
    ds_read_b64 v[10:11], v15
    s_add_u32 m0, s21, 84480
    s_nop 0
    buffer_load_dwordx4 v178, s[44:47], s95 offen offset:0 sc0 lds
    buffer_load_dwordx4 v179, s[44:47], s95 offen offset:1024 sc0 lds
    buffer_load_dwordx4 v180, s[44:47], s95 offen offset:2048 sc0 lds
    s_add_u32 m0, s39, 96768
    s_nop 0
    buffer_load_dwordx4 v181, s[44:47], s95 offen offset:0 sc0 lds
    buffer_load_dwordx4 v182, s[44:47], s95 offen offset:1024 sc0 lds
    s_waitcnt lgkmcnt(0)
    v_max_u32 v14, v10, v11
    s_waitcnt vmcnt(5)
    v_cmp_eq_u32 vcc, s84, v255
    s_nop 3
    s_cbranch_vccnz L_retry_17
L_ok_18:
    s_barrier
    buffer_store_dword v14, v254, s[64:67], s99 offen sc1
    s_and_b32 s100, s87, 3
    s_lshl_b32 s100, s100, 2
    s_add_u32 s100, s100, s84
    s_mul_i32 s100, s100, 1280
    s_add_u32 s100, s100, 163840
    v_mul_u32_u24 v2, 20480, v1
    buffer_load_dword v252, v2, s[44:47], s100 offen
    s_add_u32 s93, s93, 1
    s_cmp_eq_u32 s93, 5
    s_cselect_b32 s93, 0, s93
    s_lshl_b32 s94, s93, 8
    s_add_u32 s94, s94, s91
    s_mul_i32 s95, s93, 163840
    s_add_u32 s95, s95, s92
    s_add_u32 m0, s21, 104960
    s_nop 0
    buffer_load_dwordx4 v178, s[44:47], s95 offen offset:0 sc0 lds
    buffer_load_dwordx4 v179, s[44:47], s95 offen offset:1024 sc0 lds
    buffer_load_dwordx4 v180, s[44:47], s95 offen offset:2048 sc0 lds
    s_add_u32 m0, s39, 117248
    s_nop 0
    buffer_load_dwordx4 v181, s[44:47], s95 offen offset:0 sc0 lds
    buffer_load_dwordx4 v182, s[44:47], s95 offen offset:1024 sc0 lds
    v_mov_b64 v[66:67], 0
    v_mov_b64 v[68:69], 0
    v_mov_b64 v[70:71], 0
    v_mov_b64 v[72:73], 0
    v_mov_b64 v[74:75], 0
    v_mov_b64 v[76:77], 0
    v_mov_b64 v[78:79], 0
    v_mov_b64 v[80:81], 0
    v_mov_b64 v[82:83], 0
    v_mov_b64 v[84:85], 0
    v_mov_b64 v[86:87], 0
    v_mov_b64 v[88:89], 0
    v_mov_b64 v[90:91], 0
    v_mov_b64 v[92:93], 0
    v_mov_b64 v[94:95], 0
    v_mov_b64 v[96:97], 0
    v_mov_b32 v253, 0xdddddddd
    s_waitcnt vmcnt(9)
    s_barrier
    ds_read_b128 v[130:133], v183 offset:0
    ds_read_b64_tr_b16 v[134:135], v185 offset:0
    ds_read_b64_tr_b16 v[136:137], v185 offset:160
    ds_read_b64_tr_b16 v[138:139], v185 offset:40
    ds_read_b64_tr_b16 v[140:141], v185 offset:200
    ds_read_b128 v[142:145], v183 offset:32
    ds_read_b64_tr_b16 v[146:147], v185 offset:2560
    ds_read_b64_tr_b16 v[148:149], v185 offset:2720
    ds_read_b64_tr_b16 v[150:151], v185 offset:2600
    ds_read_b64_tr_b16 v[152:153], v185 offset:2760
    s_waitcnt lgkmcnt(7)
    v_mfma_f32_32x32x16_bf16 v[18:33], v[134:137], v[130:133], 0
    s_waitcnt lgkmcnt(5)
    ds_read_b128 v[154:157], v183 offset:64
    ds_read_b64_tr_b16 v[158:159], v185 offset:5120
    ds_read_b64_tr_b16 v[160:161], v185 offset:5280
    v_mfma_f32_32x32x16_bf16 v[34:49], v[138:141], v[130:133], 0
    s_waitcnt lgkmcnt(5)
    ds_read_b64_tr_b16 v[162:163], v185 offset:5160
    ds_read_b64_tr_b16 v[164:165], v185 offset:5320
    v_mfma_f32_32x32x16_bf16 v[18:33], v[146:149], v[142:145], v[18:33]
    s_waitcnt lgkmcnt(5)
    ds_read_b128 v[130:133], v183 offset:96
    ds_read_b64_tr_b16 v[134:135], v185 offset:7680
    ds_read_b64_tr_b16 v[136:137], v185 offset:7840
    v_mfma_f32_32x32x16_bf16 v[34:49], v[150:153], v[142:145], v[34:49]
    s_waitcnt lgkmcnt(5)
    ds_read_b64_tr_b16 v[138:139], v185 offset:7720
    ds_read_b64_tr_b16 v[140:141], v185 offset:7880
    v_mfma_f32_32x32x16_bf16 v[18:33], v[158:161], v[154:157], v[18:33]
    s_waitcnt vmcnt(7) lgkmcnt(5)
    s_barrier
    s_add_u32 s93, s93, 1
    ds_read_b128 v[142:145], v183 offset:8448
    ds_read_b64_tr_b16 v[146:147], v185 offset:10240
    ds_read_b64_tr_b16 v[148:149], v185 offset:10400
    s_cmp_eq_u32 s93, 5
    v_mfma_f32_32x32x16_bf16 v[34:49], v[162:165], v[154:157], v[34:49]
    s_waitcnt lgkmcnt(5)
    s_cselect_b32 s93, 0, s93
    ds_read_b64_tr_b16 v[150:151], v185 offset:10280
    ds_read_b64_tr_b16 v[152:153], v185 offset:10440
    v_mfma_f32_32x32x16_bf16 v[18:33], v[134:137], v[130:133], v[18:33]
    s_waitcnt lgkmcnt(5)
    s_lshl_b32 s94, s93, 8
    ds_read_b128 v[154:157], v183 offset:8480
    ds_read_b64_tr_b16 v[158:159], v185 offset:12800
    ds_read_b64_tr_b16 v[160:161], v185 offset:12960
    s_add_u32 s94, s94, s91
    v_mfma_f32_32x32x16_bf16 v[34:49], v[138:141], v[130:133], v[34:49]
    s_waitcnt lgkmcnt(5)
    s_mul_i32 s95, s93, 163840
    ds_read_b64_tr_b16 v[162:163], v185 offset:12840
    ds_read_b64_tr_b16 v[164:165], v185 offset:13000
    v_mfma_f32_32x32x16_bf16 v[18:33], v[146:149], v[142:145], v[18:33]
    s_waitcnt lgkmcnt(5)
    s_add_u32 s95, s95, s92
    ds_read_b128 v[130:133], v183 offset:8512
    ds_read_b64_tr_b16 v[134:135], v185 offset:15360
    ds_read_b64_tr_b16 v[136:137], v185 offset:15520
    s_add_u32 m0, s21, 125440
    v_mfma_f32_32x32x16_bf16 v[34:49], v[150:153], v[142:145], v[34:49]
    s_waitcnt lgkmcnt(5)
    ds_read_b64_tr_b16 v[138:139], v185 offset:15400
    ds_read_b64_tr_b16 v[140:141], v185 offset:15560
    buffer_load_dwordx4 v178, s[44:47], s95 offen offset:0 sc0 lds
    v_mfma_f32_32x32x16_bf16 v[18:33], v[158:161], v[154:157], v[18:33]
    s_waitcnt lgkmcnt(5)
    ds_read_b128 v[142:145], v183 offset:8544
    ds_read_b64_tr_b16 v[146:147], v185 offset:17920
    ds_read_b64_tr_b16 v[148:149], v185 offset:18080
    buffer_load_dwordx4 v179, s[44:47], s95 offen offset:1024 sc0 lds
    v_mfma_f32_32x32x16_bf16 v[34:49], v[162:165], v[154:157], v[34:49]
    s_waitcnt lgkmcnt(5)
    ds_read_b64_tr_b16 v[150:151], v185 offset:17960
    ds_read_b64_tr_b16 v[152:153], v185 offset:18120
    buffer_load_dwordx4 v180, s[44:47], s95 offen offset:2048 sc0 lds
    v_mfma_f32_32x32x16_bf16 v[18:33], v[134:137], v[130:133], v[18:33]
    s_waitcnt vmcnt(5) lgkmcnt(5)
    s_barrier
    s_add_u32 m0, s39, 137728
    ds_read_b128 v[154:157], v183 offset:16896
    ds_read_b64_tr_b16 v[158:159], v185 offset:20480
    ds_read_b64_tr_b16 v[160:161], v185 offset:20640
    v_mfma_f32_32x32x16_bf16 v[34:49], v[138:141], v[130:133], v[34:49]
    s_waitcnt lgkmcnt(5)
    ds_read_b64_tr_b16 v[162:163], v185 offset:20520
    ds_read_b64_tr_b16 v[164:165], v185 offset:20680
    v_mfma_f32_32x32x16_bf16 v[18:33], v[146:149], v[142:145], v[18:33]
    s_waitcnt lgkmcnt(5)
    ds_read_b128 v[130:133], v183 offset:16928
    ds_read_b64_tr_b16 v[134:135], v185 offset:23040
    ds_read_b64_tr_b16 v[136:137], v185 offset:23200
    buffer_load_dwordx4 v181, s[44:47], s95 offen offset:0 sc0 lds
    v_mfma_f32_32x32x16_bf16 v[34:49], v[150:153], v[142:145], v[34:49]
    s_waitcnt lgkmcnt(5)
    ds_read_b64_tr_b16 v[138:139], v185 offset:23080
    ds_read_b64_tr_b16 v[140:141], v185 offset:23240
    v_mfma_f32_32x32x16_bf16 v[18:33], v[158:161], v[154:157], v[18:33]
    s_waitcnt lgkmcnt(5)
    ds_read_b128 v[142:145], v183 offset:16960
    ds_read_b64_tr_b16 v[146:147], v185 offset:25600
    ds_read_b64_tr_b16 v[148:149], v185 offset:25760
    buffer_load_dwordx4 v182, s[44:47], s95 offen offset:1024 sc0 lds
    v_mfma_f32_32x32x16_bf16 v[34:49], v[162:165], v[154:157], v[34:49]
    s_waitcnt lgkmcnt(5)
    ds_read_b64_tr_b16 v[150:151], v185 offset:25640
    ds_read_b64_tr_b16 v[152:153], v185 offset:25800
    v_mfma_f32_32x32x16_bf16 v[18:33], v[134:137], v[130:133], v[18:33]
    s_waitcnt lgkmcnt(5)
    ds_read_b128 v[154:157], v183 offset:16992
    ds_read_b64_tr_b16 v[158:159], v185 offset:28160
    ds_read_b64_tr_b16 v[160:161], v185 offset:28320
    v_mfma_f32_32x32x16_bf16 v[34:49], v[138:141], v[130:133], v[34:49]
    s_waitcnt lgkmcnt(5)
    ds_read_b64_tr_b16 v[162:163], v185 offset:28200
    ds_read_b64_tr_b16 v[164:165], v185 offset:28360
    v_mfma_f32_32x32x16_bf16 v[18:33], v[146:149], v[142:145], v[18:33]
    s_waitcnt vmcnt(5) lgkmcnt(5)
    s_barrier
    s_add_u32 s93, s93, 1
    ds_read_b128 v[130:133], v183 offset:25344
    ds_read_b64_tr_b16 v[134:135], v185 offset:30720
    ds_read_b64_tr_b16 v[136:137], v185 offset:30880
    s_cmp_eq_u32 s93, 5
    v_mfma_f32_32x32x16_bf16 v[34:49], v[150:153], v[142:145], v[34:49]
    s_waitcnt lgkmcnt(5)
    s_cselect_b32 s93, 0, s93
    ds_read_b64_tr_b16 v[138:139], v185 offset:30760
    ds_read_b64_tr_b16 v[140:141], v185 offset:30920
    v_mfma_f32_32x32x16_bf16 v[18:33], v[158:161], v[154:157], v[18:33]
    s_waitcnt lgkmcnt(5)
    s_lshl_b32 s94, s93, 8
    ds_read_b128 v[142:145], v183 offset:25376
    ds_read_b64_tr_b16 v[146:147], v185 offset:33280
    ds_read_b64_tr_b16 v[148:149], v185 offset:33440
    s_add_u32 s94, s94, s91
    v_mfma_f32_32x32x16_bf16 v[34:49], v[162:165], v[154:157], v[34:49]
    s_waitcnt lgkmcnt(5)
    s_mul_i32 s95, s93, 163840
    ds_read_b64_tr_b16 v[150:151], v185 offset:33320
    ds_read_b64_tr_b16 v[152:153], v185 offset:33480
    v_mfma_f32_32x32x16_bf16 v[18:33], v[134:137], v[130:133], v[18:33]
    s_waitcnt lgkmcnt(5)
    s_add_u32 s95, s95, s92
    ds_read_b128 v[154:157], v183 offset:25408
    ds_read_b64_tr_b16 v[158:159], v185 offset:35840
    ds_read_b64_tr_b16 v[160:161], v185 offset:36000
    s_add_u32 m0, s21, 84480
    v_mfma_f32_32x32x16_bf16 v[34:49], v[138:141], v[130:133], v[34:49]
    s_waitcnt lgkmcnt(5)
    ds_read_b64_tr_b16 v[162:163], v185 offset:35880
    ds_read_b64_tr_b16 v[164:165], v185 offset:36040
    buffer_load_dwordx4 v178, s[44:47], s95 offen offset:0 sc0 lds
    v_mfma_f32_32x32x16_bf16 v[18:33], v[146:149], v[142:145], v[18:33]
    s_waitcnt lgkmcnt(5)
    ds_read_b128 v[130:133], v183 offset:25440
    ds_read_b64_tr_b16 v[134:135], v185 offset:38400
    ds_read_b64_tr_b16 v[136:137], v185 offset:38560
    buffer_load_dwordx4 v179, s[44:47], s95 offen offset:1024 sc0 lds
    v_mfma_f32_32x32x16_bf16 v[34:49], v[150:153], v[142:145], v[34:49]
    s_waitcnt lgkmcnt(5)
    ds_read_b64_tr_b16 v[138:139], v185 offset:38440
    ds_read_b64_tr_b16 v[140:141], v185 offset:38600
    buffer_load_dwordx4 v180, s[44:47], s95 offen offset:2048 sc0 lds
    v_mfma_f32_32x32x16_bf16 v[18:33], v[158:161], v[154:157], v[18:33]
    s_waitcnt vmcnt(5) lgkmcnt(5)
    s_barrier
    s_add_u32 m0, s39, 96768
    ds_read_b128 v[142:145], v183 offset:33792
    ds_read_b64_tr_b16 v[146:147], v185 offset:40960
    ds_read_b64_tr_b16 v[148:149], v185 offset:41120
    v_mfma_f32_32x32x16_bf16 v[34:49], v[162:165], v[154:157], v[34:49]
    s_waitcnt lgkmcnt(5)
    ds_read_b64_tr_b16 v[150:151], v185 offset:41000
    ds_read_b64_tr_b16 v[152:153], v185 offset:41160
    v_mfma_f32_32x32x16_bf16 v[18:33], v[134:137], v[130:133], v[18:33]
    s_waitcnt lgkmcnt(5)
    ds_read_b128 v[154:157], v183 offset:33824
    ds_read_b64_tr_b16 v[158:159], v185 offset:43520
    ds_read_b64_tr_b16 v[160:161], v185 offset:43680
    buffer_load_dwordx4 v181, s[44:47], s95 offen offset:0 sc0 lds
    v_mfma_f32_32x32x16_bf16 v[34:49], v[138:141], v[130:133], v[34:49]
    s_waitcnt lgkmcnt(5)
    ds_read_b64_tr_b16 v[162:163], v185 offset:43560
    ds_read_b64_tr_b16 v[164:165], v185 offset:43720
    v_mfma_f32_32x32x16_bf16 v[18:33], v[146:149], v[142:145], v[18:33]
    s_waitcnt lgkmcnt(5)
    ds_read_b128 v[130:133], v183 offset:33856
    ds_read_b64_tr_b16 v[134:135], v185 offset:46080
    ds_read_b64_tr_b16 v[136:137], v185 offset:46240
    buffer_load_dwordx4 v182, s[44:47], s95 offen offset:1024 sc0 lds
    v_mfma_f32_32x32x16_bf16 v[34:49], v[150:153], v[142:145], v[34:49]
    s_waitcnt lgkmcnt(5)
    ds_read_b64_tr_b16 v[138:139], v185 offset:46120
    ds_read_b64_tr_b16 v[140:141], v185 offset:46280
    v_mfma_f32_32x32x16_bf16 v[18:33], v[158:161], v[154:157], v[18:33]
    s_waitcnt lgkmcnt(5)
    ds_read_b128 v[142:145], v183 offset:33888
    ds_read_b64_tr_b16 v[146:147], v185 offset:48640
    ds_read_b64_tr_b16 v[148:149], v185 offset:48800
    v_mfma_f32_32x32x16_bf16 v[34:49], v[162:165], v[154:157], v[34:49]
    s_waitcnt lgkmcnt(5)
    ds_read_b64_tr_b16 v[150:151], v185 offset:48680
    ds_read_b64_tr_b16 v[152:153], v185 offset:48840
    v_mfma_f32_32x32x16_bf16 v[18:33], v[134:137], v[130:133], v[18:33]
    s_waitcnt vmcnt(5) lgkmcnt(5)
    s_barrier
    s_add_u32 s93, s93, 1
    ds_read_b128 v[154:157], v184 offset:0
    ds_read_b64_tr_b16 v[158:159], v185 offset:51200
    ds_read_b64_tr_b16 v[160:161], v185 offset:51360
    s_cmp_eq_u32 s93, 5
    v_mfma_f32_32x32x16_bf16 v[34:49], v[138:141], v[130:133], v[34:49]
    s_waitcnt lgkmcnt(5)
    s_cselect_b32 s93, 0, s93
    ds_read_b64_tr_b16 v[162:163], v185 offset:51240
    ds_read_b64_tr_b16 v[164:165], v185 offset:51400
    v_mfma_f32_32x32x16_bf16 v[18:33], v[146:149], v[142:145], v[18:33]
    s_waitcnt lgkmcnt(5)
    s_lshl_b32 s94, s93, 8
    ds_read_b128 v[130:133], v184 offset:32
    ds_read_b64_tr_b16 v[134:135], v185 offset:53760
    ds_read_b64_tr_b16 v[136:137], v185 offset:53920
    s_add_u32 s94, s94, s91
    v_mfma_f32_32x32x16_bf16 v[34:49], v[150:153], v[142:145], v[34:49]
    s_waitcnt lgkmcnt(5)
    s_mul_i32 s95, s93, 163840
    ds_read_b64_tr_b16 v[138:139], v185 offset:53800
    ds_read_b64_tr_b16 v[140:141], v185 offset:53960
    v_mfma_f32_32x32x16_bf16 v[18:33], v[158:161], v[154:157], v[18:33]
    s_waitcnt lgkmcnt(5)
    s_add_u32 s95, s95, s92
    ds_read_b128 v[142:145], v184 offset:64
    ds_read_b64_tr_b16 v[146:147], v185 offset:56320
    ds_read_b64_tr_b16 v[148:149], v185 offset:56480
    s_add_u32 m0, s21, 104960
    v_mfma_f32_32x32x16_bf16 v[34:49], v[162:165], v[154:157], v[34:49]
    s_waitcnt lgkmcnt(5)
    ds_read_b64_tr_b16 v[150:151], v185 offset:56360
    ds_read_b64_tr_b16 v[152:153], v185 offset:56520
    buffer_load_dwordx4 v178, s[44:47], s95 offen offset:0 sc0 lds
    v_mfma_f32_32x32x16_bf16 v[18:33], v[134:137], v[130:133], v[18:33]
    s_waitcnt lgkmcnt(5)
    ds_read_b128 v[154:157], v184 offset:96
    ds_read_b64_tr_b16 v[158:159], v185 offset:58880
    ds_read_b64_tr_b16 v[160:161], v185 offset:59040
    buffer_load_dwordx4 v179, s[44:47], s95 offen offset:1024 sc0 lds
    v_mfma_f32_32x32x16_bf16 v[34:49], v[138:141], v[130:133], v[34:49]
    s_waitcnt lgkmcnt(5)
    ds_read_b64_tr_b16 v[162:163], v185 offset:58920
    ds_read_b64_tr_b16 v[164:165], v185 offset:59080
    buffer_load_dwordx4 v180, s[44:47], s95 offen offset:2048 sc0 lds
    v_mfma_f32_32x32x16_bf16 v[18:33], v[146:149], v[142:145], v[18:33]
    s_waitcnt vmcnt(5) lgkmcnt(5)
    s_barrier
    s_add_u32 m0, s39, 117248
    ds_read_b128 v[130:133], v184 offset:8448
    ds_read_b64_tr_b16 v[134:135], v185 offset:0
    ds_read_b64_tr_b16 v[136:137], v185 offset:160
    v_mfma_f32_32x32x16_bf16 v[34:49], v[150:153], v[142:145], v[34:49]
    s_waitcnt lgkmcnt(5)
    ds_read_b64_tr_b16 v[138:139], v185 offset:40
    ds_read_b64_tr_b16 v[140:141], v185 offset:200
    v_mfma_f32_32x32x16_bf16 v[18:33], v[158:161], v[154:157], v[18:33]
    s_waitcnt lgkmcnt(5)
    ds_read_b128 v[142:145], v184 offset:8480
    ds_read_b64_tr_b16 v[146:147], v185 offset:2560
    ds_read_b64_tr_b16 v[148:149], v185 offset:2720
    buffer_load_dwordx4 v181, s[44:47], s95 offen offset:0 sc0 lds
    v_mfma_f32_32x32x16_bf16 v[34:49], v[162:165], v[154:157], v[34:49]
    s_waitcnt lgkmcnt(5)
    ds_read_b64_tr_b16 v[150:151], v185 offset:2600
    ds_read_b64_tr_b16 v[152:153], v185 offset:2760
    v_mfma_f32_32x32x16_bf16 v[18:33], v[134:137], v[130:133], v[18:33]
    s_waitcnt lgkmcnt(5)
    ds_read_b128 v[154:157], v184 offset:8512
    ds_read_b64_tr_b16 v[158:159], v185 offset:5120
    ds_read_b64_tr_b16 v[160:161], v185 offset:5280
    buffer_load_dwordx4 v182, s[44:47], s95 offen offset:1024 sc0 lds
    v_mfma_f32_32x32x16_bf16 v[34:49], v[138:141], v[130:133], v[34:49]
    s_waitcnt lgkmcnt(5)
    ds_read_b64_tr_b16 v[162:163], v185 offset:5160
    ds_read_b64_tr_b16 v[164:165], v185 offset:5320
    v_mfma_f32_32x32x16_bf16 v[18:33], v[146:149], v[142:145], v[18:33]
    s_waitcnt lgkmcnt(5)
    ds_read_b128 v[130:133], v184 offset:8544
    ds_read_b64_tr_b16 v[134:135], v185 offset:7680
    ds_read_b64_tr_b16 v[136:137], v185 offset:7840
    v_mfma_f32_32x32x16_bf16 v[34:49], v[150:153], v[142:145], v[34:49]
    s_waitcnt lgkmcnt(5)
    ds_read_b64_tr_b16 v[138:139], v185 offset:7720
    ds_read_b64_tr_b16 v[140:141], v185 offset:7880
    v_mfma_f32_32x32x16_bf16 v[18:33], v[158:161], v[154:157], v[18:33]
    s_waitcnt vmcnt(5) lgkmcnt(5)
    s_barrier
    ds_read_b128 v[142:145], v184 offset:16896
    ds_read_b64_tr_b16 v[146:147], v185 offset:10240
    ds_read_b64_tr_b16 v[148:149], v185 offset:10400
    v_add_u32 v118, 126976, v110
    v_add_u32 v119, s21, v110
    v_mfma_f32_32x32x16_bf16 v[34:49], v[162:165], v[154:157], v[34:49]
    s_waitcnt lgkmcnt(5)
    ds_read_b64_tr_b16 v[150:151], v185 offset:10280
    ds_read_b64_tr_b16 v[152:153], v185 offset:10440
    v_lshlrev_b32 v122, 3, v1
    v_mfma_f32_32x32x16_bf16 v[18:33], v[134:137], v[130:133], v[18:33]
    s_waitcnt lgkmcnt(5)
    ds_read_b128 v[154:157], v184 offset:16928
    ds_read_b64_tr_b16 v[158:159], v185 offset:12800
    ds_read_b64_tr_b16 v[160:161], v185 offset:12960
    v_add_u32 v121, 126976, v122
    v_lshrrev_b32 v3, 5, v1
    v_mfma_f32_32x32x16_bf16 v[34:49], v[138:141], v[130:133], v[34:49]
    s_waitcnt lgkmcnt(5)
    ds_read_b64_tr_b16 v[162:163], v185 offset:12840
    ds_read_b64_tr_b16 v[164:165], v185 offset:13000
    v_lshlrev_b32 v5, 7, v3
    v_mfma_f32_32x32x16_bf16 v[18:33], v[146:149], v[142:145], v[18:33]
    s_waitcnt lgkmcnt(5)
    ds_read_b128 v[130:133], v184 offset:16960
    ds_read_b64_tr_b16 v[134:135], v185 offset:15360
    ds_read_b64_tr_b16 v[136:137], v185 offset:15520
    v_sub_u32 v5, v118, v5
    v_add_u32 v5, 3072, v5
    v_mfma_f32_32x32x16_bf16 v[34:49], v[150:153], v[142:145], v[34:49]
    s_waitcnt lgkmcnt(5)
    ds_read_b64_tr_b16 v[138:139], v185 offset:15400
    ds_read_b64_tr_b16 v[140:141], v185 offset:15560
    v_and_b32 v2, 31, v1
    v_mfma_f32_32x32x16_bf16 v[18:33], v[158:161], v[154:157], v[18:33]
    s_waitcnt lgkmcnt(5)
    ds_read_b128 v[142:145], v184 offset:16992
    ds_read_b64_tr_b16 v[146:147], v185 offset:17920
    ds_read_b64_tr_b16 v[148:149], v185 offset:18080
    v_cmp_lt_u32 vcc, 20, v2
    v_mfma_f32_32x32x16_bf16 v[34:49], v[162:165], v[154:157], v[34:49]
    s_waitcnt lgkmcnt(5)
    ds_read_b64_tr_b16 v[150:151], v185 offset:17960
    ds_read_b64_tr_b16 v[152:153], v185 offset:18120
    v_mov_b32 v4, 0x40000
    v_mfma_f32_32x32x16_bf16 v[18:33], v[134:137], v[130:133], v[18:33]
    s_waitcnt vmcnt(2) lgkmcnt(5)
    s_barrier
    ds_read_b128 v[154:157], v184 offset:25344
    ds_read_b64_tr_b16 v[158:159], v185 offset:20480
    ds_read_b64_tr_b16 v[160:161], v185 offset:20640
    v_min_u32 v129, 9, v1
    v_cndmask_b32 v120, v5, v4, vcc
    v_mfma_f32_32x32x16_bf16 v[34:49], v[138:141], v[130:133], v[34:49]
    s_waitcnt lgkmcnt(5)
    ds_read_b64_tr_b16 v[162:163], v185 offset:20520
    ds_read_b64_tr_b16 v[164:165], v185 offset:20680
    v_lshlrev_b32 v129, 7, v129
    v_mfma_f32_32x32x16_bf16 v[18:33], v[146:149], v[142:145], v[18:33]
    s_waitcnt lgkmcnt(5)
    ds_read_b128 v[130:133], v184 offset:25376
    ds_read_b64_tr_b16 v[134:135], v185 offset:23040
    ds_read_b64_tr_b16 v[136:137], v185 offset:23200
    v_and_b32 v2, 15, v1
    v_lshrrev_b32 v4, 4, v1
    v_mfma_f32_32x32x16_bf16 v[34:49], v[150:153], v[142:145], v[34:49]
    s_waitcnt lgkmcnt(5)
    ds_read_b64_tr_b16 v[138:139], v185 offset:23080
    ds_read_b64_tr_b16 v[140:141], v185 offset:23240
    v_lshlrev_b32 v4, 28, v4
    v_mfma_f32_32x32x16_bf16 v[18:33], v[158:161], v[154:157], v[18:33]
    s_waitcnt lgkmcnt(5)
    ds_read_b128 v[142:145], v184 offset:25408
    ds_read_b64_tr_b16 v[146:147], v185 offset:25600
    ds_read_b64_tr_b16 v[148:149], v185 offset:25760
    v_lshl_add_u32 v128, v2, 7, v4
    s_getpc_b64 s[48:49]
L_tab_19:
    v_mfma_f32_32x32x16_bf16 v[34:49], v[162:165], v[154:157], v[34:49]
    s_waitcnt lgkmcnt(5)
    s_mul_i32 s99, s84, 6144
    ds_read_b64_tr_b16 v[150:151], v185 offset:25640
    ds_read_b64_tr_b16 v[152:153], v185 offset:25800
    v_mfma_f32_32x32x16_bf16 v[18:33], v[134:137], v[130:133], v[18:33]
    s_waitcnt lgkmcnt(5)
    s_add_u32 s99, s99, L_tab-L_tab_19+4096
    ds_read_b128 v[154:157], v184 offset:25440
    ds_read_b64_tr_b16 v[158:159], v185 offset:28160
    ds_read_b64_tr_b16 v[160:161], v185 offset:28320
    v_mfma_f32_32x32x16_bf16 v[34:49], v[138:141], v[130:133], v[34:49]
    s_waitcnt lgkmcnt(5)
    s_add_u32 s48, s48, s99
    s_addc_u32 s49, s49, 0
    ds_read_b64_tr_b16 v[162:163], v185 offset:28200
    ds_read_b64_tr_b16 v[164:165], v185 offset:28360
    v_mfma_f32_32x32x16_bf16 v[18:33], v[146:149], v[142:145], v[18:33]
    s_waitcnt vmcnt(0) lgkmcnt(5)
    s_barrier
    ds_read_b128 v[130:133], v184 offset:33792
    ds_read_b64_tr_b16 v[134:135], v185 offset:30720
    ds_read_b64_tr_b16 v[136:137], v185 offset:30880
    v_and_b32 v17, 31, v1
    v_mfma_f32_32x32x16_bf16 v[34:49], v[150:153], v[142:145], v[34:49]
    s_waitcnt lgkmcnt(5)
    ds_read_b64_tr_b16 v[138:139], v185 offset:30760
    ds_read_b64_tr_b16 v[140:141], v185 offset:30920
    v_lshlrev_b32 v16, 2, v17
    v_mfma_f32_32x32x16_bf16 v[18:33], v[158:161], v[154:157], v[18:33]
    s_waitcnt lgkmcnt(5)
    ds_read_b128 v[142:145], v184 offset:33824
    ds_read_b64_tr_b16 v[146:147], v185 offset:33280
    ds_read_b64_tr_b16 v[148:149], v185 offset:33440
    v_add_u32 v16, 40960, v16
    v_mfma_f32_32x32x16_bf16 v[34:49], v[162:165], v[154:157], v[34:49]
    s_waitcnt lgkmcnt(5)
    ds_read_b64_tr_b16 v[150:151], v185 offset:33320
    ds_read_b64_tr_b16 v[152:153], v185 offset:33480
    v_lshlrev_b32 v17, 7, v17
    v_mfma_f32_32x32x16_bf16 v[18:33], v[134:137], v[130:133], v[18:33]
    s_waitcnt lgkmcnt(5)
    s_cmp_eq_u32 s84, 0
    ds_read_b128 v[154:157], v184 offset:33856
    ds_read_b64_tr_b16 v[158:159], v185 offset:35840
    ds_read_b64_tr_b16 v[160:161], v185 offset:36000
    v_mfma_f32_32x32x16_bf16 v[34:49], v[138:141], v[130:133], v[34:49]
    s_waitcnt lgkmcnt(5)
    ds_read_b64_tr_b16 v[162:163], v185 offset:35880
    ds_read_b64_tr_b16 v[164:165], v185 offset:36040
    v_mfma_f32_32x32x16_bf16 v[18:33], v[146:149], v[142:145], v[18:33]
    s_waitcnt lgkmcnt(5)
    s_cselect_b32 s96, 0, 2130706432
    ds_read_b128 v[130:133], v184 offset:33888
    ds_read_b64_tr_b16 v[134:135], v185 offset:38400
    ds_read_b64_tr_b16 v[136:137], v185 offset:38560
    v_mfma_f32_32x32x16_bf16 v[34:49], v[150:153], v[142:145], v[34:49]
    s_waitcnt lgkmcnt(5)
    ds_read_b64_tr_b16 v[138:139], v185 offset:38440
    ds_read_b64_tr_b16 v[140:141], v185 offset:38600
    v_mfma_f32_32x32x16_bf16 v[18:33], v[158:161], v[154:157], v[18:33]
    s_waitcnt lgkmcnt(5)
    s_add_u32 s96, s96, 458752
    v_mfma_f32_32x32x16_bf16 v[34:49], v[162:165], v[154:157], v[34:49]
    s_waitcnt lgkmcnt(2)
    v_mfma_f32_32x32x16_bf16 v[18:33], v[134:137], v[130:133], v[18:33]
    s_waitcnt lgkmcnt(0)
    buffer_load_dword v116, v17, s[64:67], s96 offen sc1
    v_mfma_f32_32x32x16_bf16 v[34:49], v[138:141], v[130:133], v[34:49]
    s_mov_b32 s37, 1
    s_cmp_eq_u32 s84, 1
    s_cbranch_scc1 L_pad_p0
    s_cmp_eq_u32 s84, 2
    s_cbranch_scc1 L_pad_p1
    s_cmp_eq_u32 s84, 3
    s_cbranch_scc1 L_pad_p2
    s_mov_b32 s6, 0
    s_waitcnt vmcnt(0)
L_poll_20:
    v_cmp_eq_u32 vcc, 0, v116
    s_add_u32 s6, s6, 1
    s_nop 2
    s_cbranch_vccz L_seen_21
    s_sleep 1
    buffer_load_dword v116, v17, s[64:67], s96 offen sc1
    s_cmp_lt_u32 s6, 0x40000
    s_waitcnt vmcnt(0)
    s_cbranch_scc1 L_poll_20
L_seen_21:
    ds_write_b32 v16, v116
    s_waitcnt lgkmcnt(0)
L_ret_p:
    s_mov_b32 s37, 0
    s_waitcnt vmcnt(0)
    s_barrier
    ds_read_b32 v4, v16
    s_add_u32 m0, s21, 126976
    s_add_u32 s68, s64, 262144
    s_addc_u32 s69, s65, 0
    global_load_lds_dwordx4 v119, s[68:69] offset:0 sc1
    global_load_lds_dwordx4 v119, s[68:69] offset:1024 sc1
    global_load_lds_dwordx4 v119, s[68:69] offset:2048 sc1
    s_nop 0
    v_cvt_pk_bf16_f32 v98, v18, v19
    v_cvt_pk_bf16_f32 v99, v20, v21
    v_cvt_pk_bf16_f32 v100, v22, v23
    v_cvt_pk_bf16_f32 v101, v24, v25
    s_add_u32 m0, s21, 139264
    v_cvt_pk_bf16_f32 v106, v26, v27
    v_cvt_pk_bf16_f32 v107, v28, v29
    s_add_u32 s68, s64, 274432
    s_addc_u32 s69, s65, 0
    v_pk_mul_f32 v[2:3], v[18:19], v[18:19]
    v_pk_fma_f32 v[2:3], v[20:21], v[20:21], v[2:3]
    global_load_lds_dwordx4 v119, s[68:69] offset:0 sc1
    v_pk_fma_f32 v[2:3], v[22:23], v[22:23], v[2:3]
    v_pk_fma_f32 v[2:3], v[24:25], v[24:25], v[2:3]
    global_load_lds_dwordx4 v119, s[68:69] offset:1024 sc1
    v_pk_fma_f32 v[2:3], v[26:27], v[26:27], v[2:3]
    v_pk_fma_f32 v[2:3], v[28:29], v[28:29], v[2:3]
    global_load_lds_dwordx4 v119, s[68:69] offset:2048 sc1
    v_add_f32 v114, v2, v3
    v_add_f32 v2, v2, v3
    s_add_u32 m0, s21, 151552
    s_nop 0
    v_permlane32_swap_b32 v2, v114
    v_add_f32 v114, v114, v2
    s_add_u32 s68, s64, 286720
    s_addc_u32 s69, s65, 0
    v_cvt_pk_bf16_f32 v102, v34, v35
    v_cvt_pk_bf16_f32 v103, v36, v37
    global_load_lds_dwordx4 v119, s[68:69] offset:0 sc1
    v_cvt_pk_bf16_f32 v104, v38, v39
    v_cvt_pk_bf16_f32 v105, v40, v41
    global_load_lds_dwordx4 v119, s[68:69] offset:1024 sc1
    v_cvt_pk_bf16_f32 v108, v42, v43
    v_cvt_pk_bf16_f32 v109, v44, v45
    global_load_lds_dwordx4 v119, s[68:69] offset:2048 sc1
    v_pk_mul_f32 v[2:3], v[34:35], v[34:35]
    v_pk_fma_f32 v[2:3], v[36:37], v[36:37], v[2:3]
    v_pk_fma_f32 v[2:3], v[38:39], v[38:39], v[2:3]
    v_pk_fma_f32 v[2:3], v[40:41], v[40:41], v[2:3]
    v_pk_fma_f32 v[2:3], v[42:43], v[42:43], v[2:3]
    v_pk_fma_f32 v[2:3], v[44:45], v[44:45], v[2:3]
    v_add_f32 v115, v2, v3
    v_add_f32 v2, v2, v3
    s_nop 1
    v_permlane32_swap_b32 v2, v115
    v_add_f32 v115, v115, v2
    s_waitcnt lgkmcnt(0)
    v_max_f32_dpp v4, v4, v4 row_ror:1 row_mask:0xf bank_mask:0xf
    s_nop 1
    v_max_f32_dpp v4, v4, v4 row_ror:2 row_mask:0xf bank_mask:0xf
    s_nop 1
    v_max_f32_dpp v4, v4, v4 row_ror:4 row_mask:0xf bank_mask:0xf
    s_nop 1
    v_max_f32_dpp v4, v4, v4 row_ror:8 row_mask:0xf bank_mask:0xf
    v_mov_b32 v5, v4
    s_nop 1
    v_permlane16_swap_b32 v4, v5
    v_max_f32 v4, v4, v5
    v_mul_f32 v114, v114, v4
    v_mul_f32 v115, v115, v4
    v_sqrt_f32 v114, v114
    v_sqrt_f32 v115, v115
    s_mov_b32 s99, 0x42200000
    v_cmp_nge_f32 vcc, s99, v114
    v_cmp_nge_f32 s[12:13], s99, v115
    s_nop 3
    s_or_b64 vcc, vcc, s[12:13]
    v_cvt_pk_bf16_f32 v2, -v114, 0
    v_cvt_pk_bf16_f32 v3, -v115, 0
    s_cbranch_vccnz L_truemax_p
    v_cndmask_b32 v106, v106, v2, s[22:23]
    v_cndmask_b32 v108, v108, v3, s[22:23]
L_havemax_p:
    s_waitcnt vmcnt(6)
    s_barrier
    ds_read_b128 a[240:243], v118
    ds_read2st64_b64 a[244:247], v121 offset0:4 offset1:5
    s_waitcnt lgkmcnt(1)
    v_mfma_f32_32x32x16_bf16 v[18:33], a[240:243], v[98:101], 0
    s_waitcnt lgkmcnt(0)
    v_mfma_f32_32x32x8_bf16 v[18:33], a[244:245], v[106:107], v[18:33]
    v_mfma_f32_32x32x8_bf16 v[34:49], a[244:245], v[108:109], 0
    s_nop 10
    v_exp_f32 v18, v18
    v_exp_f32 v19, v19
    v_exp_f32 v20, v20
    v_exp_f32 v21, v21
    v_exp_f32 v22, v22
    v_exp_f32 v23, v23
    v_exp_f32 v24, v24
    v_exp_f32 v25, v25
    v_exp_f32 v26, v26
    v_exp_f32 v27, v27
    v_exp_f32 v28, v28
    v_exp_f32 v29, v29
    v_exp_f32 v30, v30
    v_exp_f32 v31, v31
    v_exp_f32 v32, v32
    v_exp_f32 v33, v33
    v_mfma_f32_32x32x16_bf16 v[34:49], a[240:243], v[102:105], v[34:49]
    ds_read_b128 a[240:243], v118 offset:1024
    ds_read_b128 a[248:251], v120 offset:0
    ds_read_b128 a[252:255], v120 offset:768
    s_mov_b32 s78, 819200
    s_mov_b32 s79, 0x00020000
    s_lshr_b32 s89, s87, 1
    s_and_b32 s90, s87, 1
    s_lshl_b32 s90, s90, 2
    s_add_u32 s90, s90, s84
    s_mul_i32 s52, s89, 51200
    s_mul_i32 s3, s90, 160
    s_add_u32 s52, s52, s3
    s_mul_i32 s7, s84, 7168
    s_mul_i32 s90, s90, 102400
    s_lshr_b32 s3, s89, 3
    s_mul_i32 s3, s3, 51200
    s_add_u32 s90, s90, s3
    s_add_u32 s90, s90, 786432
    s_and_b32 s3, s89, 7
    s_mul_i32 s53, s3, 5120
    s_add_u32 s53, s53, s90
    s_lshr_b32 s3, s3, 2
    s_mul_i32 s35, s3, 5120
    s_add_u32 s35, s35, s90
    s_and_b32 s3, s89, 3
    s_lshl_b32 s3, s3, 8
    s_add_u32 s35, s35, s3
    s_add_u32 s35, s35, 40960
    s_lshl_b32 s36, s87, 7
    s_add_u32 s36, s36, 196608
    v_mfma_f32_32x32x8_bf16 v[50:65], a[246:247], v[106:107], 0
    v_exp_f32 v34, v34
    v_exp_f32 v35, v35
    v_exp_f32 v36, v36
    v_exp_f32 v37, v37
    v_exp_f32 v38, v38
    v_exp_f32 v39, v39
    v_exp_f32 v40, v40
    v_exp_f32 v41, v41
    s_waitcnt lgkmcnt(2)
    v_mfma_f32_32x32x16_bf16 v[50:65], a[240:243], v[98:101], v[50:65]
    s_waitcnt lgkmcnt(0)
    s_cmp_eq_u32 s84, 0
    s_cselect_b32 s36, s36, 2130706432
    v_exp_f32 v42, v42
    v_exp_f32 v43, v43
    v_add_u32 v2, 0, v1
    v_mul_u32_u24 v2, 6554, v2
    v_lshrrev_b32 v2, 16, v2
    v_mul_u32_u24 v2, 1120, v2
    v_add_u32 v178, v2, v110
    v_add_u32 v2, 64, v1
    v_mul_u32_u24 v2, 6554, v2
    v_lshrrev_b32 v2, 16, v2
    v_smfmac_f32_32x32x32_bf16 v[66:81], a[248:251], v[18:25], v253
    s_add_u32 s99, s91, s92
    v_exp_f32 v44, v44
    v_exp_f32 v45, v45
    v_exp_f32 v46, v46
    v_mul_u32_u24 v2, 1120, v2
    v_add_u32 v179, v2, v110
    v_add_u32 v2, 128, v1
    v_mul_u32_u24 v2, 6554, v2
    v_lshrrev_b32 v2, 16, v2
    v_mul_u32_u24 v2, 1120, v2
    v_add_u32 v180, v2, v110
    v_add_u32 v2, 192, v1
    v_mul_u32_u24 v2, 6554, v2
    v_smfmac_f32_32x32x32_bf16 v[66:81], a[252:255], v[26:33], v253
    s_add_u32 s14, s14, s99
    s_addc_u32 s15, s15, 0
    v_exp_f32 v47, v47
    v_exp_f32 v48, v48
    v_exp_f32 v49, v49
    v_lshrrev_b32 v2, 16, v2
    v_mul_u32_u24 v2, 1120, v2
    v_add_u32 v181, v2, v110
    v_add_u32 v2, 256, v1
    v_mul_u32_u24 v2, 6554, v2
    v_lshrrev_b32 v2, 16, v2
    v_mul_u32_u24 v2, 1120, v2
    v_add_u32 v182, v2, v110
    v_add_u32 v2, 320, v1
    v_mfma_f32_32x32x8_bf16 v[18:33], a[246:247], v[108:109], 0
    v_exp_f32 v50, v50
    v_exp_f32 v51, v51
    v_exp_f32 v52, v52
    v_exp_f32 v53, v53
    v_exp_f32 v54, v54
    v_mul_u32_u24 v2, 6554, v2
    v_lshrrev_b32 v2, 16, v2
    v_mul_u32_u24 v2, 1120, v2
    v_add_u32 v183, v2, v110
    v_add_u32 v2, 384, v1
    v_mul_u32_u24 v2, 6554, v2
    v_lshrrev_b32 v2, 16, v2
    v_mfma_f32_32x32x16_bf16 v[18:33], a[240:243], v[102:105], v[18:33]
    ds_read2st64_b64 a[244:247], v121 offset0:16 offset1:17
    ds_read_b128 a[240:243], v118 offset:6144
    v_exp_f32 v55, v55
    v_exp_f32 v56, v56
    v_exp_f32 v57, v57
    v_mul_u32_u24 v2, 1120, v2
    v_add_u32 v184, v2, v110
    v_bfe_u32 v2, v1, 2, 2
    v_and_b32 v3, 3, v1
    v_lshl_add_u32 v3, v3, 3, s7
    v_lshrrev_b32 v4, 5, v1
    v_mul_u32_u24 v4, 20, v4
    v_smfmac_f32_32x32x32_bf16 v[82:97], a[248:251], v[34:41], v253
    s_add_u32 s30, s30, s92
    s_addc_u32 s31, s31, 0
    ds_read_b128 a[248:251], v120 offset:1536
    v_exp_f32 v58, v58
    v_exp_f32 v59, v59
    v_exp_f32 v60, v60
    v_exp_f32 v61, v61
    v_bfe_u32 v5, v1, 4, 1
    v_lshl_add_u32 v4, v5, 2, v4
    v_add_u32 v4, v4, v2
    v_mul_u32_u24 v4, 160, v4
    v_add_u32 v185, v4, v3
    v_mul_u32_u24 v2, 160, v2
    v_add_u32 v187, v2, v3
    v_smfmac_f32_32x32x32_bf16 v[82:97], a[252:255], v[42:49], v253
    s_waitcnt lgkmcnt(1)
    s_cmp_eq_u32 s86, 0
    s_cselect_b64 s[72:73], s[24:25], s[26:27]
    ds_read_b128 a[252:255], v120 offset:2304
    v_exp_f32 v62, v62
    v_exp_f32 v63, v63
    v_exp_f32 v64, v64
    v_exp_f32 v65, v65
    v_lshrrev_b32 v4, 4, v1
    v_lshl_add_u32 v186, v4, 5, v187
    v_and_b32 v2, 15, v1
    v_lshlrev_b32 v2, 4, v2
    v_lshl_add_u32 v188, v4, 10, v2
    v_lshl_add_u32 v189, v4, 28, v2
    v_mfma_f32_32x32x8_bf16 v[34:49], a[244:245], v[106:107], 0
    v_exp_f32 v18, v18
    v_exp_f32 v19, v19
    v_exp_f32 v20, v20
    v_exp_f32 v21, v21
    v_exp_f32 v22, v22
    v_mfma_f32_32x32x16_bf16 v[34:49], a[240:243], v[98:101], v[34:49]
    s_waitcnt lgkmcnt(1)
    s_mov_b32 s74, 819200
    v_exp_f32 v23, v23
    v_exp_f32 v24, v24
    v_exp_f32 v25, v25
    v_exp_f32 v26, v26
    v_exp_f32 v27, v27
    v_smfmac_f32_32x32x32_bf16 v[66:81], a[248:251], v[50:57], v253
    s_waitcnt vmcnt(3) lgkmcnt(0)
    s_add_u32 m0, s7, 0
    s_add_u32 s94, s52, 0
    s_mov_b32 s75, 0x00020000
    s_barrier
    buffer_load_dwordx4 v178, s[76:79], s94 offen offset:0 sc0 lds
    v_exp_f32 v28, v28
    v_exp_f32 v29, v29
    v_smfmac_f32_32x32x32_bf16 v[66:81], a[252:255], v[58:65], v253
    buffer_load_dwordx4 v179, s[76:79], s94 offen offset:1024 sc0 lds
    v_exp_f32 v30, v30
    v_exp_f32 v31, v31
    v_exp_f32 v32, v32
    v_exp_f32 v33, v33
    v_mfma_f32_32x32x8_bf16 v[50:65], a[244:245], v[108:109], 0
    v_exp_f32 v34, v34
    v_exp_f32 v35, v35
    v_exp_f32 v36, v36
    v_exp_f32 v37, v37
    v_exp_f32 v38, v38
    v_mfma_f32_32x32x16_bf16 v[50:65], a[240:243], v[102:105], v[50:65]
    ds_read_b128 a[240:243], v118 offset:7168
    buffer_load_dwordx4 v180, s[76:79], s94 offen offset:2048 sc0 lds
    v_exp_f32 v39, v39
    v_exp_f32 v40, v40
    v_exp_f32 v41, v41
    v_exp_f32 v42, v42
    v_smfmac_f32_32x32x32_bf16 v[82:97], a[248:251], v[18:25], v253
    s_mul_i32 s34, s88, 102400
    s_and_b32 s99, s87, 3
    ds_read_b128 a[248:251], v120 offset:6144
    buffer_load_dwordx4 v181, s[76:79], s94 offen offset:3072 sc0 lds
    v_exp_f32 v43, v43
    v_exp_f32 v44, v44
    v_exp_f32 v45, v45
    v_smfmac_f32_32x32x32_bf16 v[82:97], a[252:255], v[26:33], v253
    s_waitcnt lgkmcnt(1)
    s_add_u32 m0, s7, 4096
    s_add_u32 s94, s52, 4096
    ds_read_b128 a[252:255], v120 offset:6912
    v_exp_f32 v46, v46
    v_exp_f32 v47, v47
    v_exp_f32 v48, v48
    v_exp_f32 v49, v49
    v_mfma_f32_32x32x8_bf16 v[18:33], a[246:247], v[106:107], 0
    v_exp_f32 v50, v50
    v_exp_f32 v51, v51
    v_exp_f32 v52, v52
    v_exp_f32 v53, v53
    v_exp_f32 v54, v54
    v_mfma_f32_32x32x16_bf16 v[18:33], a[240:243], v[98:101], v[18:33]
    s_waitcnt lgkmcnt(1)
    s_lshl_b32 s99, s99, 1
    v_exp_f32 v55, v55
    v_exp_f32 v56, v56
    v_exp_f32 v57, v57
    v_exp_f32 v58, v58
    v_exp_f32 v59, v59
    v_smfmac_f32_32x32x32_bf16 v[66:81], a[248:251], v[34:41], v253
    s_waitcnt lgkmcnt(0)
    s_add_u32 s99, s99, s85
    buffer_load_dwordx4 v182, s[76:79], s94 offen offset:0 sc0 lds
    v_exp_f32 v60, v60
    v_exp_f32 v61, v61
    v_exp_f32 v62, v62
    v_smfmac_f32_32x32x32_bf16 v[66:81], a[252:255], v[42:49], v253
    buffer_load_dwordx4 v183, s[76:79], s94 offen offset:1024 sc0 lds
    v_exp_f32 v63, v63
    v_exp_f32 v64, v64
    v_exp_f32 v65, v65
    v_mfma_f32_32x32x8_bf16 v[34:49], a[246:247], v[108:109], 0
    v_exp_f32 v18, v18
    v_exp_f32 v19, v19
    v_exp_f32 v20, v20
    v_exp_f32 v21, v21
    v_exp_f32 v22, v22
    v_mfma_f32_32x32x16_bf16 v[34:49], a[240:243], v[102:105], v[34:49]
    ds_read2st64_b64 a[244:247], v121 offset0:28 offset1:29
    ds_read_b128 a[240:243], v118 offset:12288
    v_exp_f32 v23, v23
    v_exp_f32 v24, v24
    v_exp_f32 v25, v25
    v_exp_f32 v26, v26
    v_smfmac_f32_32x32x32_bf16 v[82:97], a[248:251], v[50:57], v253
    s_mul_i32 s99, s99, 12800
    s_add_u32 s43, s99, s34
    ds_read_b128 a[248:251], v120 offset:7680
    v_exp_f32 v27, v27
    v_exp_f32 v28, v28
    v_exp_f32 v29, v29
    v_exp_f32 v30, v30
    v_smfmac_f32_32x32x32_bf16 v[82:97], a[252:255], v[58:65], v253
    s_waitcnt lgkmcnt(1)
    ds_read_b128 a[252:255], v120 offset:8448
    buffer_load_dwordx4 v184, s[76:79], s94 offen offset:2048 sc0 lds
    v_exp_f32 v31, v31
    v_exp_f32 v32, v32
    v_exp_f32 v33, v33
    v_mfma_f32_32x32x8_bf16 v[50:65], a[244:245], v[106:107], 0
    v_exp_f32 v34, v34
    v_exp_f32 v35, v35
    v_exp_f32 v36, v36
    v_exp_f32 v37, v37
    v_mfma_f32_32x32x16_bf16 v[50:65], a[240:243], v[98:101], v[50:65]
    s_waitcnt lgkmcnt(1)
    v_exp_f32 v38, v38
    v_exp_f32 v39, v39
    v_exp_f32 v40, v40
    v_exp_f32 v41, v41
    v_smfmac_f32_32x32x32_bf16 v[66:81], a[248:251], v[18:25], v253
    s_waitcnt lgkmcnt(0)
    s_mul_i32 s5, s84, 5120
    s_lshl_b32 s50, s84, 10
    v_exp_f32 v42, v42
    v_exp_f32 v43, v43
    v_exp_f32 v44, v44
    v_exp_f32 v45, v45
    v_smfmac_f32_32x32x32_bf16 v[66:81], a[252:255], v[26:33], v253
    v_exp_f32 v46, v46
    v_exp_f32 v47, v47
    v_exp_f32 v48, v48
    v_exp_f32 v49, v49
    v_mfma_f32_32x32x8_bf16 v[18:33], a[244:245], v[108:109], 0
    v_exp_f32 v50, v50
    v_exp_f32 v51, v51
    v_exp_f32 v52, v52
    v_exp_f32 v53, v53
    v_exp_f32 v54, v54
    v_mfma_f32_32x32x16_bf16 v[18:33], a[240:243], v[102:105], v[18:33]
    ds_read_b128 a[240:243], v118 offset:13312
    v_exp_f32 v55, v55
    v_exp_f32 v56, v56
    v_exp_f32 v57, v57
    v_exp_f32 v58, v58
    v_smfmac_f32_32x32x32_bf16 v[82:97], a[248:251], v[34:41], v253
    s_add_u32 s99, s34, 786432
    ds_read_b128 a[248:251], v120 offset:12288
    v_exp_f32 v59, v59
    v_exp_f32 v60, v60
    v_exp_f32 v61, v61
    v_smfmac_f32_32x32x32_bf16 v[82:97], a[252:255], v[42:49], v253
    s_waitcnt lgkmcnt(1)
    s_add_u32 s44, s64, s99
    s_addc_u32 s45, s65, 0
    ds_read_b128 a[252:255], v120 offset:13056
    v_exp_f32 v62, v62
    v_exp_f32 v63, v63
    v_exp_f32 v64, v64
    v_exp_f32 v65, v65
    v_mfma_f32_32x32x8_bf16 v[34:49], a[246:247], v[106:107], 0
    v_exp_f32 v18, v18
    v_exp_f32 v19, v19
    v_exp_f32 v20, v20
    v_exp_f32 v21, v21
    v_mfma_f32_32x32x16_bf16 v[34:49], a[240:243], v[98:101], v[34:49]
    s_waitcnt lgkmcnt(1)
    v_exp_f32 v22, v22
    v_exp_f32 v23, v23
    v_exp_f32 v24, v24
    v_exp_f32 v25, v25
    v_smfmac_f32_32x32x32_bf16 v[66:81], a[248:251], v[50:57], v253
    s_waitcnt lgkmcnt(0)
    s_lshr_b32 s99, s88, 2
    s_lshl_b32 s99, s99, 7
    v_exp_f32 v26, v26
    v_exp_f32 v27, v27
    v_exp_f32 v28, v28
    v_exp_f32 v29, v29
    v_smfmac_f32_32x32x32_bf16 v[66:81], a[252:255], v[58:65], v253
    v_exp_f32 v30, v30
    v_exp_f32 v31, v31
    v_exp_f32 v32, v32
    v_exp_f32 v33, v33
    v_mfma_f32_32x32x8_bf16 v[50:65], a[246:247], v[108:109], 0
    v_exp_f32 v34, v34
    v_exp_f32 v35, v35
    v_exp_f32 v36, v36
    v_exp_f32 v37, v37
    v_exp_f32 v38, v38
    v_mfma_f32_32x32x16_bf16 v[50:65], a[240:243], v[102:105], v[50:65]
    ds_read2st64_b64 a[244:247], v121 offset0:40 offset1:41
    ds_read_b128 a[240:243], v118 offset:18432
    v_exp_f32 v39, v39
    v_exp_f32 v40, v40
    v_exp_f32 v41, v41
    v_exp_f32 v42, v42
    v_smfmac_f32_32x32x32_bf16 v[82:97], a[248:251], v[18:25], v253
    s_add_u32 s42, s99, 196608
    s_and_b32 s99, s88, 1
    ds_read_b128 a[248:251], v120 offset:13824
    global_load_dwordx4 v[224:227], v110, s[48:49] offset:-4096
    v_exp_f32 v43, v43
    v_exp_f32 v44, v44
    v_exp_f32 v45, v45
    v_smfmac_f32_32x32x32_bf16 v[82:97], a[252:255], v[26:33], v253
    s_waitcnt lgkmcnt(1)
    ds_read_b128 a[252:255], v120 offset:14592
    global_load_dwordx4 v[228:231], v110, s[48:49] offset:-3072
    v_exp_f32 v46, v46
    v_exp_f32 v47, v47
    v_exp_f32 v48, v48
    v_exp_f32 v49, v49
    v_mfma_f32_32x32x8_bf16 v[18:33], a[244:245], v[106:107], 0
    v_exp_f32 v50, v50
    v_exp_f32 v51, v51
    v_exp_f32 v52, v52
    v_exp_f32 v53, v53
    v_exp_f32 v54, v54
    v_mfma_f32_32x32x16_bf16 v[18:33], a[240:243], v[98:101], v[18:33]
    s_waitcnt lgkmcnt(1)
    global_load_dwordx4 v[232:235], v110, s[48:49] offset:-2048
    v_exp_f32 v55, v55
    v_exp_f32 v56, v56
    v_exp_f32 v57, v57
    v_exp_f32 v58, v58
    v_smfmac_f32_32x32x32_bf16 v[66:81], a[248:251], v[34:41], v253
    s_waitcnt vmcnt(10) lgkmcnt(0)
    s_lshl_b32 s28, s99, 5
    s_xor_b32 s99, s99, 1
    s_barrier
    v_exp_f32 v59, v59
    v_exp_f32 v60, v60
    v_exp_f32 v61, v61
    v_smfmac_f32_32x32x32_bf16 v[66:81], a[252:255], v[42:49], v253
L_pad_p0:
    s_cmp_eq_u32 s37, 1
    s_cbranch_scc1 L_pad_p3
    global_load_dwordx4 v[236:239], v110, s[48:49] offset:-1024
    v_exp_f32 v62, v62
    v_exp_f32 v63, v63
    v_exp_f32 v64, v64
    v_exp_f32 v65, v65
    v_mfma_f32_32x32x8_bf16 v[34:49], a[244:245], v[108:109], 0
    v_exp_f32 v18, v18
    v_exp_f32 v19, v19
    v_exp_f32 v20, v20
    v_exp_f32 v21, v21
    v_exp_f32 v22, v22
    v_mfma_f32_32x32x16_bf16 v[34:49], a[240:243], v[102:105], v[34:49]
    ds_read_b128 a[240:243], v118 offset:19456
    global_load_dwordx4 v[240:243], v110, s[48:49] offset:0
    v_exp_f32 v23, v23
    v_exp_f32 v24, v24
    v_exp_f32 v25, v25
    v_exp_f32 v26, v26
    v_smfmac_f32_32x32x32_bf16 v[82:97], a[248:251], v[50:57], v253
    s_add_u32 m0, s21, 126976
    s_lshl_b32 s29, s99, 7
    s_mul_i32 s99, s28, 640
    ds_read_b128 a[248:251], v120 offset:18432
    v_exp_f32 v27, v27
    v_exp_f32 v28, v28
    v_exp_f32 v29, v29
    v_exp_f32 v30, v30
    v_smfmac_f32_32x32x32_bf16 v[82:97], a[252:255], v[58:65], v253
    s_waitcnt lgkmcnt(1)
    s_add_u32 s68, s64, 299008
    s_addc_u32 s69, s65, 0
    ds_read_b128 a[252:255], v120 offset:19200
    global_load_lds_dwordx4 v119, s[68:69] offset:0 sc1
    v_exp_f32 v31, v31
    v_exp_f32 v32, v32
    v_exp_f32 v33, v33
    v_mfma_f32_32x32x8_bf16 v[50:65], a[246:247], v[106:107], 0
    v_exp_f32 v34, v34
    v_exp_f32 v35, v35
    v_exp_f32 v36, v36
    v_exp_f32 v37, v37
    v_exp_f32 v38, v38
    v_mfma_f32_32x32x16_bf16 v[50:65], a[240:243], v[98:101], v[50:65]
    s_waitcnt lgkmcnt(1)
    s_add_u32 s99, s99, s34
    v_exp_f32 v39, v39
    v_exp_f32 v40, v40
    v_exp_f32 v41, v41
    v_exp_f32 v42, v42
    v_exp_f32 v43, v43
    v_smfmac_f32_32x32x32_bf16 v[66:81], a[248:251], v[18:25], v253
    s_waitcnt lgkmcnt(0)
    s_add_u32 s18, s72, s99
    s_addc_u32 s19, s73, 0
    global_load_lds_dwordx4 v119, s[68:69] offset:1024 sc1
    v_exp_f32 v44, v44
    v_exp_f32 v45, v45
    v_exp_f32 v46, v46
    v_smfmac_f32_32x32x32_bf16 v[66:81], a[252:255], v[26:33], v253
    global_load_lds_dwordx4 v119, s[68:69] offset:2048 sc1
    v_exp_f32 v47, v47
    v_exp_f32 v48, v48
    v_exp_f32 v49, v49
    v_mfma_f32_32x32x8_bf16 v[18:33], a[246:247], v[108:109], 0
    v_exp_f32 v50, v50
    v_exp_f32 v51, v51
    v_exp_f32 v52, v52
    v_exp_f32 v53, v53
    v_exp_f32 v54, v54
    v_mfma_f32_32x32x16_bf16 v[18:33], a[240:243], v[102:105], v[18:33]
    ds_read2st64_b64 a[244:247], v121 offset0:52 offset1:53
    ds_read_b128 a[240:243], v118 offset:24576
    v_exp_f32 v55, v55
    v_exp_f32 v56, v56
    v_exp_f32 v57, v57
    v_exp_f32 v58, v58
    v_smfmac_f32_32x32x32_bf16 v[82:97], a[248:251], v[34:41], v253
    s_mul_i32 s99, s29, 640
    s_add_u32 s99, s99, s34
    ds_read_b128 a[248:251], v120 offset:19968
    v_exp_f32 v59, v59
    v_exp_f32 v60, v60
    v_exp_f32 v61, v61
    v_exp_f32 v62, v62
    v_smfmac_f32_32x32x32_bf16 v[82:97], a[252:255], v[42:49], v253
    s_waitcnt lgkmcnt(1)
    ds_read_b128 a[252:255], v120 offset:20736
    global_load_dwordx4 v[244:247], v110, s[48:49] offset:1024
    v_exp_f32 v63, v63
    v_exp_f32 v64, v64
    v_exp_f32 v65, v65
    v_mfma_f32_32x32x8_bf16 v[34:49], a[244:245], v[106:107], 0
    v_exp_f32 v18, v18
    v_exp_f32 v19, v19
    v_exp_f32 v20, v20
    v_exp_f32 v21, v21
    v_mfma_f32_32x32x16_bf16 v[34:49], a[240:243], v[98:101], v[34:49]
    s_waitcnt lgkmcnt(1)
    v_exp_f32 v22, v22
    v_exp_f32 v23, v23
    v_exp_f32 v24, v24
    v_exp_f32 v25, v25
    v_smfmac_f32_32x32x32_bf16 v[66:81], a[248:251], v[50:57], v253
    s_waitcnt lgkmcnt(0)
    s_add_u32 s32, s72, s99
    s_addc_u32 s33, s73, 0
    v_exp_f32 v26, v26
    v_exp_f32 v27, v27
    v_exp_f32 v28, v28
    v_exp_f32 v29, v29
    v_smfmac_f32_32x32x32_bf16 v[66:81], a[252:255], v[58:65], v253
    s_lshl_b32 s100, s87, 2
    v_exp_f32 v30, v30
    v_exp_f32 v31, v31
    v_exp_f32 v32, v32
    v_exp_f32 v33, v33
    v_mfma_f32_32x32x8_bf16 v[50:65], a[244:245], v[108:109], 0
    v_exp_f32 v34, v34
    v_exp_f32 v35, v35
    v_exp_f32 v36, v36
    v_exp_f32 v37, v37
    v_exp_f32 v38, v38
    v_mfma_f32_32x32x16_bf16 v[50:65], a[240:243], v[102:105], v[50:65]
    ds_read_b128 a[240:243], v118 offset:25600
    v_exp_f32 v39, v39
    v_exp_f32 v40, v40
    v_exp_f32 v41, v41
    v_exp_f32 v42, v42
    v_smfmac_f32_32x32x32_bf16 v[82:97], a[248:251], v[18:25], v253
    s_add_u32 s100, s100, s84
    s_mul_i32 s10, s100, 40960
    ds_read_b128 a[248:251], v120 offset:24576
    v_exp_f32 v43, v43
    v_exp_f32 v44, v44
    v_exp_f32 v45, v45
    v_smfmac_f32_32x32x32_bf16 v[82:97], a[252:255], v[26:33], v253
    s_waitcnt lgkmcnt(1)
    ds_read_b128 a[252:255], v120 offset:25344
    v_exp_f32 v46, v46
    v_exp_f32 v47, v47
    v_exp_f32 v48, v48
    v_exp_f32 v49, v49
    v_mfma_f32_32x32x8_bf16 v[18:33], a[246:247], v[106:107], 0
    v_exp_f32 v50, v50
    v_exp_f32 v51, v51
    v_exp_f32 v52, v52
    v_exp_f32 v53, v53
    v_exp_f32 v54, v54
    v_mfma_f32_32x32x16_bf16 v[18:33], a[240:243], v[98:101], v[18:33]
    s_waitcnt vmcnt(9) lgkmcnt(1)
    ds_read_b64_tr_b16 v[130:131], v185 offset:0
    ds_read_b64_tr_b16 v[132:133], v185 offset:1280
    v_exp_f32 v55, v55
    v_exp_f32 v56, v56
    v_exp_f32 v57, v57
    v_exp_f32 v58, v58
    v_smfmac_f32_32x32x32_bf16 v[66:81], a[248:251], v[34:41], v253
    s_waitcnt lgkmcnt(2)
    s_mul_i32 s99, s85, 38912
    s_sub_u32 s10, s10, s99
    ds_read_b64_tr_b16 v[134:135], v185 offset:32
    ds_read_b64_tr_b16 v[136:137], v185 offset:1312
    v_exp_f32 v59, v59
    v_exp_f32 v60, v60
    v_exp_f32 v61, v61
    v_smfmac_f32_32x32x32_bf16 v[66:81], a[252:255], v[42:49], v253
    ds_read_b64_tr_b16 v[138:139], v185 offset:64
    v_exp_f32 v62, v62
    v_exp_f32 v63, v63
    v_exp_f32 v64, v64
    v_exp_f32 v65, v65
    v_mfma_f32_32x32x8_bf16 v[34:49], a[246:247], v[108:109], 0
    v_exp_f32 v18, v18
    v_exp_f32 v19, v19
    v_exp_f32 v20, v20
    v_exp_f32 v21, v21
    v_exp_f32 v22, v22
    v_exp_f32 v23, v23
    v_mfma_f32_32x32x16_bf16 v[34:49], a[240:243], v[102:105], v[34:49]
    ds_read2st64_b64 a[244:247], v121 offset0:64 offset1:65
    ds_read_b128 a[240:243], v118 offset:30720
    ds_read_b64_tr_b16 v[140:141], v185 offset:1344
    ds_read_b64_tr_b16 v[142:143], v185 offset:96
    v_exp_f32 v24, v24
    v_exp_f32 v25, v25
    v_exp_f32 v26, v26
    v_smfmac_f32_32x32x32_bf16 v[82:97], a[248:251], v[50:57], v253
    s_add_u32 s10, s10, 4231168
    s_mul_i32 s27, s100, 20480
    ds_read_b128 a[248:251], v120 offset:26112
    ds_read_b64_tr_b16 v[144:145], v185 offset:1376
    ds_read_b64_tr_b16 v[146:147], v185 offset:128
    v_exp_f32 v27, v27
    v_exp_f32 v28, v28
    v_exp_f32 v29, v29
    v_smfmac_f32_32x32x32_bf16 v[82:97], a[252:255], v[58:65], v253
    s_waitcnt vmcnt(0) lgkmcnt(5)
    ds_read_b128 a[252:255], v120 offset:26880
    ds_read_b64_tr_b16 v[148:149], v185 offset:1408
    v_exp_f32 v30, v30
    v_exp_f32 v31, v31
    v_exp_f32 v32, v32
    v_exp_f32 v33, v33
    v_mfma_f32_32x32x8_bf16 v[50:65], a[244:245], v[106:107], 0
    s_barrier
    v_exp_f32 v34, v34
    v_exp_f32 v35, v35
    v_exp_f32 v36, v36
    v_exp_f32 v37, v37
    v_mfma_f32_32x32x16_bf16 v[50:65], a[240:243], v[98:101], v[50:65]
    s_waitcnt lgkmcnt(2)
    ds_read_b64_tr_b16 v[150:151], v186 offset:2560
    ds_read_b64_tr_b16 v[152:153], v186 offset:5760
    v_exp_f32 v38, v38
    v_exp_f32 v39, v39
    v_exp_f32 v40, v40
    v_exp_f32 v41, v41
    v_smfmac_f32_32x32x32_bf16 v[66:81], a[248:251], v[18:25], v253
    s_waitcnt lgkmcnt(2)
    s_mul_i32 s99, s85, 12288
    s_sub_u32 s27, s27, s99
    ds_read_b64_tr_b16 v[154:155], v187 offset:2688
    v_exp_f32 v42, v42
    v_exp_f32 v43, v43
    v_exp_f32 v44, v44
    v_exp_f32 v45, v45
    v_smfmac_f32_32x32x32_bf16 v[66:81], a[252:255], v[26:33], v253
    ds_read_b64_tr_b16 v[156:157], v187 offset:5888
    v_exp_f32 v46, v46
    v_exp_f32 v47, v47
    v_exp_f32 v48, v48
    v_exp_f32 v49, v49
    v_mfma_f32_32x32x8_bf16 v[18:33], a[244:245], v[108:109], 0
    v_exp_f32 v50, v50
    v_exp_f32 v51, v51
    v_exp_f32 v52, v52
    v_exp_f32 v53, v53
    v_exp_f32 v54, v54
    v_mfma_f32_32x32x16_bf16 v[18:33], a[240:243], v[102:105], v[18:33]
    s_add_u32 m0, s21, 139264
    ds_read_b128 a[240:243], v118 offset:31744
    v_exp_f32 v55, v55
    v_exp_f32 v56, v56
    v_exp_f32 v57, v57
    v_exp_f32 v58, v58
    v_smfmac_f32_32x32x32_bf16 v[82:97], a[248:251], v[34:41], v253
    s_add_u32 s68, s64, 311296
    s_addc_u32 s69, s65, 0
    ds_read_b128 a[248:251], v120 offset:30720
    global_load_lds_dwordx4 v119, s[68:69] offset:0 sc1
    v_exp_f32 v59, v59
    v_exp_f32 v60, v60
    v_exp_f32 v61, v61
    v_smfmac_f32_32x32x32_bf16 v[82:97], a[252:255], v[42:49], v253
    s_waitcnt lgkmcnt(1)
    s_add_u32 s27, s27, 1609728
    s_mul_i32 s99, s100, 171
    ds_read_b128 a[252:255], v120 offset:31488
    global_load_lds_dwordx4 v119, s[68:69] offset:1024 sc1
    v_exp_f32 v62, v62
    v_exp_f32 v63, v63
    v_exp_f32 v64, v64
    v_exp_f32 v65, v65
    v_mfma_f32_32x32x8_bf16 v[34:49], a[246:247], v[106:107], 0
    v_exp_f32 v18, v18
    v_exp_f32 v19, v19
    v_exp_f32 v20, v20
    v_exp_f32 v21, v21
    v_exp_f32 v22, v22
    v_mfma_f32_32x32x16_bf16 v[34:49], a[240:243], v[98:101], v[34:49]
    s_waitcnt lgkmcnt(1)
    s_lshr_b32 s99, s99, 10
    v_exp_f32 v23, v23
    v_exp_f32 v24, v24
    v_exp_f32 v25, v25
    v_exp_f32 v26, v26
    v_exp_f32 v27, v27
    v_smfmac_f32_32x32x32_bf16 v[66:81], a[248:251], v[50:57], v253
    s_waitcnt lgkmcnt(0)
    s_lshl_b32 s99, s99, 11
    global_load_lds_dwordx4 v119, s[68:69] offset:2048 sc1
    v_exp_f32 v28, v28
    v_exp_f32 v29, v29
    v_exp_f32 v30, v30
    v_smfmac_f32_32x32x32_bf16 v[66:81], a[252:255], v[58:65], v253
    buffer_store_dwordx4 v[130:133], v110, s[64:67], s53 offen offset:0 sc1
    v_exp_f32 v31, v31
    v_exp_f32 v32, v32
    v_exp_f32 v33, v33
    v_mfma_f32_32x32x8_bf16 v[50:65], a[246:247], v[108:109], 0
    v_exp_f32 v34, v34
    v_exp_f32 v35, v35
    v_exp_f32 v36, v36
    v_exp_f32 v37, v37
    v_exp_f32 v38, v38
    v_mfma_f32_32x32x16_bf16 v[50:65], a[240:243], v[102:105], v[50:65]
    ds_read2st64_b64 a[244:247], v121 offset0:4 offset1:5
    ds_read_b128 a[240:243], v118 offset:0
    v_exp_f32 v39, v39
    v_exp_f32 v40, v40
    v_exp_f32 v41, v41
    v_exp_f32 v42, v42
    v_smfmac_f32_32x32x32_bf16 v[82:97], a[248:251], v[18:25], v253
    s_add_u32 s9, s99, 114688
    s_lshl_b32 s99, s87, 10
    ds_read_b128 a[248:251], v120 offset:32256
    buffer_store_dwordx4 v[134:137], v110, s[64:67], s53 offen offset:1024 sc1
    v_exp_f32 v43, v43
    v_exp_f32 v44, v44
    v_exp_f32 v45, v45
    v_smfmac_f32_32x32x32_bf16 v[82:97], a[252:255], v[26:33], v253
    s_waitcnt lgkmcnt(1)
    ds_read_b128 a[252:255], v120 offset:33024
    buffer_store_dwordx4 v[138:141], v110, s[64:67], s53 offen offset:2048 sc1
    v_exp_f32 v46, v46
    v_exp_f32 v47, v47
    v_exp_f32 v48, v48
    v_exp_f32 v49, v49
    v_mfma_f32_32x32x8_bf16 v[18:33], a[244:245], v[106:107], 0
    v_exp_f32 v50, v50
    v_exp_f32 v51, v51
    v_exp_f32 v52, v52
    v_exp_f32 v53, v53
    v_exp_f32 v54, v54
    v_mfma_f32_32x32x16_bf16 v[18:33], a[240:243], v[98:101], v[18:33]
    s_waitcnt lgkmcnt(1)
    buffer_store_dwordx4 v[142:145], v110, s[64:67], s53 offen offset:3072 sc1
    v_exp_f32 v55, v55
    v_exp_f32 v56, v56
    v_exp_f32 v57, v57
    v_exp_f32 v58, v58
    v_smfmac_f32_32x32x32_bf16 v[66:81], a[248:251], v[34:41], v253
    s_waitcnt lgkmcnt(0)
    s_add_u32 s53, s53, 4096
    s_add_u32 s99, s99, 163840
    s_lshl_b32 s95, s85, 9
    v_exp_f32 v59, v59
    v_exp_f32 v60, v60
    v_exp_f32 v61, v61
    v_exp_f32 v62, v62
    v_smfmac_f32_32x32x32_bf16 v[66:81], a[252:255], v[42:49], v253
    buffer_store_dwordx4 v[146:149], v110, s[64:67], s53 offen offset:0 sc1
    v_exp_f32 v63, v63
    v_exp_f32 v64, v64
    v_exp_f32 v65, v65
    v_mfma_f32_32x32x8_bf16 v[34:49], a[244:245], v[108:109], 0
    v_exp_f32 v18, v18
    v_exp_f32 v19, v19
    v_exp_f32 v20, v20
    v_exp_f32 v21, v21
    v_exp_f32 v22, v22
    v_mfma_f32_32x32x16_bf16 v[34:49], a[240:243], v[102:105], v[34:49]
    ds_read_b128 a[240:243], v118 offset:1024
    v_exp_f32 v23, v23
    v_exp_f32 v24, v24
    v_exp_f32 v25, v25
    v_exp_f32 v26, v26
    v_smfmac_f32_32x32x32_bf16 v[82:97], a[248:251], v[50:57], v253
    s_add_u32 s26, s99, s95
    s_lshl_b32 s95, s88, 7
    ds_read_b128 a[248:251], v120 offset:0
    buffer_store_dwordx4 v[150:153], v188, s[64:67], s35 offen offset:0 sc1
    v_exp_f32 v27, v27
    v_exp_f32 v28, v28
    v_exp_f32 v29, v29
    v_smfmac_f32_32x32x32_bf16 v[82:97], a[252:255], v[58:65], v253
    s_waitcnt lgkmcnt(1)
    s_add_u32 s35, s35, 4096
    ds_read_b128 a[252:255], v120 offset:768
    buffer_store_dwordx4 v[154:157], v189, s[64:67], s35 offen offset:0 sc1
    v_exp_f32 v30, v30
    v_exp_f32 v31, v31
    v_exp_f32 v32, v32
    v_exp_f32 v33, v33
    v_mfma_f32_32x32x8_bf16 v[50:65], a[246:247], v[106:107], 0
    v_exp_f32 v34, v34
    v_exp_f32 v35, v35
    v_exp_f32 v36, v36
    v_exp_f32 v37, v37
    v_mfma_f32_32x32x16_bf16 v[50:65], a[240:243], v[98:101], v[50:65]
    s_waitcnt lgkmcnt(1)
    v_exp_f32 v38, v38
    v_exp_f32 v39, v39
    v_exp_f32 v40, v40
    v_exp_f32 v41, v41
    v_smfmac_f32_32x32x32_bf16 v[66:81], a[248:251], v[18:25], v253
    s_waitcnt lgkmcnt(0)
    s_add_u32 s25, s99, s95
    v_exp_f32 v42, v42
    v_exp_f32 v43, v43
    v_exp_f32 v44, v44
    v_exp_f32 v45, v45
    v_smfmac_f32_32x32x32_bf16 v[66:81], a[252:255], v[26:33], v253
    s_cmp_eq_u32 s84, 0
    s_cselect_b32 s25, s25, 2130706432
    v_exp_f32 v46, v46
    v_exp_f32 v47, v47
    v_exp_f32 v48, v48
    v_exp_f32 v49, v49
    v_mfma_f32_32x32x8_bf16 v[18:33], a[246:247], v[108:109], 0
    v_exp_f32 v50, v50
    v_exp_f32 v51, v51
    v_exp_f32 v52, v52
    v_exp_f32 v53, v53
    v_exp_f32 v54, v54
    v_mfma_f32_32x32x16_bf16 v[18:33], a[240:243], v[102:105], v[18:33]
    ds_read2st64_b64 a[244:247], v121 offset0:16 offset1:17
    ds_read_b128 a[240:243], v118 offset:6144
    v_exp_f32 v55, v55
    v_exp_f32 v56, v56
    v_exp_f32 v57, v57
    v_exp_f32 v58, v58
    v_smfmac_f32_32x32x32_bf16 v[82:97], a[248:251], v[34:41], v253
    s_lshl_b32 s99, s87, 1
    s_add_u32 s99, s99, s85
    ds_read_b128 a[248:251], v120 offset:1536
    v_exp_f32 v59, v59
    v_exp_f32 v60, v60
    v_exp_f32 v61, v61
    v_exp_f32 v62, v62
    v_smfmac_f32_32x32x32_bf16 v[82:97], a[252:255], v[42:49], v253
    s_waitcnt lgkmcnt(1)
    s_add_u32 s93, s43, 0
    ds_read_b128 a[252:255], v120 offset:2304
    buffer_load_dword v252, v128, s[72:75], s93 offen
    v_exp_f32 v63, v63
    v_exp_f32 v64, v64
    v_exp_f32 v65, v65
    v_mfma_f32_32x32x8_bf16 v[34:49], a[244:245], v[106:107], 0
    v_exp_f32 v18, v18
    v_exp_f32 v19, v19
    v_exp_f32 v20, v20
    v_exp_f32 v21, v21
    v_exp_f32 v22, v22
    v_mfma_f32_32x32x16_bf16 v[34:49], a[240:243], v[98:101], v[34:49]
    s_waitcnt lgkmcnt(1)
    v_exp_f32 v23, v23
    v_exp_f32 v24, v24
    v_exp_f32 v25, v25
    v_exp_f32 v26, v26
    v_smfmac_f32_32x32x32_bf16 v[66:81], a[248:251], v[50:57], v253
    s_waitcnt vmcnt(8) lgkmcnt(0)
    s_lshl_b32 s100, s88, 1
    s_add_u32 s100, s100, s86
    s_barrier
    v_exp_f32 v27, v27
    v_exp_f32 v28, v28
    v_exp_f32 v29, v29
    v_smfmac_f32_32x32x32_bf16 v[66:81], a[252:255], v[58:65], v253
    v_exp_f32 v30, v30
    v_exp_f32 v31, v31
    v_exp_f32 v32, v32
    v_exp_f32 v33, v33
    v_mfma_f32_32x32x8_bf16 v[50:65], a[244:245], v[108:109], 0
    v_exp_f32 v34, v34
    v_exp_f32 v35, v35
    v_exp_f32 v36, v36
    v_exp_f32 v37, v37
    v_exp_f32 v38, v38
    v_mfma_f32_32x32x16_bf16 v[50:65], a[240:243], v[102:105], v[50:65]
    s_add_u32 m0, s21, 151552
    ds_read_b128 a[240:243], v118 offset:7168
    v_exp_f32 v39, v39
    v_exp_f32 v40, v40
    v_exp_f32 v41, v41
    v_exp_f32 v42, v42
    v_smfmac_f32_32x32x32_bf16 v[82:97], a[248:251], v[18:25], v253
    s_add_u32 s68, s64, 323584
    s_addc_u32 s69, s65, 0
    ds_read_b128 a[248:251], v120 offset:6144
    global_load_lds_dwordx4 v119, s[68:69] offset:0 sc1
    v_exp_f32 v43, v43
    v_exp_f32 v44, v44
    v_exp_f32 v45, v45
    v_smfmac_f32_32x32x32_bf16 v[82:97], a[252:255], v[26:33], v253
    s_waitcnt lgkmcnt(1)
    s_mul_i32 s99, s99, 40960
    s_add_u32 s99, s99, 1605632
    ds_read_b128 a[252:255], v120 offset:6912
    global_load_lds_dwordx4 v119, s[68:69] offset:1024 sc1
    v_exp_f32 v46, v46
    v_exp_f32 v47, v47
    v_exp_f32 v48, v48
    v_exp_f32 v49, v49
    v_mfma_f32_32x32x8_bf16 v[18:33], a[246:247], v[106:107], 0
    v_exp_f32 v50, v50
    v_exp_f32 v51, v51
    v_exp_f32 v52, v52
    v_exp_f32 v53, v53
    v_exp_f32 v54, v54
    v_mfma_f32_32x32x16_bf16 v[18:33], a[240:243], v[98:101], v[18:33]
    s_waitcnt lgkmcnt(1)
    v_exp_f32 v55, v55
    v_exp_f32 v56, v56
    v_exp_f32 v57, v57
    v_exp_f32 v58, v58
    v_smfmac_f32_32x32x32_bf16 v[66:81], a[248:251], v[34:41], v253
    s_waitcnt lgkmcnt(0)
    s_lshl_b32 s11, s100, 10
    s_add_u32 s11, s11, s99
    v_exp_f32 v59, v59
    v_exp_f32 v60, v60
    v_exp_f32 v61, v61
    v_exp_f32 v62, v62
    v_smfmac_f32_32x32x32_bf16 v[66:81], a[252:255], v[42:49], v253
    global_load_lds_dwordx4 v119, s[68:69] offset:2048 sc1
    v_exp_f32 v63, v63
    v_exp_f32 v64, v64
    v_exp_f32 v65, v65
    v_mfma_f32_32x32x8_bf16 v[34:49], a[246:247], v[108:109], 0
    v_exp_f32 v18, v18
    v_exp_f32 v19, v19
    v_exp_f32 v20, v20
    v_exp_f32 v21, v21
    v_exp_f32 v22, v22
    v_mfma_f32_32x32x16_bf16 v[34:49], a[240:243], v[102:105], v[34:49]
    ds_read2st64_b64 a[244:247], v121 offset0:28 offset1:29
    ds_read_b128 a[240:243], v118 offset:12288
    v_exp_f32 v23, v23
    v_exp_f32 v24, v24
    v_exp_f32 v25, v25
    v_exp_f32 v26, v26
    v_smfmac_f32_32x32x32_bf16 v[82:97], a[248:251], v[50:57], v253
    s_lshl_b32 s24, s100, 8
    s_add_u32 s24, s24, s99
    ds_read_b128 a[248:251], v120 offset:7680
    v_exp_f32 v27, v27
    v_exp_f32 v28, v28
    v_exp_f32 v29, v29
    v_smfmac_f32_32x32x32_bf16 v[82:97], a[252:255], v[58:65], v253
    s_waitcnt lgkmcnt(1)
    ds_read_b128 a[252:255], v120 offset:8448
    v_exp_f32 v30, v30
    v_exp_f32 v31, v31
    v_exp_f32 v32, v32
    v_exp_f32 v33, v33
    v_mfma_f32_32x32x8_bf16 v[50:65], a[244:245], v[106:107], 0
    v_exp_f32 v34, v34
    v_exp_f32 v35, v35
    v_exp_f32 v36, v36
    v_exp_f32 v37, v37
    v_add_u32 v245, s28, v245
    v_add_u32 v246, s28, v246
    v_mfma_f32_32x32x16_bf16 v[50:65], a[240:243], v[98:101], v[50:65]
    s_waitcnt lgkmcnt(1)
    v_exp_f32 v38, v38
    v_exp_f32 v39, v39
    v_exp_f32 v40, v40
    v_exp_f32 v41, v41
    v_add_u32 v247, s28, v247
    v_smfmac_f32_32x32x32_bf16 v[66:81], a[248:251], v[18:25], v253
    s_waitcnt lgkmcnt(0)
    s_add_u32 s24, s24, 16384
    s_mov_b32 s82, 10485760
    v_exp_f32 v42, v42
    v_exp_f32 v43, v43
    v_exp_f32 v44, v44
    v_exp_f32 v45, v45
    v_add_u32 v240, s29, v240
    v_smfmac_f32_32x32x32_bf16 v[66:81], a[252:255], v[26:33], v253
    v_exp_f32 v46, v46
    v_exp_f32 v47, v47
    v_exp_f32 v48, v48
    v_exp_f32 v49, v49
    v_add_u32 v241, s29, v241
    v_mfma_f32_32x32x8_bf16 v[18:33], a[244:245], v[108:109], 0
    v_exp_f32 v50, v50
    v_exp_f32 v51, v51
    v_exp_f32 v52, v52
    v_exp_f32 v53, v53
    v_exp_f32 v54, v54
    v_mfma_f32_32x32x16_bf16 v[18:33], a[240:243], v[102:105], v[18:33]
    ds_read_b128 a[240:243], v118 offset:13312
    v_exp_f32 v55, v55
    v_exp_f32 v56, v56
    v_exp_f32 v57, v57
    v_exp_f32 v58, v58
    v_smfmac_f32_32x32x32_bf16 v[82:97], a[248:251], v[34:41], v253
    s_mov_b32 s83, 0x00020000
    s_lshl_b32 s99, s91, 1
    ds_read_b128 a[248:251], v120 offset:12288
    v_exp_f32 v59, v59
    v_exp_f32 v60, v60
    v_exp_f32 v61, v61
    v_exp_f32 v62, v62
    v_smfmac_f32_32x32x32_bf16 v[82:97], a[252:255], v[42:49], v253
    s_waitcnt lgkmcnt(1)
    ds_read_b128 a[252:255], v120 offset:13056
    global_load_dwordx2 v[178:179], v245, s[14:15] offset:0
    v_exp_f32 v63, v63
    v_exp_f32 v64, v64
    v_exp_f32 v65, v65
    v_mfma_f32_32x32x8_bf16 v[34:49], a[246:247], v[106:107], 0
    v_exp_f32 v18, v18
    v_exp_f32 v19, v19
    v_exp_f32 v20, v20
    v_exp_f32 v21, v21
    v_exp_f32 v22, v22
    v_mfma_f32_32x32x16_bf16 v[34:49], a[240:243], v[98:101], v[34:49]
    s_waitcnt lgkmcnt(1)
    v_exp_f32 v23, v23
    v_exp_f32 v24, v24
    v_exp_f32 v25, v25
    v_exp_f32 v26, v26
    v_smfmac_f32_32x32x32_bf16 v[66:81], a[248:251], v[50:57], v253
    s_waitcnt lgkmcnt(0)
    s_add_u32 s99, s99, s92
    s_add_u32 s100, s99, s28
    v_exp_f32 v27, v27
    v_exp_f32 v28, v28
    v_exp_f32 v29, v29
    v_exp_f32 v30, v30
    v_smfmac_f32_32x32x32_bf16 v[66:81], a[252:255], v[58:65], v253
    global_load_dwordx2 v[180:181], v246, s[14:15] offset:0
    v_exp_f32 v31, v31
    v_exp_f32 v32, v32
    v_exp_f32 v33, v33
    v_mfma_f32_32x32x8_bf16 v[50:65], a[246:247], v[108:109], 0
    v_exp_f32 v34, v34
    v_exp_f32 v35, v35
    v_exp_f32 v36, v36
    v_exp_f32 v37, v37
    v_exp_f32 v38, v38
    v_mfma_f32_32x32x16_bf16 v[50:65], a[240:243], v[102:105], v[50:65]
    ds_read2st64_b64 a[244:247], v121 offset0:40 offset1:41
    ds_read_b128 a[240:243], v118 offset:18432
    v_exp_f32 v39, v39
    v_exp_f32 v40, v40
    v_exp_f32 v41, v41
    v_exp_f32 v42, v42
    v_smfmac_f32_32x32x32_bf16 v[82:97], a[248:251], v[18:25], v253
    s_lshl_b32 s16, s100, 1
    s_add_u32 s17, s16, 40960
    ds_read_b128 a[248:251], v120 offset:13824
    v_exp_f32 v43, v43
    v_exp_f32 v44, v44
    v_exp_f32 v45, v45
    v_exp_f32 v46, v46
    v_smfmac_f32_32x32x32_bf16 v[82:97], a[252:255], v[26:33], v253
    s_waitcnt lgkmcnt(1)
    ds_read_b128 a[252:255], v120 offset:14592
    global_load_dwordx2 v[182:183], v240, s[14:15] offset:0
    v_exp_f32 v47, v47
    v_exp_f32 v48, v48
    v_exp_f32 v49, v49
    v_mfma_f32_32x32x8_bf16 v[18:33], a[244:245], v[106:107], 0
    v_exp_f32 v50, v50
    v_exp_f32 v51, v51
    v_exp_f32 v52, v52
    v_exp_f32 v53, v53
    v_exp_f32 v54, v54
    v_mfma_f32_32x32x16_bf16 v[18:33], a[240:243], v[98:101], v[18:33]
    s_waitcnt lgkmcnt(1)
    v_exp_f32 v55, v55
    v_exp_f32 v56, v56
    v_exp_f32 v57, v57
    v_exp_f32 v58, v58
    v_smfmac_f32_32x32x32_bf16 v[66:81], a[248:251], v[34:41], v253
    s_waitcnt vmcnt(3) lgkmcnt(0)
    s_add_u32 s100, s99, s29
    s_lshl_b32 s40, s100, 1
    s_barrier
    v_exp_f32 v59, v59
    v_exp_f32 v60, v60
    v_exp_f32 v61, v61
    v_smfmac_f32_32x32x32_bf16 v[66:81], a[252:255], v[42:49], v253
    global_load_dwordx2 v[184:185], v245, s[14:15] offset:64
    v_exp_f32 v62, v62
    v_exp_f32 v63, v63
    v_exp_f32 v64, v64
    v_exp_f32 v65, v65
    v_mfma_f32_32x32x8_bf16 v[34:49], a[244:245], v[108:109], 0
    v_exp_f32 v18, v18
    v_exp_f32 v19, v19
    v_exp_f32 v20, v20
    v_exp_f32 v21, v21
    v_exp_f32 v22, v22
    v_mfma_f32_32x32x16_bf16 v[34:49], a[240:243], v[102:105], v[34:49]
    ds_read_b128 a[240:243], v118 offset:19456
    global_load_dwordx2 v[186:187], v246, s[14:15] offset:64
    v_exp_f32 v23, v23
    v_exp_f32 v24, v24
    v_exp_f32 v25, v25
    v_exp_f32 v26, v26
    v_smfmac_f32_32x32x32_bf16 v[82:97], a[248:251], v[50:57], v253
    s_add_u32 m0, s21, 126976
    ds_read_b128 a[248:251], v120 offset:18432
    v_exp_f32 v27, v27
    v_exp_f32 v28, v28
    v_exp_f32 v29, v29
    v_exp_f32 v30, v30
    v_smfmac_f32_32x32x32_bf16 v[82:97], a[252:255], v[58:65], v253
    s_waitcnt lgkmcnt(1)
    s_add_u32 s68, s64, 335872
    s_addc_u32 s69, s65, 0
    ds_read_b128 a[252:255], v120 offset:19200
    global_load_lds_dwordx4 v119, s[68:69] offset:0 sc1
    v_exp_f32 v31, v31
    v_exp_f32 v32, v32
    v_exp_f32 v33, v33
    v_mfma_f32_32x32x8_bf16 v[50:65], a[246:247], v[106:107], 0
    v_exp_f32 v34, v34
    v_exp_f32 v35, v35
    v_exp_f32 v36, v36
    v_exp_f32 v37, v37
    v_exp_f32 v38, v38
    v_mfma_f32_32x32x16_bf16 v[50:65], a[240:243], v[98:101], v[50:65]
    s_waitcnt lgkmcnt(1)
    global_load_lds_dwordx4 v119, s[68:69] offset:1024 sc1
    v_exp_f32 v39, v39
    v_exp_f32 v40, v40
    v_exp_f32 v41, v41
    v_exp_f32 v42, v42
    v_smfmac_f32_32x32x32_bf16 v[66:81], a[248:251], v[18:25], v253
    s_waitcnt lgkmcnt(0)
    global_load_lds_dwordx4 v119, s[68:69] offset:2048 sc1
    v_exp_f32 v43, v43
    v_exp_f32 v44, v44
    v_exp_f32 v45, v45
    v_smfmac_f32_32x32x32_bf16 v[66:81], a[252:255], v[26:33], v253
    buffer_store_dword v254, v254, s[64:67], s36 offen sc1
    v_exp_f32 v46, v46
    v_exp_f32 v47, v47
    v_exp_f32 v48, v48
    v_exp_f32 v49, v49
    v_mfma_f32_32x32x8_bf16 v[18:33], a[246:247], v[108:109], 0
    v_exp_f32 v50, v50
    v_exp_f32 v51, v51
    v_exp_f32 v52, v52
    v_exp_f32 v53, v53
    v_exp_f32 v54, v54
    v_mfma_f32_32x32x16_bf16 v[18:33], a[240:243], v[102:105], v[18:33]
    ds_read2st64_b64 a[244:247], v121 offset0:52 offset1:53
    ds_read_b128 a[240:243], v118 offset:24576
    v_exp_f32 v55, v55
    v_exp_f32 v56, v56
    v_exp_f32 v57, v57
    v_exp_f32 v58, v58
    v_smfmac_f32_32x32x32_bf16 v[82:97], a[248:251], v[34:41], v253
    ds_read_b128 a[248:251], v120 offset:19968
    v_exp_f32 v59, v59
    v_exp_f32 v60, v60
    v_exp_f32 v61, v61
    v_exp_f32 v62, v62
    v_smfmac_f32_32x32x32_bf16 v[82:97], a[252:255], v[42:49], v253
    s_waitcnt lgkmcnt(1)
    ds_read_b128 a[252:255], v120 offset:20736
    global_load_dwordx2 v[188:189], v247, s[30:31] offset:0
    v_exp_f32 v63, v63
    v_exp_f32 v64, v64
    v_exp_f32 v65, v65
    v_mfma_f32_32x32x8_bf16 v[34:49], a[244:245], v[106:107], 0
    v_exp_f32 v18, v18
    v_exp_f32 v19, v19
    v_exp_f32 v20, v20
    v_exp_f32 v21, v21
    v_exp_f32 v22, v22
    v_mfma_f32_32x32x16_bf16 v[34:49], a[240:243], v[98:101], v[34:49]
    s_waitcnt lgkmcnt(1)
    v_exp_f32 v23, v23
    v_exp_f32 v24, v24
    v_exp_f32 v25, v25
    v_exp_f32 v26, v26
    v_smfmac_f32_32x32x32_bf16 v[66:81], a[248:251], v[50:57], v253
    s_waitcnt lgkmcnt(0)
    v_exp_f32 v27, v27
    v_exp_f32 v28, v28
    v_exp_f32 v29, v29
    v_exp_f32 v30, v30
    v_smfmac_f32_32x32x32_bf16 v[66:81], a[252:255], v[58:65], v253
    global_load_dwordx2 v[190:191], v241, s[30:31] offset:0
    v_exp_f32 v31, v31
    v_exp_f32 v32, v32
    v_exp_f32 v33, v33
    v_mfma_f32_32x32x8_bf16 v[50:65], a[244:245], v[108:109], 0
    v_exp_f32 v34, v34
    v_exp_f32 v35, v35
    v_exp_f32 v36, v36
    v_exp_f32 v37, v37
    v_exp_f32 v38, v38
    v_mfma_f32_32x32x16_bf16 v[50:65], a[240:243], v[102:105], v[50:65]
L_pad_p1:
    s_cmp_eq_u32 s37, 1
    s_cbranch_scc1 L_ret_p
    ds_read_b128 a[240:243], v118 offset:25600
    v_exp_f32 v39, v39
    v_exp_f32 v40, v40
    v_exp_f32 v41, v41
    v_exp_f32 v42, v42
    v_smfmac_f32_32x32x32_bf16 v[82:97], a[248:251], v[18:25], v253
    ds_read_b128 a[248:251], v120 offset:24576
    global_load_dwordx2 v[192:193], v247, s[30:31] offset:64
    v_exp_f32 v43, v43
    v_exp_f32 v44, v44
    v_exp_f32 v45, v45
    v_smfmac_f32_32x32x32_bf16 v[82:97], a[252:255], v[26:33], v253
    s_waitcnt lgkmcnt(1)
    s_add_u32 s93, s43, 2048
    ds_read_b128 a[252:255], v120 offset:25344
    buffer_load_dword v252, v128, s[72:75], s93 offen
    v_exp_f32 v46, v46
    v_exp_f32 v47, v47
    v_exp_f32 v48, v48
    v_exp_f32 v49, v49
    v_mfma_f32_32x32x8_bf16 v[18:33], a[246:247], v[106:107], 0
    v_exp_f32 v50, v50
    v_exp_f32 v51, v51
    v_exp_f32 v52, v52
    v_exp_f32 v53, v53
    v_mfma_f32_32x32x16_bf16 v[18:33], a[240:243], v[98:101], v[18:33]
    s_waitcnt lgkmcnt(1)
    v_exp_f32 v54, v54
    v_exp_f32 v55, v55
    v_exp_f32 v56, v56
    v_exp_f32 v57, v57
    v_smfmac_f32_32x32x32_bf16 v[66:81], a[248:251], v[34:41], v253
    s_waitcnt lgkmcnt(0)
    v_exp_f32 v58, v58
    v_exp_f32 v59, v59
    v_exp_f32 v60, v60
    v_exp_f32 v61, v61
    v_smfmac_f32_32x32x32_bf16 v[66:81], a[252:255], v[42:49], v253
    v_exp_f32 v62, v62
    v_exp_f32 v63, v63
    v_exp_f32 v64, v64
    v_exp_f32 v65, v65
    v_mfma_f32_32x32x8_bf16 v[34:49], a[246:247], v[108:109], 0
    v_exp_f32 v18, v18
    v_exp_f32 v19, v19
    v_exp_f32 v20, v20
    v_exp_f32 v21, v21
    v_exp_f32 v22, v22
    v_mfma_f32_32x32x16_bf16 v[34:49], a[240:243], v[102:105], v[34:49]
    ds_read2st64_b64 a[244:247], v121 offset0:64 offset1:65
    ds_read_b128 a[240:243], v118 offset:30720
    v_exp_f32 v23, v23
    v_exp_f32 v24, v24
    v_exp_f32 v25, v25
    v_exp_f32 v26, v26
    v_smfmac_f32_32x32x32_bf16 v[82:97], a[248:251], v[50:57], v253
    ds_read_b128 a[248:251], v120 offset:26112
    v_exp_f32 v27, v27
    v_exp_f32 v28, v28
    v_exp_f32 v29, v29
    v_exp_f32 v30, v30
    v_smfmac_f32_32x32x32_bf16 v[82:97], a[252:255], v[58:65], v253
    s_waitcnt lgkmcnt(1)
    s_add_u32 s93, s43, 4096
    ds_read_b128 a[252:255], v120 offset:26880
    buffer_load_dword v252, v128, s[72:75], s93 offen
    v_exp_f32 v31, v31
    v_exp_f32 v32, v32
    v_exp_f32 v33, v33
    v_mfma_f32_32x32x8_bf16 v[50:65], a[244:245], v[106:107], 0
    v_exp_f32 v34, v34
    v_exp_f32 v35, v35
    v_exp_f32 v36, v36
    v_exp_f32 v37, v37
    v_exp_f32 v38, v38
    v_mfma_f32_32x32x16_bf16 v[50:65], a[240:243], v[98:101], v[50:65]
    s_waitcnt lgkmcnt(1)
    v_exp_f32 v39, v39
    v_exp_f32 v40, v40
    v_exp_f32 v41, v41
    v_exp_f32 v42, v42
    v_smfmac_f32_32x32x32_bf16 v[66:81], a[248:251], v[18:25], v253
    s_waitcnt vmcnt(6) lgkmcnt(0)
    s_barrier
    v_exp_f32 v43, v43
    v_exp_f32 v44, v44
    v_exp_f32 v45, v45
    v_smfmac_f32_32x32x32_bf16 v[66:81], a[252:255], v[26:33], v253
    v_exp_f32 v46, v46
    v_exp_f32 v47, v47
    v_exp_f32 v48, v48
    v_exp_f32 v49, v49
    v_mfma_f32_32x32x8_bf16 v[18:33], a[244:245], v[108:109], 0
    v_exp_f32 v50, v50
    v_exp_f32 v51, v51
    v_exp_f32 v52, v52
    v_exp_f32 v53, v53
    v_exp_f32 v54, v54
    v_mfma_f32_32x32x16_bf16 v[18:33], a[240:243], v[102:105], v[18:33]
    s_add_u32 m0, s21, 139264
    ds_read_b128 a[240:243], v118 offset:31744
    v_exp_f32 v55, v55
    v_exp_f32 v56, v56
    v_exp_f32 v57, v57
    v_exp_f32 v58, v58
    v_smfmac_f32_32x32x32_bf16 v[82:97], a[248:251], v[34:41], v253
    s_add_u32 s68, s64, 348160
    s_addc_u32 s69, s65, 0
    ds_read_b128 a[248:251], v120 offset:30720
    global_load_lds_dwordx4 v119, s[68:69] offset:0 sc1
    v_exp_f32 v59, v59
    v_exp_f32 v60, v60
    v_exp_f32 v61, v61
    v_smfmac_f32_32x32x32_bf16 v[82:97], a[252:255], v[42:49], v253
    s_waitcnt lgkmcnt(1)
    ds_read_b128 a[252:255], v120 offset:31488
    global_load_lds_dwordx4 v119, s[68:69] offset:1024 sc1
    v_exp_f32 v62, v62
    v_exp_f32 v63, v63
    v_exp_f32 v64, v64
    v_exp_f32 v65, v65
    v_mfma_f32_32x32x8_bf16 v[34:49], a[246:247], v[106:107], 0
    v_exp_f32 v18, v18
    v_exp_f32 v19, v19
    v_exp_f32 v20, v20
    v_exp_f32 v21, v21
    v_exp_f32 v22, v22
    v_mfma_f32_32x32x16_bf16 v[34:49], a[240:243], v[98:101], v[34:49]
    s_waitcnt lgkmcnt(1)
    v_exp_f32 v23, v23
    v_exp_f32 v24, v24
    v_exp_f32 v25, v25
    v_exp_f32 v26, v26
    v_exp_f32 v27, v27
    v_smfmac_f32_32x32x32_bf16 v[66:81], a[248:251], v[50:57], v253
    s_waitcnt lgkmcnt(0)
    global_load_lds_dwordx4 v119, s[68:69] offset:2048 sc1
    v_exp_f32 v28, v28
    v_exp_f32 v29, v29
    v_exp_f32 v30, v30
    v_smfmac_f32_32x32x32_bf16 v[66:81], a[252:255], v[58:65], v253
    buffer_load_dword v116, v242, s[64:67], s42 offen sc1
    v_exp_f32 v31, v31
    v_exp_f32 v32, v32
    v_exp_f32 v33, v33
    v_mfma_f32_32x32x8_bf16 v[50:65], a[246:247], v[108:109], 0
    v_exp_f32 v34, v34
    v_exp_f32 v35, v35
    v_exp_f32 v36, v36
    v_exp_f32 v37, v37
    v_exp_f32 v38, v38
    v_mfma_f32_32x32x16_bf16 v[50:65], a[240:243], v[102:105], v[50:65]
    ds_read2st64_b64 a[244:247], v121 offset0:4 offset1:5
    ds_read_b128 a[240:243], v118 offset:0
    v_exp_f32 v39, v39
    v_exp_f32 v40, v40
    v_exp_f32 v41, v41
    v_exp_f32 v42, v42
    v_smfmac_f32_32x32x32_bf16 v[82:97], a[248:251], v[18:25], v253
    ds_read_b128 a[248:251], v120 offset:32256
    v_exp_f32 v43, v43
    v_exp_f32 v44, v44
    v_exp_f32 v45, v45
    v_smfmac_f32_32x32x32_bf16 v[82:97], a[252:255], v[26:33], v253
    s_waitcnt lgkmcnt(1)
    ds_read_b128 a[252:255], v120 offset:33024
    v_exp_f32 v46, v46
    v_exp_f32 v47, v47
    v_exp_f32 v48, v48
    v_exp_f32 v49, v49
    v_mfma_f32_32x32x8_bf16 v[18:33], a[244:245], v[106:107], 0
    v_exp_f32 v50, v50
    v_exp_f32 v51, v51
    v_exp_f32 v52, v52
    v_exp_f32 v53, v53
    v_mfma_f32_32x32x16_bf16 v[18:33], a[240:243], v[98:101], v[18:33]
    s_waitcnt lgkmcnt(1)
    v_exp_f32 v54, v54
    v_exp_f32 v55, v55
    v_exp_f32 v56, v56
    v_exp_f32 v57, v57
    v_smfmac_f32_32x32x32_bf16 v[66:81], a[248:251], v[34:41], v253
    s_waitcnt lgkmcnt(0)
    v_exp_f32 v58, v58
    v_exp_f32 v59, v59
    v_exp_f32 v60, v60
    v_exp_f32 v61, v61
    v_smfmac_f32_32x32x32_bf16 v[66:81], a[252:255], v[42:49], v253
    v_exp_f32 v62, v62
    v_exp_f32 v63, v63
    v_exp_f32 v64, v64
    v_exp_f32 v65, v65
    v_mfma_f32_32x32x8_bf16 v[34:49], a[244:245], v[108:109], 0
    v_exp_f32 v18, v18
    v_exp_f32 v19, v19
    v_exp_f32 v20, v20
    v_exp_f32 v21, v21
    v_exp_f32 v22, v22
    v_mfma_f32_32x32x16_bf16 v[34:49], a[240:243], v[102:105], v[34:49]
    ds_read_b128 a[240:243], v118 offset:1024
    v_exp_f32 v23, v23
    v_exp_f32 v24, v24
    v_exp_f32 v25, v25
    v_exp_f32 v26, v26
    v_smfmac_f32_32x32x32_bf16 v[82:97], a[248:251], v[50:57], v253
    ds_read_b128 a[248:251], v120 offset:0
    v_exp_f32 v27, v27
    v_exp_f32 v28, v28
    v_exp_f32 v29, v29
    v_smfmac_f32_32x32x32_bf16 v[82:97], a[252:255], v[58:65], v253
    s_waitcnt vmcnt(0) lgkmcnt(1)
    ds_read_b128 a[252:255], v120 offset:768
    v_exp_f32 v30, v30
    v_exp_f32 v31, v31
    v_exp_f32 v32, v32
    v_exp_f32 v33, v33
    v_mfma_f32_32x32x8_bf16 v[50:65], a[246:247], v[106:107], 0
    v_exp_f32 v34, v34
    v_exp_f32 v35, v35
    v_exp_f32 v36, v36
    v_exp_f32 v37, v37
    v_cmp_eq_u32 vcc, -1, v116
    v_mfma_f32_32x32x16_bf16 v[50:65], a[240:243], v[98:101], v[50:65]
    s_nop 2
    s_cbranch_vccnz L_retry_23
L_ok_24:
    v_exp_f32 v38, v38
    v_exp_f32 v39, v39
    v_exp_f32 v40, v40
    v_exp_f32 v41, v41
    s_waitcnt lgkmcnt(1)
    v_smfmac_f32_32x32x32_bf16 v[66:81], a[248:251], v[18:25], v253
    s_waitcnt lgkmcnt(0)
    v_exp_f32 v42, v42
    v_exp_f32 v43, v43
    v_exp_f32 v44, v44
    v_exp_f32 v45, v45
    v_smfmac_f32_32x32x32_bf16 v[66:81], a[252:255], v[26:33], v253
    v_exp_f32 v46, v46
    v_exp_f32 v47, v47
    v_exp_f32 v48, v48
    v_exp_f32 v49, v49
    v_mfma_f32_32x32x8_bf16 v[18:33], a[246:247], v[108:109], 0
    v_exp_f32 v50, v50
    v_exp_f32 v51, v51
    v_exp_f32 v52, v52
    v_exp_f32 v53, v53
    v_exp_f32 v54, v54
    v_mfma_f32_32x32x16_bf16 v[18:33], a[240:243], v[102:105], v[18:33]
    s_add_u32 m0, s50, 0
    s_add_u32 s76, s32, 384
    s_addc_u32 s77, s33, 0
    ds_read2st64_b64 a[244:247], v121 offset0:16 offset1:17
    ds_read_b128 a[240:243], v118 offset:6144
    global_load_lds_dwordx4 v228, s[76:77] sc0
    v_exp_f32 v55, v55
    v_exp_f32 v56, v56
    v_exp_f32 v57, v57
    v_smfmac_f32_32x32x32_bf16 v[82:97], a[248:251], v[34:41], v253
    s_add_u32 m0, s50, 4096
    s_add_u32 s76, s32, 512
    s_addc_u32 s77, s33, 0
    ds_read_b128 a[248:251], v120 offset:1536
    global_load_lds_dwordx4 v228, s[76:77] sc0
    v_exp_f32 v58, v58
    v_exp_f32 v59, v59
    v_exp_f32 v60, v60
    v_exp_f32 v61, v61
    v_smfmac_f32_32x32x32_bf16 v[82:97], a[252:255], v[42:49], v253
    s_waitcnt lgkmcnt(1)
    s_add_u32 m0, s50, 8192
    s_add_u32 s76, s18, 40960
    s_addc_u32 s77, s19, 0
    ds_read_b128 a[252:255], v120 offset:2304
    global_load_lds_dwordx4 v228, s[76:77] sc0
    v_exp_f32 v62, v62
    v_exp_f32 v63, v63
    v_exp_f32 v64, v64
    v_exp_f32 v65, v65
    v_mfma_f32_32x32x8_bf16 v[34:49], a[244:245], v[106:107], 0
    v_exp_f32 v18, v18
    v_exp_f32 v19, v19
    v_exp_f32 v20, v20
    v_exp_f32 v21, v21
    v_exp_f32 v22, v22
    v_mfma_f32_32x32x16_bf16 v[34:49], a[240:243], v[98:101], v[34:49]
    s_waitcnt lgkmcnt(1)
    s_add_u32 m0, s50, 12288
    s_add_u32 s76, s18, 41088
    s_addc_u32 s77, s19, 0
    global_load_lds_dwordx4 v228, s[76:77] sc0
    v_exp_f32 v23, v23
    v_exp_f32 v24, v24
    v_exp_f32 v25, v25
    v_exp_f32 v26, v26
    v_smfmac_f32_32x32x32_bf16 v[66:81], a[248:251], v[50:57], v253
    s_waitcnt lgkmcnt(0)
    s_add_u32 m0, s50, 16384
    s_add_u32 s76, s18, 41216
    s_addc_u32 s77, s19, 0
    s_barrier
    global_load_lds_dwordx4 v228, s[76:77] sc0
    v_exp_f32 v27, v27
    v_exp_f32 v28, v28
    v_exp_f32 v29, v29
    v_smfmac_f32_32x32x32_bf16 v[66:81], a[252:255], v[58:65], v253
    s_add_u32 s93, s43, 6144
    buffer_load_dword v252, v128, s[72:75], s93 offen
    v_exp_f32 v30, v30
    v_exp_f32 v31, v31
    v_exp_f32 v32, v32
    v_exp_f32 v33, v33
    v_mfma_f32_32x32x8_bf16 v[50:65], a[244:245], v[108:109], 0
    v_exp_f32 v34, v34
    v_exp_f32 v35, v35
    v_exp_f32 v36, v36
    v_exp_f32 v37, v37
    v_exp_f32 v38, v38
    v_mfma_f32_32x32x16_bf16 v[50:65], a[240:243], v[102:105], v[50:65]
    s_add_u32 m0, s5, 40960
    s_add_u32 s70, s44, 40960
    s_addc_u32 s71, s45, 0
    ds_read_b128 a[240:243], v118 offset:7168
    global_load_lds_dwordx4 v232, s[70:71] offset:0 sc1
    v_exp_f32 v39, v39
    v_exp_f32 v40, v40
    v_exp_f32 v41, v41
    v_exp_f32 v42, v42
    v_smfmac_f32_32x32x32_bf16 v[82:97], a[248:251], v[18:25], v253
    ds_read_b128 a[248:251], v120 offset:6144
    global_load_lds_dwordx4 v232, s[70:71] offset:1024 sc1
    v_exp_f32 v43, v43
    v_exp_f32 v44, v44
    v_exp_f32 v45, v45
    v_smfmac_f32_32x32x32_bf16 v[82:97], a[252:255], v[26:33], v253
    s_waitcnt lgkmcnt(1)
    ds_read_b128 a[252:255], v120 offset:6912
    global_load_lds_dwordx4 v232, s[70:71] offset:2048 sc1
    v_exp_f32 v46, v46
    v_exp_f32 v47, v47
    v_exp_f32 v48, v48
    v_exp_f32 v49, v49
    v_mfma_f32_32x32x8_bf16 v[18:33], a[246:247], v[106:107], 0
    v_exp_f32 v50, v50
    v_exp_f32 v51, v51
    v_exp_f32 v52, v52
    v_exp_f32 v53, v53
    v_exp_f32 v54, v54
    v_mfma_f32_32x32x16_bf16 v[18:33], a[240:243], v[98:101], v[18:33]
    s_waitcnt lgkmcnt(1)
    global_load_lds_dwordx4 v232, s[70:71] offset:3072 sc1
    v_exp_f32 v55, v55
    v_exp_f32 v56, v56
    v_exp_f32 v57, v57
    v_exp_f32 v58, v58
    v_smfmac_f32_32x32x32_bf16 v[66:81], a[248:251], v[34:41], v253
    s_waitcnt lgkmcnt(0)
    s_add_u32 m0, s21, 151552
    v_exp_f32 v59, v59
    v_exp_f32 v60, v60
    v_exp_f32 v61, v61
    v_exp_f32 v62, v62
    v_smfmac_f32_32x32x32_bf16 v[66:81], a[252:255], v[42:49], v253
    s_add_u32 s68, s64, 360448
    s_addc_u32 s69, s65, 0
    global_load_lds_dwordx4 v119, s[68:69] offset:0 sc1
    v_exp_f32 v63, v63
    v_exp_f32 v64, v64
    v_exp_f32 v65, v65
    v_mfma_f32_32x32x8_bf16 v[34:49], a[246:247], v[108:109], 0
    global_load_lds_dwordx4 v119, s[68:69] offset:1024 sc1
    v_exp_f32 v18, v18
    v_exp_f32 v19, v19
    v_exp_f32 v20, v20
    v_exp_f32 v21, v21
    v_exp_f32 v22, v22
    v_mfma_f32_32x32x16_bf16 v[34:49], a[240:243], v[102:105], v[34:49]
    ds_read2st64_b64 a[244:247], v121 offset0:28 offset1:29
    ds_read_b128 a[240:243], v118 offset:12288
    global_load_lds_dwordx4 v119, s[68:69] offset:2048 sc1
    v_exp_f32 v23, v23
    v_exp_f32 v24, v24
    v_exp_f32 v25, v25
    v_smfmac_f32_32x32x32_bf16 v[82:97], a[248:251], v[50:57], v253
    s_add_u32 m0, s5, 45056
    ds_read_b128 a[248:251], v120 offset:7680
    v_exp_f32 v26, v26
    v_exp_f32 v27, v27
    v_exp_f32 v28, v28
    v_exp_f32 v29, v29
    v_smfmac_f32_32x32x32_bf16 v[82:97], a[252:255], v[58:65], v253
    s_waitcnt lgkmcnt(1)
    s_add_u32 s70, s44, 45056
    s_addc_u32 s71, s45, 0
    ds_read_b128 a[252:255], v120 offset:8448
    global_load_lds_dwordx4 v232, s[70:71] offset:0 sc1
    v_exp_f32 v30, v30
    v_exp_f32 v31, v31
    v_exp_f32 v32, v32
    v_exp_f32 v33, v33
    v_mfma_f32_32x32x8_bf16 v[50:65], a[244:245], v[106:107], 0
    v_exp_f32 v34, v34
    v_exp_f32 v35, v35
    v_exp_f32 v36, v36
    v_exp_f32 v37, v37
    v_exp_f32 v38, v38
    v_mfma_f32_32x32x16_bf16 v[50:65], a[240:243], v[98:101], v[50:65]
    s_waitcnt lgkmcnt(1)
    s_add_u32 m0, s5, 61440
    s_add_u32 s70, s44, 61440
    s_addc_u32 s71, s45, 0
    global_load_lds_dwordx4 v232, s[70:71] offset:0 sc1
    v_exp_f32 v39, v39
    v_exp_f32 v40, v40
    v_exp_f32 v41, v41
    v_exp_f32 v42, v42
    v_smfmac_f32_32x32x32_bf16 v[66:81], a[248:251], v[18:25], v253
    s_waitcnt lgkmcnt(0)
    global_load_lds_dwordx4 v232, s[70:71] offset:1024 sc1
    v_exp_f32 v43, v43
    v_exp_f32 v44, v44
    v_exp_f32 v45, v45
    v_smfmac_f32_32x32x32_bf16 v[66:81], a[252:255], v[26:33], v253
    global_load_lds_dwordx4 v232, s[70:71] offset:2048 sc1
    v_exp_f32 v46, v46
    v_exp_f32 v47, v47
    v_exp_f32 v48, v48
    v_exp_f32 v49, v49
    v_mfma_f32_32x32x8_bf16 v[18:33], a[244:245], v[108:109], 0
    v_exp_f32 v50, v50
    v_exp_f32 v51, v51
    v_exp_f32 v52, v52
    v_exp_f32 v53, v53
    v_exp_f32 v54, v54
    v_mfma_f32_32x32x16_bf16 v[18:33], a[240:243], v[102:105], v[18:33]
    ds_read_b128 a[240:243], v118 offset:13312
    global_load_lds_dwordx4 v232, s[70:71] offset:3072 sc1
    v_exp_f32 v55, v55
    v_exp_f32 v56, v56
    v_exp_f32 v57, v57
    v_exp_f32 v58, v58
    v_smfmac_f32_32x32x32_bf16 v[82:97], a[248:251], v[34:41], v253
    s_add_u32 m0, s5, 65536
    ds_read_b128 a[248:251], v120 offset:12288
    v_exp_f32 v59, v59
    v_exp_f32 v60, v60
    v_exp_f32 v61, v61
    v_exp_f32 v62, v62
    v_smfmac_f32_32x32x32_bf16 v[82:97], a[252:255], v[42:49], v253
    s_waitcnt lgkmcnt(1)
    s_add_u32 s70, s44, 65536
    s_addc_u32 s71, s45, 0
    ds_read_b128 a[252:255], v120 offset:13056
    global_load_lds_dwordx4 v232, s[70:71] offset:0 sc1
    v_exp_f32 v63, v63
    v_exp_f32 v64, v64
    v_exp_f32 v65, v65
    v_mfma_f32_32x32x8_bf16 v[34:49], a[246:247], v[106:107], 0
    v_exp_f32 v18, v18
    v_exp_f32 v19, v19
    v_exp_f32 v20, v20
    v_exp_f32 v21, v21
    v_mfma_f32_32x32x16_bf16 v[34:49], a[240:243], v[98:101], v[34:49]
    s_waitcnt lgkmcnt(1)
    v_exp_f32 v22, v22
    v_exp_f32 v23, v23
    v_exp_f32 v24, v24
    v_exp_f32 v25, v25
    v_smfmac_f32_32x32x32_bf16 v[66:81], a[248:251], v[50:57], v253
    s_waitcnt lgkmcnt(0)
    v_exp_f32 v26, v26
    v_exp_f32 v27, v27
    v_exp_f32 v28, v28
    v_exp_f32 v29, v29
    v_smfmac_f32_32x32x32_bf16 v[66:81], a[252:255], v[58:65], v253
    v_exp_f32 v30, v30
    v_exp_f32 v31, v31
    v_exp_f32 v32, v32
    v_exp_f32 v33, v33
    v_mfma_f32_32x32x8_bf16 v[50:65], a[246:247], v[108:109], 0
    v_exp_f32 v34, v34
    v_exp_f32 v35, v35
    v_exp_f32 v36, v36
    v_exp_f32 v37, v37
    v_exp_f32 v38, v38
    v_mfma_f32_32x32x16_bf16 v[50:65], a[240:243], v[102:105], v[50:65]
    ds_read2st64_b64 a[244:247], v121 offset0:40 offset1:41
    ds_read_b128 a[240:243], v118 offset:18432
    v_exp_f32 v39, v39
    v_exp_f32 v40, v40
    v_exp_f32 v41, v41
    v_exp_f32 v42, v42
    v_smfmac_f32_32x32x32_bf16 v[82:97], a[248:251], v[18:25], v253
    ds_read_b128 a[248:251], v120 offset:13824
    v_exp_f32 v43, v43
    v_exp_f32 v44, v44
    v_exp_f32 v45, v45
    v_exp_f32 v46, v46
    v_smfmac_f32_32x32x32_bf16 v[82:97], a[252:255], v[26:33], v253
    s_waitcnt lgkmcnt(1)
    s_add_u32 s93, s43, 8192
    ds_read_b128 a[252:255], v120 offset:14592
    buffer_load_dword v252, v128, s[72:75], s93 offen
    v_exp_f32 v47, v47
    v_exp_f32 v48, v48
    v_exp_f32 v49, v49
    v_mfma_f32_32x32x8_bf16 v[18:33], a[244:245], v[106:107], 0
    v_exp_f32 v50, v50
    v_exp_f32 v51, v51
    v_exp_f32 v52, v52
    v_exp_f32 v53, v53
    v_exp_f32 v54, v54
    v_mfma_f32_32x32x16_bf16 v[18:33], a[240:243], v[98:101], v[18:33]
    s_waitcnt lgkmcnt(1)
    v_exp_f32 v55, v55
    v_exp_f32 v56, v56
    v_exp_f32 v57, v57
    v_exp_f32 v58, v58
    v_smfmac_f32_32x32x32_bf16 v[66:81], a[248:251], v[34:41], v253
    s_waitcnt vmcnt(7) lgkmcnt(0)
    s_barrier
    v_exp_f32 v59, v59
    v_exp_f32 v60, v60
    v_exp_f32 v61, v61
    v_smfmac_f32_32x32x32_bf16 v[66:81], a[252:255], v[42:49], v253
    v_exp_f32 v62, v62
    v_exp_f32 v63, v63
    v_exp_f32 v64, v64
    v_exp_f32 v65, v65
    v_mfma_f32_32x32x8_bf16 v[34:49], a[244:245], v[108:109], 0
    v_exp_f32 v18, v18
    v_exp_f32 v19, v19
    v_exp_f32 v20, v20
    v_exp_f32 v21, v21
    v_exp_f32 v22, v22
    v_subrev_u32 v14, 102400, v229
    v_mfma_f32_32x32x16_bf16 v[34:49], a[240:243], v[102:105], v[34:49]
    s_add_u32 m0, s21, 126976
    ds_read_b128 a[240:243], v118 offset:19456
    v_exp_f32 v23, v23
    v_exp_f32 v24, v24
    v_exp_f32 v25, v25
    v_exp_f32 v26, v26
    v_subrev_u32 v15, 102400, v230
    v_smfmac_f32_32x32x32_bf16 v[82:97], a[248:251], v[50:57], v253
    s_add_u32 s68, s64, 372736
    s_addc_u32 s69, s65, 0
    ds_read_b128 a[248:251], v120 offset:18432
    global_load_lds_dwordx4 v119, s[68:69] offset:0 sc1
    ds_read_b128 a[160:163], v14 offset:0
    v_exp_f32 v27, v27
    v_exp_f32 v28, v28
    v_exp_f32 v29, v29
    v_smfmac_f32_32x32x32_bf16 v[82:97], a[252:255], v[58:65], v253
    s_waitcnt lgkmcnt(2)
    ds_read_b128 a[252:255], v120 offset:19200
    global_load_lds_dwordx4 v119, s[68:69] offset:1024 sc1
    v_exp_f32 v30, v30
    v_exp_f32 v31, v31
    v_exp_f32 v32, v32
    v_exp_f32 v33, v33
    v_mfma_f32_32x32x8_bf16 v[50:65], a[246:247], v[106:107], 0
    v_exp_f32 v34, v34
    v_exp_f32 v35, v35
    v_exp_f32 v36, v36
    v_exp_f32 v37, v37
    v_exp_f32 v38, v38
    v_mfma_f32_32x32x16_bf16 v[50:65], a[240:243], v[98:101], v[50:65]
    s_waitcnt lgkmcnt(1)
    ds_read_b128 a[164:167], v15 offset:0
    v_exp_f32 v39, v39
    v_exp_f32 v40, v40
    v_exp_f32 v41, v41
    v_exp_f32 v42, v42
    v_smfmac_f32_32x32x32_bf16 v[66:81], a[248:251], v[18:25], v253
    s_waitcnt lgkmcnt(1)
    ds_read_b128 a[168:171], v14 offset:4096
    v_exp_f32 v43, v43
    v_exp_f32 v44, v44
    v_exp_f32 v45, v45
    v_smfmac_f32_32x32x32_bf16 v[66:81], a[252:255], v[26:33], v253
    global_load_lds_dwordx4 v119, s[68:69] offset:2048 sc1
    v_exp_f32 v46, v46
    v_exp_f32 v47, v47
    v_exp_f32 v48, v48
    v_exp_f32 v49, v49
    v_mfma_f32_32x32x8_bf16 v[18:33], a[246:247], v[108:109], 0
    v_exp_f32 v50, v50
    v_exp_f32 v51, v51
    v_exp_f32 v52, v52
    v_exp_f32 v53, v53
    v_exp_f32 v54, v54
    v_mfma_f32_32x32x16_bf16 v[18:33], a[240:243], v[102:105], v[18:33]
    ds_read2st64_b64 a[244:247], v121 offset0:52 offset1:53
    ds_read_b128 a[240:243], v118 offset:24576
    ds_read_b128 a[172:175], v15 offset:4096
    v_exp_f32 v55, v55
    v_exp_f32 v56, v56
    v_exp_f32 v57, v57
    v_smfmac_f32_32x32x32_bf16 v[82:97], a[248:251], v[34:41], v253
    ds_read_b128 a[248:251], v120 offset:19968
    ds_read_b128 a[176:179], v14 offset:8192
    v_exp_f32 v58, v58
    v_exp_f32 v59, v59
    v_exp_f32 v60, v60
    v_exp_f32 v61, v61
    v_smfmac_f32_32x32x32_bf16 v[82:97], a[252:255], v[42:49], v253
    s_waitcnt lgkmcnt(3)
    ds_read_b128 a[252:255], v120 offset:20736
    ds_read_b128 a[180:183], v15 offset:8192
    v_exp_f32 v62, v62
    v_exp_f32 v63, v63
    v_exp_f32 v64, v64
    v_exp_f32 v65, v65
    v_mfma_f32_32x32x8_bf16 v[34:49], a[244:245], v[106:107], 0
    v_exp_f32 v18, v18
    v_exp_f32 v19, v19
    v_exp_f32 v20, v20
    v_exp_f32 v21, v21
    v_exp_f32 v22, v22
    v_mfma_f32_32x32x16_bf16 v[34:49], a[240:243], v[98:101], v[34:49]
    s_waitcnt lgkmcnt(2)
    ds_read_b128 a[184:187], v14 offset:12288
    v_exp_f32 v23, v23
    v_exp_f32 v24, v24
    v_exp_f32 v25, v25
    v_exp_f32 v26, v26
    v_smfmac_f32_32x32x32_bf16 v[66:81], a[248:251], v[50:57], v253
    s_waitcnt lgkmcnt(1)
    ds_read_b128 a[188:191], v15 offset:12288
    v_exp_f32 v27, v27
    v_exp_f32 v28, v28
    v_exp_f32 v29, v29
    v_smfmac_f32_32x32x32_bf16 v[66:81], a[252:255], v[58:65], v253
    v_exp_f32 v30, v30
    v_exp_f32 v31, v31
    v_exp_f32 v32, v32
    v_exp_f32 v33, v33
    v_mfma_f32_32x32x8_bf16 v[50:65], a[244:245], v[108:109], 0
    v_exp_f32 v34, v34
    v_exp_f32 v35, v35
    v_exp_f32 v36, v36
    v_exp_f32 v37, v37
    v_exp_f32 v38, v38
    v_mfma_f32_32x32x16_bf16 v[50:65], a[240:243], v[102:105], v[50:65]
    ds_read_b128 a[240:243], v118 offset:25600
    ds_read_b128 a[192:195], v14 offset:16384
    v_exp_f32 v39, v39
    v_exp_f32 v40, v40
    v_exp_f32 v41, v41
    v_exp_f32 v42, v42
    v_smfmac_f32_32x32x32_bf16 v[82:97], a[248:251], v[18:25], v253
    ds_read_b128 a[248:251], v120 offset:24576
    ds_read_b128 a[196:199], v15 offset:16384
    v_exp_f32 v43, v43
    v_exp_f32 v44, v44
    v_exp_f32 v45, v45
    v_smfmac_f32_32x32x32_bf16 v[82:97], a[252:255], v[26:33], v253
    s_waitcnt lgkmcnt(3)
    ds_read_b128 a[252:255], v120 offset:25344
    v_exp_f32 v46, v46
    v_exp_f32 v47, v47
    v_exp_f32 v48, v48
    v_exp_f32 v49, v49
    v_mfma_f32_32x32x8_bf16 v[18:33], a[246:247], v[106:107], 0
    v_exp_f32 v50, v50
    v_exp_f32 v51, v51
    v_exp_f32 v52, v52
    v_exp_f32 v53, v53
    v_mfma_f32_32x32x16_bf16 v[18:33], a[240:243], v[98:101], v[18:33]
    s_waitcnt lgkmcnt(2)
    v_exp_f32 v54, v54
    v_exp_f32 v55, v55
    v_exp_f32 v56, v56
    v_exp_f32 v57, v57
    v_smfmac_f32_32x32x32_bf16 v[66:81], a[248:251], v[34:41], v253
    s_waitcnt lgkmcnt(0)
    v_exp_f32 v58, v58
    v_exp_f32 v59, v59
    v_exp_f32 v60, v60
    v_exp_f32 v61, v61
    v_smfmac_f32_32x32x32_bf16 v[66:81], a[252:255], v[42:49], v253
    v_exp_f32 v62, v62
    v_exp_f32 v63, v63
    v_exp_f32 v64, v64
    v_exp_f32 v65, v65
    v_mfma_f32_32x32x8_bf16 v[34:49], a[246:247], v[108:109], 0
    v_exp_f32 v18, v18
    v_exp_f32 v19, v19
    v_exp_f32 v20, v20
    v_exp_f32 v21, v21
    v_exp_f32 v22, v22
    v_mfma_f32_32x32x16_bf16 v[34:49], a[240:243], v[102:105], v[34:49]
    ds_read2st64_b64 a[244:247], v121 offset0:64 offset1:65
    ds_read_b128 a[240:243], v118 offset:30720
    v_exp_f32 v23, v23
    v_exp_f32 v24, v24
    v_exp_f32 v25, v25
    v_exp_f32 v26, v26
    v_smfmac_f32_32x32x32_bf16 v[82:97], a[248:251], v[50:57], v253
    ds_read_b128 a[248:251], v120 offset:26112
    v_exp_f32 v27, v27
    v_exp_f32 v28, v28
    v_exp_f32 v29, v29
    v_exp_f32 v30, v30
    v_smfmac_f32_32x32x32_bf16 v[82:97], a[252:255], v[58:65], v253
    s_waitcnt lgkmcnt(1)
    s_add_u32 s93, s43, 10240
    ds_read_b128 a[252:255], v120 offset:26880
    buffer_load_dword v252, v128, s[72:75], s93 offen
    v_exp_f32 v31, v31
    v_exp_f32 v32, v32
    v_exp_f32 v33, v33
    v_mfma_f32_32x32x8_bf16 v[50:65], a[244:245], v[106:107], 0
    v_exp_f32 v34, v34
    v_exp_f32 v35, v35
    v_exp_f32 v36, v36
    v_exp_f32 v37, v37
    v_exp_f32 v38, v38
    v_mfma_f32_32x32x16_bf16 v[50:65], a[240:243], v[98:101], v[50:65]
    s_waitcnt lgkmcnt(1)
    v_exp_f32 v39, v39
    v_exp_f32 v40, v40
    v_exp_f32 v41, v41
    v_exp_f32 v42, v42
    v_smfmac_f32_32x32x32_bf16 v[66:81], a[248:251], v[18:25], v253
    s_waitcnt vmcnt(1) lgkmcnt(0)
    s_barrier
    v_exp_f32 v43, v43
    v_exp_f32 v44, v44
    v_exp_f32 v45, v45
    v_smfmac_f32_32x32x32_bf16 v[66:81], a[252:255], v[26:33], v253
    v_exp_f32 v46, v46
    v_exp_f32 v47, v47
    v_exp_f32 v48, v48
    v_exp_f32 v49, v49
    v_mfma_f32_32x32x8_bf16 v[18:33], a[244:245], v[108:109], 0
    v_exp_f32 v50, v50
    v_exp_f32 v51, v51
    v_exp_f32 v52, v52
    v_exp_f32 v53, v53
    v_exp_f32 v54, v54
    v_mfma_f32_32x32x16_bf16 v[18:33], a[240:243], v[102:105], v[18:33]
    s_add_u32 m0, s21, 139264
    ds_read_b128 a[240:243], v118 offset:31744
    v_exp_f32 v55, v55
    v_exp_f32 v56, v56
    v_exp_f32 v57, v57
    v_exp_f32 v58, v58
    v_smfmac_f32_32x32x32_bf16 v[82:97], a[248:251], v[34:41], v253
    s_add_u32 s68, s64, 385024
    s_addc_u32 s69, s65, 0
    ds_read_b128 a[248:251], v120 offset:30720
    global_load_lds_dwordx4 v119, s[68:69] offset:0 sc1
    v_exp_f32 v59, v59
    v_exp_f32 v60, v60
    v_exp_f32 v61, v61
    v_smfmac_f32_32x32x32_bf16 v[82:97], a[252:255], v[42:49], v253
    s_waitcnt lgkmcnt(1)
    ds_read_b128 a[252:255], v120 offset:31488
    global_load_lds_dwordx4 v119, s[68:69] offset:1024 sc1
    v_exp_f32 v62, v62
    v_exp_f32 v63, v63
    v_exp_f32 v64, v64
    v_exp_f32 v65, v65
    v_mfma_f32_32x32x8_bf16 v[34:49], a[246:247], v[106:107], 0
    v_exp_f32 v18, v18
    v_exp_f32 v19, v19
    v_exp_f32 v20, v20
    v_exp_f32 v21, v21
    v_exp_f32 v22, v22
    v_mfma_f32_32x32x16_bf16 v[34:49], a[240:243], v[98:101], v[34:49]
    s_waitcnt lgkmcnt(1)
    global_load_lds_dwordx4 v119, s[68:69] offset:2048 sc1
    v_exp_f32 v23, v23
    v_exp_f32 v24, v24
    v_exp_f32 v25, v25
    v_exp_f32 v26, v26
    v_smfmac_f32_32x32x32_bf16 v[66:81], a[248:251], v[50:57], v253
L_pad_p2:
    s_cmp_eq_u32 s37, 1
    s_cbranch_scc1 L_ret_p
    s_waitcnt lgkmcnt(0)
    s_add_u32 m0, s5, 0
    s_add_u32 s70, s44, 0
    s_addc_u32 s71, s45, 0
    global_load_lds_dwordx4 v232, s[70:71] offset:0 sc1
    v_exp_f32 v27, v27
    v_exp_f32 v28, v28
    v_exp_f32 v29, v29
    v_smfmac_f32_32x32x32_bf16 v[66:81], a[252:255], v[58:65], v253
    global_load_lds_dwordx4 v232, s[70:71] offset:1024 sc1
    v_exp_f32 v30, v30
    v_exp_f32 v31, v31
    v_exp_f32 v32, v32
    v_exp_f32 v33, v33
    v_mfma_f32_32x32x8_bf16 v[50:65], a[246:247], v[108:109], 0
    global_load_lds_dwordx4 v232, s[70:71] offset:2048 sc1
    v_exp_f32 v34, v34
    v_exp_f32 v35, v35
    v_exp_f32 v36, v36
    v_exp_f32 v37, v37
    v_exp_f32 v38, v38
    v_mfma_f32_32x32x16_bf16 v[50:65], a[240:243], v[102:105], v[50:65]
    ds_read2st64_b64 a[244:247], v121 offset0:4 offset1:5
    ds_read_b128 a[240:243], v118 offset:0
    global_load_lds_dwordx4 v232, s[70:71] offset:3072 sc1
    v_exp_f32 v39, v39
    v_exp_f32 v40, v40
    v_exp_f32 v41, v41
    v_smfmac_f32_32x32x32_bf16 v[82:97], a[248:251], v[18:25], v253
    s_add_u32 m0, s5, 4096
    ds_read_b128 a[248:251], v120 offset:32256
    v_exp_f32 v42, v42
    v_exp_f32 v43, v43
    v_exp_f32 v44, v44
    v_exp_f32 v45, v45
    v_smfmac_f32_32x32x32_bf16 v[82:97], a[252:255], v[26:33], v253
    s_waitcnt lgkmcnt(1)
    s_add_u32 s70, s44, 4096
    s_addc_u32 s71, s45, 0
    ds_read_b128 a[252:255], v120 offset:33024
    global_load_lds_dwordx4 v232, s[70:71] offset:0 sc1
    v_exp_f32 v46, v46
    v_exp_f32 v47, v47
    v_exp_f32 v48, v48
    v_exp_f32 v49, v49
    v_mfma_f32_32x32x8_bf16 v[18:33], a[244:245], v[106:107], 0
    v_exp_f32 v50, v50
    v_exp_f32 v51, v51
    v_exp_f32 v52, v52
    v_exp_f32 v53, v53
    v_exp_f32 v54, v54
    v_mfma_f32_32x32x16_bf16 v[18:33], a[240:243], v[98:101], v[18:33]
    s_waitcnt lgkmcnt(1)
    s_add_u32 m0, s5, 20480
    s_add_u32 s70, s44, 20480
    s_addc_u32 s71, s45, 0
    global_load_lds_dwordx4 v232, s[70:71] offset:0 sc1
    v_exp_f32 v55, v55
    v_exp_f32 v56, v56
    v_exp_f32 v57, v57
    v_exp_f32 v58, v58
    v_smfmac_f32_32x32x32_bf16 v[66:81], a[248:251], v[34:41], v253
    s_waitcnt lgkmcnt(0)
    global_load_lds_dwordx4 v232, s[70:71] offset:1024 sc1
    v_exp_f32 v59, v59
    v_exp_f32 v60, v60
    v_exp_f32 v61, v61
    v_smfmac_f32_32x32x32_bf16 v[66:81], a[252:255], v[42:49], v253
    global_load_lds_dwordx4 v232, s[70:71] offset:2048 sc1
    v_exp_f32 v62, v62
    v_exp_f32 v63, v63
    v_exp_f32 v64, v64
    v_exp_f32 v65, v65
    v_mfma_f32_32x32x8_bf16 v[34:49], a[244:245], v[108:109], 0
    v_exp_f32 v18, v18
    v_exp_f32 v19, v19
    v_exp_f32 v20, v20
    v_exp_f32 v21, v21
    v_exp_f32 v22, v22
    v_mfma_f32_32x32x16_bf16 v[34:49], a[240:243], v[102:105], v[34:49]
    ds_read_b128 a[240:243], v118 offset:1024
    global_load_lds_dwordx4 v232, s[70:71] offset:3072 sc1
    v_exp_f32 v23, v23
    v_exp_f32 v24, v24
    v_exp_f32 v25, v25
    v_exp_f32 v26, v26
    v_smfmac_f32_32x32x32_bf16 v[82:97], a[248:251], v[50:57], v253
    s_add_u32 m0, s5, 24576
    s_add_u32 s70, s44, 24576
    s_addc_u32 s71, s45, 0
    ds_read_b128 a[248:251], v120 offset:0
    global_load_lds_dwordx4 v232, s[70:71] offset:0 sc1
    v_exp_f32 v27, v27
    v_exp_f32 v28, v28
    v_exp_f32 v29, v29
    v_smfmac_f32_32x32x32_bf16 v[82:97], a[252:255], v[58:65], v253
    s_waitcnt lgkmcnt(1)
    s_add_u32 m0, s5, 81920
    s_add_u32 s70, s44, 81920
    s_addc_u32 s71, s45, 0
    ds_read_b128 a[252:255], v120 offset:768
    global_load_lds_dwordx4 v232, s[70:71] offset:0 sc1
    v_exp_f32 v30, v30
    v_exp_f32 v31, v31
    v_exp_f32 v32, v32
    v_exp_f32 v33, v33
    v_mfma_f32_32x32x8_bf16 v[50:65], a[246:247], v[106:107], 0
    v_exp_f32 v34, v34
    v_exp_f32 v35, v35
    v_exp_f32 v36, v36
    v_exp_f32 v37, v37
    v_exp_f32 v38, v38
    v_mfma_f32_32x32x16_bf16 v[50:65], a[240:243], v[98:101], v[50:65]
    s_waitcnt lgkmcnt(1)
    global_load_lds_dwordx4 v232, s[70:71] offset:1024 sc1
    v_exp_f32 v39, v39
    v_exp_f32 v40, v40
    v_exp_f32 v41, v41
    v_exp_f32 v42, v42
    v_smfmac_f32_32x32x32_bf16 v[66:81], a[248:251], v[18:25], v253
    s_waitcnt lgkmcnt(0)
    global_load_lds_dwordx4 v232, s[70:71] offset:2048 sc1
    v_exp_f32 v43, v43
    v_exp_f32 v44, v44
    v_exp_f32 v45, v45
    v_smfmac_f32_32x32x32_bf16 v[66:81], a[252:255], v[26:33], v253
    global_load_lds_dwordx4 v232, s[70:71] offset:3072 sc1
    v_exp_f32 v46, v46
    v_exp_f32 v47, v47
    v_exp_f32 v48, v48
    v_exp_f32 v49, v49
    v_mfma_f32_32x32x8_bf16 v[18:33], a[246:247], v[108:109], 0
    v_exp_f32 v50, v50
    v_exp_f32 v51, v51
    v_exp_f32 v52, v52
    v_exp_f32 v53, v53
    v_exp_f32 v54, v54
    v_mfma_f32_32x32x16_bf16 v[18:33], a[240:243], v[102:105], v[18:33]
    s_add_u32 m0, s5, 86016
    s_add_u32 s70, s44, 86016
    s_addc_u32 s71, s45, 0
    ds_read2st64_b64 a[244:247], v121 offset0:16 offset1:17
    ds_read_b128 a[240:243], v118 offset:6144
    global_load_lds_dwordx4 v232, s[70:71] offset:0 sc1
    v_exp_f32 v55, v55
    v_exp_f32 v56, v56
    v_exp_f32 v57, v57
    v_smfmac_f32_32x32x32_bf16 v[82:97], a[248:251], v[34:41], v253
    s_add_u32 m0, s50, 102400
    ds_read_b128 a[248:251], v120 offset:1536
    global_load_lds_dwordx4 v228, s[18:19] offset:0 sc0
    v_exp_f32 v58, v58
    v_exp_f32 v59, v59
    v_exp_f32 v60, v60
    v_exp_f32 v61, v61
    v_smfmac_f32_32x32x32_bf16 v[82:97], a[252:255], v[42:49], v253
    s_waitcnt lgkmcnt(1)
    s_add_u32 m0, s50, 106368
    ds_read_b128 a[252:255], v120 offset:2304
    v_exp_f32 v62, v62
    v_exp_f32 v63, v63
    v_exp_f32 v64, v64
    v_exp_f32 v65, v65
    v_mfma_f32_32x32x8_bf16 v[34:49], a[244:245], v[106:107], 0
    v_exp_f32 v18, v18
    v_exp_f32 v19, v19
    v_exp_f32 v20, v20
    v_exp_f32 v21, v21
    v_exp_f32 v22, v22
    v_mfma_f32_32x32x16_bf16 v[34:49], a[240:243], v[98:101], v[34:49]
    s_waitcnt lgkmcnt(1)
    global_load_lds_dwordx4 v228, s[18:19] offset:128 sc0
    v_exp_f32 v23, v23
    v_exp_f32 v24, v24
    v_exp_f32 v25, v25
    v_exp_f32 v26, v26
    v_smfmac_f32_32x32x32_bf16 v[66:81], a[248:251], v[50:57], v253
    s_waitcnt vmcnt(17) lgkmcnt(0)
    s_add_u32 m0, s50, 110336
    s_barrier
    global_load_lds_dwordx4 v228, s[18:19] offset:256 sc0
    v_exp_f32 v27, v27
    v_exp_f32 v28, v28
    v_exp_f32 v29, v29
    v_smfmac_f32_32x32x32_bf16 v[66:81], a[252:255], v[58:65], v253
    s_add_u32 m0, s50, 114304
    v_exp_f32 v30, v30
    v_exp_f32 v31, v31
    v_exp_f32 v32, v32
    v_exp_f32 v33, v33
    v_mfma_f32_32x32x8_bf16 v[50:65], a[244:245], v[108:109], 0
    v_exp_f32 v34, v34
    v_exp_f32 v35, v35
    v_exp_f32 v36, v36
    v_exp_f32 v37, v37
    v_exp_f32 v38, v38
    v_mfma_f32_32x32x16_bf16 v[50:65], a[240:243], v[102:105], v[50:65]
    ds_read_b128 a[240:243], v118 offset:7168
    global_load_lds_dwordx4 v228, s[18:19] offset:384 sc0
    v_exp_f32 v39, v39
    v_exp_f32 v40, v40
    v_exp_f32 v41, v41
    v_exp_f32 v42, v42
    v_smfmac_f32_32x32x32_bf16 v[82:97], a[248:251], v[18:25], v253
    s_add_u32 m0, s21, 151552
    ds_read_b128 a[248:251], v120 offset:6144
    v_exp_f32 v43, v43
    v_exp_f32 v44, v44
    v_exp_f32 v45, v45
    v_exp_f32 v46, v46
    v_smfmac_f32_32x32x32_bf16 v[82:97], a[252:255], v[26:33], v253
    s_waitcnt lgkmcnt(1)
    s_add_u32 s68, s64, 397312
    s_addc_u32 s69, s65, 0
    ds_read_b128 a[252:255], v120 offset:6912
    global_load_lds_dwordx4 v119, s[68:69] offset:0 sc1
    v_exp_f32 v47, v47
    v_exp_f32 v48, v48
    v_exp_f32 v49, v49
    v_mfma_f32_32x32x8_bf16 v[18:33], a[246:247], v[106:107], 0
    v_exp_f32 v50, v50
    v_exp_f32 v51, v51
    v_exp_f32 v52, v52
    v_exp_f32 v53, v53
    v_exp_f32 v54, v54
    v_mfma_f32_32x32x16_bf16 v[18:33], a[240:243], v[98:101], v[18:33]
    s_waitcnt lgkmcnt(1)
    global_load_lds_dwordx4 v119, s[68:69] offset:1024 sc1
    v_exp_f32 v55, v55
    v_exp_f32 v56, v56
    v_exp_f32 v57, v57
    v_exp_f32 v58, v58
    v_smfmac_f32_32x32x32_bf16 v[66:81], a[248:251], v[34:41], v253
    s_waitcnt lgkmcnt(0)
    global_load_lds_dwordx4 v119, s[68:69] offset:2048 sc1
    v_exp_f32 v59, v59
    v_exp_f32 v60, v60
    v_exp_f32 v61, v61
    v_smfmac_f32_32x32x32_bf16 v[66:81], a[252:255], v[42:49], v253
    s_add_u32 m0, s50, 118272
    v_exp_f32 v62, v62
    v_exp_f32 v63, v63
    v_exp_f32 v64, v64
    v_exp_f32 v65, v65
    v_mfma_f32_32x32x8_bf16 v[34:49], a[246:247], v[108:109], 0
    v_exp_f32 v18, v18
    v_exp_f32 v19, v19
    v_exp_f32 v20, v20
    v_exp_f32 v21, v21
    v_exp_f32 v22, v22
    v_mfma_f32_32x32x16_bf16 v[34:49], a[240:243], v[102:105], v[34:49]
    ds_read2st64_b64 a[244:247], v121 offset0:28 offset1:29
    ds_read_b128 a[240:243], v118 offset:12288
    v_exp_f32 v23, v23
    v_exp_f32 v24, v24
    v_exp_f32 v25, v25
    v_exp_f32 v26, v26
    v_smfmac_f32_32x32x32_bf16 v[82:97], a[248:251], v[50:57], v253
    ds_read_b128 a[248:251], v120 offset:7680
    global_load_lds_dwordx4 v228, s[18:19] offset:512 sc0
    v_exp_f32 v27, v27
    v_exp_f32 v28, v28
    v_exp_f32 v29, v29
    v_smfmac_f32_32x32x32_bf16 v[82:97], a[252:255], v[58:65], v253
    s_waitcnt lgkmcnt(1)
    s_add_u32 s93, s43, 12288
    ds_read_b128 a[252:255], v120 offset:8448
    buffer_load_dword v252, v128, s[72:75], s93 offen
    v_exp_f32 v30, v30
    v_exp_f32 v31, v31
    v_exp_f32 v32, v32
    v_exp_f32 v33, v33
    v_mfma_f32_32x32x8_bf16 v[50:65], a[244:245], v[106:107], 0
    v_exp_f32 v34, v34
    v_exp_f32 v35, v35
    v_exp_f32 v36, v36
    v_exp_f32 v37, v37
    v_mfma_f32_32x32x16_bf16 v[50:65], a[240:243], v[98:101], v[50:65]
    s_waitcnt lgkmcnt(1)
    v_exp_f32 v38, v38
    v_exp_f32 v39, v39
    v_exp_f32 v40, v40
    v_exp_f32 v41, v41
    v_smfmac_f32_32x32x32_bf16 v[66:81], a[248:251], v[18:25], v253
    s_waitcnt lgkmcnt(0)
    v_exp_f32 v42, v42
    v_exp_f32 v43, v43
    v_exp_f32 v44, v44
    v_exp_f32 v45, v45
    v_smfmac_f32_32x32x32_bf16 v[66:81], a[252:255], v[26:33], v253
    v_exp_f32 v46, v46
    v_exp_f32 v47, v47
    v_exp_f32 v48, v48
    v_exp_f32 v49, v49
    v_mfma_f32_32x32x8_bf16 v[18:33], a[244:245], v[108:109], 0
    v_exp_f32 v50, v50
    v_exp_f32 v51, v51
    v_exp_f32 v52, v52
    v_exp_f32 v53, v53
    v_exp_f32 v54, v54
    v_mfma_f32_32x32x16_bf16 v[18:33], a[240:243], v[102:105], v[18:33]
    ds_read_b128 a[240:243], v118 offset:13312
    v_exp_f32 v55, v55
    v_exp_f32 v56, v56
    v_exp_f32 v57, v57
    v_exp_f32 v58, v58
    v_smfmac_f32_32x32x32_bf16 v[82:97], a[248:251], v[34:41], v253
    ds_read_b128 a[248:251], v120 offset:12288
    v_exp_f32 v59, v59
    v_exp_f32 v60, v60
    v_exp_f32 v61, v61
    v_smfmac_f32_32x32x32_bf16 v[82:97], a[252:255], v[42:49], v253
    s_waitcnt lgkmcnt(1)
    ds_read_b128 a[252:255], v120 offset:13056
    v_exp_f32 v62, v62
    v_exp_f32 v63, v63
    v_exp_f32 v64, v64
    v_exp_f32 v65, v65
    v_mfma_f32_32x32x8_bf16 v[34:49], a[246:247], v[106:107], 0
    v_exp_f32 v18, v18
    v_exp_f32 v19, v19
    v_exp_f32 v20, v20
    v_exp_f32 v21, v21
    v_mfma_f32_32x32x16_bf16 v[34:49], a[240:243], v[98:101], v[34:49]
    s_waitcnt lgkmcnt(1)
    v_exp_f32 v22, v22
    v_exp_f32 v23, v23
    v_exp_f32 v24, v24
    v_exp_f32 v25, v25
    v_smfmac_f32_32x32x32_bf16 v[66:81], a[248:251], v[50:57], v253
    s_waitcnt lgkmcnt(0)
    v_exp_f32 v26, v26
    v_exp_f32 v27, v27
    v_exp_f32 v28, v28
    v_exp_f32 v29, v29
    v_smfmac_f32_32x32x32_bf16 v[66:81], a[252:255], v[58:65], v253
    v_exp_f32 v30, v30
    v_exp_f32 v31, v31
    v_exp_f32 v32, v32
    v_exp_f32 v33, v33
    v_mfma_f32_32x32x8_bf16 v[50:65], a[246:247], v[108:109], 0
    v_exp_f32 v34, v34
    v_exp_f32 v35, v35
    v_exp_f32 v36, v36
    v_exp_f32 v37, v37
    v_exp_f32 v38, v38
    v_mfma_f32_32x32x16_bf16 v[50:65], a[240:243], v[102:105], v[50:65]
    ds_read2st64_b64 a[244:247], v121 offset0:40 offset1:41
    ds_read_b128 a[240:243], v118 offset:18432
    v_exp_f32 v39, v39
    v_exp_f32 v40, v40
    v_exp_f32 v41, v41
    v_exp_f32 v42, v42
    v_smfmac_f32_32x32x32_bf16 v[82:97], a[248:251], v[18:25], v253
    ds_read_b128 a[248:251], v120 offset:13824
    v_exp_f32 v43, v43
    v_exp_f32 v44, v44
    v_exp_f32 v45, v45
    v_smfmac_f32_32x32x32_bf16 v[82:97], a[252:255], v[26:33], v253
    s_waitcnt lgkmcnt(1)
    ds_read_b128 a[252:255], v120 offset:14592
    v_exp_f32 v46, v46
    v_exp_f32 v47, v47
    v_exp_f32 v48, v48
    v_exp_f32 v49, v49
    v_mfma_f32_32x32x8_bf16 v[18:33], a[244:245], v[106:107], 0
    v_exp_f32 v50, v50
    v_exp_f32 v51, v51
    v_exp_f32 v52, v52
    v_exp_f32 v53, v53
    v_exp_f32 v54, v54
    v_mfma_f32_32x32x16_bf16 v[18:33], a[240:243], v[98:101], v[18:33]
    s_waitcnt lgkmcnt(1)
    v_exp_f32 v55, v55
    v_exp_f32 v56, v56
    v_exp_f32 v57, v57
    v_exp_f32 v58, v58
    v_smfmac_f32_32x32x32_bf16 v[66:81], a[248:251], v[34:41], v253
    s_waitcnt vmcnt(2) lgkmcnt(0)
    s_barrier
    v_exp_f32 v59, v59
    v_exp_f32 v60, v60
    v_exp_f32 v61, v61
    v_smfmac_f32_32x32x32_bf16 v[66:81], a[252:255], v[42:49], v253
    v_exp_f32 v62, v62
    v_exp_f32 v63, v63
    v_exp_f32 v64, v64
    v_exp_f32 v65, v65
    v_mfma_f32_32x32x8_bf16 v[34:49], a[244:245], v[108:109], 0
    v_exp_f32 v18, v18
    v_exp_f32 v19, v19
    v_exp_f32 v20, v20
    v_exp_f32 v21, v21
    v_exp_f32 v22, v22
    v_mfma_f32_32x32x16_bf16 v[34:49], a[240:243], v[102:105], v[34:49]
    s_add_u32 m0, s21, 126976
    ds_read_b128 a[240:243], v118 offset:19456
    v_exp_f32 v23, v23
    v_exp_f32 v24, v24
    v_exp_f32 v25, v25
    v_exp_f32 v26, v26
    v_smfmac_f32_32x32x32_bf16 v[82:97], a[248:251], v[50:57], v253
    s_add_u32 s68, s64, 409600
    s_addc_u32 s69, s65, 0
    ds_read_b128 a[248:251], v120 offset:18432
    global_load_lds_dwordx4 v119, s[68:69] offset:0 sc1
    v_exp_f32 v27, v27
    v_exp_f32 v28, v28
    v_exp_f32 v29, v29
    v_smfmac_f32_32x32x32_bf16 v[82:97], a[252:255], v[58:65], v253
    s_waitcnt lgkmcnt(1)
    ds_read_b128 a[252:255], v120 offset:19200
    global_load_lds_dwordx4 v119, s[68:69] offset:1024 sc1
    v_exp_f32 v30, v30
    v_exp_f32 v31, v31
    v_exp_f32 v32, v32
    v_exp_f32 v33, v33
    v_mfma_f32_32x32x8_bf16 v[50:65], a[246:247], v[106:107], 0
    v_exp_f32 v34, v34
    v_exp_f32 v35, v35
    v_exp_f32 v36, v36
    v_exp_f32 v37, v37
    v_exp_f32 v38, v38
    v_mfma_f32_32x32x16_bf16 v[50:65], a[240:243], v[98:101], v[50:65]
    s_waitcnt lgkmcnt(1)
    v_exp_f32 v39, v39
    v_exp_f32 v40, v40
    v_exp_f32 v41, v41
    v_exp_f32 v42, v42
    v_smfmac_f32_32x32x32_bf16 v[66:81], a[248:251], v[18:25], v253
    s_waitcnt lgkmcnt(0)
    v_exp_f32 v43, v43
    v_exp_f32 v44, v44
    v_exp_f32 v45, v45
    v_exp_f32 v46, v46
    v_smfmac_f32_32x32x32_bf16 v[66:81], a[252:255], v[26:33], v253
    global_load_lds_dwordx4 v119, s[68:69] offset:2048 sc1
    v_exp_f32 v47, v47
    v_exp_f32 v48, v48
    v_exp_f32 v49, v49
    v_mfma_f32_32x32x8_bf16 v[18:33], a[246:247], v[108:109], 0
    v_exp_f32 v50, v50
    v_exp_f32 v51, v51
    v_exp_f32 v52, v52
    v_exp_f32 v53, v53
    v_exp_f32 v54, v54
    v_mfma_f32_32x32x16_bf16 v[18:33], a[240:243], v[102:105], v[18:33]
    ds_read2st64_b64 a[244:247], v121 offset0:52 offset1:53
    ds_read_b128 a[240:243], v118 offset:24576
    v_exp_f32 v55, v55
    v_exp_f32 v56, v56
    v_exp_f32 v57, v57
    v_exp_f32 v58, v58
    v_smfmac_f32_32x32x32_bf16 v[82:97], a[248:251], v[34:41], v253
    ds_read_b128 a[248:251], v120 offset:19968
    v_exp_f32 v59, v59
    v_exp_f32 v60, v60
    v_exp_f32 v61, v61
    v_smfmac_f32_32x32x32_bf16 v[82:97], a[252:255], v[42:49], v253
    s_waitcnt lgkmcnt(1)
    ds_read_b128 a[252:255], v120 offset:20736
    v_exp_f32 v62, v62
    v_exp_f32 v63, v63
    v_exp_f32 v64, v64
    v_exp_f32 v65, v65
    v_mfma_f32_32x32x8_bf16 v[34:49], a[244:245], v[106:107], 0
    v_exp_f32 v18, v18
    v_exp_f32 v19, v19
    v_exp_f32 v20, v20
    v_exp_f32 v21, v21
    v_mfma_f32_32x32x16_bf16 v[34:49], a[240:243], v[98:101], v[34:49]
    s_waitcnt lgkmcnt(1)
    v_exp_f32 v22, v22
    v_exp_f32 v23, v23
    v_exp_f32 v24, v24
    v_exp_f32 v25, v25
    v_smfmac_f32_32x32x32_bf16 v[66:81], a[248:251], v[50:57], v253
    s_waitcnt lgkmcnt(0)
    v_exp_f32 v26, v26
    v_exp_f32 v27, v27
    v_exp_f32 v28, v28
    v_exp_f32 v29, v29
    v_smfmac_f32_32x32x32_bf16 v[66:81], a[252:255], v[58:65], v253
    v_exp_f32 v30, v30
    v_exp_f32 v31, v31
    v_exp_f32 v32, v32
    v_exp_f32 v33, v33
    v_mfma_f32_32x32x8_bf16 v[50:65], a[244:245], v[108:109], 0
    v_exp_f32 v34, v34
    v_exp_f32 v35, v35
    v_exp_f32 v36, v36
    v_exp_f32 v37, v37
    v_exp_f32 v38, v38
    v_mfma_f32_32x32x16_bf16 v[50:65], a[240:243], v[102:105], v[50:65]
    ds_read_b128 a[240:243], v118 offset:25600
    v_exp_f32 v39, v39
    v_exp_f32 v40, v40
    v_exp_f32 v41, v41
    v_exp_f32 v42, v42
    v_smfmac_f32_32x32x32_bf16 v[82:97], a[248:251], v[18:25], v253
    ds_read_b128 a[248:251], v120 offset:24576
    v_exp_f32 v43, v43
    v_exp_f32 v44, v44
    v_exp_f32 v45, v45
    v_smfmac_f32_32x32x32_bf16 v[82:97], a[252:255], v[26:33], v253
    s_waitcnt lgkmcnt(1)
    ds_read_b128 a[252:255], v120 offset:25344
    v_exp_f32 v46, v46
    v_exp_f32 v47, v47
    v_exp_f32 v48, v48
    v_exp_f32 v49, v49
    v_mfma_f32_32x32x8_bf16 v[18:33], a[246:247], v[106:107], 0
    v_exp_f32 v50, v50
    v_exp_f32 v51, v51
    v_exp_f32 v52, v52
    v_exp_f32 v53, v53
    v_mfma_f32_32x32x16_bf16 v[18:33], a[240:243], v[98:101], v[18:33]
    s_waitcnt lgkmcnt(1)
    v_exp_f32 v54, v54
    v_exp_f32 v55, v55
    v_exp_f32 v56, v56
    v_exp_f32 v57, v57
    v_smfmac_f32_32x32x32_bf16 v[66:81], a[248:251], v[34:41], v253
    s_waitcnt lgkmcnt(0)
    v_exp_f32 v58, v58
    v_exp_f32 v59, v59
    v_exp_f32 v60, v60
    v_exp_f32 v61, v61
    v_smfmac_f32_32x32x32_bf16 v[66:81], a[252:255], v[42:49], v253
    v_exp_f32 v62, v62
    v_exp_f32 v63, v63
    v_exp_f32 v64, v64
    v_exp_f32 v65, v65
    v_mfma_f32_32x32x8_bf16 v[34:49], a[246:247], v[108:109], 0
    v_exp_f32 v18, v18
    v_exp_f32 v19, v19
    v_exp_f32 v20, v20
    v_exp_f32 v21, v21
    v_exp_f32 v22, v22
    v_mfma_f32_32x32x16_bf16 v[34:49], a[240:243], v[102:105], v[34:49]
    ds_read2st64_b64 a[244:247], v121 offset0:64 offset1:65
    ds_read_b128 a[240:243], v118 offset:30720
    v_exp_f32 v23, v23
    v_exp_f32 v24, v24
    v_exp_f32 v25, v25
    v_exp_f32 v26, v26
    v_smfmac_f32_32x32x32_bf16 v[82:97], a[248:251], v[50:57], v253
    ds_read_b128 a[248:251], v120 offset:26112
    v_exp_f32 v27, v27
    v_exp_f32 v28, v28
    v_exp_f32 v29, v29
    v_smfmac_f32_32x32x32_bf16 v[82:97], a[252:255], v[58:65], v253
    s_waitcnt lgkmcnt(1)
    ds_read_b128 a[252:255], v120 offset:26880
    v_exp_f32 v30, v30
    v_exp_f32 v31, v31
    v_exp_f32 v32, v32
    v_exp_f32 v33, v33
    v_mfma_f32_32x32x8_bf16 v[50:65], a[244:245], v[106:107], 0
    v_exp_f32 v34, v34
    v_exp_f32 v35, v35
    v_exp_f32 v36, v36
    v_exp_f32 v37, v37
    v_exp_f32 v38, v38
    v_mfma_f32_32x32x16_bf16 v[50:65], a[240:243], v[98:101], v[50:65]
    s_waitcnt lgkmcnt(1)
    v_exp_f32 v39, v39
    v_exp_f32 v40, v40
    v_exp_f32 v41, v41
    v_exp_f32 v42, v42
    v_smfmac_f32_32x32x32_bf16 v[66:81], a[248:251], v[18:25], v253
    s_waitcnt vmcnt(0) lgkmcnt(0)
    s_barrier
    v_exp_f32 v43, v43
    v_exp_f32 v44, v44
    v_exp_f32 v45, v45
    v_smfmac_f32_32x32x32_bf16 v[66:81], a[252:255], v[26:33], v253
    v_exp_f32 v46, v46
    v_exp_f32 v47, v47
    v_exp_f32 v48, v48
    v_exp_f32 v49, v49
    v_mfma_f32_32x32x8_bf16 v[18:33], a[244:245], v[108:109], 0
    v_exp_f32 v50, v50
    v_exp_f32 v51, v51
    v_exp_f32 v52, v52
    v_exp_f32 v53, v53
    v_exp_f32 v54, v54
    v_mfma_f32_32x32x16_bf16 v[18:33], a[240:243], v[102:105], v[18:33]
    s_add_u32 m0, s21, 139264
    ds_read_b128 a[240:243], v118 offset:31744
    v_exp_f32 v55, v55
    v_exp_f32 v56, v56
    v_exp_f32 v57, v57
    v_exp_f32 v58, v58
    v_smfmac_f32_32x32x32_bf16 v[82:97], a[248:251], v[34:41], v253
    s_add_u32 s68, s64, 421888
    s_addc_u32 s69, s65, 0
    ds_read_b128 a[248:251], v120 offset:30720
    global_load_lds_dwordx4 v119, s[68:69] offset:0 sc1
    v_exp_f32 v59, v59
    v_exp_f32 v60, v60
    v_exp_f32 v61, v61
    v_smfmac_f32_32x32x32_bf16 v[82:97], a[252:255], v[42:49], v253
    s_waitcnt lgkmcnt(1)
    ds_read_b128 a[252:255], v120 offset:31488
    global_load_lds_dwordx4 v119, s[68:69] offset:1024 sc1
    v_exp_f32 v62, v62
    v_exp_f32 v63, v63
    v_exp_f32 v64, v64
    v_exp_f32 v65, v65
    v_mfma_f32_32x32x8_bf16 v[34:49], a[246:247], v[106:107], 0
    v_exp_f32 v18, v18
    v_exp_f32 v19, v19
    v_exp_f32 v20, v20
    v_exp_f32 v21, v21
    v_exp_f32 v22, v22
    v_mfma_f32_32x32x16_bf16 v[34:49], a[240:243], v[98:101], v[34:49]
    s_waitcnt lgkmcnt(1)
    v_exp_f32 v23, v23
    v_exp_f32 v24, v24
    v_exp_f32 v25, v25
    v_exp_f32 v26, v26
    v_smfmac_f32_32x32x32_bf16 v[66:81], a[248:251], v[50:57], v253
    s_waitcnt lgkmcnt(0)
    v_exp_f32 v27, v27
    v_exp_f32 v28, v28
    v_exp_f32 v29, v29
    v_exp_f32 v30, v30
    v_smfmac_f32_32x32x32_bf16 v[66:81], a[252:255], v[58:65], v253
    global_load_lds_dwordx4 v119, s[68:69] offset:2048 sc1
    v_exp_f32 v31, v31
    v_exp_f32 v32, v32
    v_exp_f32 v33, v33
    v_mfma_f32_32x32x8_bf16 v[50:65], a[246:247], v[108:109], 0
    v_exp_f32 v34, v34
    v_exp_f32 v35, v35
    v_exp_f32 v36, v36
    v_exp_f32 v37, v37
    v_exp_f32 v38, v38
    v_mfma_f32_32x32x16_bf16 v[50:65], a[240:243], v[102:105], v[50:65]
    ds_read2st64_b64 a[244:247], v121 offset0:4 offset1:5
    ds_read_b128 a[240:243], v118 offset:0
    v_exp_f32 v39, v39
    v_exp_f32 v40, v40
    v_exp_f32 v41, v41
    v_exp_f32 v42, v42
    v_smfmac_f32_32x32x32_bf16 v[82:97], a[248:251], v[18:25], v253
    ds_read_b128 a[248:251], v120 offset:32256
    v_exp_f32 v43, v43
    v_exp_f32 v44, v44
    v_exp_f32 v45, v45
    v_smfmac_f32_32x32x32_bf16 v[82:97], a[252:255], v[26:33], v253
    s_waitcnt lgkmcnt(1)
    ds_read_b128 a[252:255], v120 offset:33024
    v_exp_f32 v46, v46
    v_exp_f32 v47, v47
    v_exp_f32 v48, v48
    v_exp_f32 v49, v49
    v_mfma_f32_32x32x8_bf16 v[18:33], a[244:245], v[106:107], 0
    v_exp_f32 v50, v50
    v_exp_f32 v51, v51
    v_exp_f32 v52, v52
    v_exp_f32 v53, v53
    v_mfma_f32_32x32x16_bf16 v[18:33], a[240:243], v[98:101], v[18:33]
    s_waitcnt lgkmcnt(1)
    v_exp_f32 v54, v54
    v_exp_f32 v55, v55
    v_exp_f32 v56, v56
    v_exp_f32 v57, v57
    v_smfmac_f32_32x32x32_bf16 v[66:81], a[248:251], v[34:41], v253
    s_waitcnt lgkmcnt(0)
    v_exp_f32 v58, v58
    v_exp_f32 v59, v59
    v_exp_f32 v60, v60
    v_exp_f32 v61, v61
    v_smfmac_f32_32x32x32_bf16 v[66:81], a[252:255], v[42:49], v253
    v_exp_f32 v62, v62
    v_exp_f32 v63, v63
    v_exp_f32 v64, v64
    v_exp_f32 v65, v65
    v_mfma_f32_32x32x8_bf16 v[34:49], a[244:245], v[108:109], 0
    v_exp_f32 v18, v18
    v_exp_f32 v19, v19
    v_exp_f32 v20, v20
    v_exp_f32 v21, v21
    v_exp_f32 v22, v22
    v_mfma_f32_32x32x16_bf16 v[34:49], a[240:243], v[102:105], v[34:49]
    ds_read_b128 a[240:243], v118 offset:1024
    v_exp_f32 v23, v23
    v_exp_f32 v24, v24
    v_exp_f32 v25, v25
    v_exp_f32 v26, v26
    v_smfmac_f32_32x32x32_bf16 v[82:97], a[248:251], v[50:57], v253
    ds_read_b128 a[248:251], v120 offset:0
    v_exp_f32 v27, v27
    v_exp_f32 v28, v28
    v_exp_f32 v29, v29
    v_smfmac_f32_32x32x32_bf16 v[82:97], a[252:255], v[58:65], v253
    s_waitcnt lgkmcnt(1)
    ds_read_b128 a[252:255], v120 offset:768
    v_exp_f32 v30, v30
    v_exp_f32 v31, v31
    v_exp_f32 v32, v32
    v_exp_f32 v33, v33
    v_mfma_f32_32x32x8_bf16 v[50:65], a[246:247], v[106:107], 0
    v_exp_f32 v34, v34
    v_exp_f32 v35, v35
    v_exp_f32 v36, v36
    v_exp_f32 v37, v37
    v_mfma_f32_32x32x16_bf16 v[50:65], a[240:243], v[98:101], v[50:65]
    s_waitcnt lgkmcnt(1)
    v_exp_f32 v38, v38
    v_exp_f32 v39, v39
    v_exp_f32 v40, v40
    v_exp_f32 v41, v41
    v_smfmac_f32_32x32x32_bf16 v[66:81], a[248:251], v[18:25], v253
    s_waitcnt lgkmcnt(0)
    v_exp_f32 v42, v42
    v_exp_f32 v43, v43
    v_exp_f32 v44, v44
    v_exp_f32 v45, v45
    v_smfmac_f32_32x32x32_bf16 v[66:81], a[252:255], v[26:33], v253
    v_exp_f32 v46, v46
    v_exp_f32 v47, v47
    v_exp_f32 v48, v48
    v_exp_f32 v49, v49
    v_mfma_f32_32x32x8_bf16 v[18:33], a[246:247], v[108:109], 0
    v_exp_f32 v50, v50
    v_exp_f32 v51, v51
    v_exp_f32 v52, v52
    v_exp_f32 v53, v53
    v_exp_f32 v54, v54
    v_mfma_f32_32x32x16_bf16 v[18:33], a[240:243], v[102:105], v[18:33]
    ds_read2st64_b64 a[244:247], v121 offset0:16 offset1:17
    ds_read_b128 a[240:243], v118 offset:6144
    v_exp_f32 v55, v55
    v_exp_f32 v56, v56
    v_exp_f32 v57, v57
    v_exp_f32 v58, v58
    v_smfmac_f32_32x32x32_bf16 v[82:97], a[248:251], v[34:41], v253
    ds_read_b128 a[248:251], v120 offset:1536
    v_exp_f32 v59, v59
    v_exp_f32 v60, v60
    v_exp_f32 v61, v61
    v_smfmac_f32_32x32x32_bf16 v[82:97], a[252:255], v[42:49], v253
    s_waitcnt lgkmcnt(1)
    ds_read_b128 a[252:255], v120 offset:2304
    v_exp_f32 v62, v62
    v_exp_f32 v63, v63
    v_exp_f32 v64, v64
    v_exp_f32 v65, v65
    v_mfma_f32_32x32x8_bf16 v[34:49], a[244:245], v[106:107], 0
    v_exp_f32 v18, v18
    v_exp_f32 v19, v19
    v_exp_f32 v20, v20
    v_exp_f32 v21, v21
    v_exp_f32 v22, v22
    v_mfma_f32_32x32x16_bf16 v[34:49], a[240:243], v[98:101], v[34:49]
    s_waitcnt lgkmcnt(1)
    v_exp_f32 v23, v23
    v_exp_f32 v24, v24
    v_exp_f32 v25, v25
    v_exp_f32 v26, v26
    v_smfmac_f32_32x32x32_bf16 v[66:81], a[248:251], v[50:57], v253
    s_waitcnt vmcnt(0) lgkmcnt(0)
    s_barrier
    v_exp_f32 v27, v27
    v_exp_f32 v28, v28
    v_exp_f32 v29, v29
    v_smfmac_f32_32x32x32_bf16 v[66:81], a[252:255], v[58:65], v253
    v_exp_f32 v30, v30
    v_exp_f32 v31, v31
    v_exp_f32 v32, v32
    v_exp_f32 v33, v33
    v_mfma_f32_32x32x8_bf16 v[50:65], a[244:245], v[108:109], 0
    v_exp_f32 v34, v34
    v_exp_f32 v35, v35
    v_exp_f32 v36, v36
    v_exp_f32 v37, v37
    v_exp_f32 v38, v38
    v_mfma_f32_32x32x16_bf16 v[50:65], a[240:243], v[102:105], v[50:65]
    s_add_u32 m0, s21, 151552
    ds_read_b128 a[240:243], v118 offset:7168
    v_exp_f32 v39, v39
    v_exp_f32 v40, v40
    v_exp_f32 v41, v41
    v_exp_f32 v42, v42
    v_smfmac_f32_32x32x32_bf16 v[82:97], a[248:251], v[18:25], v253
    s_add_u32 s68, s64, 434176
    s_addc_u32 s69, s65, 0
    ds_read_b128 a[248:251], v120 offset:6144
    global_load_lds_dwordx4 v119, s[68:69] offset:0 sc1
    v_exp_f32 v43, v43
L_pad_p3:
    s_cmp_eq_u32 s37, 1
    s_cbranch_scc1 L_ret_p
    v_exp_f32 v44, v44
    v_exp_f32 v45, v45
    v_smfmac_f32_32x32x32_bf16 v[82:97], a[252:255], v[26:33], v253
    s_waitcnt lgkmcnt(1)
    ds_read_b128 a[252:255], v120 offset:6912
    global_load_lds_dwordx4 v119, s[68:69] offset:1024 sc1
    v_exp_f32 v46, v46
    v_exp_f32 v47, v47
    v_exp_f32 v48, v48
    v_exp_f32 v49, v49
    v_mfma_f32_32x32x8_bf16 v[18:33], a[246:247], v[106:107], 0
    v_exp_f32 v50, v50
    v_exp_f32 v51, v51
    v_exp_f32 v52, v52
    v_exp_f32 v53, v53
    v_exp_f32 v54, v54
    v_mfma_f32_32x32x16_bf16 v[18:33], a[240:243], v[98:101], v[18:33]
    s_waitcnt lgkmcnt(1)
    v_exp_f32 v55, v55
    v_exp_f32 v56, v56
    v_exp_f32 v57, v57
    v_exp_f32 v58, v58
    v_smfmac_f32_32x32x32_bf16 v[66:81], a[248:251], v[34:41], v253
    s_waitcnt lgkmcnt(0)
    v_exp_f32 v59, v59
    v_exp_f32 v60, v60
    v_exp_f32 v61, v61
    v_exp_f32 v62, v62
    v_smfmac_f32_32x32x32_bf16 v[66:81], a[252:255], v[42:49], v253
    global_load_lds_dwordx4 v119, s[68:69] offset:2048 sc1
    v_exp_f32 v63, v63
    v_exp_f32 v64, v64
    v_exp_f32 v65, v65
    v_mfma_f32_32x32x8_bf16 v[34:49], a[246:247], v[108:109], 0
    v_exp_f32 v18, v18
    v_exp_f32 v19, v19
    v_exp_f32 v20, v20
    v_exp_f32 v21, v21
    v_exp_f32 v22, v22
    v_mfma_f32_32x32x16_bf16 v[34:49], a[240:243], v[102:105], v[34:49]
    ds_read2st64_b64 a[244:247], v121 offset0:28 offset1:29
    ds_read_b128 a[240:243], v118 offset:12288
    v_exp_f32 v23, v23
    v_exp_f32 v24, v24
    v_exp_f32 v25, v25
    v_exp_f32 v26, v26
    v_smfmac_f32_32x32x32_bf16 v[82:97], a[248:251], v[50:57], v253
    ds_read_b128 a[248:251], v120 offset:7680
    v_exp_f32 v27, v27
    v_exp_f32 v28, v28
    v_exp_f32 v29, v29
    v_smfmac_f32_32x32x32_bf16 v[82:97], a[252:255], v[58:65], v253
    s_waitcnt lgkmcnt(1)
    ds_read_b128 a[252:255], v120 offset:8448
    v_exp_f32 v30, v30
    v_exp_f32 v31, v31
    v_exp_f32 v32, v32
    v_exp_f32 v33, v33
    v_mfma_f32_32x32x8_bf16 v[50:65], a[244:245], v[106:107], 0
    v_exp_f32 v34, v34
    v_exp_f32 v35, v35
    v_exp_f32 v36, v36
    v_exp_f32 v37, v37
    v_mfma_f32_32x32x16_bf16 v[50:65], a[240:243], v[98:101], v[50:65]
    s_waitcnt lgkmcnt(1)
    v_exp_f32 v38, v38
    v_exp_f32 v39, v39
    v_exp_f32 v40, v40
    v_exp_f32 v41, v41
    v_smfmac_f32_32x32x32_bf16 v[66:81], a[248:251], v[18:25], v253
    s_waitcnt lgkmcnt(0)
    v_exp_f32 v42, v42
    v_exp_f32 v43, v43
    v_exp_f32 v44, v44
    v_exp_f32 v45, v45
    v_smfmac_f32_32x32x32_bf16 v[66:81], a[252:255], v[26:33], v253
    v_exp_f32 v46, v46
    v_exp_f32 v47, v47
    v_exp_f32 v48, v48
    v_exp_f32 v49, v49
    v_mfma_f32_32x32x8_bf16 v[18:33], a[244:245], v[108:109], 0
    v_exp_f32 v50, v50
    v_exp_f32 v51, v51
    v_exp_f32 v52, v52
    v_exp_f32 v53, v53
    v_exp_f32 v54, v54
    v_mfma_f32_32x32x16_bf16 v[18:33], a[240:243], v[102:105], v[18:33]
    ds_read_b128 a[240:243], v118 offset:13312
    v_exp_f32 v55, v55
    v_exp_f32 v56, v56
    v_exp_f32 v57, v57
    v_exp_f32 v58, v58
    v_smfmac_f32_32x32x32_bf16 v[82:97], a[248:251], v[34:41], v253
    ds_read_b128 a[248:251], v120 offset:12288
    v_exp_f32 v59, v59
    v_exp_f32 v60, v60
    v_exp_f32 v61, v61
    v_smfmac_f32_32x32x32_bf16 v[82:97], a[252:255], v[42:49], v253
    s_waitcnt lgkmcnt(1)
    ds_read_b128 a[252:255], v120 offset:13056
    v_exp_f32 v62, v62
    v_exp_f32 v63, v63
    v_exp_f32 v64, v64
    v_exp_f32 v65, v65
    v_mfma_f32_32x32x8_bf16 v[34:49], a[246:247], v[106:107], 0
    v_exp_f32 v18, v18
    v_exp_f32 v19, v19
    v_exp_f32 v20, v20
    v_exp_f32 v21, v21
    v_mfma_f32_32x32x16_bf16 v[34:49], a[240:243], v[98:101], v[34:49]
    s_waitcnt lgkmcnt(1)
    v_exp_f32 v22, v22
    v_exp_f32 v23, v23
    v_exp_f32 v24, v24
    v_exp_f32 v25, v25
    v_smfmac_f32_32x32x32_bf16 v[66:81], a[248:251], v[50:57], v253
    s_waitcnt lgkmcnt(0)
    v_exp_f32 v26, v26
    v_exp_f32 v27, v27
    v_exp_f32 v28, v28
    v_exp_f32 v29, v29
    v_smfmac_f32_32x32x32_bf16 v[66:81], a[252:255], v[58:65], v253
    v_exp_f32 v30, v30
    v_exp_f32 v31, v31
    v_exp_f32 v32, v32
    v_exp_f32 v33, v33
    v_mfma_f32_32x32x8_bf16 v[50:65], a[246:247], v[108:109], 0
    v_exp_f32 v34, v34
    v_exp_f32 v35, v35
    v_exp_f32 v36, v36
    v_exp_f32 v37, v37
    v_exp_f32 v38, v38
    v_mfma_f32_32x32x16_bf16 v[50:65], a[240:243], v[102:105], v[50:65]
    ds_read2st64_b64 a[244:247], v121 offset0:40 offset1:41
    ds_read_b128 a[240:243], v118 offset:18432
    v_exp_f32 v39, v39
    v_exp_f32 v40, v40
    v_exp_f32 v41, v41
    v_exp_f32 v42, v42
    v_smfmac_f32_32x32x32_bf16 v[82:97], a[248:251], v[18:25], v253
    ds_read_b128 a[248:251], v120 offset:13824
    v_exp_f32 v43, v43
    v_exp_f32 v44, v44
    v_exp_f32 v45, v45
    v_exp_f32 v46, v46
    v_smfmac_f32_32x32x32_bf16 v[82:97], a[252:255], v[26:33], v253
    s_waitcnt lgkmcnt(1)
    ds_read_b128 a[252:255], v120 offset:14592
    buffer_load_dword v116, v129, s[64:67], s9 offen sc1
    v_exp_f32 v47, v47
    v_exp_f32 v48, v48
    v_exp_f32 v49, v49
    v_mfma_f32_32x32x8_bf16 v[18:33], a[244:245], v[106:107], 0
    v_exp_f32 v50, v50
    v_exp_f32 v51, v51
    v_exp_f32 v52, v52
    v_exp_f32 v53, v53
    v_exp_f32 v54, v54
    v_mfma_f32_32x32x16_bf16 v[18:33], a[240:243], v[98:101], v[18:33]
    s_waitcnt lgkmcnt(1)
    v_exp_f32 v55, v55
    v_exp_f32 v56, v56
    v_exp_f32 v57, v57
    v_exp_f32 v58, v58
    v_smfmac_f32_32x32x32_bf16 v[66:81], a[248:251], v[34:41], v253
    s_waitcnt vmcnt(1) lgkmcnt(0)
    s_barrier
    v_exp_f32 v59, v59
    v_exp_f32 v60, v60
    v_exp_f32 v61, v61
    v_smfmac_f32_32x32x32_bf16 v[66:81], a[252:255], v[42:49], v253
    v_exp_f32 v62, v62
    v_exp_f32 v63, v63
    v_exp_f32 v64, v64
    v_exp_f32 v65, v65
    v_mfma_f32_32x32x8_bf16 v[34:49], a[244:245], v[108:109], 0
    v_exp_f32 v18, v18
    v_exp_f32 v19, v19
    v_exp_f32 v20, v20
    v_exp_f32 v21, v21
    v_exp_f32 v22, v22
    v_mfma_f32_32x32x16_bf16 v[34:49], a[240:243], v[102:105], v[34:49]
    s_add_u32 m0, s21, 126976
    ds_read_b128 a[240:243], v118 offset:19456
    v_exp_f32 v23, v23
    v_exp_f32 v24, v24
    v_exp_f32 v25, v25
    v_exp_f32 v26, v26
    v_smfmac_f32_32x32x32_bf16 v[82:97], a[248:251], v[50:57], v253
    s_add_u32 s68, s64, 446464
    s_addc_u32 s69, s65, 0
    ds_read_b128 a[248:251], v120 offset:18432
    global_load_lds_dwordx4 v119, s[68:69] offset:0 sc1
    v_exp_f32 v27, v27
    v_exp_f32 v28, v28
    v_exp_f32 v29, v29
    v_smfmac_f32_32x32x32_bf16 v[82:97], a[252:255], v[58:65], v253
    s_waitcnt lgkmcnt(1)
    ds_read_b128 a[252:255], v120 offset:19200
    global_load_lds_dwordx4 v119, s[68:69] offset:1024 sc1
    v_exp_f32 v30, v30
    v_exp_f32 v31, v31
    v_exp_f32 v32, v32
    v_exp_f32 v33, v33
    v_mfma_f32_32x32x8_bf16 v[50:65], a[246:247], v[106:107], 0
    v_exp_f32 v34, v34
    v_exp_f32 v35, v35
    v_exp_f32 v36, v36
    v_exp_f32 v37, v37
    v_exp_f32 v38, v38
    v_mfma_f32_32x32x16_bf16 v[50:65], a[240:243], v[98:101], v[50:65]
    s_waitcnt lgkmcnt(1)
    s_mul_i32 s100, s85, 40960
    v_exp_f32 v39, v39
    v_exp_f32 v40, v40
    v_exp_f32 v41, v41
    v_exp_f32 v42, v42
    v_add_u32 v248, s100, v110
    v_smfmac_f32_32x32x32_bf16 v[66:81], a[248:251], v[18:25], v253
    s_waitcnt lgkmcnt(0)
    s_sub_u32 s100, 40960, s100
    v_exp_f32 v43, v43
    v_exp_f32 v44, v44
    v_exp_f32 v45, v45
    v_exp_f32 v46, v46
    v_smfmac_f32_32x32x32_bf16 v[66:81], a[252:255], v[26:33], v253
    s_waitcnt vmcnt(2)
    global_load_lds_dwordx4 v119, s[68:69] offset:2048 sc1
    v_exp_f32 v47, v47
    v_exp_f32 v48, v48
    v_exp_f32 v49, v49
    v_add_u32 v249, s100, v110
    v_mfma_f32_32x32x8_bf16 v[18:33], a[246:247], v[108:109], 0
    v_exp_f32 v50, v50
    v_exp_f32 v51, v51
    v_exp_f32 v52, v52
    v_exp_f32 v53, v53
    v_exp_f32 v54, v54
    v_cmp_eq_u32 vcc, -1, v116
    v_mfma_f32_32x32x16_bf16 v[18:33], a[240:243], v[102:105], v[18:33]
    ds_read2st64_b64 a[244:247], v121 offset0:52 offset1:53
    ds_read_b128 a[240:243], v118 offset:24576
    s_nop 0
    s_cbranch_vccnz L_retry_25
L_ok_26:
    v_exp_f32 v55, v55
    v_exp_f32 v56, v56
    v_exp_f32 v57, v57
    v_smfmac_f32_32x32x32_bf16 v[82:97], a[248:251], v[34:41], v253
    ds_read_b128 a[248:251], v120 offset:19968
    v_exp_f32 v58, v58
    v_exp_f32 v59, v59
    v_exp_f32 v60, v60
    v_exp_f32 v61, v61
    v_smfmac_f32_32x32x32_bf16 v[82:97], a[252:255], v[42:49], v253
    s_waitcnt lgkmcnt(1)
    ds_read_b128 a[252:255], v120 offset:20736
    v_exp_f32 v62, v62
    v_exp_f32 v63, v63
    v_exp_f32 v64, v64
    v_exp_f32 v65, v65
    v_mfma_f32_32x32x8_bf16 v[34:49], a[244:245], v[106:107], 0
    v_exp_f32 v18, v18
    v_exp_f32 v19, v19
    v_exp_f32 v20, v20
    v_exp_f32 v21, v21
    v_exp_f32 v22, v22
    v_mfma_f32_32x32x16_bf16 v[34:49], a[240:243], v[98:101], v[34:49]
    s_waitcnt lgkmcnt(1)
    s_add_u32 s78, s64, s10
    s_addc_u32 s79, s65, 0
    global_load_dwordx4 a[0:3], v248, s[78:79] offset:-4096 sc1
    v_exp_f32 v23, v23
    v_exp_f32 v24, v24
    v_exp_f32 v25, v25
    v_exp_f32 v26, v26
    v_smfmac_f32_32x32x32_bf16 v[66:81], a[248:251], v[50:57], v253
    s_waitcnt lgkmcnt(0)
    global_load_dwordx4 a[4:7], v249, s[78:79] offset:-4096 sc1
    v_exp_f32 v27, v27
    v_exp_f32 v28, v28
    v_exp_f32 v29, v29
    v_smfmac_f32_32x32x32_bf16 v[66:81], a[252:255], v[58:65], v253
    global_load_dwordx4 a[8:11], v248, s[78:79] offset:-3072 sc1
    v_exp_f32 v30, v30
    v_exp_f32 v31, v31
    v_exp_f32 v32, v32
    v_exp_f32 v33, v33
    v_mfma_f32_32x32x8_bf16 v[50:65], a[244:245], v[108:109], 0
    v_exp_f32 v34, v34
    v_exp_f32 v35, v35
    v_exp_f32 v36, v36
    v_exp_f32 v37, v37
    v_exp_f32 v38, v38
    v_mfma_f32_32x32x16_bf16 v[50:65], a[240:243], v[102:105], v[50:65]
    ds_read_b128 a[240:243], v118 offset:25600
    global_load_dwordx4 a[12:15], v249, s[78:79] offset:-3072 sc1
    v_exp_f32 v39, v39
    v_exp_f32 v40, v40
    v_exp_f32 v41, v41
    v_exp_f32 v42, v42
    v_smfmac_f32_32x32x32_bf16 v[82:97], a[248:251], v[18:25], v253
    ds_read_b128 a[248:251], v120 offset:24576
    global_load_dwordx4 a[16:19], v248, s[78:79] offset:0 sc1
    v_exp_f32 v43, v43
    v_exp_f32 v44, v44
    v_exp_f32 v45, v45
    v_smfmac_f32_32x32x32_bf16 v[82:97], a[252:255], v[26:33], v253
    s_waitcnt lgkmcnt(1)
    ds_read_b128 a[252:255], v120 offset:25344
    global_load_dwordx4 a[20:23], v249, s[78:79] offset:0 sc1
    v_exp_f32 v46, v46
    v_exp_f32 v47, v47
    v_exp_f32 v48, v48
    v_exp_f32 v49, v49
    v_mfma_f32_32x32x8_bf16 v[18:33], a[246:247], v[106:107], 0
    v_exp_f32 v50, v50
    v_exp_f32 v51, v51
    v_exp_f32 v52, v52
    v_exp_f32 v53, v53
    v_exp_f32 v54, v54
    v_mfma_f32_32x32x16_bf16 v[18:33], a[240:243], v[98:101], v[18:33]
    s_waitcnt lgkmcnt(1)
    global_load_dwordx4 a[24:27], v248, s[78:79] offset:1024 sc1
    v_exp_f32 v55, v55
    v_exp_f32 v56, v56
    v_exp_f32 v57, v57
    v_exp_f32 v58, v58
    v_smfmac_f32_32x32x32_bf16 v[66:81], a[248:251], v[34:41], v253
    s_waitcnt lgkmcnt(0)
    global_load_dwordx4 a[28:31], v249, s[78:79] offset:1024 sc1
    v_exp_f32 v59, v59
    v_exp_f32 v60, v60
    v_exp_f32 v61, v61
    v_smfmac_f32_32x32x32_bf16 v[66:81], a[252:255], v[42:49], v253
    s_add_u32 s78, s78, 8192
    s_addc_u32 s79, s79, 0
    global_load_dwordx4 a[32:35], v248, s[78:79] offset:-4096 sc1
    v_exp_f32 v62, v62
    v_exp_f32 v63, v63
    v_exp_f32 v64, v64
    v_exp_f32 v65, v65
    v_mfma_f32_32x32x8_bf16 v[34:49], a[246:247], v[108:109], 0
    v_exp_f32 v18, v18
    v_exp_f32 v19, v19
    v_exp_f32 v20, v20
    v_exp_f32 v21, v21
    v_exp_f32 v22, v22
    v_mfma_f32_32x32x16_bf16 v[34:49], a[240:243], v[102:105], v[34:49]
    ds_read2st64_b64 a[244:247], v121 offset0:64 offset1:65
    ds_read_b128 a[240:243], v118 offset:30720
    global_load_dwordx4 a[36:39], v249, s[78:79] offset:-4096 sc1
    v_exp_f32 v23, v23
    v_exp_f32 v24, v24
    v_exp_f32 v25, v25
    v_smfmac_f32_32x32x32_bf16 v[82:97], a[248:251], v[50:57], v253
    ds_read_b128 a[248:251], v120 offset:26112
    global_load_dwordx4 a[40:43], v248, s[78:79] offset:-3072 sc1
    v_exp_f32 v26, v26
    v_exp_f32 v27, v27
    v_exp_f32 v28, v28
    v_exp_f32 v29, v29
    v_smfmac_f32_32x32x32_bf16 v[82:97], a[252:255], v[58:65], v253
    s_waitcnt lgkmcnt(1)
    ds_read_b128 a[252:255], v120 offset:26880
    global_load_dwordx4 a[44:47], v249, s[78:79] offset:-3072 sc1
    v_exp_f32 v30, v30
    v_exp_f32 v31, v31
    v_exp_f32 v32, v32
    v_exp_f32 v33, v33
    v_mfma_f32_32x32x8_bf16 v[50:65], a[244:245], v[106:107], 0
    global_load_dwordx4 a[48:51], v248, s[78:79] offset:0 sc1
    v_exp_f32 v34, v34
    v_exp_f32 v35, v35
    v_exp_f32 v36, v36
    v_exp_f32 v37, v37
    v_exp_f32 v38, v38
    v_mfma_f32_32x32x16_bf16 v[50:65], a[240:243], v[98:101], v[50:65]
    s_waitcnt lgkmcnt(1)
    global_load_dwordx4 a[52:55], v249, s[78:79] offset:0 sc1
    v_exp_f32 v39, v39
    v_exp_f32 v40, v40
    v_exp_f32 v41, v41
    v_exp_f32 v42, v42
    v_smfmac_f32_32x32x32_bf16 v[66:81], a[248:251], v[18:25], v253
    s_waitcnt vmcnt(14) lgkmcnt(0)
    s_barrier
    v_exp_f32 v43, v43
    v_exp_f32 v44, v44
    v_exp_f32 v45, v45
    v_smfmac_f32_32x32x32_bf16 v[66:81], a[252:255], v[26:33], v253
    global_load_dwordx4 a[56:59], v248, s[78:79] offset:1024 sc1
    v_exp_f32 v46, v46
    v_exp_f32 v47, v47
    v_exp_f32 v48, v48
    v_exp_f32 v49, v49
    v_mfma_f32_32x32x8_bf16 v[18:33], a[244:245], v[108:109], 0
    v_exp_f32 v50, v50
    v_exp_f32 v51, v51
    v_exp_f32 v52, v52
    v_exp_f32 v53, v53
    v_exp_f32 v54, v54
    v_mfma_f32_32x32x16_bf16 v[18:33], a[240:243], v[102:105], v[18:33]
    ds_read_b128 a[240:243], v118 offset:31744
    global_load_dwordx4 a[60:63], v249, s[78:79] offset:1024 sc1
    v_exp_f32 v55, v55
    v_exp_f32 v56, v56
    v_exp_f32 v57, v57
    v_exp_f32 v58, v58
    v_smfmac_f32_32x32x32_bf16 v[82:97], a[248:251], v[34:41], v253
    s_add_u32 s78, s78, 8192
    s_addc_u32 s79, s79, 0
    ds_read_b128 a[248:251], v120 offset:30720
    global_load_dwordx4 a[64:67], v248, s[78:79] offset:-4096 sc1
    v_exp_f32 v59, v59
    v_exp_f32 v60, v60
    v_exp_f32 v61, v61
    v_smfmac_f32_32x32x32_bf16 v[82:97], a[252:255], v[42:49], v253
    s_waitcnt lgkmcnt(1)
    ds_read_b128 a[252:255], v120 offset:31488
    global_load_dwordx4 a[68:71], v249, s[78:79] offset:-4096 sc1
    v_exp_f32 v62, v62
    v_exp_f32 v63, v63
    v_exp_f32 v64, v64
    v_exp_f32 v65, v65
    v_mfma_f32_32x32x8_bf16 v[34:49], a[246:247], v[106:107], 0
    v_exp_f32 v18, v18
    v_exp_f32 v19, v19
    v_exp_f32 v20, v20
    v_exp_f32 v21, v21
    v_exp_f32 v22, v22
    v_mfma_f32_32x32x16_bf16 v[34:49], a[240:243], v[98:101], v[34:49]
    s_waitcnt lgkmcnt(1)
    global_load_dwordx4 a[72:75], v248, s[78:79] offset:-3072 sc1
    v_exp_f32 v23, v23
    v_exp_f32 v24, v24
    v_exp_f32 v25, v25
    v_exp_f32 v26, v26
    v_smfmac_f32_32x32x32_bf16 v[66:81], a[248:251], v[50:57], v253
    s_waitcnt lgkmcnt(0)
    global_load_dwordx4 a[76:79], v249, s[78:79] offset:-3072 sc1
    v_exp_f32 v27, v27
    v_exp_f32 v28, v28
    v_exp_f32 v29, v29
    v_smfmac_f32_32x32x32_bf16 v[66:81], a[252:255], v[58:65], v253
    global_load_dwordx4 a[80:83], v248, s[78:79] offset:0 sc1
    v_exp_f32 v30, v30
    v_exp_f32 v31, v31
    v_exp_f32 v32, v32
    v_exp_f32 v33, v33
    v_mfma_f32_32x32x8_bf16 v[50:65], a[246:247], v[108:109], 0
    v_exp_f32 v34, v34
    v_exp_f32 v35, v35
    v_exp_f32 v36, v36
    v_exp_f32 v37, v37
    v_exp_f32 v38, v38
    v_mfma_f32_32x32x16_bf16 v[50:65], a[240:243], v[102:105], v[50:65]
    ds_read2st64_b64 a[244:247], v121 offset0:4 offset1:5
    ds_read_b128 a[240:243], v118 offset:0
    global_load_dwordx4 a[84:87], v249, s[78:79] offset:0 sc1
    v_exp_f32 v39, v39
    v_exp_f32 v40, v40
    v_exp_f32 v41, v41
    v_smfmac_f32_32x32x32_bf16 v[82:97], a[248:251], v[18:25], v253
    ds_read_b128 a[248:251], v120 offset:32256
    global_load_dwordx4 a[88:91], v248, s[78:79] offset:1024 sc1
    v_exp_f32 v42, v42
    v_exp_f32 v43, v43
    v_exp_f32 v44, v44
    v_exp_f32 v45, v45
    v_smfmac_f32_32x32x32_bf16 v[82:97], a[252:255], v[26:33], v253
    s_waitcnt lgkmcnt(1)
    ds_read_b128 a[252:255], v120 offset:33024
    global_load_dwordx4 a[92:95], v249, s[78:79] offset:1024 sc1
    v_exp_f32 v46, v46
    v_exp_f32 v47, v47
    v_exp_f32 v48, v48
    v_exp_f32 v49, v49
    v_mfma_f32_32x32x8_bf16 v[18:33], a[244:245], v[106:107], 0
    v_exp_f32 v50, v50
    v_exp_f32 v51, v51
    v_exp_f32 v52, v52
    v_exp_f32 v53, v53
    v_exp_f32 v54, v54
    v_mfma_f32_32x32x16_bf16 v[18:33], a[240:243], v[98:101], v[18:33]
    s_waitcnt lgkmcnt(1)
    s_add_u32 s78, s78, 8192
    s_addc_u32 s79, s79, 0
    global_load_dwordx4 a[96:99], v248, s[78:79] offset:-4096 sc1
    v_exp_f32 v55, v55
    v_exp_f32 v56, v56
    v_exp_f32 v57, v57
    v_exp_f32 v58, v58
    v_smfmac_f32_32x32x32_bf16 v[66:81], a[248:251], v[34:41], v253
    s_waitcnt lgkmcnt(0)
    global_load_dwordx4 a[100:103], v249, s[78:79] offset:-4096 sc1
    v_exp_f32 v59, v59
    v_exp_f32 v60, v60
    v_exp_f32 v61, v61
    v_smfmac_f32_32x32x32_bf16 v[66:81], a[252:255], v[42:49], v253
    global_load_dwordx4 a[104:107], v248, s[78:79] offset:-3072 sc1
    v_exp_f32 v62, v62
    v_exp_f32 v63, v63
    v_exp_f32 v64, v64
    v_exp_f32 v65, v65
    v_mfma_f32_32x32x8_bf16 v[34:49], a[244:245], v[108:109], 0
    v_exp_f32 v18, v18
    v_exp_f32 v19, v19
    v_exp_f32 v20, v20
    v_exp_f32 v21, v21
    v_exp_f32 v22, v22
    v_mfma_f32_32x32x16_bf16 v[34:49], a[240:243], v[102:105], v[34:49]
    ds_read_b128 a[240:243], v118 offset:1024
    global_load_dwordx4 a[108:111], v249, s[78:79] offset:-3072 sc1
    v_exp_f32 v23, v23
    v_exp_f32 v24, v24
    v_exp_f32 v25, v25
    v_exp_f32 v26, v26
    v_smfmac_f32_32x32x32_bf16 v[82:97], a[248:251], v[50:57], v253
    ds_read_b128 a[248:251], v120 offset:0
    global_load_dwordx4 a[112:115], v248, s[78:79] offset:0 sc1
    v_exp_f32 v27, v27
    v_exp_f32 v28, v28
    v_exp_f32 v29, v29
    v_smfmac_f32_32x32x32_bf16 v[82:97], a[252:255], v[58:65], v253
    s_waitcnt lgkmcnt(1)
    ds_read_b128 a[252:255], v120 offset:768
    global_load_dwordx4 a[116:119], v249, s[78:79] offset:0 sc1
    v_exp_f32 v30, v30
    v_exp_f32 v31, v31
    v_exp_f32 v32, v32
    v_exp_f32 v33, v33
    v_mfma_f32_32x32x8_bf16 v[50:65], a[246:247], v[106:107], 0
    v_exp_f32 v34, v34
    v_exp_f32 v35, v35
    v_exp_f32 v36, v36
    v_exp_f32 v37, v37
    v_exp_f32 v38, v38
    v_mfma_f32_32x32x16_bf16 v[50:65], a[240:243], v[98:101], v[50:65]
    s_waitcnt lgkmcnt(1)
    global_load_dwordx4 a[120:123], v248, s[78:79] offset:1024 sc1
    v_exp_f32 v39, v39
    v_exp_f32 v40, v40
    v_exp_f32 v41, v41
    v_exp_f32 v42, v42
    v_smfmac_f32_32x32x32_bf16 v[66:81], a[248:251], v[18:25], v253
    s_waitcnt lgkmcnt(0)
    s_barrier
    v_exp_f32 v43, v43
    v_exp_f32 v44, v44
    v_exp_f32 v45, v45
    v_smfmac_f32_32x32x32_bf16 v[66:81], a[252:255], v[26:33], v253
    global_load_dwordx4 a[124:127], v249, s[78:79] offset:1024 sc1
    v_exp_f32 v46, v46
    v_exp_f32 v47, v47
    v_exp_f32 v48, v48
    v_exp_f32 v49, v49
    v_mfma_f32_32x32x8_bf16 v[18:33], a[246:247], v[108:109], 0
    v_exp_f32 v50, v50
    v_exp_f32 v51, v51
    v_exp_f32 v52, v52
    v_exp_f32 v53, v53
    v_exp_f32 v54, v54
    v_mfma_f32_32x32x16_bf16 v[18:33], a[240:243], v[102:105], v[18:33]
    s_add_u32 m0, s50, 143360
    s_add_u32 s76, s18, 20480
    s_addc_u32 s77, s19, 0
    ds_read2st64_b64 a[244:247], v121 offset0:16 offset1:17
    ds_read_b128 a[240:243], v118 offset:6144
    global_load_lds_dwordx4 v228, s[76:77] offset:0 sc0
    v_exp_f32 v55, v55
    v_exp_f32 v56, v56
    v_exp_f32 v57, v57
    v_smfmac_f32_32x32x32_bf16 v[82:97], a[248:251], v[34:41], v253
    s_add_u32 m0, s50, 147328
    ds_read_b128 a[248:251], v120 offset:1536
    global_load_lds_dwordx4 v228, s[76:77] offset:128 sc0
    v_exp_f32 v58, v58
    v_exp_f32 v59, v59
    v_exp_f32 v60, v60
    v_exp_f32 v61, v61
    v_smfmac_f32_32x32x32_bf16 v[82:97], a[252:255], v[42:49], v253
    s_waitcnt lgkmcnt(1)
    s_add_u32 m0, s50, 151296
    ds_read_b128 a[252:255], v120 offset:2304
    global_load_lds_dwordx4 v228, s[76:77] offset:256 sc0
    v_exp_f32 v62, v62
    v_exp_f32 v63, v63
    v_exp_f32 v64, v64
    v_exp_f32 v65, v65
    v_mfma_f32_32x32x8_bf16 v[34:49], a[244:245], v[106:107], 0
    v_exp_f32 v18, v18
    v_exp_f32 v19, v19
    v_exp_f32 v20, v20
    v_exp_f32 v21, v21
    v_exp_f32 v22, v22
    v_mfma_f32_32x32x16_bf16 v[34:49], a[240:243], v[98:101], v[34:49]
    s_waitcnt lgkmcnt(1)
    s_add_u32 m0, s50, 155264
    s_nop 0
    global_load_lds_dwordx4 v228, s[76:77] offset:384 sc0
    v_exp_f32 v23, v23
    v_exp_f32 v24, v24
    v_exp_f32 v25, v25
    v_exp_f32 v26, v26
    v_smfmac_f32_32x32x32_bf16 v[66:81], a[248:251], v[50:57], v253
    s_waitcnt lgkmcnt(0)
    s_add_u32 m0, s50, 159232
    s_nop 0
    global_load_lds_dwordx4 v228, s[76:77] offset:512 sc0
    v_exp_f32 v27, v27
    v_exp_f32 v28, v28
    v_exp_f32 v29, v29
    v_smfmac_f32_32x32x32_bf16 v[66:81], a[252:255], v[58:65], v253
    s_add_u32 s78, s78, 8192
    s_addc_u32 s79, s79, 0
    global_load_dwordx4 a[128:131], v248, s[78:79] offset:-4096 sc1
    v_exp_f32 v30, v30
    v_exp_f32 v31, v31
    v_exp_f32 v32, v32
    v_exp_f32 v33, v33
    v_mfma_f32_32x32x8_bf16 v[50:65], a[244:245], v[108:109], 0
    v_exp_f32 v34, v34
    v_exp_f32 v35, v35
    v_exp_f32 v36, v36
    v_exp_f32 v37, v37
    v_exp_f32 v38, v38
    v_mfma_f32_32x32x16_bf16 v[50:65], a[240:243], v[102:105], v[50:65]
    ds_read_b128 a[240:243], v118 offset:7168
    global_load_dwordx4 a[132:135], v249, s[78:79] offset:-4096 sc1
    v_exp_f32 v39, v39
    v_exp_f32 v40, v40
    v_exp_f32 v41, v41
    v_exp_f32 v42, v42
    v_smfmac_f32_32x32x32_bf16 v[82:97], a[248:251], v[18:25], v253
    ds_read_b128 a[248:251], v120 offset:6144
    global_load_dwordx4 a[136:139], v248, s[78:79] offset:-3072 sc1
    v_exp_f32 v43, v43
    v_exp_f32 v44, v44
    v_exp_f32 v45, v45
    v_smfmac_f32_32x32x32_bf16 v[82:97], a[252:255], v[26:33], v253
    s_waitcnt lgkmcnt(1)
    ds_read_b128 a[252:255], v120 offset:6912
    global_load_dwordx4 a[140:143], v249, s[78:79] offset:-3072 sc1
    v_exp_f32 v46, v46
    v_exp_f32 v47, v47
    v_exp_f32 v48, v48
    v_exp_f32 v49, v49
    v_mfma_f32_32x32x8_bf16 v[18:33], a[246:247], v[106:107], 0
    v_exp_f32 v50, v50
    v_exp_f32 v51, v51
    v_exp_f32 v52, v52
    v_exp_f32 v53, v53
    v_exp_f32 v54, v54
    v_mfma_f32_32x32x16_bf16 v[18:33], a[240:243], v[98:101], v[18:33]
    s_waitcnt lgkmcnt(1)
    global_load_dwordx4 a[144:147], v248, s[78:79] offset:0 sc1
    v_exp_f32 v55, v55
    v_exp_f32 v56, v56
    v_exp_f32 v57, v57
    v_exp_f32 v58, v58
    v_smfmac_f32_32x32x32_bf16 v[66:81], a[248:251], v[34:41], v253
    s_waitcnt lgkmcnt(0)
    global_load_dwordx4 a[148:151], v249, s[78:79] offset:0 sc1
    v_exp_f32 v59, v59
    v_exp_f32 v60, v60
    v_exp_f32 v61, v61
    v_smfmac_f32_32x32x32_bf16 v[66:81], a[252:255], v[42:49], v253
    global_load_dwordx4 a[152:155], v248, s[78:79] offset:1024 sc1
    v_exp_f32 v62, v62
    v_exp_f32 v63, v63
    v_exp_f32 v64, v64
    v_exp_f32 v65, v65
    v_mfma_f32_32x32x8_bf16 v[34:49], a[246:247], v[108:109], 0
    v_exp_f32 v18, v18
    v_exp_f32 v19, v19
    v_exp_f32 v20, v20
    v_exp_f32 v21, v21
    v_exp_f32 v22, v22
    v_mfma_f32_32x32x16_bf16 v[34:49], a[240:243], v[102:105], v[34:49]
    global_load_dwordx4 a[156:159], v249, s[78:79] offset:1024 sc1
    v_exp_f32 v23, v23
    v_exp_f32 v24, v24
    v_exp_f32 v25, v25
    v_exp_f32 v26, v26
    v_smfmac_f32_32x32x32_bf16 v[82:97], a[248:251], v[50:57], v253
    ds_read_b128 a[248:251], v120 offset:7680
    v_exp_f32 v27, v27
    v_exp_f32 v28, v28
    v_exp_f32 v29, v29
    v_smfmac_f32_32x32x32_bf16 v[82:97], a[252:255], v[58:65], v253
    s_waitcnt lgkmcnt(0)
    ds_read_b128 a[252:255], v120 offset:8448
    v_exp_f32 v30, v30
    v_exp_f32 v31, v31
    v_exp_f32 v32, v32
    v_exp_f32 v33, v33
    v_smfmac_f32_32x32x32_bf16 v[66:81], a[248:251], v[18:25], v253
    s_waitcnt lgkmcnt(0)
    v_exp_f32 v34, v34
    v_exp_f32 v35, v35
    v_exp_f32 v36, v36
    v_exp_f32 v37, v37
    v_exp_f32 v38, v38
    v_exp_f32 v39, v39
    v_exp_f32 v40, v40
    v_exp_f32 v41, v41
    v_smfmac_f32_32x32x32_bf16 v[66:81], a[252:255], v[26:33], v253
    v_exp_f32 v42, v42
    v_exp_f32 v43, v43
    v_exp_f32 v44, v44
    v_exp_f32 v45, v45
    v_exp_f32 v46, v46
    v_exp_f32 v47, v47
    v_exp_f32 v48, v48
    v_exp_f32 v49, v49
    s_branch L_back
L_truemax_n:
    v_mov_b32 v114, 0xff800000
    v_mov_b32 v115, 0xff800000
    s_mov_b32 s99, 262144
L_truemax_l_n:
    buffer_load_dwordx4 a[240:243], v110, s[64:67], s99 offen sc1
    buffer_load_dwordx4 a[248:251], v110, s[64:67], s99 offen offset:1024 sc1
    buffer_load_dwordx2 a[244:245], v122, s[64:67], s99 offen offset:2048 sc1
    buffer_load_dwordx2 a[246:247], v122, s[64:67], s99 offen offset:2560 sc1
    s_waitcnt vmcnt(0)
    v_mfma_f32_32x32x16_bf16 v[18:33], a[240:243], v[98:101], 0
    v_mfma_f32_32x32x16_bf16 v[34:49], a[240:243], v[102:105], 0
    v_mfma_f32_32x32x8_bf16 v[18:33], a[244:245], v[106:107], v[18:33]
    v_mfma_f32_32x32x8_bf16 v[34:49], a[244:245], v[108:109], v[34:49]
    s_nop 10
    v_max3_f32 v114, v114, v18, v19
    v_max3_f32 v114, v114, v20, v21
    v_max3_f32 v114, v114, v22, v23
    v_max3_f32 v114, v114, v24, v25
    v_max3_f32 v114, v114, v26, v27
    v_max3_f32 v114, v114, v28, v29
    v_max3_f32 v114, v114, v30, v31
    v_max3_f32 v114, v114, v32, v33
    v_max3_f32 v115, v115, v34, v35
    v_max3_f32 v115, v115, v36, v37
    v_max3_f32 v115, v115, v38, v39
    v_max3_f32 v115, v115, v40, v41
    v_max3_f32 v115, v115, v42, v43
    v_max3_f32 v115, v115, v44, v45
    v_max3_f32 v115, v115, v46, v47
    v_max3_f32 v115, v115, v48, v49
    v_mfma_f32_32x32x16_bf16 v[18:33], a[248:251], v[98:101], 0
    v_mfma_f32_32x32x16_bf16 v[34:49], a[248:251], v[102:105], 0
    v_mfma_f32_32x32x8_bf16 v[18:33], a[246:247], v[106:107], v[18:33]
    v_mfma_f32_32x32x8_bf16 v[34:49], a[246:247], v[108:109], v[34:49]
    s_nop 10
    v_max3_f32 v114, v114, v18, v19
    v_max3_f32 v114, v114, v20, v21
    v_max3_f32 v114, v114, v22, v23
    v_max3_f32 v114, v114, v24, v25
    v_max3_f32 v114, v114, v26, v27
    v_max3_f32 v114, v114, v28, v29
    v_max3_f32 v114, v114, v30, v31
    v_max3_f32 v114, v114, v32, v33
    v_max3_f32 v115, v115, v34, v35
    v_max3_f32 v115, v115, v36, v37
    v_max3_f32 v115, v115, v38, v39
    v_max3_f32 v115, v115, v40, v41
    v_max3_f32 v115, v115, v42, v43
    v_max3_f32 v115, v115, v44, v45
    v_max3_f32 v115, v115, v46, v47
    v_max3_f32 v115, v115, v48, v49
    s_add_u32 s99, s99, 6144
    s_cmp_lt_u32 s99, 458752
    s_cbranch_scc1 L_truemax_l_n
    v_mov_b32 v2, v114
    s_nop 1
    v_permlane32_swap_b32 v114, v2
    v_max_f32 v114, v114, v2
    v_mov_b32 v2, v115
    s_nop 1
    v_permlane32_swap_b32 v115, v2
    v_max_f32 v115, v115, v2
    v_cvt_pk_bf16_f32 v2, -v114, -v114
    v_and_b32 v3, 0xffff0000, v2
    v_add_f32 v114, v114, v3
    v_cvt_pk_bf16_f32 v4, -v114, -v114
    v_and_b32 v3, 0xffff0000, v4
    v_add_f32 v114, v114, v3
    v_cvt_pk_bf16_f32 v5, -v114, 0
    v_and_b32 v2, 0xffff, v2
    v_or_b32 v2, v2, v3
    v_cndmask_b32 v106, v106, v2, s[22:23]
    v_cndmask_b32 v107, v107, v5, s[22:23]
    v_cvt_pk_bf16_f32 v2, -v115, -v115
    v_and_b32 v3, 0xffff0000, v2
    v_add_f32 v115, v115, v3
    v_cvt_pk_bf16_f32 v4, -v115, -v115
    v_and_b32 v3, 0xffff0000, v4
    v_add_f32 v115, v115, v3
    v_cvt_pk_bf16_f32 v5, -v115, 0
    v_and_b32 v2, 0xffff, v2
    v_or_b32 v2, v2, v3
    v_cndmask_b32 v108, v108, v2, s[22:23]
    v_cndmask_b32 v109, v109, v5, s[22:23]
    s_branch L_havemax_n
L_truemax_p:
    v_mov_b32 v114, 0xff800000
    v_mov_b32 v115, 0xff800000
    s_mov_b32 s99, 262144
L_truemax_l_p:
    buffer_load_dwordx4 a[240:243], v110, s[64:67], s99 offen sc1
    buffer_load_dwordx4 a[248:251], v110, s[64:67], s99 offen offset:1024 sc1
    buffer_load_dwordx2 a[244:245], v122, s[64:67], s99 offen offset:2048 sc1
    buffer_load_dwordx2 a[246:247], v122, s[64:67], s99 offen offset:2560 sc1
    s_waitcnt vmcnt(0)
    v_mfma_f32_32x32x16_bf16 v[18:33], a[240:243], v[98:101], 0
    v_mfma_f32_32x32x16_bf16 v[34:49], a[240:243], v[102:105], 0
    v_mfma_f32_32x32x8_bf16 v[18:33], a[244:245], v[106:107], v[18:33]
    v_mfma_f32_32x32x8_bf16 v[34:49], a[244:245], v[108:109], v[34:49]
    s_nop 10
    v_max3_f32 v114, v114, v18, v19
    v_max3_f32 v114, v114, v20, v21
    v_max3_f32 v114, v114, v22, v23
    v_max3_f32 v114, v114, v24, v25
    v_max3_f32 v114, v114, v26, v27
    v_max3_f32 v114, v114, v28, v29
    v_max3_f32 v114, v114, v30, v31
    v_max3_f32 v114, v114, v32, v33
    v_max3_f32 v115, v115, v34, v35
    v_max3_f32 v115, v115, v36, v37
    v_max3_f32 v115, v115, v38, v39
    v_max3_f32 v115, v115, v40, v41
    v_max3_f32 v115, v115, v42, v43
    v_max3_f32 v115, v115, v44, v45
    v_max3_f32 v115, v115, v46, v47
    v_max3_f32 v115, v115, v48, v49
    v_mfma_f32_32x32x16_bf16 v[18:33], a[248:251], v[98:101], 0
    v_mfma_f32_32x32x16_bf16 v[34:49], a[248:251], v[102:105], 0
    v_mfma_f32_32x32x8_bf16 v[18:33], a[246:247], v[106:107], v[18:33]
    v_mfma_f32_32x32x8_bf16 v[34:49], a[246:247], v[108:109], v[34:49]
    s_nop 10
    v_max3_f32 v114, v114, v18, v19
    v_max3_f32 v114, v114, v20, v21
    v_max3_f32 v114, v114, v22, v23
    v_max3_f32 v114, v114, v24, v25
    v_max3_f32 v114, v114, v26, v27
    v_max3_f32 v114, v114, v28, v29
    v_max3_f32 v114, v114, v30, v31
    v_max3_f32 v114, v114, v32, v33
    v_max3_f32 v115, v115, v34, v35
    v_max3_f32 v115, v115, v36, v37
    v_max3_f32 v115, v115, v38, v39
    v_max3_f32 v115, v115, v40, v41
    v_max3_f32 v115, v115, v42, v43
    v_max3_f32 v115, v115, v44, v45
    v_max3_f32 v115, v115, v46, v47
    v_max3_f32 v115, v115, v48, v49
    s_add_u32 s99, s99, 6144
    s_cmp_lt_u32 s99, 458752
    s_cbranch_scc1 L_truemax_l_p
    v_mov_b32 v2, v114
    s_nop 1
    v_permlane32_swap_b32 v114, v2
    v_max_f32 v114, v114, v2
    v_mov_b32 v2, v115
    s_nop 1
    v_permlane32_swap_b32 v115, v2
    v_max_f32 v115, v115, v2
    v_cvt_pk_bf16_f32 v2, -v114, -v114
    v_and_b32 v3, 0xffff0000, v2
    v_add_f32 v114, v114, v3
    v_cvt_pk_bf16_f32 v4, -v114, -v114
    v_and_b32 v3, 0xffff0000, v4
    v_add_f32 v114, v114, v3
    v_cvt_pk_bf16_f32 v5, -v114, 0
    v_and_b32 v2, 0xffff, v2
    v_or_b32 v2, v2, v3
    v_cndmask_b32 v106, v106, v2, s[22:23]
    v_cndmask_b32 v107, v107, v5, s[22:23]
    v_cvt_pk_bf16_f32 v2, -v115, -v115
    v_and_b32 v3, 0xffff0000, v2
    v_add_f32 v115, v115, v3
    v_cvt_pk_bf16_f32 v4, -v115, -v115
    v_and_b32 v3, 0xffff0000, v4
    v_add_f32 v115, v115, v3
    v_cvt_pk_bf16_f32 v5, -v115, 0
    v_and_b32 v2, 0xffff, v2
    v_or_b32 v2, v2, v3
    v_cndmask_b32 v108, v108, v2, s[22:23]
    v_cndmask_b32 v109, v109, v5, s[22:23]
    s_branch L_havemax_p
L_retry_2:
    s_mov_b32 s6, 0
L_retry_2_l:
    s_sleep 1
    buffer_load_dword v255, v192, s[68:71], s39 offen sc1
    s_add_u32 s6, s6, 1
    s_waitcnt vmcnt(0)
    v_cmp_eq_u32 vcc, s84, v255
    s_nop 3
    s_cbranch_vccz L_ok_3
    s_cmp_lt_u32 s6, 0x40000
    s_cbranch_scc1 L_retry_2_l
    s_branch L_ok_3
L_retry_7:
    s_mov_b32 s6, 0
L_retry_7_l:
    s_sleep 1
    buffer_load_dwordx2 v[178:179], v227, s[64:67], s47 offen sc1
    buffer_load_dwordx2 v[180:181], v190, s[64:67], s47 offen sc1
    buffer_load_dwordx2 v[182:183], v191, s[64:67], s47 offen sc1
    buffer_load_dwordx2 v[184:185], v192, s[64:67], s47 offen sc1
    buffer_load_dwordx2 v[186:187], v193, s[64:67], s47 offen sc1
    buffer_load_dwordx2 v[188:189], v194, s[64:67], s47 offen sc1
    s_add_u32 s6, s6, 1
    s_waitcnt vmcnt(0)
    v_max3_u32 v2, v178, v179, v180
    v_max3_u32 v2, v2, v181, v182
    v_max3_u32 v2, v2, v183, v184
    v_max3_u32 v2, v2, v185, v186
    v_max3_u32 v2, v2, v187, v188
    v_max_u32 v2, v2, v189
    v_cmp_eq_u32 vcc, -1, v2
    s_nop 3
    s_cbranch_vccz L_ok_8
    s_cmp_lt_u32 s6, 0x40000
    s_cbranch_scc1 L_retry_7_l
    s_branch L_ok_8
L_retry_9:
    s_mov_b32 s6, 0
L_retry_9_l:
    s_sleep 1
    buffer_load_dword v116, v242, s[64:67], s42 offen sc1
    s_add_u32 s6, s6, 1
    s_waitcnt vmcnt(0)
    v_cmp_eq_u32 vcc, -1, v116
    s_nop 3
    s_cbranch_vccz L_ok_10
    s_cmp_lt_u32 s6, 0x40000
    s_cbranch_scc1 L_retry_9_l
    s_branch L_ok_10
L_retry_11:
    s_mov_b32 s6, 0
L_retry_11_l:
    s_sleep 1
    buffer_load_dword v116, v129, s[64:67], s9 offen sc1
    s_add_u32 s6, s6, 1
    s_waitcnt vmcnt(0)
    v_cmp_eq_u32 vcc, -1, v116
    s_nop 3
    s_cbranch_vccz L_ok_12
    s_cmp_lt_u32 s6, 0x40000
    s_cbranch_scc1 L_retry_11_l
    s_branch L_ok_12
L_retry_13:
    s_mov_b32 s6, 0
L_retry_13_l:
    s_sleep 1
    buffer_load_dword v116, v235, s[64:67], s26 offen sc1
    s_add_u32 s6, s6, 1
    s_waitcnt vmcnt(0)
    v_cmp_eq_u32 vcc, -1, v116
    s_nop 3
    s_cbranch_vccz L_ok_14
    s_cmp_lt_u32 s6, 0x40000
    s_cbranch_scc1 L_retry_13_l
    s_branch L_ok_14
L_retry_17:
    s_mov_b32 s6, 0
L_retry_17_l:
    s_sleep 1
    buffer_load_dword v255, v192, s[68:71], s39 offen sc1
    s_add_u32 s6, s6, 1
    s_waitcnt vmcnt(0)
    v_cmp_eq_u32 vcc, s84, v255
    s_nop 3
    s_cbranch_vccz L_ok_18
    s_cmp_lt_u32 s6, 0x40000
    s_cbranch_scc1 L_retry_17_l
    s_branch L_ok_18
L_retry_23:
    s_mov_b32 s6, 0
L_retry_23_l:
    s_sleep 1
    buffer_load_dword v116, v242, s[64:67], s42 offen sc1
    s_add_u32 s6, s6, 1
    s_waitcnt vmcnt(0)
    v_cmp_eq_u32 vcc, -1, v116
    s_nop 3
    s_cbranch_vccz L_ok_24
    s_cmp_lt_u32 s6, 0x40000
    s_cbranch_scc1 L_retry_23_l
    s_branch L_ok_24
L_retry_25:
    s_mov_b32 s6, 0
L_retry_25_l:
    s_sleep 1
    buffer_load_dword v116, v129, s[64:67], s9 offen sc1
    s_add_u32 s6, s6, 1
    s_waitcnt vmcnt(0)
    v_cmp_eq_u32 vcc, -1, v116
    s_nop 3
    s_cbranch_vccz L_ok_26
    s_cmp_lt_u32 s6, 0x40000
    s_cbranch_scc1 L_retry_25_l
    s_branch L_ok_26
L_end:
    s_endpgm
.p2align 7
.type L_tab,@object
L_tab:
.long 100352,100352,0,0,100560,100360,8,8
.long 100768,100368,16,16,100976,100376,24,24
.long 101184,100560,32,32,101392,100568,40,40
.long 101600,100576,48,48,101808,100584,56,56
.long 102016,100768,64,64,102224,100776,72,72
.long 102432,100784,80,80,102640,100792,88,88
.long 102848,100976,96,96,103056,100984,104,104
.long 103264,100992,112,112,103472,101000,120,120
.long 100400,102016,268435456,768,100608,102024,268435464,776
.long 100816,102032,268435472,784,101024,102040,268435480,792
.long 101232,102224,268435488,800,101440,102232,268435496,808
.long 101648,102240,268435504,816,101856,102248,268435512,824
.long 102064,102432,268435520,832,102272,102440,268435528,840
.long 102480,102448,268435536,848,102688,102456,268435544,856
.long 102896,102640,268435552,864,103104,102648,268435560,872
.long 103312,102656,268435568,880,103520,102664,268435576,888
.long 100448,103680,536870912,1536,100656,103688,536870920,1544
.long 100864,103696,536870928,1552,101072,103704,536870936,1560
.long 101280,103888,536870944,1568,101488,103896,536870952,1576
.long 101696,103904,536870960,1584,101904,103912,536870968,1592
.long 102112,104096,536870976,1600,102320,104104,536870984,1608
.long 102528,104112,536870992,1616,102736,104120,536871000,1624
.long 102944,104304,536871008,1632,103152,104312,536871016,1640
.long 103360,104320,536871024,1648,103568,104328,536871032,1656
.long 100496,105344,805306368,2304,100704,105352,805306376,2312
.long 100912,105360,805306384,2320,101120,105368,805306392,2328
.long 101328,105552,805306400,2336,101536,105560,805306408,2344
.long 101744,105568,805306416,2352,101952,105576,805306424,2360
.long 102160,105760,805306432,2368,102368,105768,805306440,2376
.long 102576,105776,805306448,2384,102784,105784,805306456,2392
.long 102992,105968,805306464,2400,103200,105976,805306472,2408
.long 103408,105984,805306480,2416,103616,105992,805306488,2424
.long 0,102400,102432,0,16,102528,102560,16
.long 32,102672,102704,32,48,102800,102832,48
.long 64,102944,102912,64,80,103072,103040,80
.long 96,103216,103184,96,112,103344,103312,112
.long 1280,103488,103520,128,1296,103616,103648,144
.long 1312,103760,103792,160,1328,103888,103920,176
.long 1344,104032,104000,192,1360,104160,104128,208
.long 1376,104304,104272,224,1392,104432,104400,240
.long 2576,102416,102448,256,2560,102544,102576,272
.long 2608,102656,102688,288,2592,102784,102816,304
.long 2640,102960,102928,320,2624,103088,103056,336
.long 2672,103200,103168,352,2656,103328,103296,368
.long 3856,103504,103536,384,3840,103632,103664,400
.long 3888,103744,103776,416,3872,103872,103904,432
.long 3920,104048,104016,448,3904,104176,104144,464
.long 3952,104288,104256,480,3936,104416,104384,496
.long 5152,104448,104480,512,5168,104576,104608,528
.long 5120,104720,104752,544,5136,104848,104880,560
.long 5216,104992,104960,576,5232,105120,105088,592
.long 5184,105264,105232,608,5200,105392,105360,624
.long 6432,105536,105568,640,6448,105664,105696,656
.long 6400,105808,105840,672,6416,105936,105968,688
.long 6496,106080,106048,704,6512,106208,106176,720
.long 6464,106352,106320,736,6480,106480,106448,752
.long 7728,104464,104496,768,7712,104592,104624,784
.long 7696,104704,104736,800,7680,104832,104864,816
.long 7792,105008,104976,832,7776,105136,105104,848
.long 7760,105248,105216,864,7744,105376,105344,880
.long 9008,105552,105584,896,8992,105680,105712,912
.long 8976,105792,105824,928,8960,105920,105952,944
.long 9072,106096,106064,960,9056,106224,106192,976
.long 9040,106336,106304,992,9024,106464,106432,1008
.long 0,0,0,0,16,16,16,128
.long 32,32,32,256,48,48,48,384
.long 64,64,64,384,80,80,80,384
.long 96,96,96,384,112,112,112,384
.long 128,128,128,384,144,144,144,384
.long 160,160,160,384,176,176,176,384
.long 192,192,192,384,208,208,208,384
.long 224,224,224,384,240,240,240,384
.long 256,20480,20480,384,272,20496,20496,384
.long 288,20512,20512,384,304,20528,20528,384
.long 320,20544,20544,384,336,20560,20560,384
.long 352,20576,20576,384,368,20592,20592,384
.long 384,20608,20608,384,400,20624,20624,384
.long 416,20640,20640,384,432,20656,20656,384
.long 448,20672,20672,384,464,20688,20688,384
.long 480,20704,20704,384,496,20720,20720,384
.long 512,256,1073741824,384,528,272,1073741840,384
.long 544,288,1073741856,384,560,304,1073741872,384
.long 576,320,1073741888,384,592,336,1073741904,384
.long 608,352,1073741920,384,624,368,1073741936,384
.long 640,384,1073741952,384,656,400,1073741968,384
.long 672,416,1073741984,384,688,432,1073742000,384
.long 704,448,1073742016,384,720,464,1073742032,384
.long 736,480,1073742048,384,752,496,1073742064,384
.long 768,20736,1073762304,384,784,20752,1073762320,384
.long 800,20768,1073762336,384,816,20784,1073762352,384
.long 832,20800,1073762368,384,848,20816,1073762384,384
.long 864,20832,1073762400,384,880,20848,1073762416,384
.long 896,20864,1073762432,384,912,20880,1073762448,384
.long 928,20896,1073762464,384,944,20912,1073762480,384
.long 960,20928,1073762496,384,976,20944,1073762512,384
.long 992,20960,1073762528,384,1008,20976,1073762544,384
.long 102400,102400,104448,0,102416,102464,104512,16
.long 102432,102544,104592,32,102448,102608,104656,48
.long 102464,102688,104736,5120,102480,102752,104800,5136
.long 102496,102832,104880,5152,102512,102896,104944,5168
.long 102544,102912,104960,10240,102560,102976,105024,10256
.long 102576,103056,105104,10272,102528,103120,105168,10288
.long 102608,103200,105248,15360,102624,103264,105312,15376
.long 102640,103344,105392,15392,102592,103408,105456,15408
.long 102688,102416,104464,20480,102704,102480,104528,20496
.long 102656,102560,104608,20512,102672,102624,104672,20528
.long 102752,102704,104752,25600,102768,102768,104816,25616
.long 102720,102784,104832,25632,102736,102848,104896,25648
.long 102832,102928,104976,30720,102784,102992,105040,30736
.long 102800,103072,105120,30752,102816,103136,105184,30768
.long 102896,103216,105264,35840,102848,103280,105328,35856
.long 102864,103296,105344,35872,102880,103360,105408,35888
.long 102912,102432,104480,40960,102928,102496,104544,40976
.long 102944,102576,104624,40992,102960,102640,104688,41008
.long 102976,102656,104704,46080,102992,102720,104768,46096
.long 103008,102800,104848,46112,103024,102864,104912,46128
.long 103056,102944,104992,51200,103072,103008,105056,51216
.long 103088,103088,105136,51232,103040,103152,105200,51248
.long 103120,103168,105216,56320,103136,103232,105280,56336
.long 103152,103312,105360,56352,103104,103376,105424,56368
.long 103200,102448,104496,61440,103216,102512,104560,61456
.long 103168,102528,104576,61472,103184,102592,104640,61488
.long 103264,102672,104720,66560,103280,102736,104784,66576
.long 103232,102816,104864,66592,103248,102880,104928,66608
.long 103344,102960,105008,71680,103296,103024,105072,71696
.long 103312,103040,105088,71712,103328,103104,105152,71728
.long 103408,103184,105232,76800,103360,103248,105296,76816
.long 103376,103328,105376,76832,103392,103392,105440,76848
.long 0,0,0,102400,8,8,256,102416
.long 16,16,512,102432,24,24,768,102448
.long 1280,0,1024,110592,1288,8,1280,110608
.long 1296,16,1536,110624,1304,24,1792,110640
.long 2560,0,2048,102464,2568,8,2304,102480
.long 2576,16,2560,102496,2584,24,2816,102512
.long 3840,0,3072,110656,3848,8,3328,110672
.long 3856,16,3584,110688,3864,24,3840,110704
.long 5120,0,0,102544,5128,8,256,102560
.long 5136,16,512,102576,5144,24,768,102528
.long 6400,0,1024,110736,6408,8,1280,110752
.long 6416,16,1536,110768,6424,24,1792,110720
.long 7680,0,2048,102608,7688,8,2304,102624
.long 7696,16,2560,102640,7704,24,2816,102592
.long 8960,0,3072,110800,8968,8,3328,110816
.long 8976,16,3584,110832,8984,24,3840,110784
.long 10240,0,0,102688,10248,8,256,102704
.long 10256,16,512,102656,10264,24,768,102672
.long 11520,0,1024,110880,11528,8,1280,110896
.long 11536,16,1536,110848,11544,24,1792,110864
.long 12800,0,2048,102752,12808,8,2304,102768
.long 12816,16,2560,102720,12824,24,2816,102736
.long 14080,0,3072,110944,14088,8,3328,110960
.long 14096,16,3584,110912,14104,24,3840,110928
.long 15360,0,0,102832,15368,8,256,102784
.long 15376,16,512,102800,15384,24,768,102816
.long 16640,0,1024,111024,16648,8,1280,110976
.long 16656,16,1536,110992,16664,24,1792,111008
.long 17920,0,2048,102896,17928,8,2304,102848
.long 17936,16,2560,102864,17944,24,2816,102880
.long 19200,0,3072,111088,19208,8,3328,111040
.long 19216,16,3584,111056,19224,24,3840,111072
.long 0,0,10240,0,16,8,10248,8
.long 32,16,10256,16,48,24,10264,24
.long 64,32,10272,32,80,40,10280,40
.long 96,48,10288,48,112,56,10296,56
.long 5120,1280,11520,0,5136,1288,11528,8
.long 5152,1296,11536,16,5168,1304,11544,24
.long 5184,1312,11552,32,5200,1320,11560,40
.long 5216,1328,11568,48,5232,1336,11576,56
.long 10240,2560,12800,0,10256,2568,12808,8
.long 10272,2576,12816,16,10288,2584,12824,24
.long 10304,2592,12832,32,10320,2600,12840,40
.long 10336,2608,12848,48,10352,2616,12856,56
.long 15360,3840,14080,0,15376,3848,14088,8
.long 15392,3856,14096,16,15408,3864,14104,24
.long 15424,3872,14112,32,15440,3880,14120,40
.long 15456,3888,14128,48,15472,3896,14136,56
.long 20480,5120,15360,0,20496,5128,15368,8
.long 20512,5136,15376,16,20528,5144,15384,24
.long 20544,5152,15392,32,20560,5160,15400,40
.long 20576,5168,15408,48,20592,5176,15416,56
.long 25600,6400,16640,0,25616,6408,16648,8
.long 25632,6416,16656,16,25648,6424,16664,24
.long 25664,6432,16672,32,25680,6440,16680,40
.long 25696,6448,16688,48,25712,6456,16696,56
.long 30720,7680,17920,0,30736,7688,17928,8
.long 30752,7696,17936,16,30768,7704,17944,24
.long 30784,7712,17952,32,30800,7720,17960,40
.long 30816,7728,17968,48,30832,7736,17976,56
.long 35840,8960,19200,0,35856,8968,19208,8
.long 35872,8976,19216,16,35888,8984,19224,24
.long 35904,8992,19232,32,35920,9000,19240,40
.long 35936,9008,19248,48,35952,9016,19256,56
.long 107008,107008,0,0,107216,107016,8,8
.long 107424,107024,16,16,107632,107032,24,24
.long 107840,107216,32,32,108048,107224,40,40
.long 108256,107232,48,48,108464,107240,56,56
.long 108672,107424,64,64,108880,107432,72,72
.long 109088,107440,80,80,109296,107448,88,88
.long 109504,107632,96,96,109712,107640,104,104
.long 109920,107648,112,112,110128,107656,120,120
.long 107056,108672,268435456,768,107264,108680,268435464,776
.long 107472,108688,268435472,784,107680,108696,268435480,792
.long 107888,108880,268435488,800,108096,108888,268435496,808
.long 108304,108896,268435504,816,108512,108904,268435512,824
.long 108720,109088,268435520,832,108928,109096,268435528,840
.long 109136,109104,268435536,848,109344,109112,268435544,856
.long 109552,109296,268435552,864,109760,109304,268435560,872
.long 109968,109312,268435568,880,110176,109320,268435576,888
.long 107104,110336,536870912,1536,107312,110344,536870920,1544
.long 107520,110352,536870928,1552,107728,110360,536870936,1560
.long 107936,110544,536870944,1568,108144,110552,536870952,1576
.long 108352,110560,536870960,1584,108560,110568,536870968,1592
.long 108768,110752,536870976,1600,108976,110760,536870984,1608
.long 109184,110768,536870992,1616,109392,110776,536871000,1624
.long 109600,110960,536871008,1632,109808,110968,536871016,1640
.long 110016,110976,536871024,1648,110224,110984,536871032,1656
.long 107152,112000,805306368,2304,107360,112008,805306376,2312
.long 107568,112016,805306384,2320,107776,112024,805306392,2328
.long 107984,112208,805306400,2336,108192,112216,805306408,2344
.long 108400,112224,805306416,2352,108608,112232,805306424,2360
.long 108816,112416,805306432,2368,109024,112424,805306440,2376
.long 109232,112432,805306448,2384,109440,112440,805306456,2392
.long 109648,112624,805306464,2400,109856,112632,805306472,2408
.long 110064,112640,805306480,2416,110272,112648,805306488,2424
.long 10304,102464,102496,51200,10320,102592,102624,51216
.long 10336,102736,102768,51232,10352,102864,102896,51248
.long 10240,103008,102976,51264,10256,103136,103104,51280
.long 10272,103280,103248,51296,10288,103408,103376,51312
.long 11584,103424,103456,51328,11600,103552,103584,51344
.long 11616,103696,103728,51360,11632,103824,103856,51376
.long 11520,103968,103936,51392,11536,104096,104064,51408
.long 11552,104240,104208,51424,11568,104368,104336,51440
.long 12880,102480,102512,51456,12864,102608,102640,51472
.long 12912,102720,102752,51488,12896,102848,102880,51504
.long 12816,103024,102992,51520,12800,103152,103120,51536
.long 12848,103264,103232,51552,12832,103392,103360,51568
.long 14160,103440,103472,51584,14144,103568,103600,51600
.long 14192,103680,103712,51616,14176,103808,103840,51632
.long 14096,103984,103952,51648,14080,104112,104080,51664
.long 14128,104224,104192,51680,14112,104352,104320,51696
.long 15456,104512,104544,51712,15472,104640,104672,51728
.long 15424,104784,104816,51744,15440,104912,104944,51760
.long 15392,105056,105024,51776,15408,105184,105152,51792
.long 15360,105328,105296,51808,15376,105456,105424,51824
.long 16736,105472,105504,51840,16752,105600,105632,51856
.long 16704,105744,105776,51872,16720,105872,105904,51888
.long 16672,106016,105984,51904,16688,106144,106112,51920
.long 16640,106288,106256,51936,16656,106416,106384,51952
.long 18032,104528,104560,51968,18016,104656,104688,51984
.long 18000,104768,104800,52000,17984,104896,104928,52016
.long 17968,105072,105040,52032,17952,105200,105168,52048
.long 17936,105312,105280,52064,17920,105440,105408,52080
.long 19312,105488,105520,52096,19296,105616,105648,52112
.long 19280,105728,105760,52128,19264,105856,105888,52144
.long 19248,106032,106000,52160,19232,106160,106128,52176
.long 19216,106272,106240,52192,19200,106400,106368,52208
.long 5120,0,0,0,5136,16,16,128
.long 5152,32,32,256,5168,48,48,384
.long 5184,64,64,384,5200,80,80,384
.long 5216,96,96,384,5232,112,112,384
.long 5248,128,128,384,5264,144,144,384
.long 5280,160,160,384,5296,176,176,384
.long 5312,192,192,384,5328,208,208,384
.long 5344,224,224,384,5360,240,240,384
.long 5376,20480,20480,384,5392,20496,20496,384
.long 5408,20512,20512,384,5424,20528,20528,384
.long 5440,20544,20544,384,5456,20560,20560,384
.long 5472,20576,20576,384,5488,20592,20592,384
.long 5504,20608,20608,384,5520,20624,20624,384
.long 5536,20640,20640,384,5552,20656,20656,384
.long 5568,20672,20672,384,5584,20688,20688,384
.long 5600,20704,20704,384,5616,20720,20720,384
.long 5632,256,1073741824,384,5648,272,1073741840,384
.long 5664,288,1073741856,384,5680,304,1073741872,384
.long 5696,320,1073741888,384,5712,336,1073741904,384
.long 5728,352,1073741920,384,5744,368,1073741936,384
.long 5760,384,1073741952,384,5776,400,1073741968,384
.long 5792,416,1073741984,384,5808,432,1073742000,384
.long 5824,448,1073742016,384,5840,464,1073742032,384
.long 5856,480,1073742048,384,5872,496,1073742064,384
.long 5888,20736,1073762304,384,5904,20752,1073762320,384
.long 5920,20768,1073762336,384,5936,20784,1073762352,384
.long 5952,20800,1073762368,384,5968,20816,1073762384,384
.long 5984,20832,1073762400,384,6000,20848,1073762416,384
.long 6016,20864,1073762432,384,6032,20880,1073762448,384
.long 6048,20896,1073762464,384,6064,20912,1073762480,384
.long 6080,20928,1073762496,384,6096,20944,1073762512,384
.long 6112,20960,1073762528,384,6128,20976,1073762544,384
.long 104448,104448,102400,81920,104464,104512,102464,81936
.long 104480,104592,102544,81952,104496,104656,102608,81968
.long 104512,104736,102688,87040,104528,104800,102752,87056
.long 104544,104880,102832,87072,104560,104944,102896,87088
.long 104592,104960,102912,92160,104608,105024,102976,92176
.long 104624,105104,103056,92192,104576,105168,103120,92208
.long 104656,105248,103200,97280,104672,105312,103264,97296
.long 104688,105392,103344,97312,104640,105456,103408,97328
.long 104736,104464,102416,102400,104752,104528,102480,102416
.long 104704,104608,102560,102432,104720,104672,102624,102448
.long 104800,104752,102704,107520,104816,104816,102768,107536
.long 104768,104832,102784,107552,104784,104896,102848,107568
.long 104880,104976,102928,112640,104832,105040,102992,112656
.long 104848,105120,103072,112672,104864,105184,103136,112688
.long 104944,105264,103216,117760,104896,105328,103280,117776
.long 104912,105344,103296,117792,104928,105408,103360,117808
.long 104960,104480,102432,122880,104976,104544,102496,122896
.long 104992,104624,102576,122912,105008,104688,102640,122928
.long 105024,104704,102656,128000,105040,104768,102720,128016
.long 105056,104848,102800,128032,105072,104912,102864,128048
.long 105104,104992,102944,133120,105120,105056,103008,133136
.long 105136,105136,103088,133152,105088,105200,103152,133168
.long 105168,105216,103168,138240,105184,105280,103232,138256
.long 105200,105360,103312,138272,105152,105424,103376,138288
.long 105248,104496,102448,143360,105264,104560,102512,143376
.long 105216,104576,102528,143392,105232,104640,102592,143408
.long 105312,104720,102672,148480,105328,104784,102736,148496
.long 105280,104864,102816,148512,105296,104928,102880,148528
.long 105392,105008,102960,153600,105344,105072,103024,153616
.long 105360,105088,103040,153632,105376,105152,103104,153648
.long 105456,105232,103184,158720,105408,105296,103248,158736
.long 105424,105376,103328,158752,105440,105440,103392,158768
.long 20480,0,0,104448,20488,8,256,104464
.long 20496,16,512,104480,20504,24,768,104496
.long 21760,0,1024,112640,21768,8,1280,112656
.long 21776,16,1536,112672,21784,24,1792,112688
.long 23040,0,2048,104512,23048,8,2304,104528
.long 23056,16,2560,104544,23064,24,2816,104560
.long 24320,0,3072,112704,24328,8,3328,112720
.long 24336,16,3584,112736,24344,24,3840,112752
.long 25600,0,0,104592,25608,8,256,104608
.long 25616,16,512,104624,25624,24,768,104576
.long 26880,0,1024,112784,26888,8,1280,112800
.long 26896,16,1536,112816,26904,24,1792,112768
.long 28160,0,2048,104656,28168,8,2304,104672
.long 28176,16,2560,104688,28184,24,2816,104640
.long 29440,0,3072,112848,29448,8,3328,112864
.long 29456,16,3584,112880,29464,24,3840,112832
.long 30720,0,0,104736,30728,8,256,104752
.long 30736,16,512,104704,30744,24,768,104720
.long 32000,0,1024,112928,32008,8,1280,112944
.long 32016,16,1536,112896,32024,24,1792,112912
.long 33280,0,2048,104800,33288,8,2304,104816
.long 33296,16,2560,104768,33304,24,2816,104784
.long 34560,0,3072,112992,34568,8,3328,113008
.long 34576,16,3584,112960,34584,24,3840,112976
.long 35840,0,0,104880,35848,8,256,104832
.long 35856,16,512,104848,35864,24,768,104864
.long 37120,0,1024,113072,37128,8,1280,113024
.long 37136,16,1536,113040,37144,24,1792,113056
.long 38400,0,2048,104944,38408,8,2304,104896
.long 38416,16,2560,104912,38424,24,2816,104928
.long 39680,0,3072,113136,39688,8,3328,113088
.long 39696,16,3584,113104,39704,24,3840,113120
.long 81920,20480,30720,0,81936,20488,30728,8
.long 81952,20496,30736,16,81968,20504,30744,24
.long 81984,20512,30752,32,82000,20520,30760,40
.long 82016,20528,30768,48,82032,20536,30776,56
.long 87040,21760,32000,0,87056,21768,32008,8
.long 87072,21776,32016,16,87088,21784,32024,24
.long 87104,21792,32032,32,87120,21800,32040,40
.long 87136,21808,32048,48,87152,21816,32056,56
.long 92160,23040,33280,0,92176,23048,33288,8
.long 92192,23056,33296,16,92208,23064,33304,24
.long 92224,23072,33312,32,92240,23080,33320,40
.long 92256,23088,33328,48,92272,23096,33336,56
.long 97280,24320,34560,0,97296,24328,34568,8
.long 97312,24336,34576,16,97328,24344,34584,24
.long 97344,24352,34592,32,97360,24360,34600,40
.long 97376,24368,34608,48,97392,24376,34616,56
.long 102400,25600,35840,0,102416,25608,35848,8
.long 102432,25616,35856,16,102448,25624,35864,24
.long 102464,25632,35872,32,102480,25640,35880,40
.long 102496,25648,35888,48,102512,25656,35896,56
.long 107520,26880,37120,0,107536,26888,37128,8
.long 107552,26896,37136,16,107568,26904,37144,24
.long 107584,26912,37152,32,107600,26920,37160,40
.long 107616,26928,37168,48,107632,26936,37176,56
.long 112640,28160,38400,0,112656,28168,38408,8
.long 112672,28176,38416,16,112688,28184,38424,24
.long 112704,28192,38432,32,112720,28200,38440,40
.long 112736,28208,38448,48,112752,28216,38456,56
.long 117760,29440,39680,0,117776,29448,39688,8
.long 117792,29456,39696,16,117808,29464,39704,24
.long 117824,29472,39712,32,117840,29480,39720,40
.long 117856,29488,39728,48,117872,29496,39736,56
.long 113664,113664,0,0,113872,113672,8,8
.long 114080,113680,16,16,114288,113688,24,24
.long 114496,113872,32,32,114704,113880,40,40
.long 114912,113888,48,48,115120,113896,56,56
.long 115328,114080,64,64,115536,114088,72,72
.long 115744,114096,80,80,115952,114104,88,88
.long 116160,114288,96,96,116368,114296,104,104
.long 116576,114304,112,112,116784,114312,120,120
.long 113712,115328,268435456,768,113920,115336,268435464,776
.long 114128,115344,268435472,784,114336,115352,268435480,792
.long 114544,115536,268435488,800,114752,115544,268435496,808
.long 114960,115552,268435504,816,115168,115560,268435512,824
.long 115376,115744,268435520,832,115584,115752,268435528,840
.long 115792,115760,268435536,848,116000,115768,268435544,856
.long 116208,115952,268435552,864,116416,115960,268435560,872
.long 116624,115968,268435568,880,116832,115976,268435576,888
.long 113760,116992,536870912,1536,113968,117000,536870920,1544
.long 114176,117008,536870928,1552,114384,117016,536870936,1560
.long 114592,117200,536870944,1568,114800,117208,536870952,1576
.long 115008,117216,536870960,1584,115216,117224,536870968,1592
.long 115424,117408,536870976,1600,115632,117416,536870984,1608
.long 115840,117424,536870992,1616,116048,117432,536871000,1624
.long 116256,117616,536871008,1632,116464,117624,536871016,1640
.long 116672,117632,536871024,1648,116880,117640,536871032,1656
.long 113808,118656,805306368,2304,114016,118664,805306376,2312
.long 114224,118672,805306384,2320,114432,118680,805306392,2328
.long 114640,118864,805306400,2336,114848,118872,805306408,2344
.long 115056,118880,805306416,2352,115264,118888,805306424,2360
.long 115472,119072,805306432,2368,115680,119080,805306440,2376
.long 115888,119088,805306448,2384,116096,119096,805306456,2392
.long 116304,119280,805306464,2400,116512,119288,805306472,2408
.long 116720,119296,805306480,2416,116928,119304,805306488,2424
.long 0,102400,102432,0,16,102528,102560,16
.long 32,102672,102704,32,48,102800,102832,48
.long 64,102944,102912,64,80,103072,103040,80
.long 96,103216,103184,96,112,103344,103312,112
.long 1280,103488,103520,128,1296,103616,103648,144
.long 1312,103760,103792,160,1328,103888,103920,176
.long 1344,104032,104000,192,1360,104160,104128,208
.long 1376,104304,104272,224,1392,104432,104400,240
.long 2576,102416,102448,256,2560,102544,102576,272
.long 2608,102656,102688,288,2592,102784,102816,304
.long 2640,102960,102928,320,2624,103088,103056,336
.long 2672,103200,103168,352,2656,103328,103296,368
.long 3856,103504,103536,384,3840,103632,103664,400
.long 3888,103744,103776,416,3872,103872,103904,432
.long 3920,104048,104016,448,3904,104176,104144,464
.long 3952,104288,104256,480,3936,104416,104384,496
.long 5152,104448,104480,512,5168,104576,104608,528
.long 5120,104720,104752,544,5136,104848,104880,560
.long 5216,104992,104960,576,5232,105120,105088,592
.long 5184,105264,105232,608,5200,105392,105360,624
.long 6432,105536,105568,640,6448,105664,105696,656
.long 6400,105808,105840,672,6416,105936,105968,688
.long 6496,106080,106048,704,6512,106208,106176,720
.long 6464,106352,106320,736,6480,106480,106448,752
.long 7728,104464,104496,768,7712,104592,104624,784
.long 7696,104704,104736,800,7680,104832,104864,816
.long 7792,105008,104976,832,7776,105136,105104,848
.long 7760,105248,105216,864,7744,105376,105344,880
.long 9008,105552,105584,896,8992,105680,105712,912
.long 8976,105792,105824,928,8960,105920,105952,944
.long 9072,106096,106064,960,9056,106224,106192,976
.long 9040,106336,106304,992,9024,106464,106432,1008
.long 10240,0,0,0,10256,16,16,128
.long 10272,32,32,256,10288,48,48,384
.long 10304,64,64,384,10320,80,80,384
.long 10336,96,96,384,10352,112,112,384
.long 10368,128,128,384,10384,144,144,384
.long 10400,160,160,384,10416,176,176,384
.long 10432,192,192,384,10448,208,208,384
.long 10464,224,224,384,10480,240,240,384
.long 10496,20480,20480,384,10512,20496,20496,384
.long 10528,20512,20512,384,10544,20528,20528,384
.long 10560,20544,20544,384,10576,20560,20560,384
.long 10592,20576,20576,384,10608,20592,20592,384
.long 10624,20608,20608,384,10640,20624,20624,384
.long 10656,20640,20640,384,10672,20656,20656,384
.long 10688,20672,20672,384,10704,20688,20688,384
.long 10720,20704,20704,384,10736,20720,20720,384
.long 10752,256,1073741824,384,10768,272,1073741840,384
.long 10784,288,1073741856,384,10800,304,1073741872,384
.long 10816,320,1073741888,384,10832,336,1073741904,384
.long 10848,352,1073741920,384,10864,368,1073741936,384
.long 10880,384,1073741952,384,10896,400,1073741968,384
.long 10912,416,1073741984,384,10928,432,1073742000,384
.long 10944,448,1073742016,384,10960,464,1073742032,384
.long 10976,480,1073742048,384,10992,496,1073742064,384
.long 11008,20736,1073762304,384,11024,20752,1073762320,384
.long 11040,20768,1073762336,384,11056,20784,1073762352,384
.long 11072,20800,1073762368,384,11088,20816,1073762384,384
.long 11104,20832,1073762400,384,11120,20848,1073762416,384
.long 11136,20864,1073762432,384,11152,20880,1073762448,384
.long 11168,20896,1073762464,384,11184,20912,1073762480,384
.long 11200,20928,1073762496,384,11216,20944,1073762512,384
.long 11232,20960,1073762528,384,11248,20976,1073762544,384
.long 106496,106496,108544,163840,106512,106560,108608,163856
.long 106528,106640,108688,163872,106544,106704,108752,163888
.long 106560,106784,108832,168960,106576,106848,108896,168976
.long 106592,106928,108976,168992,106608,106992,109040,169008
.long 106640,107008,109056,174080,106656,107072,109120,174096
.long 106672,107152,109200,174112,106624,107216,109264,174128
.long 106704,107296,109344,179200,106720,107360,109408,179216
.long 106736,107440,109488,179232,106688,107504,109552,179248
.long 106784,106512,108560,184320,106800,106576,108624,184336
.long 106752,106656,108704,184352,106768,106720,108768,184368
.long 106848,106800,108848,189440,106864,106864,108912,189456
.long 106816,106880,108928,189472,106832,106944,108992,189488
.long 106928,107024,109072,194560,106880,107088,109136,194576
.long 106896,107168,109216,194592,106912,107232,109280,194608
.long 106992,107312,109360,199680,106944,107376,109424,199696
.long 106960,107392,109440,199712,106976,107456,109504,199728
.long 107008,106528,108576,204800,107024,106592,108640,204816
.long 107040,106672,108720,204832,107056,106736,108784,204848
.long 107072,106752,108800,209920,107088,106816,108864,209936
.long 107104,106896,108944,209952,107120,106960,109008,209968
.long 107152,107040,109088,215040,107168,107104,109152,215056
.long 107184,107184,109232,215072,107136,107248,109296,215088
.long 107216,107264,109312,220160,107232,107328,109376,220176
.long 107248,107408,109456,220192,107200,107472,109520,220208
.long 107296,106544,108592,225280,107312,106608,108656,225296
.long 107264,106624,108672,225312,107280,106688,108736,225328
.long 107360,106768,108816,230400,107376,106832,108880,230416
.long 107328,106912,108960,230432,107344,106976,109024,230448
.long 107440,107056,109104,235520,107392,107120,109168,235536
.long 107408,107136,109184,235552,107424,107200,109248,235568
.long 107504,107280,109328,240640,107456,107344,109392,240656
.long 107472,107424,109472,240672,107488,107488,109536,240688
.long 40960,0,0,106496,40968,8,256,106512
.long 40976,16,512,106528,40984,24,768,106544
.long 42240,0,1024,114688,42248,8,1280,114704
.long 42256,16,1536,114720,42264,24,1792,114736
.long 43520,0,2048,106560,43528,8,2304,106576
.long 43536,16,2560,106592,43544,24,2816,106608
.long 44800,0,3072,114752,44808,8,3328,114768
.long 44816,16,3584,114784,44824,24,3840,114800
.long 46080,0,0,106640,46088,8,256,106656
.long 46096,16,512,106672,46104,24,768,106624
.long 47360,0,1024,114832,47368,8,1280,114848
.long 47376,16,1536,114864,47384,24,1792,114816
.long 48640,0,2048,106704,48648,8,2304,106720
.long 48656,16,2560,106736,48664,24,2816,106688
.long 49920,0,3072,114896,49928,8,3328,114912
.long 49936,16,3584,114928,49944,24,3840,114880
.long 51200,0,0,106784,51208,8,256,106800
.long 51216,16,512,106752,51224,24,768,106768
.long 52480,0,1024,114976,52488,8,1280,114992
.long 52496,16,1536,114944,52504,24,1792,114960
.long 53760,0,2048,106848,53768,8,2304,106864
.long 53776,16,2560,106816,53784,24,2816,106832
.long 55040,0,3072,115040,55048,8,3328,115056
.long 55056,16,3584,115008,55064,24,3840,115024
.long 56320,0,0,106928,56328,8,256,106880
.long 56336,16,512,106896,56344,24,768,106912
.long 57600,0,1024,115120,57608,8,1280,115072
.long 57616,16,1536,115088,57624,24,1792,115104
.long 58880,0,2048,106992,58888,8,2304,106944
.long 58896,16,2560,106960,58904,24,2816,106976
.long 60160,0,3072,115184,60168,8,3328,115136
.long 60176,16,3584,115152,60184,24,3840,115168
.long 163840,40960,51200,0,163856,40968,51208,8
.long 163872,40976,51216,16,163888,40984,51224,24
.long 163904,40992,51232,32,163920,41000,51240,40
.long 163936,41008,51248,48,163952,41016,51256,56
.long 168960,42240,52480,0,168976,42248,52488,8
.long 168992,42256,52496,16,169008,42264,52504,24
.long 169024,42272,52512,32,169040,42280,52520,40
.long 169056,42288,52528,48,169072,42296,52536,56
.long 174080,43520,53760,0,174096,43528,53768,8
.long 174112,43536,53776,16,174128,43544,53784,24
.long 174144,43552,53792,32,174160,43560,53800,40
.long 174176,43568,53808,48,174192,43576,53816,56
.long 179200,44800,55040,0,179216,44808,55048,8
.long 179232,44816,55056,16,179248,44824,55064,24
.long 179264,44832,55072,32,179280,44840,55080,40
.long 179296,44848,55088,48,179312,44856,55096,56
.long 184320,46080,56320,0,184336,46088,56328,8
.long 184352,46096,56336,16,184368,46104,56344,24
.long 184384,46112,56352,32,184400,46120,56360,40
.long 184416,46128,56368,48,184432,46136,56376,56
.long 189440,47360,57600,0,189456,47368,57608,8
.long 189472,47376,57616,16,189488,47384,57624,24
.long 189504,47392,57632,32,189520,47400,57640,40
.long 189536,47408,57648,48,189552,47416,57656,56
.long 194560,48640,58880,0,194576,48648,58888,8
.long 194592,48656,58896,16,194608,48664,58904,24
.long 194624,48672,58912,32,194640,48680,58920,40
.long 194656,48688,58928,48,194672,48696,58936,56
.long 199680,49920,60160,0,199696,49928,60168,8
.long 199712,49936,60176,16,199728,49944,60184,24
.long 199744,49952,60192,32,199760,49960,60200,40
.long 199776,49968,60208,48,199792,49976,60216,56
.long 120320,120320,0,0,120528,120328,8,8
.long 120736,120336,16,16,120944,120344,24,24
.long 121152,120528,32,32,121360,120536,40,40
.long 121568,120544,48,48,121776,120552,56,56
.long 121984,120736,64,64,122192,120744,72,72
.long 122400,120752,80,80,122608,120760,88,88
.long 122816,120944,96,96,123024,120952,104,104
.long 123232,120960,112,112,123440,120968,120,120
.long 120368,121984,268435456,768,120576,121992,268435464,776
.long 120784,122000,268435472,784,120992,122008,268435480,792
.long 121200,122192,268435488,800,121408,122200,268435496,808
.long 121616,122208,268435504,816,121824,122216,268435512,824
.long 122032,122400,268435520,832,122240,122408,268435528,840
.long 122448,122416,268435536,848,122656,122424,268435544,856
.long 122864,122608,268435552,864,123072,122616,268435560,872
.long 123280,122624,268435568,880,123488,122632,268435576,888
.long 120416,123648,536870912,1536,120624,123656,536870920,1544
.long 120832,123664,536870928,1552,121040,123672,536870936,1560
.long 121248,123856,536870944,1568,121456,123864,536870952,1576
.long 121664,123872,536870960,1584,121872,123880,536870968,1592
.long 122080,124064,536870976,1600,122288,124072,536870984,1608
.long 122496,124080,536870992,1616,122704,124088,536871000,1624
.long 122912,124272,536871008,1632,123120,124280,536871016,1640
.long 123328,124288,536871024,1648,123536,124296,536871032,1656
.long 120464,125312,805306368,2304,120672,125320,805306376,2312
.long 120880,125328,805306384,2320,121088,125336,805306392,2328
.long 121296,125520,805306400,2336,121504,125528,805306408,2344
.long 121712,125536,805306416,2352,121920,125544,805306424,2360
.long 122128,125728,805306432,2368,122336,125736,805306440,2376
.long 122544,125744,805306448,2384,122752,125752,805306456,2392
.long 122960,125936,805306464,2400,123168,125944,805306472,2408
.long 123376,125952,805306480,2416,123584,125960,805306488,2424
.long 10304,102464,102496,51200,10320,102592,102624,51216
.long 10336,102736,102768,51232,10352,102864,102896,51248
.long 10240,103008,102976,51264,10256,103136,103104,51280
.long 10272,103280,103248,51296,10288,103408,103376,51312
.long 11584,103424,103456,51328,11600,103552,103584,51344
.long 11616,103696,103728,51360,11632,103824,103856,51376
.long 11520,103968,103936,51392,11536,104096,104064,51408
.long 11552,104240,104208,51424,11568,104368,104336,51440
.long 12880,102480,102512,51456,12864,102608,102640,51472
.long 12912,102720,102752,51488,12896,102848,102880,51504
.long 12816,103024,102992,51520,12800,103152,103120,51536
.long 12848,103264,103232,51552,12832,103392,103360,51568
.long 14160,103440,103472,51584,14144,103568,103600,51600
.long 14192,103680,103712,51616,14176,103808,103840,51632
.long 14096,103984,103952,51648,14080,104112,104080,51664
.long 14128,104224,104192,51680,14112,104352,104320,51696
.long 15456,104512,104544,51712,15472,104640,104672,51728
.long 15424,104784,104816,51744,15440,104912,104944,51760
.long 15392,105056,105024,51776,15408,105184,105152,51792
.long 15360,105328,105296,51808,15376,105456,105424,51824
.long 16736,105472,105504,51840,16752,105600,105632,51856
.long 16704,105744,105776,51872,16720,105872,105904,51888
.long 16672,106016,105984,51904,16688,106144,106112,51920
.long 16640,106288,106256,51936,16656,106416,106384,51952
.long 18032,104528,104560,51968,18016,104656,104688,51984
.long 18000,104768,104800,52000,17984,104896,104928,52016
.long 17968,105072,105040,52032,17952,105200,105168,52048
.long 17936,105312,105280,52064,17920,105440,105408,52080
.long 19312,105488,105520,52096,19296,105616,105648,52112
.long 19280,105728,105760,52128,19264,105856,105888,52144
.long 19248,106032,106000,52160,19232,106160,106128,52176
.long 19216,106272,106240,52192,19200,106400,106368,52208
.long 15360,0,0,0,15376,16,16,128
.long 15392,32,32,256,15408,48,48,384
.long 15424,64,64,384,15440,80,80,384
.long 15456,96,96,384,15472,112,112,384
.long 15488,128,128,384,15504,144,144,384
.long 15520,160,160,384,15536,176,176,384
.long 15552,192,192,384,15568,208,208,384
.long 15584,224,224,384,15600,240,240,384
.long 15616,20480,20480,384,15632,20496,20496,384
.long 15648,20512,20512,384,15664,20528,20528,384
.long 15680,20544,20544,384,15696,20560,20560,384
.long 15712,20576,20576,384,15728,20592,20592,384
.long 15744,20608,20608,384,15760,20624,20624,384
.long 15776,20640,20640,384,15792,20656,20656,384
.long 15808,20672,20672,384,15824,20688,20688,384
.long 15840,20704,20704,384,15856,20720,20720,384
.long 15872,256,1073741824,384,15888,272,1073741840,384
.long 15904,288,1073741856,384,15920,304,1073741872,384
.long 15936,320,1073741888,384,15952,336,1073741904,384
.long 15968,352,1073741920,384,15984,368,1073741936,384
.long 16000,384,1073741952,384,16016,400,1073741968,384
.long 16032,416,1073741984,384,16048,432,1073742000,384
.long 16064,448,1073742016,384,16080,464,1073742032,384
.long 16096,480,1073742048,384,16112,496,1073742064,384
.long 16128,20736,1073762304,384,16144,20752,1073762320,384
.long 16160,20768,1073762336,384,16176,20784,1073762352,384
.long 16192,20800,1073762368,384,16208,20816,1073762384,384
.long 16224,20832,1073762400,384,16240,20848,1073762416,384
.long 16256,20864,1073762432,384,16272,20880,1073762448,384
.long 16288,20896,1073762464,384,16304,20912,1073762480,384
.long 16320,20928,1073762496,384,16336,20944,1073762512,384
.long 16352,20960,1073762528,384,16368,20976,1073762544,384
.long 108544,108544,106496,245760,108560,108608,106560,245776
.long 108576,108688,106640,245792,108592,108752,106704,245808
.long 108608,108832,106784,250880,108624,108896,106848,250896
.long 108640,108976,106928,250912,108656,109040,106992,250928
.long 108688,109056,107008,256000,108704,109120,107072,256016
.long 108720,109200,107152,256032,108672,109264,107216,256048
.long 108752,109344,107296,261120,108768,109408,107360,261136
.long 108784,109488,107440,261152,108736,109552,107504,261168
.long 108832,108560,106512,266240,108848,108624,106576,266256
.long 108800,108704,106656,266272,108816,108768,106720,266288
.long 108896,108848,106800,271360,108912,108912,106864,271376
.long 108864,108928,106880,271392,108880,108992,106944,271408
.long 108976,109072,107024,276480,108928,109136,107088,276496
.long 108944,109216,107168,276512,108960,109280,107232,276528
.long 109040,109360,107312,281600,108992,109424,107376,281616
.long 109008,109440,107392,281632,109024,109504,107456,281648
.long 109056,108576,106528,286720,109072,108640,106592,286736
.long 109088,108720,106672,286752,109104,108784,106736,286768
.long 109120,108800,106752,291840,109136,108864,106816,291856
.long 109152,108944,106896,291872,109168,109008,106960,291888
.long 109200,109088,107040,296960,109216,109152,107104,296976
.long 109232,109232,107184,296992,109184,109296,107248,297008
.long 109264,109312,107264,302080,109280,109376,107328,302096
.long 109296,109456,107408,302112,109248,109520,107472,302128
.long 109344,108592,106544,307200,109360,108656,106608,307216
.long 109312,108672,106624,307232,109328,108736,106688,307248
.long 109408,108816,106768,312320,109424,108880,106832,312336
.long 109376,108960,106912,312352,109392,109024,106976,312368
.long 109488,109104,107056,317440,109440,109168,107120,317456
.long 109456,109184,107136,317472,109472,109248,107200,317488
.long 109552,109328,107280,322560,109504,109392,107344,322576
.long 109520,109472,107424,322592,109536,109536,107488,322608
.long 61440,0,0,108544,61448,8,256,108560
.long 61456,16,512,108576,61464,24,768,108592
.long 62720,0,1024,116736,62728,8,1280,116752
.long 62736,16,1536,116768,62744,24,1792,116784
.long 64000,0,2048,108608,64008,8,2304,108624
.long 64016,16,2560,108640,64024,24,2816,108656
.long 65280,0,3072,116800,65288,8,3328,116816
.long 65296,16,3584,116832,65304,24,3840,116848
.long 66560,0,0,108688,66568,8,256,108704
.long 66576,16,512,108720,66584,24,768,108672
.long 67840,0,1024,116880,67848,8,1280,116896
.long 67856,16,1536,116912,67864,24,1792,116864
.long 69120,0,2048,108752,69128,8,2304,108768
.long 69136,16,2560,108784,69144,24,2816,108736
.long 70400,0,3072,116944,70408,8,3328,116960
.long 70416,16,3584,116976,70424,24,3840,116928
.long 71680,0,0,108832,71688,8,256,108848
.long 71696,16,512,108800,71704,24,768,108816
.long 72960,0,1024,117024,72968,8,1280,117040
.long 72976,16,1536,116992,72984,24,1792,117008
.long 74240,0,2048,108896,74248,8,2304,108912
.long 74256,16,2560,108864,74264,24,2816,108880
.long 75520,0,3072,117088,75528,8,3328,117104
.long 75536,16,3584,117056,75544,24,3840,117072
.long 76800,0,0,108976,76808,8,256,108928
.long 76816,16,512,108944,76824,24,768,108960
.long 78080,0,1024,117168,78088,8,1280,117120
.long 78096,16,1536,117136,78104,24,1792,117152
.long 79360,0,2048,109040,79368,8,2304,108992
.long 79376,16,2560,109008,79384,24,2816,109024
.long 80640,0,3072,117232,80648,8,3328,117184
.long 80656,16,3584,117200,80664,24,3840,117216
.long 245760,61440,71680,0,245776,61448,71688,8
.long 245792,61456,71696,16,245808,61464,71704,24
.long 245824,61472,71712,32,245840,61480,71720,40
.long 245856,61488,71728,48,245872,61496,71736,56
.long 250880,62720,72960,0,250896,62728,72968,8
.long 250912,62736,72976,16,250928,62744,72984,24
.long 250944,62752,72992,32,250960,62760,73000,40
.long 250976,62768,73008,48,250992,62776,73016,56
.long 256000,64000,74240,0,256016,64008,74248,8
.long 256032,64016,74256,16,256048,64024,74264,24
.long 256064,64032,74272,32,256080,64040,74280,40
.long 256096,64048,74288,48,256112,64056,74296,56
.long 261120,65280,75520,0,261136,65288,75528,8
.long 261152,65296,75536,16,261168,65304,75544,24
.long 261184,65312,75552,32,261200,65320,75560,40
.long 261216,65328,75568,48,261232,65336,75576,56
.long 266240,66560,76800,0,266256,66568,76808,8
.long 266272,66576,76816,16,266288,66584,76824,24
.long 266304,66592,76832,32,266320,66600,76840,40
.long 266336,66608,76848,48,266352,66616,76856,56
.long 271360,67840,78080,0,271376,67848,78088,8
.long 271392,67856,78096,16,271408,67864,78104,24
.long 271424,67872,78112,32,271440,67880,78120,40
.long 271456,67888,78128,48,271472,67896,78136,56
.long 276480,69120,79360,0,276496,69128,79368,8
.long 276512,69136,79376,16,276528,69144,79384,24
.long 276544,69152,79392,32,276560,69160,79400,40
.long 276576,69168,79408,48,276592,69176,79416,56
.long 281600,70400,80640,0,281616,70408,80648,8
.long 281632,70416,80656,16,281648,70424,80664,24
.long 281664,70432,80672,32,281680,70440,80680,40
.long 281696,70448,80688,48,281712,70456,80696,56
L_tabend:
.size L_tab, L_tabend-L_tab
.section .rodata,"a"
.p2align 6
.amdhsa_kernel concat_heads__grouped_kv_mqa__ssm_conv_s5__prompt_kernel
  .amdhsa_next_free_vgpr 512
  .amdhsa_next_free_sgpr 102
  .amdhsa_accum_offset 256
  .amdhsa_group_segment_fixed_size 0
  .amdhsa_kernarg_size 136
  .amdhsa_user_sgpr_count 2
  .amdhsa_user_sgpr_kernarg_segment_ptr 1
  .amdhsa_system_sgpr_workgroup_id_x 1
.end_amdhsa_kernel
```
